```python
import torch

def _softmax(x, axis=-1):
    return torch.softmax(x, dim=axis)
def _gelu(x):
    return torch.nn.functional.gelu(x, approximate="tanh")
def _silu(x):
    return torch.nn.functional.silu(x)
def _sigmoid(x):
    return torch.sigmoid(x)
def _layernorm(x, axis=-1, eps=1e-5):
    m = x.mean(dim=axis, keepdim=True)
    v = x.var(dim=axis, keepdim=True, unbiased=False)
    return (x - m) / torch.sqrt(v + eps)
def _scatter_add(tgt, idx, src, axis=0):
    return tgt.clone().index_add_(axis, idx, src)
def _segment_sum(src, seg, n):
    out = torch.zeros((n,) + src.shape[1:], dtype=src.dtype)
    return out.index_add_(0, seg, src)
def _pad(x, pw):
    flat = tuple(v for pair in reversed(pw) for v in pair)
    return torch.nn.functional.pad(x, flat)

kernel_name = 'gated_mix__linear_attn_block__compressed_kv_cla__prompt'

def setup_inputs():

    _w = (lambda a: (lambda t: t.to(torch.bfloat16) if t.is_floating_point() else t)(torch.as_tensor(a)))
    def _A_setup():
        B, S, D = 1, 2048, 512
        return {
            "x": _w((lambda *s: torch.randn(*s, dtype=torch.bfloat16) * 0.05)(B, S, D)),
            "wqkv": _w((lambda *s: torch.randn(*s, dtype=torch.bfloat16) * 0.8)(D, 3 * D)),
            "wo": _w((lambda *s: torch.randn(*s, dtype=torch.bfloat16) * 0.4)(D, D)),
        }
    _A_in = _A_setup()

    def _B_setup():
        B, H, Sq, Sk, D, M = 1, 32, 2048, 2048, 128, 512
        Dc = 4 * D
        return {
            "x": _w((lambda *s: torch.randn(*s, dtype=torch.bfloat16) * 0.05)(B, Sq, M)),
            "c_kv": _w((lambda *s: torch.randn(*s, dtype=torch.bfloat16) * 0.8)(B, Sk, Dc)),
            "w_q": _w((lambda *s: torch.randn(*s, dtype=torch.bfloat16) * 6.4)(M, H, D) * (M ** -0.5)),
            "w_uk": _w((lambda *s: torch.randn(*s, dtype=torch.bfloat16) * 6.4)(Dc, H, D) * (Dc ** -0.5)),
            "w_uv": _w((lambda *s: torch.randn(*s, dtype=torch.bfloat16) * 0.8)(Dc, H, D) * (Dc ** -0.5)),
            "w_o": _w((lambda *s: torch.randn(*s, dtype=torch.bfloat16) * 0.8)(H, D, M) * ((H * D) ** -0.5)),
        }
    _B_in = _B_setup()

    return {
        "A_x": _A_in["x"],
        "A_wqkv": _A_in["wqkv"],
        "A_wo": _A_in["wo"],
        "B_x": _B_in["x"],
        "B_c_kv": _B_in["c_kv"],
        "B_w_q": _B_in["w_q"],
        "B_w_uk": _B_in["w_uk"],
        "B_w_uv": _B_in["w_uv"],
        "B_w_o": _B_in["w_o"],
        "gate_w": _w((lambda *s: torch.randn(*s, dtype=torch.bfloat16) * 0.05)(512) * 16.0),
    }

def reference(A_x, A_wqkv, A_wo, B_x, B_c_kv, B_w_q, B_w_uk, B_w_uv, B_w_o, gate_w):
    def _A_ref(x, wqkv, wo):
        B, S, D = x.shape
        H = 32; Dh = D // H
        qkv = (lambda x, *d: x.permute(*d))((x @ wqkv).reshape(B, S, 3, H, Dh), 2, 0, 3, 1, 4)
        q, k, v = qkv[0], qkv[1], qkv[2]
        phi = lambda t: torch.where(t > 0, t + 1, torch.exp(t)) + 1e-6
        pq, pk = phi(q), phi(k)
        kv = torch.einsum("bhsd,bhse->bhde", pk, v)
        z = torch.einsum("bhsd->bhd", pk)
        num = torch.einsum("bhqd,bhde->bhqe", pq, kv)
        den = torch.einsum("bhqd,bhd->bhq", pq, z)[..., None] + 1e-6
        o = num / den
        return (lambda x, *d: x.permute(*d))(o, 0, 2, 1, 3).reshape(B, S, D) @ wo

    def _B_ref(x, c_kv, w_q, w_uk, w_uv, w_o):
        B, Sq, M = x.shape[0], x.shape[1], x.shape[2]
        Sk = c_kv.shape[1]
        H, D = w_q.shape[1], w_q.shape[2]
        q = torch.einsum("bqm,mhd->bhqd", x, w_q)
        k = torch.einsum("bkc,chd->bhkd", c_kv, w_uk)
        v = torch.einsum("bkc,chd->bhkd", c_kv, w_uv)
        scores = torch.einsum("bhqd,bhkd->bhqk", q, k) * (D ** -0.5)
        off = Sk - Sq
        qi = torch.arange(Sq)[:, None]
        kj = torch.arange(Sk)[None, :]
        cmask = kj <= (qi + off)
        scores = torch.where(cmask[None, None], scores, -1e9)
        p = _softmax(scores, axis=-1)
        ctx = torch.einsum("bhqk,bhkd->bhqd", p, v)
        return torch.einsum("bhqd,hdm->bqm", ctx, w_o)

    x = A_x
    g = _sigmoid((x * gate_w).sum(-1, keepdims=True))
    a = _A_ref(x, A_wqkv, A_wo)
    b = _B_ref(x, B_c_kv, B_w_q, B_w_uk, B_w_uv, B_w_o)
    return g * a + (1 - g) * b
```

```asm
; @launch grid=(256,1,1) block=(512,1,1) lds=163840
.amdgcn_target "amdgcn-amd-amdhsa--gfx950"
.text
.globl gated_mix__linear_attn_block__compressed_kv_cla__prompt_kernel
.p2align 8
.type gated_mix__linear_attn_block__compressed_kv_cla__prompt_kernel,@function
gated_mix__linear_attn_block__compressed_kv_cla__prompt_kernel:
s_cmp_ge_u32 s2, 256
s_cbranch_scc1 L_kk_kernel_end
s_load_dwordx4 s[4:7], s[0:1], 0
s_load_dwordx4 s[8:11], s[0:1], 32
s_load_dwordx4 s[12:15], s[0:1], 48
s_load_dwordx4 s[68:71], s[0:1], 88
s_load_dwordx2 s[72:73], s[0:1], 72
s_load_dwordx2 s[76:77], s[0:1], 16
s_load_dwordx2 s[78:79], s[0:1], 64
s_load_dwordx2 s[100:101], s[0:1], 80
s_getpc_b64 s[96:97]
.set L_pc_kk_kernel, .
s_lshr_b32 s98, s2, 3
s_mul_i32 s98, s98, 2560
v_and_b32 v92, 31, v0
v_min_u32 v92, 19, v92
v_lshl_add_u32 v92, v92, 7, s98
v_min_u32 v92, L_code_end-L_pc_kk_kernel-4, v92
v_mov_b32 v93, s97
v_add_co_u32 v92, vcc, s96, v92
s_nop 1
v_addc_co_u32 v93, vcc, 0, v93, vcc
global_load_dword v94, v[92:93], off
v_lshrrev_b32 v1, 6, v0
v_and_b32 v0, 63, v0
v_readfirstlane_b32 s3, v1
s_and_b32 s20, s2, 31
s_lshr_b32 s21, s2, 5
s_and_b32 s22, s3, 3
s_lshr_b32 s23, s3, 2
v_lshlrev_b32 v1, 4, v0
v_lshrrev_b32 v24, 3, v0
v_lshlrev_b32 v24, 10, v24
v_lshrrev_b32 v25, 4, v0
v_and_b32 v26, 7, v0
v_xor_b32 v25, v25, v26
v_lshlrev_b32 v25, 4, v25
v_add_u32 v2, v24, v25
v_xor_b32 v3, 64, v2
v_add_u32 v3, 7168, v3
v_add_u32 v4, 14336, v2
v_add_u32 v5, 14336, v3
v_lshrrev_b32 v24, 4, v0
s_and_b32 s24, s22, 1
s_lshl_b32 s24, s24, 2
v_or_b32 v25, s24, v24
v_lshlrev_b32 v25, 1, v25
v_and_b32 v26, 15, v0
v_xor_b32 v25, v25, v26
v_lshlrev_b32 v25, 4, v25
v_lshlrev_b32 v24, 13, v24
s_lshl_b32 s24, s22, 16
v_add3_u32 v6, v24, v25, s24
v_add_u32 v7, 31744, v6
s_lshl_b32 s52, s21, 18
s_lshl_b32 s24, s3, 15
s_add_u32 s52, s52, s24
s_lshl_b32 s53, s20, 8
s_lshl_b32 s54, s20, 5
s_lshl_b32 s55, s3, 12
s_add_u32 s55, s55, 65536
s_lshl_b32 s56, s3, 11
s_waitcnt lgkmcnt(0)
s_mov_b32 s32, s8
s_and_b32 s33, s9, 0xffff
s_mov_b32 s34, 2097152
s_mov_b32 s35, 0x20000
s_cmp_eq_u32 s23, 0
s_cselect_b32 s36, s12, s14
s_cselect_b32 s37, s13, s15
s_and_b32 s37, s37, 0xffff
s_mov_b32 s38, 4194304
s_mov_b32 s39, 0x20000
s_cmp_eq_u32 s23, 0
s_cbranch_scc0 L_kk_kernel_ch1
s_add_u32 m0, s56, 0
s_add_u32 s64, s53, 0
buffer_load_dwordx4 v6, s[36:39], s64 offen offset:0 lds
buffer_load_dwordx4 v7, s[36:39], s64 offen offset:1024 lds
s_add_u32 m0, s55, 0
s_add_u32 s66, s52, 0
buffer_load_dwordx4 v2, s[32:35], s66 offen offset:0 lds
buffer_load_dwordx4 v3, s[32:35], s66 offen offset:1024 lds
s_add_u32 m0, s55, 0
s_add_u32 s66, s52, 0
buffer_load_dwordx4 v4, s[32:35], s66 offen offset:2048 lds
buffer_load_dwordx4 v5, s[32:35], s66 offen offset:3072 lds
s_add_u32 m0, s56, 16384
s_add_u32 s64, s53, 262144
buffer_load_dwordx4 v6, s[36:39], s64 offen offset:0 lds
buffer_load_dwordx4 v7, s[36:39], s64 offen offset:1024 lds
s_add_u32 m0, s55, 32768
s_add_u32 s66, s52, 128
buffer_load_dwordx4 v2, s[32:35], s66 offen offset:0 lds
buffer_load_dwordx4 v3, s[32:35], s66 offen offset:1024 lds
s_add_u32 m0, s56, 32768
s_add_u32 s64, s53, 524288
buffer_load_dwordx4 v6, s[36:39], s64 offen offset:0 lds
buffer_load_dwordx4 v7, s[36:39], s64 offen offset:1024 lds
s_add_u32 m0, s55, 32768
s_add_u32 s66, s52, 128
buffer_load_dwordx4 v4, s[32:35], s66 offen offset:2048 lds
buffer_load_dwordx4 v5, s[32:35], s66 offen offset:3072 lds
s_mov_b32 s28, s4
s_and_b32 s29, s5, 0xffff
s_mov_b32 s30, 2097152
s_mov_b32 s31, 0x20000
s_mov_b32 s44, s70
s_and_b32 s45, s71, 0xffff
s_mov_b32 s46, 268435456
s_mov_b32 s47, 0x20000
s_mov_b32 s16, s68
s_and_b32 s17, s69, 0xffff
s_mov_b32 s18, 256
s_mov_b32 s19, 0x20000
s_mov_b32 s40, s10
s_and_b32 s41, s11, 0xffff
s_mov_b32 s42, 4194304
s_mov_b32 s43, 0x20000
s_sub_u32 s26, 15, s21
s_lshl_b32 s25, s26, 17
s_lshl_b32 s24, s22, 15
s_add_u32 s25, s25, s24
s_mov_b32 s48, s72
s_and_b32 s49, s73, 0xffff
s_mov_b32 s50, 1024
s_mov_b32 s51, 0x20000
s_lshl_b32 s58, s20, 3
s_add_u32 s58, s58, s3
s_cmp_lt_u32 s58, 128
s_cselect_b32 s59, s26, s21
s_and_b32 s58, s58, 127
s_lshl_b32 s59, s59, 7
s_add_u32 s58, s58, s59
s_lshl_b32 s59, s58, 10
buffer_load_dwordx4 v[228:231], v1, s[48:51], 0 offen
v_and_b32 v24, 15, v0
v_lshrrev_b32 v25, 1, v24
v_lshrrev_b32 v26, 4, v0
v_xor_b32 v25, v25, v26
v_lshlrev_b32 v25, 4, v25
v_lshlrev_b32 v24, 7, v24
s_lshl_b32 s24, s22, 13
s_add_u32 s24, s24, 65536
v_add3_u32 v10, v24, v25, s24
v_xor_b32 v11, 64, v10
v_add_u32 v12, 0x10000, v10
v_add_u32 v13, 0x10000, v11
v_lshrrev_b32 v24, 4, v0
v_bfe_u32 v25, v0, 2, 2
v_lshl_add_u32 v26, v24, 3, v25
v_lshlrev_b32 v26, 8, v26
v_and_b32 v27, 1, v24
v_lshl_add_u32 v27, v27, 2, v25
v_lshlrev_b32 v27, 5, v27
v_and_b32 v28, 3, v0
v_lshlrev_b32 v28, 3, v28
v_add3_u32 v14, v26, v27, v28
v_xor_b32 v15, 32, v14
v_xor_b32 v16, 64, v14
v_xor_b32 v17, 96, v14
v_xor_b32 v18, 128, v14
v_xor_b32 v19, 160, v14
v_xor_b32 v20, 192, v14
v_xor_b32 v21, 224, v14
v_lshlrev_b32 v26, 8, v24
v_add3_u32 v22, v26, v27, v28
v_xor_b32 v23, 128, v22
s_lshl_b32 s57, s20, 19
s_lshl_b32 s24, s21, 2
s_add_u32 s24, s24, s22
s_lshl_b32 s24, s24, 14
s_add_u32 s57, s57, s24
s_add_u32 s60, s57, 16777216
s_add_u32 s61, s57, 16781312
s_add_u32 s62, s57, 16785408
s_add_u32 s63, s57, 16789504
s_lshl_b32 s51, s20, 15
s_add_u32 s51, s51, 88096768
v_mov_b32 v31, 1
s_lshl_b32 s24, s20, 2
v_mov_b32 v29, s24
s_movk_i32 s24, 128
v_writelane_b32 v29, s24, 1
v_min_u32 v29, 32, v0
v_lshlrev_b32 v29, 2, v29
v_mov_b32 v88, 0
s_lshl_b32 s27, s21, 2
s_add_u32 s27, s27, s22
s_cmp_eq_u32 s27, 0
s_cselect_b32 s24, s51, 268435456
v_lshl_add_u32 v24, v0, 2, s24
buffer_store_dword v88, v24, s[44:47], 0 offen sc1
v_mov_b32 v89, 0
v_mov_b32 v90, 0
v_mov_b32 v91, 0
s_mul_i32 s24, s22, 2048
s_add_u32 s24, s24, 90177536
s_cmp_eq_u32 s2, 0
s_cselect_b32 s24, s24, 268435456
v_add_u32 v25, s24, v1
buffer_store_dwordx4 v[88:91], v25, s[44:47], 0 offen offset:0 sc1
buffer_store_dwordx4 v[88:91], v25, s[44:47], 0 offen offset:1024 sc1
s_lshl_b32 s24, s20, 2
s_cmp_eq_u32 s27, 0
s_cselect_b32 s24, s24, 0x1000
v_mov_b32 v9, s24
s_add_u32 s24, s2, s3
s_cmp_eq_u32 s24, 0
s_movk_i32 s24, 0x1000
s_cselect_b32 s24, 128, s24
v_writelane_b32 v9, s24, 1
s_lshl_b32 s24, s21, 2
s_add_u32 s24, s24, s51
s_cmp_eq_u32 s22, 0
s_cselect_b32 s24, s24, 268435456
v_mov_b32 v30, s24
s_waitcnt vmcnt(12) lgkmcnt(0)
s_barrier
ds_read_b128 v[32:35], v10 offset:0
ds_read_b128 v[36:39], v10 offset:2048
ds_read_b128 v[40:43], v10 offset:4096
ds_read_b128 v[44:47], v10 offset:6144
ds_read_b64_tr_b16 v[64:65], v14 offset:0
ds_read_b64_tr_b16 v[66:67], v14 offset:1024
ds_read_b64_tr_b16 v[68:69], v15 offset:0
ds_read_b64_tr_b16 v[70:71], v15 offset:1024
ds_read_b64_tr_b16 v[72:73], v16 offset:0
ds_read_b64_tr_b16 v[74:75], v16 offset:1024
ds_read_b64_tr_b16 v[76:77], v17 offset:0
ds_read_b64_tr_b16 v[78:79], v17 offset:1024
ds_read_b64_tr_b16 v[80:81], v18 offset:0
ds_read_b64_tr_b16 v[82:83], v18 offset:1024
s_waitcnt lgkmcnt(8)
v_mfma_f32_16x16x32_bf16 v[96:99], v[64:67], v[32:35], 0
ds_read_b64_tr_b16 v[84:85], v19 offset:0
s_add_u32 m0, s56, 49152
s_add_u32 s64, s53, 786432
v_mfma_f32_16x16x32_bf16 v[104:107], v[64:67], v[36:39], 0
ds_read_b64_tr_b16 v[86:87], v19 offset:1024
buffer_load_dwordx4 v6, s[36:39], s64 offen offset:0 lds
v_mfma_f32_16x16x32_bf16 v[112:115], v[64:67], v[40:43], 0
v_mfma_f32_16x16x32_bf16 v[120:123], v[64:67], v[44:47], 0
s_waitcnt lgkmcnt(8)
v_mfma_f32_16x16x32_bf16 v[100:103], v[68:71], v[32:35], 0
ds_read_b64_tr_b16 v[64:65], v20 offset:0
v_mfma_f32_16x16x32_bf16 v[108:111], v[68:71], v[36:39], 0
ds_read_b64_tr_b16 v[66:67], v20 offset:1024
buffer_load_dwordx4 v7, s[36:39], s64 offen offset:1024 lds
v_mfma_f32_16x16x32_bf16 v[116:119], v[68:71], v[40:43], 0
s_cmp_lg_u32 s22, 2
s_cbranch_scc1 L_kk_kernel_c0_sk3
v_bfe_u32 v92, v0, 1, 2
v_lshlrev_b32 v92, 13, v92
v_and_b32 v235, 1, v0
v_lshl_add_u32 v92, v235, 7, v92
s_lshl_b32 s68, s21, 15
s_add_u32 s68, s68, s53
s_add_u32 s68, s68, 2097152
buffer_load_dword v94, v92, s[36:39], s68 offen
v_and_b32 v92, 7, v0
v_lshlrev_b32 v92, 10, v92
s_lshl_b32 s68, s21, 18
s_lshl_b32 s69, s20, 13
s_add_u32 s68, s68, s69
s_add_u32 s68, s68, 512
buffer_load_dword v94, v92, s[32:35], s68 offen
L_kk_kernel_c0_sk3:
v_mfma_f32_16x16x32_bf16 v[124:127], v[68:71], v[44:47], 0
s_waitcnt lgkmcnt(8)
v_mfma_f32_16x16x32_bf16 v[128:131], v[72:75], v[32:35], 0
ds_read_b64_tr_b16 v[68:69], v21 offset:0
s_add_u32 m0, s55, 65536
s_add_u32 s66, s52, 256
v_mfma_f32_16x16x32_bf16 v[136:139], v[72:75], v[36:39], 0
ds_read_b64_tr_b16 v[70:71], v21 offset:1024
buffer_load_dwordx4 v2, s[32:35], s66 offen offset:0 lds
v_mfma_f32_16x16x32_bf16 v[144:147], v[72:75], v[40:43], 0
s_cmp_lg_u32 s22, 0
s_cbranch_scc1 L_kk_kernel_c0_sk2
s_lshl_b32 s68, s2, 14
s_add_u32 s68, s68, 0
v_lshlrev_b32 v92, 6, v0
buffer_load_dword v94, v92, s[40:43], s68 offen
L_kk_kernel_c0_sk2:
v_mfma_f32_16x16x32_bf16 v[152:155], v[72:75], v[44:47], 0
s_waitcnt lgkmcnt(8)
v_mfma_f32_16x16x32_bf16 v[132:135], v[76:79], v[32:35], 0
v_mfma_f32_16x16x32_bf16 v[140:143], v[76:79], v[36:39], 0
buffer_load_dwordx4 v3, s[32:35], s66 offen offset:1024 lds
v_mfma_f32_16x16x32_bf16 v[148:151], v[76:79], v[40:43], 0
s_cmp_lg_u32 s22, 0
s_cbranch_scc1 L_kk_kernel_c0_sk1
buffer_load_dwordx4 v[224:227], v1, s[28:31], s59 offen
L_kk_kernel_c0_sk1:
v_mfma_f32_16x16x32_bf16 v[156:159], v[76:79], v[44:47], 0
s_waitcnt vmcnt(14) lgkmcnt(0)
s_barrier
ds_read_b64_tr_b16 v[72:73], v14 offset:16384
ds_read_b64_tr_b16 v[74:75], v14 offset:17408
v_mfma_f32_16x16x32_bf16 v[160:163], v[80:83], v[32:35], 0
ds_read_b64_tr_b16 v[76:77], v15 offset:16384
v_mfma_f32_16x16x32_bf16 v[168:171], v[80:83], v[36:39], 0
ds_read_b64_tr_b16 v[78:79], v15 offset:17408
s_add_u32 m0, s56, 0
s_add_u32 s64, s53, 1048576
v_mfma_f32_16x16x32_bf16 v[176:179], v[80:83], v[40:43], 0
buffer_load_dwordx4 v6, s[36:39], s64 offen offset:0 lds
ds_read_b128 v[48:51], v11 offset:0
v_mfma_f32_16x16x32_bf16 v[184:187], v[80:83], v[44:47], 0
v_mfma_f32_16x16x32_bf16 v[164:167], v[84:87], v[32:35], 0
ds_read_b64_tr_b16 v[80:81], v16 offset:16384
v_mfma_f32_16x16x32_bf16 v[172:175], v[84:87], v[36:39], 0
ds_read_b64_tr_b16 v[82:83], v16 offset:17408
ds_read_b128 v[52:55], v11 offset:2048
v_mfma_f32_16x16x32_bf16 v[180:183], v[84:87], v[40:43], 0
v_mfma_f32_16x16x32_bf16 v[188:191], v[84:87], v[44:47], 0
v_mfma_f32_16x16x32_bf16 v[192:195], v[64:67], v[32:35], 0
ds_read_b64_tr_b16 v[84:85], v17 offset:16384
ds_read_b128 v[56:59], v11 offset:4096
v_mfma_f32_16x16x32_bf16 v[200:203], v[64:67], v[36:39], 0
ds_read_b64_tr_b16 v[86:87], v17 offset:17408
v_mfma_f32_16x16x32_bf16 v[208:211], v[64:67], v[40:43], 0
buffer_load_dwordx4 v7, s[36:39], s64 offen offset:1024 lds
v_mfma_f32_16x16x32_bf16 v[216:219], v[64:67], v[44:47], 0
ds_read_b128 v[60:63], v11 offset:6144
v_mfma_f32_16x16x32_bf16 v[196:199], v[68:71], v[32:35], 0
ds_read_b64_tr_b16 v[64:65], v18 offset:16384
v_mfma_f32_16x16x32_bf16 v[204:207], v[68:71], v[36:39], 0
ds_read_b64_tr_b16 v[66:67], v18 offset:17408
v_mfma_f32_16x16x32_bf16 v[212:215], v[68:71], v[40:43], 0
v_mfma_f32_16x16x32_bf16 v[220:223], v[68:71], v[44:47], 0
s_waitcnt lgkmcnt(9)
v_mfma_f32_16x16x32_bf16 v[96:99], v[72:75], v[48:51], v[96:99]
ds_read_b64_tr_b16 v[68:69], v19 offset:16384
s_waitcnt lgkmcnt(7)
v_mfma_f32_16x16x32_bf16 v[104:107], v[72:75], v[52:55], v[104:107]
ds_read_b64_tr_b16 v[70:71], v19 offset:17408
s_add_u32 m0, s55, 65536
s_add_u32 s66, s52, 256
s_waitcnt lgkmcnt(6)
v_mfma_f32_16x16x32_bf16 v[112:115], v[72:75], v[56:59], v[112:115]
buffer_load_dwordx4 v4, s[32:35], s66 offen offset:2048 lds
s_waitcnt lgkmcnt(4)
v_mfma_f32_16x16x32_bf16 v[120:123], v[72:75], v[60:63], v[120:123]
v_mfma_f32_16x16x32_bf16 v[100:103], v[76:79], v[48:51], v[100:103]
ds_read_b64_tr_b16 v[72:73], v20 offset:16384
v_mfma_f32_16x16x32_bf16 v[108:111], v[76:79], v[52:55], v[108:111]
ds_read_b64_tr_b16 v[74:75], v20 offset:17408
v_mfma_f32_16x16x32_bf16 v[116:119], v[76:79], v[56:59], v[116:119]
s_cmp_lg_u32 s22, 3
s_cbranch_scc1 L_kk_kernel_c0_sk6
v_bfe_u32 v92, v0, 1, 2
v_lshlrev_b32 v92, 13, v92
v_and_b32 v235, 1, v0
v_lshl_add_u32 v92, v235, 7, v92
s_lshl_b32 s68, s21, 15
s_add_u32 s68, s68, s53
s_add_u32 s68, s68, 2359296
buffer_load_dword v94, v92, s[36:39], s68 offen
L_kk_kernel_c0_sk6:
v_mfma_f32_16x16x32_bf16 v[124:127], v[76:79], v[60:63], v[124:127]
v_mfma_f32_16x16x32_bf16 v[128:131], v[80:83], v[48:51], v[128:131]
ds_read_b64_tr_b16 v[76:77], v21 offset:16384
v_mfma_f32_16x16x32_bf16 v[136:139], v[80:83], v[52:55], v[136:139]
ds_read_b64_tr_b16 v[78:79], v21 offset:17408
v_mfma_f32_16x16x32_bf16 v[144:147], v[80:83], v[56:59], v[144:147]
buffer_load_dwordx4 v5, s[32:35], s66 offen offset:3072 lds
s_cmp_lg_u32 s22, 1
s_cbranch_scc1 L_kk_kernel_c0_sk5
s_lshl_b32 s68, s2, 14
s_add_u32 s68, s68, 4096
v_lshlrev_b32 v92, 6, v0
buffer_load_dword v94, v92, s[40:43], s68 offen
L_kk_kernel_c0_sk5:
v_mfma_f32_16x16x32_bf16 v[152:155], v[80:83], v[60:63], v[152:155]
v_mfma_f32_16x16x32_bf16 v[132:135], v[84:87], v[48:51], v[132:135]
v_mfma_f32_16x16x32_bf16 v[140:143], v[84:87], v[52:55], v[140:143]
v_mfma_f32_16x16x32_bf16 v[148:151], v[84:87], v[56:59], v[148:151]
s_cmp_lg_u32 s22, 1
s_cbranch_scc1 L_kk_kernel_c0_sk4
buffer_load_dwordx4 v[224:227], v1, s[28:31], s59 offen
L_kk_kernel_c0_sk4:
v_mfma_f32_16x16x32_bf16 v[156:159], v[84:87], v[60:63], v[156:159]
s_waitcnt vmcnt(12) lgkmcnt(0)
s_barrier
ds_read_b64_tr_b16 v[80:81], v14 offset:32768
ds_read_b64_tr_b16 v[82:83], v14 offset:33792
v_mfma_f32_16x16x32_bf16 v[160:163], v[64:67], v[48:51], v[160:163]
ds_read_b64_tr_b16 v[84:85], v15 offset:32768
v_mfma_f32_16x16x32_bf16 v[168:171], v[64:67], v[52:55], v[168:171]
ds_read_b64_tr_b16 v[86:87], v15 offset:33792
s_add_u32 m0, s56, 16384
s_add_u32 s64, s53, 1310720
v_mfma_f32_16x16x32_bf16 v[176:179], v[64:67], v[56:59], v[176:179]
buffer_load_dwordx4 v6, s[36:39], s64 offen offset:0 lds
ds_read_b128 v[32:35], v10 offset:32768
v_mfma_f32_16x16x32_bf16 v[184:187], v[64:67], v[60:63], v[184:187]
v_mfma_f32_16x16x32_bf16 v[164:167], v[68:71], v[48:51], v[164:167]
ds_read_b64_tr_b16 v[64:65], v16 offset:32768
v_mfma_f32_16x16x32_bf16 v[172:175], v[68:71], v[52:55], v[172:175]
ds_read_b64_tr_b16 v[66:67], v16 offset:33792
ds_read_b128 v[36:39], v10 offset:34816
v_mfma_f32_16x16x32_bf16 v[180:183], v[68:71], v[56:59], v[180:183]
v_mfma_f32_16x16x32_bf16 v[188:191], v[68:71], v[60:63], v[188:191]
v_mfma_f32_16x16x32_bf16 v[192:195], v[72:75], v[48:51], v[192:195]
ds_read_b64_tr_b16 v[68:69], v17 offset:32768
ds_read_b128 v[40:43], v10 offset:36864
v_mfma_f32_16x16x32_bf16 v[200:203], v[72:75], v[52:55], v[200:203]
ds_read_b64_tr_b16 v[70:71], v17 offset:33792
v_mfma_f32_16x16x32_bf16 v[208:211], v[72:75], v[56:59], v[208:211]
buffer_load_dwordx4 v7, s[36:39], s64 offen offset:1024 lds
v_mfma_f32_16x16x32_bf16 v[216:219], v[72:75], v[60:63], v[216:219]
ds_read_b128 v[44:47], v10 offset:38912
v_mfma_f32_16x16x32_bf16 v[196:199], v[76:79], v[48:51], v[196:199]
ds_read_b64_tr_b16 v[72:73], v18 offset:32768
v_mfma_f32_16x16x32_bf16 v[204:207], v[76:79], v[52:55], v[204:207]
ds_read_b64_tr_b16 v[74:75], v18 offset:33792
v_mfma_f32_16x16x32_bf16 v[212:215], v[76:79], v[56:59], v[212:215]
v_mfma_f32_16x16x32_bf16 v[220:223], v[76:79], v[60:63], v[220:223]
s_waitcnt lgkmcnt(9)
v_mfma_f32_16x16x32_bf16 v[96:99], v[80:83], v[32:35], v[96:99]
ds_read_b64_tr_b16 v[76:77], v19 offset:32768
s_waitcnt lgkmcnt(7)
v_mfma_f32_16x16x32_bf16 v[104:107], v[80:83], v[36:39], v[104:107]
ds_read_b64_tr_b16 v[78:79], v19 offset:33792
s_add_u32 m0, s55, 0
s_add_u32 s66, s52, 384
s_waitcnt lgkmcnt(6)
v_mfma_f32_16x16x32_bf16 v[112:115], v[80:83], v[40:43], v[112:115]
buffer_load_dwordx4 v2, s[32:35], s66 offen offset:0 lds
s_waitcnt lgkmcnt(4)
v_mfma_f32_16x16x32_bf16 v[120:123], v[80:83], v[44:47], v[120:123]
v_mfma_f32_16x16x32_bf16 v[100:103], v[84:87], v[32:35], v[100:103]
ds_read_b64_tr_b16 v[80:81], v20 offset:32768
v_mfma_f32_16x16x32_bf16 v[108:111], v[84:87], v[36:39], v[108:111]
ds_read_b64_tr_b16 v[82:83], v20 offset:33792
v_mfma_f32_16x16x32_bf16 v[116:119], v[84:87], v[40:43], v[116:119]
s_cmp_lg_u32 s22, 0
s_cbranch_scc1 L_kk_kernel_c0_sk9
v_bfe_u32 v92, v0, 1, 2
v_lshlrev_b32 v92, 13, v92
v_and_b32 v235, 1, v0
v_lshl_add_u32 v92, v235, 7, v92
s_lshl_b32 s68, s21, 15
s_add_u32 s68, s68, s53
s_add_u32 s68, s68, 2621440
buffer_load_dword v94, v92, s[36:39], s68 offen
v_and_b32 v92, 7, v0
v_lshlrev_b32 v92, 10, v92
s_lshl_b32 s68, s21, 18
s_lshl_b32 s69, s20, 13
s_add_u32 s68, s68, s69
s_add_u32 s68, s68, 640
buffer_load_dword v94, v92, s[32:35], s68 offen
L_kk_kernel_c0_sk9:
v_mfma_f32_16x16x32_bf16 v[124:127], v[84:87], v[44:47], v[124:127]
v_mfma_f32_16x16x32_bf16 v[128:131], v[64:67], v[32:35], v[128:131]
ds_read_b64_tr_b16 v[84:85], v21 offset:32768
v_mfma_f32_16x16x32_bf16 v[136:139], v[64:67], v[36:39], v[136:139]
ds_read_b64_tr_b16 v[86:87], v21 offset:33792
v_mfma_f32_16x16x32_bf16 v[144:147], v[64:67], v[40:43], v[144:147]
buffer_load_dwordx4 v3, s[32:35], s66 offen offset:1024 lds
s_cmp_lg_u32 s22, 2
s_cbranch_scc1 L_kk_kernel_c0_sk8
s_lshl_b32 s68, s2, 14
s_add_u32 s68, s68, 8192
v_lshlrev_b32 v92, 6, v0
buffer_load_dword v94, v92, s[40:43], s68 offen
L_kk_kernel_c0_sk8:
v_mfma_f32_16x16x32_bf16 v[152:155], v[64:67], v[44:47], v[152:155]
v_mfma_f32_16x16x32_bf16 v[132:135], v[68:71], v[32:35], v[132:135]
v_mfma_f32_16x16x32_bf16 v[140:143], v[68:71], v[36:39], v[140:143]
v_mfma_f32_16x16x32_bf16 v[148:151], v[68:71], v[40:43], v[148:151]
s_cmp_lg_u32 s22, 2
s_cbranch_scc1 L_kk_kernel_c0_sk7
buffer_load_dwordx4 v[224:227], v1, s[28:31], s59 offen
L_kk_kernel_c0_sk7:
v_mfma_f32_16x16x32_bf16 v[156:159], v[68:71], v[44:47], v[156:159]
s_waitcnt vmcnt(10) lgkmcnt(0)
s_barrier
ds_read_b64_tr_b16 v[64:65], v14 offset:49152
ds_read_b64_tr_b16 v[66:67], v14 offset:50176
v_mfma_f32_16x16x32_bf16 v[160:163], v[72:75], v[32:35], v[160:163]
ds_read_b64_tr_b16 v[68:69], v15 offset:49152
v_mfma_f32_16x16x32_bf16 v[168:171], v[72:75], v[36:39], v[168:171]
ds_read_b64_tr_b16 v[70:71], v15 offset:50176
buffer_store_dword v31, v9, s[16:19], 0 offen sc1
v_mfma_f32_16x16x32_bf16 v[176:179], v[72:75], v[40:43], v[176:179]
ds_read_b128 v[48:51], v11 offset:32768
v_mfma_f32_16x16x32_bf16 v[184:187], v[72:75], v[44:47], v[184:187]
v_mfma_f32_16x16x32_bf16 v[164:167], v[76:79], v[32:35], v[164:167]
ds_read_b64_tr_b16 v[72:73], v16 offset:49152
v_mfma_f32_16x16x32_bf16 v[172:175], v[76:79], v[36:39], v[172:175]
ds_read_b64_tr_b16 v[74:75], v16 offset:50176
ds_read_b128 v[52:55], v11 offset:34816
v_mfma_f32_16x16x32_bf16 v[180:183], v[76:79], v[40:43], v[180:183]
v_mfma_f32_16x16x32_bf16 v[188:191], v[76:79], v[44:47], v[188:191]
s_add_u32 m0, s56, 32768
s_add_u32 s64, s53, 1572864
v_mfma_f32_16x16x32_bf16 v[192:195], v[80:83], v[32:35], v[192:195]
ds_read_b64_tr_b16 v[76:77], v17 offset:49152
buffer_load_dwordx4 v6, s[36:39], s64 offen offset:0 lds
ds_read_b128 v[56:59], v11 offset:36864
v_mfma_f32_16x16x32_bf16 v[200:203], v[80:83], v[36:39], v[200:203]
ds_read_b64_tr_b16 v[78:79], v17 offset:50176
v_mfma_f32_16x16x32_bf16 v[208:211], v[80:83], v[40:43], v[208:211]
v_mfma_f32_16x16x32_bf16 v[216:219], v[80:83], v[44:47], v[216:219]
ds_read_b128 v[60:63], v11 offset:38912
v_mfma_f32_16x16x32_bf16 v[196:199], v[84:87], v[32:35], v[196:199]
ds_read_b64_tr_b16 v[80:81], v18 offset:49152
v_mfma_f32_16x16x32_bf16 v[204:207], v[84:87], v[36:39], v[204:207]
ds_read_b64_tr_b16 v[82:83], v18 offset:50176
v_mfma_f32_16x16x32_bf16 v[212:215], v[84:87], v[40:43], v[212:215]
buffer_load_dwordx4 v7, s[36:39], s64 offen offset:1024 lds
v_mfma_f32_16x16x32_bf16 v[220:223], v[84:87], v[44:47], v[220:223]
s_waitcnt lgkmcnt(9)
v_mfma_f32_16x16x32_bf16 v[96:99], v[64:67], v[48:51], v[96:99]
ds_read_b64_tr_b16 v[84:85], v19 offset:49152
s_waitcnt lgkmcnt(7)
v_mfma_f32_16x16x32_bf16 v[104:107], v[64:67], v[52:55], v[104:107]
ds_read_b64_tr_b16 v[86:87], v19 offset:50176
s_waitcnt lgkmcnt(6)
v_mfma_f32_16x16x32_bf16 v[112:115], v[64:67], v[56:59], v[112:115]
s_waitcnt lgkmcnt(4)
v_mfma_f32_16x16x32_bf16 v[120:123], v[64:67], v[60:63], v[120:123]
s_add_u32 m0, s55, 0
s_add_u32 s66, s52, 384
v_mfma_f32_16x16x32_bf16 v[100:103], v[68:71], v[48:51], v[100:103]
ds_read_b64_tr_b16 v[64:65], v20 offset:49152
buffer_load_dwordx4 v4, s[32:35], s66 offen offset:2048 lds
v_mfma_f32_16x16x32_bf16 v[108:111], v[68:71], v[52:55], v[108:111]
ds_read_b64_tr_b16 v[66:67], v20 offset:50176
v_mfma_f32_16x16x32_bf16 v[116:119], v[68:71], v[56:59], v[116:119]
s_cmp_lg_u32 s22, 1
s_cbranch_scc1 L_kk_kernel_c0_sk12
v_bfe_u32 v92, v0, 1, 2
v_lshlrev_b32 v92, 13, v92
v_and_b32 v235, 1, v0
v_lshl_add_u32 v92, v235, 7, v92
s_lshl_b32 s68, s21, 15
s_add_u32 s68, s68, s53
s_add_u32 s68, s68, 2883584
buffer_load_dword v94, v92, s[36:39], s68 offen
L_kk_kernel_c0_sk12:
v_mfma_f32_16x16x32_bf16 v[124:127], v[68:71], v[60:63], v[124:127]
v_mfma_f32_16x16x32_bf16 v[128:131], v[72:75], v[48:51], v[128:131]
ds_read_b64_tr_b16 v[68:69], v21 offset:49152
v_mfma_f32_16x16x32_bf16 v[136:139], v[72:75], v[52:55], v[136:139]
ds_read_b64_tr_b16 v[70:71], v21 offset:50176
v_mfma_f32_16x16x32_bf16 v[144:147], v[72:75], v[56:59], v[144:147]
s_cmp_lg_u32 s22, 3
s_cbranch_scc1 L_kk_kernel_c0_sk11
s_lshl_b32 s68, s2, 14
s_add_u32 s68, s68, 12288
v_lshlrev_b32 v92, 6, v0
buffer_load_dword v94, v92, s[40:43], s68 offen
L_kk_kernel_c0_sk11:
v_mfma_f32_16x16x32_bf16 v[152:155], v[72:75], v[60:63], v[152:155]
buffer_load_dwordx4 v5, s[32:35], s66 offen offset:3072 lds
v_mfma_f32_16x16x32_bf16 v[132:135], v[76:79], v[48:51], v[132:135]
v_mfma_f32_16x16x32_bf16 v[140:143], v[76:79], v[52:55], v[140:143]
v_mfma_f32_16x16x32_bf16 v[148:151], v[76:79], v[56:59], v[148:151]
s_cmp_lg_u32 s22, 3
s_cbranch_scc1 L_kk_kernel_c0_sk10
buffer_load_dwordx4 v[224:227], v1, s[28:31], s59 offen
L_kk_kernel_c0_sk10:
v_mfma_f32_16x16x32_bf16 v[156:159], v[76:79], v[60:63], v[156:159]
s_waitcnt vmcnt(9) lgkmcnt(0)
s_barrier
ds_read_b64_tr_b16 v[72:73], v14 offset:0
ds_read_b64_tr_b16 v[74:75], v14 offset:1024
v_mfma_f32_16x16x32_bf16 v[160:163], v[80:83], v[48:51], v[160:163]
ds_read_b64_tr_b16 v[76:77], v15 offset:0
v_mfma_f32_16x16x32_bf16 v[168:171], v[80:83], v[52:55], v[168:171]
ds_read_b64_tr_b16 v[78:79], v15 offset:1024
s_add_u32 m0, s56, 49152
s_add_u32 s64, s53, 1835008
v_mfma_f32_16x16x32_bf16 v[176:179], v[80:83], v[56:59], v[176:179]
buffer_load_dwordx4 v6, s[36:39], s64 offen offset:0 lds
ds_read_b128 v[32:35], v12 offset:0
v_mfma_f32_16x16x32_bf16 v[184:187], v[80:83], v[60:63], v[184:187]
v_mfma_f32_16x16x32_bf16 v[164:167], v[84:87], v[48:51], v[164:167]
ds_read_b64_tr_b16 v[80:81], v16 offset:0
v_mfma_f32_16x16x32_bf16 v[172:175], v[84:87], v[52:55], v[172:175]
ds_read_b64_tr_b16 v[82:83], v16 offset:1024
ds_read_b128 v[36:39], v12 offset:2048
v_mfma_f32_16x16x32_bf16 v[180:183], v[84:87], v[56:59], v[180:183]
v_mfma_f32_16x16x32_bf16 v[188:191], v[84:87], v[60:63], v[188:191]
v_mfma_f32_16x16x32_bf16 v[192:195], v[64:67], v[48:51], v[192:195]
ds_read_b64_tr_b16 v[84:85], v17 offset:0
ds_read_b128 v[40:43], v12 offset:4096
v_mfma_f32_16x16x32_bf16 v[200:203], v[64:67], v[52:55], v[200:203]
ds_read_b64_tr_b16 v[86:87], v17 offset:1024
v_mfma_f32_16x16x32_bf16 v[208:211], v[64:67], v[56:59], v[208:211]
buffer_load_dwordx4 v7, s[36:39], s64 offen offset:1024 lds
v_mfma_f32_16x16x32_bf16 v[216:219], v[64:67], v[60:63], v[216:219]
ds_read_b128 v[44:47], v12 offset:6144
v_mfma_f32_16x16x32_bf16 v[196:199], v[68:71], v[48:51], v[196:199]
ds_read_b64_tr_b16 v[64:65], v18 offset:0
v_mfma_f32_16x16x32_bf16 v[204:207], v[68:71], v[52:55], v[204:207]
ds_read_b64_tr_b16 v[66:67], v18 offset:1024
v_mfma_f32_16x16x32_bf16 v[212:215], v[68:71], v[56:59], v[212:215]
v_mfma_f32_16x16x32_bf16 v[220:223], v[68:71], v[60:63], v[220:223]
s_waitcnt lgkmcnt(9)
v_mfma_f32_16x16x32_bf16 v[96:99], v[72:75], v[32:35], v[96:99]
ds_read_b64_tr_b16 v[68:69], v19 offset:0
s_waitcnt lgkmcnt(7)
v_mfma_f32_16x16x32_bf16 v[104:107], v[72:75], v[36:39], v[104:107]
ds_read_b64_tr_b16 v[70:71], v19 offset:1024
s_add_u32 m0, s55, 32768
s_add_u32 s66, s52, 512
s_waitcnt lgkmcnt(6)
v_mfma_f32_16x16x32_bf16 v[112:115], v[72:75], v[40:43], v[112:115]
buffer_load_dwordx4 v2, s[32:35], s66 offen offset:0 lds
s_waitcnt lgkmcnt(4)
v_mfma_f32_16x16x32_bf16 v[120:123], v[72:75], v[44:47], v[120:123]
v_mfma_f32_16x16x32_bf16 v[100:103], v[76:79], v[32:35], v[100:103]
ds_read_b64_tr_b16 v[72:73], v20 offset:0
v_mfma_f32_16x16x32_bf16 v[108:111], v[76:79], v[36:39], v[108:111]
ds_read_b64_tr_b16 v[74:75], v20 offset:1024
v_mfma_f32_16x16x32_bf16 v[116:119], v[76:79], v[40:43], v[116:119]
v_mfma_f32_16x16x32_bf16 v[124:127], v[76:79], v[44:47], v[124:127]
v_mfma_f32_16x16x32_bf16 v[128:131], v[80:83], v[32:35], v[128:131]
ds_read_b64_tr_b16 v[76:77], v21 offset:0
v_mfma_f32_16x16x32_bf16 v[136:139], v[80:83], v[36:39], v[136:139]
ds_read_b64_tr_b16 v[78:79], v21 offset:1024
v_mfma_f32_16x16x32_bf16 v[144:147], v[80:83], v[40:43], v[144:147]
buffer_load_dwordx4 v3, s[32:35], s66 offen offset:1024 lds
v_mfma_f32_16x16x32_bf16 v[152:155], v[80:83], v[44:47], v[152:155]
v_mfma_f32_16x16x32_bf16 v[132:135], v[84:87], v[32:35], v[132:135]
v_mfma_f32_16x16x32_bf16 v[140:143], v[84:87], v[36:39], v[140:143]
v_mfma_f32_16x16x32_bf16 v[148:151], v[84:87], v[40:43], v[148:151]
s_cmp_lg_u32 s22, 2
s_cbranch_scc1 L_kk_kernel_c0_sk13
v_bfe_u32 v92, v0, 1, 2
v_lshlrev_b32 v92, 13, v92
v_and_b32 v235, 1, v0
v_lshl_add_u32 v92, v235, 7, v92
s_lshl_b32 s68, s21, 15
s_add_u32 s68, s68, s53
s_add_u32 s68, s68, 3145728
buffer_load_dword v94, v92, s[36:39], s68 offen
v_and_b32 v92, 7, v0
v_lshlrev_b32 v92, 10, v92
s_lshl_b32 s68, s21, 18
s_lshl_b32 s69, s20, 13
s_add_u32 s68, s68, s69
s_add_u32 s68, s68, 768
buffer_load_dword v94, v92, s[32:35], s68 offen
L_kk_kernel_c0_sk13:
v_mfma_f32_16x16x32_bf16 v[156:159], v[84:87], v[44:47], v[156:159]
s_waitcnt vmcnt(11) lgkmcnt(0)
s_barrier
ds_read_b64_tr_b16 v[80:81], v14 offset:16384
ds_read_b64_tr_b16 v[82:83], v14 offset:17408
v_mfma_f32_16x16x32_bf16 v[160:163], v[64:67], v[32:35], v[160:163]
ds_read_b64_tr_b16 v[84:85], v15 offset:16384
v_mfma_f32_16x16x32_bf16 v[168:171], v[64:67], v[36:39], v[168:171]
ds_read_b64_tr_b16 v[86:87], v15 offset:17408
s_add_u32 m0, s56, 0
s_add_u32 s64, s53, 2097152
v_mfma_f32_16x16x32_bf16 v[176:179], v[64:67], v[40:43], v[176:179]
buffer_load_dwordx4 v6, s[36:39], s64 offen offset:0 lds
ds_read_b128 v[48:51], v13 offset:0
v_mfma_f32_16x16x32_bf16 v[184:187], v[64:67], v[44:47], v[184:187]
v_mfma_f32_16x16x32_bf16 v[164:167], v[68:71], v[32:35], v[164:167]
ds_read_b64_tr_b16 v[64:65], v16 offset:16384
v_mfma_f32_16x16x32_bf16 v[172:175], v[68:71], v[36:39], v[172:175]
ds_read_b64_tr_b16 v[66:67], v16 offset:17408
ds_read_b128 v[52:55], v13 offset:2048
v_mfma_f32_16x16x32_bf16 v[180:183], v[68:71], v[40:43], v[180:183]
v_mfma_f32_16x16x32_bf16 v[188:191], v[68:71], v[44:47], v[188:191]
v_mfma_f32_16x16x32_bf16 v[192:195], v[72:75], v[32:35], v[192:195]
ds_read_b64_tr_b16 v[68:69], v17 offset:16384
ds_read_b128 v[56:59], v13 offset:4096
v_mfma_f32_16x16x32_bf16 v[200:203], v[72:75], v[36:39], v[200:203]
ds_read_b64_tr_b16 v[70:71], v17 offset:17408
v_mfma_f32_16x16x32_bf16 v[208:211], v[72:75], v[40:43], v[208:211]
buffer_load_dwordx4 v7, s[36:39], s64 offen offset:1024 lds
v_mfma_f32_16x16x32_bf16 v[216:219], v[72:75], v[44:47], v[216:219]
ds_read_b128 v[60:63], v13 offset:6144
v_mfma_f32_16x16x32_bf16 v[196:199], v[76:79], v[32:35], v[196:199]
ds_read_b64_tr_b16 v[72:73], v18 offset:16384
v_mfma_f32_16x16x32_bf16 v[204:207], v[76:79], v[36:39], v[204:207]
ds_read_b64_tr_b16 v[74:75], v18 offset:17408
v_mfma_f32_16x16x32_bf16 v[212:215], v[76:79], v[40:43], v[212:215]
v_mfma_f32_16x16x32_bf16 v[220:223], v[76:79], v[44:47], v[220:223]
s_waitcnt lgkmcnt(9)
v_mfma_f32_16x16x32_bf16 v[96:99], v[80:83], v[48:51], v[96:99]
ds_read_b64_tr_b16 v[76:77], v19 offset:16384
s_waitcnt lgkmcnt(7)
v_mfma_f32_16x16x32_bf16 v[104:107], v[80:83], v[52:55], v[104:107]
ds_read_b64_tr_b16 v[78:79], v19 offset:17408
s_add_u32 m0, s55, 32768
s_add_u32 s66, s52, 512
s_waitcnt lgkmcnt(6)
v_mfma_f32_16x16x32_bf16 v[112:115], v[80:83], v[56:59], v[112:115]
buffer_load_dwordx4 v4, s[32:35], s66 offen offset:2048 lds
s_waitcnt lgkmcnt(4)
v_mfma_f32_16x16x32_bf16 v[120:123], v[80:83], v[60:63], v[120:123]
v_mfma_f32_16x16x32_bf16 v[100:103], v[84:87], v[48:51], v[100:103]
ds_read_b64_tr_b16 v[80:81], v20 offset:16384
v_mfma_f32_16x16x32_bf16 v[108:111], v[84:87], v[52:55], v[108:111]
ds_read_b64_tr_b16 v[82:83], v20 offset:17408
v_mfma_f32_16x16x32_bf16 v[116:119], v[84:87], v[56:59], v[116:119]
v_mfma_f32_16x16x32_bf16 v[124:127], v[84:87], v[60:63], v[124:127]
v_mfma_f32_16x16x32_bf16 v[128:131], v[64:67], v[48:51], v[128:131]
ds_read_b64_tr_b16 v[84:85], v21 offset:16384
v_mfma_f32_16x16x32_bf16 v[136:139], v[64:67], v[52:55], v[136:139]
ds_read_b64_tr_b16 v[86:87], v21 offset:17408
v_mfma_f32_16x16x32_bf16 v[144:147], v[64:67], v[56:59], v[144:147]
buffer_load_dwordx4 v5, s[32:35], s66 offen offset:3072 lds
v_mfma_f32_16x16x32_bf16 v[152:155], v[64:67], v[60:63], v[152:155]
v_mfma_f32_16x16x32_bf16 v[132:135], v[68:71], v[48:51], v[132:135]
v_mfma_f32_16x16x32_bf16 v[140:143], v[68:71], v[52:55], v[140:143]
v_mfma_f32_16x16x32_bf16 v[148:151], v[68:71], v[56:59], v[148:151]
s_cmp_lg_u32 s22, 3
s_cbranch_scc1 L_kk_kernel_c0_sk14
v_bfe_u32 v92, v0, 1, 2
v_lshlrev_b32 v92, 13, v92
v_and_b32 v235, 1, v0
v_lshl_add_u32 v92, v235, 7, v92
s_lshl_b32 s68, s21, 15
s_add_u32 s68, s68, s53
s_add_u32 s68, s68, 3407872
buffer_load_dword v94, v92, s[36:39], s68 offen
L_kk_kernel_c0_sk14:
v_mfma_f32_16x16x32_bf16 v[156:159], v[68:71], v[60:63], v[156:159]
s_waitcnt vmcnt(8) lgkmcnt(0)
s_barrier
ds_read_b64_tr_b16 v[64:65], v14 offset:32768
ds_read_b64_tr_b16 v[66:67], v14 offset:33792
v_mfma_f32_16x16x32_bf16 v[160:163], v[72:75], v[48:51], v[160:163]
ds_read_b64_tr_b16 v[68:69], v15 offset:32768
v_mfma_f32_16x16x32_bf16 v[168:171], v[72:75], v[52:55], v[168:171]
ds_read_b64_tr_b16 v[70:71], v15 offset:33792
buffer_load_dword v93, v29, s[16:19], 0 offen sc1
v_mfma_f32_16x16x32_bf16 v[176:179], v[72:75], v[56:59], v[176:179]
ds_read_b128 v[32:35], v10 offset:0
v_mfma_f32_16x16x32_bf16 v[184:187], v[72:75], v[60:63], v[184:187]
v_mfma_f32_16x16x32_bf16 v[164:167], v[76:79], v[48:51], v[164:167]
ds_read_b64_tr_b16 v[72:73], v16 offset:32768
v_mfma_f32_16x16x32_bf16 v[172:175], v[76:79], v[52:55], v[172:175]
ds_read_b64_tr_b16 v[74:75], v16 offset:33792
ds_read_b128 v[36:39], v10 offset:2048
v_mfma_f32_16x16x32_bf16 v[180:183], v[76:79], v[56:59], v[180:183]
v_mfma_f32_16x16x32_bf16 v[188:191], v[76:79], v[60:63], v[188:191]
s_add_u32 m0, s56, 16384
s_add_u32 s64, s53, 2359296
v_mfma_f32_16x16x32_bf16 v[192:195], v[80:83], v[48:51], v[192:195]
ds_read_b64_tr_b16 v[76:77], v17 offset:32768
buffer_load_dwordx4 v6, s[36:39], s64 offen offset:0 lds
ds_read_b128 v[40:43], v10 offset:4096
v_mfma_f32_16x16x32_bf16 v[200:203], v[80:83], v[52:55], v[200:203]
ds_read_b64_tr_b16 v[78:79], v17 offset:33792
v_mfma_f32_16x16x32_bf16 v[208:211], v[80:83], v[56:59], v[208:211]
v_mfma_f32_16x16x32_bf16 v[216:219], v[80:83], v[60:63], v[216:219]
ds_read_b128 v[44:47], v10 offset:6144
v_mfma_f32_16x16x32_bf16 v[196:199], v[84:87], v[48:51], v[196:199]
ds_read_b64_tr_b16 v[80:81], v18 offset:32768
v_mfma_f32_16x16x32_bf16 v[204:207], v[84:87], v[52:55], v[204:207]
ds_read_b64_tr_b16 v[82:83], v18 offset:33792
v_mfma_f32_16x16x32_bf16 v[212:215], v[84:87], v[56:59], v[212:215]
buffer_load_dwordx4 v7, s[36:39], s64 offen offset:1024 lds
v_mfma_f32_16x16x32_bf16 v[220:223], v[84:87], v[60:63], v[220:223]
s_waitcnt lgkmcnt(9)
v_mfma_f32_16x16x32_bf16 v[96:99], v[64:67], v[32:35], v[96:99]
ds_read_b64_tr_b16 v[84:85], v19 offset:32768
s_waitcnt lgkmcnt(7)
v_mfma_f32_16x16x32_bf16 v[104:107], v[64:67], v[36:39], v[104:107]
ds_read_b64_tr_b16 v[86:87], v19 offset:33792
s_waitcnt lgkmcnt(6)
v_mfma_f32_16x16x32_bf16 v[112:115], v[64:67], v[40:43], v[112:115]
s_waitcnt lgkmcnt(4)
v_mfma_f32_16x16x32_bf16 v[120:123], v[64:67], v[44:47], v[120:123]
s_add_u32 m0, s55, 65536
s_add_u32 s66, s52, 640
v_mfma_f32_16x16x32_bf16 v[100:103], v[68:71], v[32:35], v[100:103]
ds_read_b64_tr_b16 v[64:65], v20 offset:32768
buffer_load_dwordx4 v2, s[32:35], s66 offen offset:0 lds
v_mfma_f32_16x16x32_bf16 v[108:111], v[68:71], v[36:39], v[108:111]
ds_read_b64_tr_b16 v[66:67], v20 offset:33792
v_mfma_f32_16x16x32_bf16 v[116:119], v[68:71], v[40:43], v[116:119]
v_mfma_f32_16x16x32_bf16 v[124:127], v[68:71], v[44:47], v[124:127]
v_mfma_f32_16x16x32_bf16 v[128:131], v[72:75], v[32:35], v[128:131]
ds_read_b64_tr_b16 v[68:69], v21 offset:32768
v_mfma_f32_16x16x32_bf16 v[136:139], v[72:75], v[36:39], v[136:139]
ds_read_b64_tr_b16 v[70:71], v21 offset:33792
v_mfma_f32_16x16x32_bf16 v[144:147], v[72:75], v[40:43], v[144:147]
v_mfma_f32_16x16x32_bf16 v[152:155], v[72:75], v[44:47], v[152:155]
buffer_load_dwordx4 v3, s[32:35], s66 offen offset:1024 lds
v_mfma_f32_16x16x32_bf16 v[132:135], v[76:79], v[32:35], v[132:135]
v_mfma_f32_16x16x32_bf16 v[140:143], v[76:79], v[36:39], v[140:143]
v_mfma_f32_16x16x32_bf16 v[148:151], v[76:79], v[40:43], v[148:151]
s_cmp_lg_u32 s22, 0
s_cbranch_scc1 L_kk_kernel_c0_sk15
v_bfe_u32 v92, v0, 1, 2
v_lshlrev_b32 v92, 13, v92
v_and_b32 v235, 1, v0
v_lshl_add_u32 v92, v235, 7, v92
s_lshl_b32 s68, s21, 15
s_add_u32 s68, s68, s53
s_add_u32 s68, s68, 3670016
buffer_load_dword v94, v92, s[36:39], s68 offen
v_and_b32 v92, 7, v0
v_lshlrev_b32 v92, 10, v92
s_lshl_b32 s68, s21, 18
s_lshl_b32 s69, s20, 13
s_add_u32 s68, s68, s69
s_add_u32 s68, s68, 896
buffer_load_dword v94, v92, s[32:35], s68 offen
L_kk_kernel_c0_sk15:
v_mfma_f32_16x16x32_bf16 v[156:159], v[76:79], v[44:47], v[156:159]
s_waitcnt vmcnt(11) lgkmcnt(0)
s_barrier
ds_read_b64_tr_b16 v[72:73], v14 offset:49152
ds_read_b64_tr_b16 v[74:75], v14 offset:50176
v_mfma_f32_16x16x32_bf16 v[160:163], v[80:83], v[32:35], v[160:163]
ds_read_b64_tr_b16 v[76:77], v15 offset:49152
v_mfma_f32_16x16x32_bf16 v[168:171], v[80:83], v[36:39], v[168:171]
ds_read_b64_tr_b16 v[78:79], v15 offset:50176
s_add_u32 m0, s56, 32768
s_add_u32 s64, s53, 2621440
v_mfma_f32_16x16x32_bf16 v[176:179], v[80:83], v[40:43], v[176:179]
buffer_load_dwordx4 v6, s[36:39], s64 offen offset:0 lds
ds_read_b128 v[48:51], v11 offset:0
v_mfma_f32_16x16x32_bf16 v[184:187], v[80:83], v[44:47], v[184:187]
v_mfma_f32_16x16x32_bf16 v[164:167], v[84:87], v[32:35], v[164:167]
ds_read_b64_tr_b16 v[80:81], v16 offset:49152
v_mfma_f32_16x16x32_bf16 v[172:175], v[84:87], v[36:39], v[172:175]
ds_read_b64_tr_b16 v[82:83], v16 offset:50176
ds_read_b128 v[52:55], v11 offset:2048
v_mfma_f32_16x16x32_bf16 v[180:183], v[84:87], v[40:43], v[180:183]
v_mfma_f32_16x16x32_bf16 v[188:191], v[84:87], v[44:47], v[188:191]
v_mfma_f32_16x16x32_bf16 v[192:195], v[64:67], v[32:35], v[192:195]
ds_read_b64_tr_b16 v[84:85], v17 offset:49152
ds_read_b128 v[56:59], v11 offset:4096
v_mfma_f32_16x16x32_bf16 v[200:203], v[64:67], v[36:39], v[200:203]
ds_read_b64_tr_b16 v[86:87], v17 offset:50176
v_mfma_f32_16x16x32_bf16 v[208:211], v[64:67], v[40:43], v[208:211]
buffer_load_dwordx4 v7, s[36:39], s64 offen offset:1024 lds
v_mfma_f32_16x16x32_bf16 v[216:219], v[64:67], v[44:47], v[216:219]
ds_read_b128 v[60:63], v11 offset:6144
v_mfma_f32_16x16x32_bf16 v[196:199], v[68:71], v[32:35], v[196:199]
ds_read_b64_tr_b16 v[64:65], v18 offset:49152
v_mfma_f32_16x16x32_bf16 v[204:207], v[68:71], v[36:39], v[204:207]
ds_read_b64_tr_b16 v[66:67], v18 offset:50176
v_mfma_f32_16x16x32_bf16 v[212:215], v[68:71], v[40:43], v[212:215]
v_mfma_f32_16x16x32_bf16 v[220:223], v[68:71], v[44:47], v[220:223]
s_waitcnt lgkmcnt(9)
v_mfma_f32_16x16x32_bf16 v[96:99], v[72:75], v[48:51], v[96:99]
ds_read_b64_tr_b16 v[68:69], v19 offset:49152
s_waitcnt lgkmcnt(7)
v_mfma_f32_16x16x32_bf16 v[104:107], v[72:75], v[52:55], v[104:107]
ds_read_b64_tr_b16 v[70:71], v19 offset:50176
s_add_u32 m0, s55, 65536
s_add_u32 s66, s52, 640
s_waitcnt lgkmcnt(6)
v_mfma_f32_16x16x32_bf16 v[112:115], v[72:75], v[56:59], v[112:115]
buffer_load_dwordx4 v4, s[32:35], s66 offen offset:2048 lds
s_waitcnt lgkmcnt(4)
v_mfma_f32_16x16x32_bf16 v[120:123], v[72:75], v[60:63], v[120:123]
v_mfma_f32_16x16x32_bf16 v[100:103], v[76:79], v[48:51], v[100:103]
ds_read_b64_tr_b16 v[72:73], v20 offset:49152
v_mfma_f32_16x16x32_bf16 v[108:111], v[76:79], v[52:55], v[108:111]
ds_read_b64_tr_b16 v[74:75], v20 offset:50176
v_mfma_f32_16x16x32_bf16 v[116:119], v[76:79], v[56:59], v[116:119]
v_mfma_f32_16x16x32_bf16 v[124:127], v[76:79], v[60:63], v[124:127]
v_mfma_f32_16x16x32_bf16 v[128:131], v[80:83], v[48:51], v[128:131]
ds_read_b64_tr_b16 v[76:77], v21 offset:49152
v_mfma_f32_16x16x32_bf16 v[136:139], v[80:83], v[52:55], v[136:139]
ds_read_b64_tr_b16 v[78:79], v21 offset:50176
v_mfma_f32_16x16x32_bf16 v[144:147], v[80:83], v[56:59], v[144:147]
buffer_load_dwordx4 v5, s[32:35], s66 offen offset:3072 lds
v_mfma_f32_16x16x32_bf16 v[152:155], v[80:83], v[60:63], v[152:155]
v_mfma_f32_16x16x32_bf16 v[132:135], v[84:87], v[48:51], v[132:135]
v_mfma_f32_16x16x32_bf16 v[140:143], v[84:87], v[52:55], v[140:143]
v_mfma_f32_16x16x32_bf16 v[148:151], v[84:87], v[56:59], v[148:151]
s_cmp_lg_u32 s22, 1
s_cbranch_scc1 L_kk_kernel_c0_sk16
v_bfe_u32 v92, v0, 1, 2
v_lshlrev_b32 v92, 13, v92
v_and_b32 v235, 1, v0
v_lshl_add_u32 v92, v235, 7, v92
s_lshl_b32 s68, s21, 15
s_add_u32 s68, s68, s53
s_add_u32 s68, s68, 3932160
buffer_load_dword v94, v92, s[36:39], s68 offen
L_kk_kernel_c0_sk16:
v_mfma_f32_16x16x32_bf16 v[156:159], v[84:87], v[60:63], v[156:159]
s_waitcnt vmcnt(9) lgkmcnt(0)
s_barrier
ds_read_b64_tr_b16 v[80:81], v14 offset:0
ds_read_b64_tr_b16 v[82:83], v14 offset:1024
s_waitcnt vmcnt(8)
v_cmp_ne_u32 vcc, 0, v93
s_cmp_eq_u64 vcc, -1
s_cbranch_scc1 L_kk_kernel_c0_cok
s_mov_b32 s66, 0x20000
L_kk_kernel_c0_cspin:
s_sleep 8
buffer_load_dword v93, v29, s[16:19], 0 offen sc1
s_waitcnt vmcnt(0)
v_cmp_ne_u32 vcc, 0, v93
s_cmp_eq_u64 vcc, -1
s_cbranch_scc1 L_kk_kernel_c0_cok
s_sub_u32 s66, s66, 1
s_cmp_lg_u32 s66, 0
s_cbranch_scc1 L_kk_kernel_c0_cspin
L_kk_kernel_c0_cok:
v_mfma_f32_16x16x32_bf16 v[160:163], v[64:67], v[48:51], v[160:163]
ds_read_b64_tr_b16 v[84:85], v15 offset:0
s_andn2_b32 s24, s20, 3
s_lshl_b32 s24, s24, 15
s_and_b32 s27, s20, 3
s_lshl_b32 s27, s27, 3
s_add_u32 s27, s27, s21
s_lshl_b32 s27, s27, 2
s_add_u32 s24, s24, s27
s_add_u32 s24, s24, 88096832
s_cmp_eq_u32 s22, 0
s_cselect_b32 s24, s24, 268435456
v_min_u32 v9, 3, v0
v_lshlrev_b32 v9, 15, v9
v_add_u32 v9, s24, v9
v_mfma_f32_16x16x32_bf16 v[168:171], v[64:67], v[52:55], v[168:171]
ds_read_b64_tr_b16 v[86:87], v15 offset:1024
buffer_store_dword v31, v9, s[44:47], 0 offen sc1
v_mfma_f32_16x16x32_bf16 v[176:179], v[64:67], v[56:59], v[176:179]
ds_read_b128 v[32:35], v10 offset:32768
v_mfma_f32_16x16x32_bf16 v[184:187], v[64:67], v[60:63], v[184:187]
v_mfma_f32_16x16x32_bf16 v[164:167], v[68:71], v[48:51], v[164:167]
ds_read_b64_tr_b16 v[64:65], v16 offset:0
v_mfma_f32_16x16x32_bf16 v[172:175], v[68:71], v[52:55], v[172:175]
ds_read_b64_tr_b16 v[66:67], v16 offset:1024
ds_read_b128 v[36:39], v10 offset:34816
v_mfma_f32_16x16x32_bf16 v[180:183], v[68:71], v[56:59], v[180:183]
v_mfma_f32_16x16x32_bf16 v[188:191], v[68:71], v[60:63], v[188:191]
s_add_u32 m0, s56, 49152
s_add_u32 s64, s53, 2883584
v_mfma_f32_16x16x32_bf16 v[192:195], v[72:75], v[48:51], v[192:195]
ds_read_b64_tr_b16 v[68:69], v17 offset:0
buffer_load_dwordx4 v6, s[36:39], s64 offen offset:0 lds
ds_read_b128 v[40:43], v10 offset:36864
v_mfma_f32_16x16x32_bf16 v[200:203], v[72:75], v[52:55], v[200:203]
ds_read_b64_tr_b16 v[70:71], v17 offset:1024
v_mfma_f32_16x16x32_bf16 v[208:211], v[72:75], v[56:59], v[208:211]
v_mfma_f32_16x16x32_bf16 v[216:219], v[72:75], v[60:63], v[216:219]
ds_read_b128 v[44:47], v10 offset:38912
v_mfma_f32_16x16x32_bf16 v[196:199], v[76:79], v[48:51], v[196:199]
ds_read_b64_tr_b16 v[72:73], v18 offset:0
v_mfma_f32_16x16x32_bf16 v[204:207], v[76:79], v[52:55], v[204:207]
ds_read_b64_tr_b16 v[74:75], v18 offset:1024
v_mfma_f32_16x16x32_bf16 v[212:215], v[76:79], v[56:59], v[212:215]
buffer_load_dwordx4 v7, s[36:39], s64 offen offset:1024 lds
v_mfma_f32_16x16x32_bf16 v[220:223], v[76:79], v[60:63], v[220:223]
s_waitcnt lgkmcnt(9)
v_mfma_f32_16x16x32_bf16 v[96:99], v[80:83], v[32:35], v[96:99]
ds_read_b64_tr_b16 v[76:77], v19 offset:0
s_waitcnt lgkmcnt(7)
v_mfma_f32_16x16x32_bf16 v[104:107], v[80:83], v[36:39], v[104:107]
ds_read_b64_tr_b16 v[78:79], v19 offset:1024
s_waitcnt lgkmcnt(6)
v_mfma_f32_16x16x32_bf16 v[112:115], v[80:83], v[40:43], v[112:115]
s_waitcnt lgkmcnt(4)
v_mfma_f32_16x16x32_bf16 v[120:123], v[80:83], v[44:47], v[120:123]
s_add_u32 m0, s55, 0
s_add_u32 s66, s52, 768
v_mfma_f32_16x16x32_bf16 v[100:103], v[84:87], v[32:35], v[100:103]
ds_read_b64_tr_b16 v[80:81], v20 offset:0
buffer_load_dwordx4 v2, s[32:35], s66 offen offset:0 lds
v_mfma_f32_16x16x32_bf16 v[108:111], v[84:87], v[36:39], v[108:111]
ds_read_b64_tr_b16 v[82:83], v20 offset:1024
v_mfma_f32_16x16x32_bf16 v[116:119], v[84:87], v[40:43], v[116:119]
v_mfma_f32_16x16x32_bf16 v[124:127], v[84:87], v[44:47], v[124:127]
v_mfma_f32_16x16x32_bf16 v[128:131], v[64:67], v[32:35], v[128:131]
ds_read_b64_tr_b16 v[84:85], v21 offset:0
v_mfma_f32_16x16x32_bf16 v[136:139], v[64:67], v[36:39], v[136:139]
ds_read_b64_tr_b16 v[86:87], v21 offset:1024
v_mfma_f32_16x16x32_bf16 v[144:147], v[64:67], v[40:43], v[144:147]
v_mfma_f32_16x16x32_bf16 v[152:155], v[64:67], v[44:47], v[152:155]
buffer_load_dwordx4 v3, s[32:35], s66 offen offset:1024 lds
v_mfma_f32_16x16x32_bf16 v[132:135], v[68:71], v[32:35], v[132:135]
v_mfma_f32_16x16x32_bf16 v[140:143], v[68:71], v[36:39], v[140:143]
v_mfma_f32_16x16x32_bf16 v[148:151], v[68:71], v[40:43], v[148:151]
v_mfma_f32_16x16x32_bf16 v[156:159], v[68:71], v[44:47], v[156:159]
s_waitcnt vmcnt(11) lgkmcnt(0)
s_barrier
ds_read_b64_tr_b16 v[64:65], v14 offset:16384
ds_read_b64_tr_b16 v[66:67], v14 offset:17408
v_mfma_f32_16x16x32_bf16 v[160:163], v[72:75], v[32:35], v[160:163]
ds_read_b64_tr_b16 v[68:69], v15 offset:16384
v_mfma_f32_16x16x32_bf16 v[168:171], v[72:75], v[36:39], v[168:171]
ds_read_b64_tr_b16 v[70:71], v15 offset:17408
s_add_u32 m0, s56, 0
s_add_u32 s64, s53, 3145728
v_mfma_f32_16x16x32_bf16 v[176:179], v[72:75], v[40:43], v[176:179]
buffer_load_dwordx4 v6, s[36:39], s64 offen offset:0 lds
ds_read_b128 v[48:51], v11 offset:32768
v_mfma_f32_16x16x32_bf16 v[184:187], v[72:75], v[44:47], v[184:187]
v_mfma_f32_16x16x32_bf16 v[164:167], v[76:79], v[32:35], v[164:167]
ds_read_b64_tr_b16 v[72:73], v16 offset:16384
v_mfma_f32_16x16x32_bf16 v[172:175], v[76:79], v[36:39], v[172:175]
ds_read_b64_tr_b16 v[74:75], v16 offset:17408
ds_read_b128 v[52:55], v11 offset:34816
v_mfma_f32_16x16x32_bf16 v[180:183], v[76:79], v[40:43], v[180:183]
v_mfma_f32_16x16x32_bf16 v[188:191], v[76:79], v[44:47], v[188:191]
v_mfma_f32_16x16x32_bf16 v[192:195], v[80:83], v[32:35], v[192:195]
ds_read_b64_tr_b16 v[76:77], v17 offset:16384
ds_read_b128 v[56:59], v11 offset:36864
v_mfma_f32_16x16x32_bf16 v[200:203], v[80:83], v[36:39], v[200:203]
ds_read_b64_tr_b16 v[78:79], v17 offset:17408
v_mfma_f32_16x16x32_bf16 v[208:211], v[80:83], v[40:43], v[208:211]
buffer_load_dwordx4 v7, s[36:39], s64 offen offset:1024 lds
v_mfma_f32_16x16x32_bf16 v[216:219], v[80:83], v[44:47], v[216:219]
ds_read_b128 v[60:63], v11 offset:38912
v_mfma_f32_16x16x32_bf16 v[196:199], v[84:87], v[32:35], v[196:199]
ds_read_b64_tr_b16 v[80:81], v18 offset:16384
v_mfma_f32_16x16x32_bf16 v[204:207], v[84:87], v[36:39], v[204:207]
ds_read_b64_tr_b16 v[82:83], v18 offset:17408
v_mfma_f32_16x16x32_bf16 v[212:215], v[84:87], v[40:43], v[212:215]
v_mfma_f32_16x16x32_bf16 v[220:223], v[84:87], v[44:47], v[220:223]
s_waitcnt lgkmcnt(9)
v_mfma_f32_16x16x32_bf16 v[96:99], v[64:67], v[48:51], v[96:99]
ds_read_b64_tr_b16 v[84:85], v19 offset:16384
s_waitcnt lgkmcnt(7)
v_mfma_f32_16x16x32_bf16 v[104:107], v[64:67], v[52:55], v[104:107]
ds_read_b64_tr_b16 v[86:87], v19 offset:17408
s_add_u32 m0, s55, 0
s_add_u32 s66, s52, 768
s_waitcnt lgkmcnt(6)
v_mfma_f32_16x16x32_bf16 v[112:115], v[64:67], v[56:59], v[112:115]
buffer_load_dwordx4 v4, s[32:35], s66 offen offset:2048 lds
s_waitcnt lgkmcnt(4)
v_mfma_f32_16x16x32_bf16 v[120:123], v[64:67], v[60:63], v[120:123]
v_mfma_f32_16x16x32_bf16 v[100:103], v[68:71], v[48:51], v[100:103]
ds_read_b64_tr_b16 v[64:65], v20 offset:16384
v_mfma_f32_16x16x32_bf16 v[108:111], v[68:71], v[52:55], v[108:111]
ds_read_b64_tr_b16 v[66:67], v20 offset:17408
v_mfma_f32_16x16x32_bf16 v[116:119], v[68:71], v[56:59], v[116:119]
v_mfma_f32_16x16x32_bf16 v[124:127], v[68:71], v[60:63], v[124:127]
v_mfma_f32_16x16x32_bf16 v[128:131], v[72:75], v[48:51], v[128:131]
ds_read_b64_tr_b16 v[68:69], v21 offset:16384
v_mfma_f32_16x16x32_bf16 v[136:139], v[72:75], v[52:55], v[136:139]
ds_read_b64_tr_b16 v[70:71], v21 offset:17408
v_mfma_f32_16x16x32_bf16 v[144:147], v[72:75], v[56:59], v[144:147]
buffer_load_dwordx4 v5, s[32:35], s66 offen offset:3072 lds
v_mfma_f32_16x16x32_bf16 v[152:155], v[72:75], v[60:63], v[152:155]
v_mfma_f32_16x16x32_bf16 v[132:135], v[76:79], v[48:51], v[132:135]
v_mfma_f32_16x16x32_bf16 v[140:143], v[76:79], v[52:55], v[140:143]
v_mfma_f32_16x16x32_bf16 v[148:151], v[76:79], v[56:59], v[148:151]
v_mfma_f32_16x16x32_bf16 v[156:159], v[76:79], v[60:63], v[156:159]
s_waitcnt vmcnt(9) lgkmcnt(0)
s_barrier
ds_read_b64_tr_b16 v[72:73], v14 offset:32768
ds_read_b64_tr_b16 v[74:75], v14 offset:33792
v_mfma_f32_16x16x32_bf16 v[160:163], v[80:83], v[48:51], v[160:163]
ds_read_b64_tr_b16 v[76:77], v15 offset:32768
v_mfma_f32_16x16x32_bf16 v[168:171], v[80:83], v[52:55], v[168:171]
ds_read_b64_tr_b16 v[78:79], v15 offset:33792
s_add_u32 m0, s56, 16384
s_add_u32 s64, s53, 3407872
v_mfma_f32_16x16x32_bf16 v[176:179], v[80:83], v[56:59], v[176:179]
buffer_load_dwordx4 v6, s[36:39], s64 offen offset:0 lds
ds_read_b128 v[32:35], v12 offset:0
v_mfma_f32_16x16x32_bf16 v[184:187], v[80:83], v[60:63], v[184:187]
v_mfma_f32_16x16x32_bf16 v[164:167], v[84:87], v[48:51], v[164:167]
ds_read_b64_tr_b16 v[80:81], v16 offset:32768
v_mfma_f32_16x16x32_bf16 v[172:175], v[84:87], v[52:55], v[172:175]
ds_read_b64_tr_b16 v[82:83], v16 offset:33792
ds_read_b128 v[36:39], v12 offset:2048
v_mfma_f32_16x16x32_bf16 v[180:183], v[84:87], v[56:59], v[180:183]
v_mfma_f32_16x16x32_bf16 v[188:191], v[84:87], v[60:63], v[188:191]
v_mfma_f32_16x16x32_bf16 v[192:195], v[64:67], v[48:51], v[192:195]
ds_read_b64_tr_b16 v[84:85], v17 offset:32768
ds_read_b128 v[40:43], v12 offset:4096
v_mfma_f32_16x16x32_bf16 v[200:203], v[64:67], v[52:55], v[200:203]
ds_read_b64_tr_b16 v[86:87], v17 offset:33792
v_mfma_f32_16x16x32_bf16 v[208:211], v[64:67], v[56:59], v[208:211]
buffer_load_dwordx4 v7, s[36:39], s64 offen offset:1024 lds
v_mfma_f32_16x16x32_bf16 v[216:219], v[64:67], v[60:63], v[216:219]
ds_read_b128 v[44:47], v12 offset:6144
v_mfma_f32_16x16x32_bf16 v[196:199], v[68:71], v[48:51], v[196:199]
ds_read_b64_tr_b16 v[64:65], v18 offset:32768
v_mfma_f32_16x16x32_bf16 v[204:207], v[68:71], v[52:55], v[204:207]
ds_read_b64_tr_b16 v[66:67], v18 offset:33792
v_mfma_f32_16x16x32_bf16 v[212:215], v[68:71], v[56:59], v[212:215]
v_mfma_f32_16x16x32_bf16 v[220:223], v[68:71], v[60:63], v[220:223]
s_waitcnt lgkmcnt(9)
v_mfma_f32_16x16x32_bf16 v[96:99], v[72:75], v[32:35], v[96:99]
ds_read_b64_tr_b16 v[68:69], v19 offset:32768
s_waitcnt lgkmcnt(7)
v_mfma_f32_16x16x32_bf16 v[104:107], v[72:75], v[36:39], v[104:107]
ds_read_b64_tr_b16 v[70:71], v19 offset:33792
s_add_u32 m0, s55, 32768
s_add_u32 s66, s52, 896
s_waitcnt lgkmcnt(6)
v_mfma_f32_16x16x32_bf16 v[112:115], v[72:75], v[40:43], v[112:115]
buffer_load_dwordx4 v2, s[32:35], s66 offen offset:0 lds
s_waitcnt lgkmcnt(4)
v_mfma_f32_16x16x32_bf16 v[120:123], v[72:75], v[44:47], v[120:123]
v_mfma_f32_16x16x32_bf16 v[100:103], v[76:79], v[32:35], v[100:103]
ds_read_b64_tr_b16 v[72:73], v20 offset:32768
v_mfma_f32_16x16x32_bf16 v[108:111], v[76:79], v[36:39], v[108:111]
ds_read_b64_tr_b16 v[74:75], v20 offset:33792
v_mfma_f32_16x16x32_bf16 v[116:119], v[76:79], v[40:43], v[116:119]
v_mfma_f32_16x16x32_bf16 v[124:127], v[76:79], v[44:47], v[124:127]
v_mfma_f32_16x16x32_bf16 v[128:131], v[80:83], v[32:35], v[128:131]
ds_read_b64_tr_b16 v[76:77], v21 offset:32768
v_mfma_f32_16x16x32_bf16 v[136:139], v[80:83], v[36:39], v[136:139]
ds_read_b64_tr_b16 v[78:79], v21 offset:33792
v_mfma_f32_16x16x32_bf16 v[144:147], v[80:83], v[40:43], v[144:147]
buffer_load_dwordx4 v3, s[32:35], s66 offen offset:1024 lds
v_mfma_f32_16x16x32_bf16 v[152:155], v[80:83], v[44:47], v[152:155]
v_mfma_f32_16x16x32_bf16 v[132:135], v[84:87], v[32:35], v[132:135]
v_mfma_f32_16x16x32_bf16 v[140:143], v[84:87], v[36:39], v[140:143]
v_mfma_f32_16x16x32_bf16 v[148:151], v[84:87], v[40:43], v[148:151]
v_mfma_f32_16x16x32_bf16 v[156:159], v[84:87], v[44:47], v[156:159]
s_waitcnt vmcnt(10) lgkmcnt(0)
s_barrier
ds_read_b64_tr_b16 v[80:81], v14 offset:49152
ds_read_b64_tr_b16 v[82:83], v14 offset:50176
v_mfma_f32_16x16x32_bf16 v[160:163], v[64:67], v[32:35], v[160:163]
ds_read_b64_tr_b16 v[84:85], v15 offset:49152
v_mfma_f32_16x16x32_bf16 v[168:171], v[64:67], v[36:39], v[168:171]
ds_read_b64_tr_b16 v[86:87], v15 offset:50176
s_add_u32 m0, s56, 32768
s_add_u32 s64, s53, 3670016
v_mfma_f32_16x16x32_bf16 v[176:179], v[64:67], v[40:43], v[176:179]
buffer_load_dwordx4 v6, s[36:39], s64 offen offset:0 lds
ds_read_b128 v[48:51], v13 offset:0
v_mfma_f32_16x16x32_bf16 v[184:187], v[64:67], v[44:47], v[184:187]
v_mfma_f32_16x16x32_bf16 v[164:167], v[68:71], v[32:35], v[164:167]
ds_read_b64_tr_b16 v[64:65], v16 offset:49152
v_mfma_f32_16x16x32_bf16 v[172:175], v[68:71], v[36:39], v[172:175]
ds_read_b64_tr_b16 v[66:67], v16 offset:50176
ds_read_b128 v[52:55], v13 offset:2048
v_mfma_f32_16x16x32_bf16 v[180:183], v[68:71], v[40:43], v[180:183]
v_mfma_f32_16x16x32_bf16 v[188:191], v[68:71], v[44:47], v[188:191]
v_mfma_f32_16x16x32_bf16 v[192:195], v[72:75], v[32:35], v[192:195]
ds_read_b64_tr_b16 v[68:69], v17 offset:49152
ds_read_b128 v[56:59], v13 offset:4096
v_mfma_f32_16x16x32_bf16 v[200:203], v[72:75], v[36:39], v[200:203]
ds_read_b64_tr_b16 v[70:71], v17 offset:50176
v_mfma_f32_16x16x32_bf16 v[208:211], v[72:75], v[40:43], v[208:211]
buffer_load_dwordx4 v7, s[36:39], s64 offen offset:1024 lds
v_mfma_f32_16x16x32_bf16 v[216:219], v[72:75], v[44:47], v[216:219]
ds_read_b128 v[60:63], v13 offset:6144
v_mfma_f32_16x16x32_bf16 v[196:199], v[76:79], v[32:35], v[196:199]
ds_read_b64_tr_b16 v[72:73], v18 offset:49152
v_mfma_f32_16x16x32_bf16 v[204:207], v[76:79], v[36:39], v[204:207]
ds_read_b64_tr_b16 v[74:75], v18 offset:50176
v_mfma_f32_16x16x32_bf16 v[212:215], v[76:79], v[40:43], v[212:215]
v_mfma_f32_16x16x32_bf16 v[220:223], v[76:79], v[44:47], v[220:223]
s_waitcnt lgkmcnt(9)
v_mfma_f32_16x16x32_bf16 v[96:99], v[80:83], v[48:51], v[96:99]
ds_read_b64_tr_b16 v[76:77], v19 offset:49152
s_waitcnt lgkmcnt(7)
v_mfma_f32_16x16x32_bf16 v[104:107], v[80:83], v[52:55], v[104:107]
ds_read_b64_tr_b16 v[78:79], v19 offset:50176
s_add_u32 m0, s55, 32768
s_add_u32 s66, s52, 896
s_waitcnt lgkmcnt(6)
v_mfma_f32_16x16x32_bf16 v[112:115], v[80:83], v[56:59], v[112:115]
buffer_load_dwordx4 v4, s[32:35], s66 offen offset:2048 lds
s_waitcnt lgkmcnt(4)
v_mfma_f32_16x16x32_bf16 v[120:123], v[80:83], v[60:63], v[120:123]
v_mfma_f32_16x16x32_bf16 v[100:103], v[84:87], v[48:51], v[100:103]
ds_read_b64_tr_b16 v[80:81], v20 offset:49152
v_mfma_f32_16x16x32_bf16 v[108:111], v[84:87], v[52:55], v[108:111]
ds_read_b64_tr_b16 v[82:83], v20 offset:50176
v_mfma_f32_16x16x32_bf16 v[116:119], v[84:87], v[56:59], v[116:119]
v_mfma_f32_16x16x32_bf16 v[124:127], v[84:87], v[60:63], v[124:127]
v_mfma_f32_16x16x32_bf16 v[128:131], v[64:67], v[48:51], v[128:131]
ds_read_b64_tr_b16 v[84:85], v21 offset:49152
v_mfma_f32_16x16x32_bf16 v[136:139], v[64:67], v[52:55], v[136:139]
ds_read_b64_tr_b16 v[86:87], v21 offset:50176
v_mfma_f32_16x16x32_bf16 v[144:147], v[64:67], v[56:59], v[144:147]
buffer_load_dwordx4 v5, s[32:35], s66 offen offset:3072 lds
v_mfma_f32_16x16x32_bf16 v[152:155], v[64:67], v[60:63], v[152:155]
v_mfma_f32_16x16x32_bf16 v[132:135], v[68:71], v[48:51], v[132:135]
v_mfma_f32_16x16x32_bf16 v[140:143], v[68:71], v[52:55], v[140:143]
v_mfma_f32_16x16x32_bf16 v[148:151], v[68:71], v[56:59], v[148:151]
v_mfma_f32_16x16x32_bf16 v[156:159], v[68:71], v[60:63], v[156:159]
s_waitcnt vmcnt(8) lgkmcnt(0)
s_barrier
ds_read_b64_tr_b16 v[64:65], v14 offset:0
ds_read_b64_tr_b16 v[66:67], v14 offset:1024
v_mfma_f32_16x16x32_bf16 v[160:163], v[72:75], v[48:51], v[160:163]
ds_read_b64_tr_b16 v[68:69], v15 offset:0
v_mov_b32 v232, 0
v_mfma_f32_16x16x32_bf16 v[168:171], v[72:75], v[52:55], v[168:171]
ds_read_b64_tr_b16 v[70:71], v15 offset:1024
v_lshlrev_b32 v233, 16, v224
v_lshlrev_b32 v234, 16, v228
s_add_u32 m0, s56, 49152
s_add_u32 s64, s53, 3932160
v_mfma_f32_16x16x32_bf16 v[176:179], v[72:75], v[56:59], v[176:179]
v_fmac_f32 v232, v233, v234
v_and_b32 v233, 0xffff0000, v224
buffer_load_dwordx4 v6, s[36:39], s64 offen offset:0 lds
ds_read_b128 v[32:35], v10 offset:0
v_mfma_f32_16x16x32_bf16 v[184:187], v[72:75], v[60:63], v[184:187]
v_and_b32 v234, 0xffff0000, v228
v_fmac_f32 v232, v233, v234
v_mfma_f32_16x16x32_bf16 v[164:167], v[76:79], v[48:51], v[164:167]
ds_read_b64_tr_b16 v[72:73], v16 offset:0
v_lshlrev_b32 v233, 16, v225
v_lshlrev_b32 v234, 16, v229
v_mfma_f32_16x16x32_bf16 v[172:175], v[76:79], v[52:55], v[172:175]
ds_read_b64_tr_b16 v[74:75], v16 offset:1024
v_fmac_f32 v232, v233, v234
v_and_b32 v233, 0xffff0000, v225
ds_read_b128 v[36:39], v10 offset:2048
v_mfma_f32_16x16x32_bf16 v[180:183], v[76:79], v[56:59], v[180:183]
v_and_b32 v234, 0xffff0000, v229
v_fmac_f32 v232, v233, v234
v_mfma_f32_16x16x32_bf16 v[188:191], v[76:79], v[60:63], v[188:191]
v_lshlrev_b32 v233, 16, v226
v_lshlrev_b32 v234, 16, v230
v_mfma_f32_16x16x32_bf16 v[192:195], v[80:83], v[48:51], v[192:195]
ds_read_b64_tr_b16 v[76:77], v17 offset:0
v_fmac_f32 v232, v233, v234
v_and_b32 v233, 0xffff0000, v226
ds_read_b128 v[40:43], v10 offset:4096
v_mfma_f32_16x16x32_bf16 v[200:203], v[80:83], v[52:55], v[200:203]
ds_read_b64_tr_b16 v[78:79], v17 offset:1024
v_and_b32 v234, 0xffff0000, v230
v_fmac_f32 v232, v233, v234
v_mfma_f32_16x16x32_bf16 v[208:211], v[80:83], v[56:59], v[208:211]
v_lshlrev_b32 v233, 16, v227
v_lshlrev_b32 v234, 16, v231
buffer_load_dwordx4 v7, s[36:39], s64 offen offset:1024 lds
v_mfma_f32_16x16x32_bf16 v[216:219], v[80:83], v[60:63], v[216:219]
v_fmac_f32 v232, v233, v234
v_and_b32 v233, 0xffff0000, v227
ds_read_b128 v[44:47], v10 offset:6144
v_mfma_f32_16x16x32_bf16 v[196:199], v[84:87], v[48:51], v[196:199]
ds_read_b64_tr_b16 v[80:81], v18 offset:0
v_and_b32 v234, 0xffff0000, v231
v_fmac_f32 v232, v233, v234
v_mfma_f32_16x16x32_bf16 v[204:207], v[84:87], v[52:55], v[204:207]
ds_read_b64_tr_b16 v[82:83], v18 offset:1024
v_add_f32_dpp v232, v232, v232 row_shr:1 row_mask:0xf bank_mask:0xf bound_ctrl:0
v_mfma_f32_16x16x32_bf16 v[212:215], v[84:87], v[56:59], v[212:215]
s_nop 0
v_add_f32_dpp v232, v232, v232 row_shr:2 row_mask:0xf bank_mask:0xf bound_ctrl:0
v_mfma_f32_16x16x32_bf16 v[220:223], v[84:87], v[60:63], v[220:223]
s_nop 0
v_add_f32_dpp v232, v232, v232 row_shr:4 row_mask:0xf bank_mask:0xf bound_ctrl:0
s_waitcnt lgkmcnt(9)
v_mfma_f32_16x16x32_bf16 v[96:99], v[64:67], v[32:35], v[96:99]
ds_read_b64_tr_b16 v[84:85], v19 offset:0
v_add_f32_dpp v232, v232, v232 row_shr:8 row_mask:0xf bank_mask:0xf bound_ctrl:0
s_waitcnt lgkmcnt(7)
v_mfma_f32_16x16x32_bf16 v[104:107], v[64:67], v[36:39], v[104:107]
ds_read_b64_tr_b16 v[86:87], v19 offset:1024
v_add_f32_dpp v232, v232, v232 row_bcast:15 row_mask:0xa bank_mask:0xf
s_add_u32 m0, s55, 65536
s_add_u32 s66, s25, 0
s_waitcnt lgkmcnt(6)
v_mfma_f32_16x16x32_bf16 v[112:115], v[64:67], v[40:43], v[112:115]
v_add_f32_dpp v232, v232, v232 row_bcast:31 row_mask:0xc bank_mask:0xf
buffer_load_dwordx4 v2, s[28:31], s66 offen offset:0 lds
s_waitcnt lgkmcnt(4)
v_mfma_f32_16x16x32_bf16 v[120:123], v[64:67], v[44:47], v[120:123]
v_mul_f32 v232, 0xbfb8aa3b, v232
v_mfma_f32_16x16x32_bf16 v[100:103], v[68:71], v[32:35], v[100:103]
ds_read_b64_tr_b16 v[64:65], v20 offset:0
v_exp_f32 v232, v232
v_mfma_f32_16x16x32_bf16 v[108:111], v[68:71], v[36:39], v[108:111]
ds_read_b64_tr_b16 v[66:67], v20 offset:1024
v_add_f32 v232, 1.0, v232
v_mfma_f32_16x16x32_bf16 v[116:119], v[68:71], v[40:43], v[116:119]
v_rcp_f32 v232, v232
v_mfma_f32_16x16x32_bf16 v[124:127], v[68:71], v[44:47], v[124:127]
s_lshl_b32 s58, s58, 2
s_add_u32 s58, s58, 74448896
v_mfma_f32_16x16x32_bf16 v[128:131], v[72:75], v[32:35], v[128:131]
ds_read_b64_tr_b16 v[68:69], v21 offset:0
v_readlane_b32 s59, v232, 63
v_mfma_f32_16x16x32_bf16 v[136:139], v[72:75], v[36:39], v[136:139]
ds_read_b64_tr_b16 v[70:71], v21 offset:1024
v_mov_b32 v234, 0
v_mfma_f32_16x16x32_bf16 v[144:147], v[72:75], v[40:43], v[144:147]
v_mov_b32 v233, s59
buffer_load_dwordx4 v3, s[28:31], s66 offen offset:1024 lds
v_mfma_f32_16x16x32_bf16 v[152:155], v[72:75], v[44:47], v[152:155]
buffer_store_dword v233, v234, s[44:47], s58 offen sc1
v_mfma_f32_16x16x32_bf16 v[132:135], v[76:79], v[32:35], v[132:135]
v_mfma_f32_16x16x32_bf16 v[140:143], v[76:79], v[36:39], v[140:143]
v_mfma_f32_16x16x32_bf16 v[148:151], v[76:79], v[40:43], v[148:151]
s_cmp_lg_u32 s22, 0
s_cbranch_scc1 L_kk_kernel_c0_sk17
v_and_b32 v92, 31, v0
v_min_u32 v92, 19, v92
v_lshl_add_u32 v92, v92, 7, s98
v_min_u32 v92, L_code_end-L_pc_kk_kernel-4, v92
v_mov_b32 v93, s97
v_add_co_u32 v92, vcc, s96, v92
s_nop 1
v_addc_co_u32 v93, vcc, 0, v93, vcc
global_load_dword v94, v[92:93], off
L_kk_kernel_c0_sk17:
v_mfma_f32_16x16x32_bf16 v[156:159], v[76:79], v[44:47], v[156:159]
s_waitcnt vmcnt(11) lgkmcnt(0)
s_barrier
ds_read_b64_tr_b16 v[72:73], v14 offset:16384
ds_read_b64_tr_b16 v[74:75], v14 offset:17408
v_mfma_f32_16x16x32_bf16 v[160:163], v[80:83], v[32:35], v[160:163]
ds_read_b64_tr_b16 v[76:77], v15 offset:16384
v_mfma_f32_16x16x32_bf16 v[168:171], v[80:83], v[36:39], v[168:171]
ds_read_b64_tr_b16 v[78:79], v15 offset:17408
s_add_u32 m0, s56, 0
s_add_u32 s64, s53, 0
v_mfma_f32_16x16x32_bf16 v[176:179], v[80:83], v[40:43], v[176:179]
buffer_load_dwordx4 v6, s[40:43], s64 offen offset:0 lds
ds_read_b128 v[48:51], v11 offset:0
v_mfma_f32_16x16x32_bf16 v[184:187], v[80:83], v[44:47], v[184:187]
v_mfma_f32_16x16x32_bf16 v[164:167], v[84:87], v[32:35], v[164:167]
ds_read_b64_tr_b16 v[80:81], v16 offset:16384
v_mfma_f32_16x16x32_bf16 v[172:175], v[84:87], v[36:39], v[172:175]
ds_read_b64_tr_b16 v[82:83], v16 offset:17408
ds_read_b128 v[52:55], v11 offset:2048
v_mfma_f32_16x16x32_bf16 v[180:183], v[84:87], v[40:43], v[180:183]
v_mfma_f32_16x16x32_bf16 v[188:191], v[84:87], v[44:47], v[188:191]
v_mfma_f32_16x16x32_bf16 v[192:195], v[64:67], v[32:35], v[192:195]
ds_read_b64_tr_b16 v[84:85], v17 offset:16384
ds_read_b128 v[56:59], v11 offset:4096
v_mfma_f32_16x16x32_bf16 v[200:203], v[64:67], v[36:39], v[200:203]
ds_read_b64_tr_b16 v[86:87], v17 offset:17408
v_mfma_f32_16x16x32_bf16 v[208:211], v[64:67], v[40:43], v[208:211]
buffer_load_dwordx4 v7, s[40:43], s64 offen offset:1024 lds
v_mfma_f32_16x16x32_bf16 v[216:219], v[64:67], v[44:47], v[216:219]
ds_read_b128 v[60:63], v11 offset:6144
v_mfma_f32_16x16x32_bf16 v[196:199], v[68:71], v[32:35], v[196:199]
ds_read_b64_tr_b16 v[64:65], v18 offset:16384
v_mfma_f32_16x16x32_bf16 v[204:207], v[68:71], v[36:39], v[204:207]
ds_read_b64_tr_b16 v[66:67], v18 offset:17408
v_mfma_f32_16x16x32_bf16 v[212:215], v[68:71], v[40:43], v[212:215]
v_mfma_f32_16x16x32_bf16 v[220:223], v[68:71], v[44:47], v[220:223]
s_waitcnt lgkmcnt(9)
v_mfma_f32_16x16x32_bf16 v[96:99], v[72:75], v[48:51], v[96:99]
ds_read_b64_tr_b16 v[68:69], v19 offset:16384
s_waitcnt lgkmcnt(7)
v_mfma_f32_16x16x32_bf16 v[104:107], v[72:75], v[52:55], v[104:107]
ds_read_b64_tr_b16 v[70:71], v19 offset:17408
s_add_u32 m0, s55, 65536
s_add_u32 s66, s25, 0
s_waitcnt lgkmcnt(6)
v_mfma_f32_16x16x32_bf16 v[112:115], v[72:75], v[56:59], v[112:115]
buffer_load_dwordx4 v4, s[28:31], s66 offen offset:2048 lds
s_waitcnt lgkmcnt(4)
v_mfma_f32_16x16x32_bf16 v[120:123], v[72:75], v[60:63], v[120:123]
v_mfma_f32_16x16x32_bf16 v[100:103], v[76:79], v[48:51], v[100:103]
ds_read_b64_tr_b16 v[72:73], v20 offset:16384
v_mfma_f32_16x16x32_bf16 v[108:111], v[76:79], v[52:55], v[108:111]
ds_read_b64_tr_b16 v[74:75], v20 offset:17408
v_mfma_f32_16x16x32_bf16 v[116:119], v[76:79], v[56:59], v[116:119]
v_mfma_f32_16x16x32_bf16 v[124:127], v[76:79], v[60:63], v[124:127]
v_mfma_f32_16x16x32_bf16 v[128:131], v[80:83], v[48:51], v[128:131]
ds_read_b64_tr_b16 v[76:77], v21 offset:16384
v_mfma_f32_16x16x32_bf16 v[136:139], v[80:83], v[52:55], v[136:139]
ds_read_b64_tr_b16 v[78:79], v21 offset:17408
v_mfma_f32_16x16x32_bf16 v[144:147], v[80:83], v[56:59], v[144:147]
buffer_load_dwordx4 v5, s[28:31], s66 offen offset:3072 lds
v_mfma_f32_16x16x32_bf16 v[152:155], v[80:83], v[60:63], v[152:155]
v_mfma_f32_16x16x32_bf16 v[132:135], v[84:87], v[48:51], v[132:135]
v_mfma_f32_16x16x32_bf16 v[140:143], v[84:87], v[52:55], v[140:143]
v_mfma_f32_16x16x32_bf16 v[148:151], v[84:87], v[56:59], v[148:151]
v_mfma_f32_16x16x32_bf16 v[156:159], v[84:87], v[60:63], v[156:159]
s_waitcnt vmcnt(9) lgkmcnt(0)
s_barrier
ds_read_b64_tr_b16 v[80:81], v14 offset:32768
ds_read_b64_tr_b16 v[82:83], v14 offset:33792
v_mfma_f32_16x16x32_bf16 v[160:163], v[64:67], v[48:51], v[160:163]
ds_read_b64_tr_b16 v[84:85], v15 offset:32768
v_mfma_f32_16x16x32_bf16 v[168:171], v[64:67], v[52:55], v[168:171]
ds_read_b64_tr_b16 v[86:87], v15 offset:33792
s_add_u32 m0, s56, 16384
s_add_u32 s64, s53, 262144
v_mfma_f32_16x16x32_bf16 v[176:179], v[64:67], v[56:59], v[176:179]
buffer_load_dwordx4 v6, s[40:43], s64 offen offset:0 lds
ds_read_b128 v[32:35], v10 offset:32768
v_mfma_f32_16x16x32_bf16 v[184:187], v[64:67], v[60:63], v[184:187]
v_mfma_f32_16x16x32_bf16 v[164:167], v[68:71], v[48:51], v[164:167]
ds_read_b64_tr_b16 v[64:65], v16 offset:32768
v_mfma_f32_16x16x32_bf16 v[172:175], v[68:71], v[52:55], v[172:175]
ds_read_b64_tr_b16 v[66:67], v16 offset:33792
ds_read_b128 v[36:39], v10 offset:34816
v_mfma_f32_16x16x32_bf16 v[180:183], v[68:71], v[56:59], v[180:183]
v_mfma_f32_16x16x32_bf16 v[188:191], v[68:71], v[60:63], v[188:191]
v_mfma_f32_16x16x32_bf16 v[192:195], v[72:75], v[48:51], v[192:195]
ds_read_b64_tr_b16 v[68:69], v17 offset:32768
ds_read_b128 v[40:43], v10 offset:36864
v_mfma_f32_16x16x32_bf16 v[200:203], v[72:75], v[52:55], v[200:203]
ds_read_b64_tr_b16 v[70:71], v17 offset:33792
v_mfma_f32_16x16x32_bf16 v[208:211], v[72:75], v[56:59], v[208:211]
buffer_load_dwordx4 v7, s[40:43], s64 offen offset:1024 lds
v_mfma_f32_16x16x32_bf16 v[216:219], v[72:75], v[60:63], v[216:219]
ds_read_b128 v[44:47], v10 offset:38912
v_mfma_f32_16x16x32_bf16 v[196:199], v[76:79], v[48:51], v[196:199]
ds_read_b64_tr_b16 v[72:73], v18 offset:32768
v_mfma_f32_16x16x32_bf16 v[204:207], v[76:79], v[52:55], v[204:207]
ds_read_b64_tr_b16 v[74:75], v18 offset:33792
v_mfma_f32_16x16x32_bf16 v[212:215], v[76:79], v[56:59], v[212:215]
v_mfma_f32_16x16x32_bf16 v[220:223], v[76:79], v[60:63], v[220:223]
s_waitcnt lgkmcnt(9)
v_mfma_f32_16x16x32_bf16 v[96:99], v[80:83], v[32:35], v[96:99]
ds_read_b64_tr_b16 v[76:77], v19 offset:32768
s_waitcnt lgkmcnt(7)
v_mfma_f32_16x16x32_bf16 v[104:107], v[80:83], v[36:39], v[104:107]
ds_read_b64_tr_b16 v[78:79], v19 offset:33792
s_add_u32 m0, s55, 0
s_add_u32 s66, s25, 128
s_waitcnt lgkmcnt(6)
v_mfma_f32_16x16x32_bf16 v[112:115], v[80:83], v[40:43], v[112:115]
buffer_load_dwordx4 v2, s[28:31], s66 offen offset:0 lds
s_waitcnt lgkmcnt(4)
v_mfma_f32_16x16x32_bf16 v[120:123], v[80:83], v[44:47], v[120:123]
v_mfma_f32_16x16x32_bf16 v[100:103], v[84:87], v[32:35], v[100:103]
ds_read_b64_tr_b16 v[80:81], v20 offset:32768
v_mfma_f32_16x16x32_bf16 v[108:111], v[84:87], v[36:39], v[108:111]
ds_read_b64_tr_b16 v[82:83], v20 offset:33792
v_mfma_f32_16x16x32_bf16 v[116:119], v[84:87], v[40:43], v[116:119]
v_mfma_f32_16x16x32_bf16 v[124:127], v[84:87], v[44:47], v[124:127]
v_mfma_f32_16x16x32_bf16 v[128:131], v[64:67], v[32:35], v[128:131]
ds_read_b64_tr_b16 v[84:85], v21 offset:32768
v_mfma_f32_16x16x32_bf16 v[136:139], v[64:67], v[36:39], v[136:139]
ds_read_b64_tr_b16 v[86:87], v21 offset:33792
v_mfma_f32_16x16x32_bf16 v[144:147], v[64:67], v[40:43], v[144:147]
buffer_load_dwordx4 v3, s[28:31], s66 offen offset:1024 lds
v_mfma_f32_16x16x32_bf16 v[152:155], v[64:67], v[44:47], v[152:155]
v_mfma_f32_16x16x32_bf16 v[132:135], v[68:71], v[32:35], v[132:135]
v_mfma_f32_16x16x32_bf16 v[140:143], v[68:71], v[36:39], v[140:143]
v_mfma_f32_16x16x32_bf16 v[148:151], v[68:71], v[40:43], v[148:151]
v_mfma_f32_16x16x32_bf16 v[156:159], v[68:71], v[44:47], v[156:159]
s_waitcnt vmcnt(11) lgkmcnt(0)
s_barrier
ds_read_b64_tr_b16 v[64:65], v14 offset:49152
ds_read_b64_tr_b16 v[66:67], v14 offset:50176
v_mfma_f32_16x16x32_bf16 v[160:163], v[72:75], v[32:35], v[160:163]
ds_read_b64_tr_b16 v[68:69], v15 offset:49152
v_mfma_f32_16x16x32_bf16 v[168:171], v[72:75], v[36:39], v[168:171]
ds_read_b64_tr_b16 v[70:71], v15 offset:50176
s_add_u32 m0, s56, 32768
s_add_u32 s64, s53, 524288
v_mfma_f32_16x16x32_bf16 v[176:179], v[72:75], v[40:43], v[176:179]
buffer_load_dwordx4 v6, s[40:43], s64 offen offset:0 lds
ds_read_b128 v[48:51], v11 offset:32768
v_mfma_f32_16x16x32_bf16 v[184:187], v[72:75], v[44:47], v[184:187]
v_mfma_f32_16x16x32_bf16 v[164:167], v[76:79], v[32:35], v[164:167]
ds_read_b64_tr_b16 v[72:73], v16 offset:49152
v_mfma_f32_16x16x32_bf16 v[172:175], v[76:79], v[36:39], v[172:175]
ds_read_b64_tr_b16 v[74:75], v16 offset:50176
ds_read_b128 v[52:55], v11 offset:34816
v_mfma_f32_16x16x32_bf16 v[180:183], v[76:79], v[40:43], v[180:183]
v_mfma_f32_16x16x32_bf16 v[188:191], v[76:79], v[44:47], v[188:191]
v_mfma_f32_16x16x32_bf16 v[192:195], v[80:83], v[32:35], v[192:195]
ds_read_b64_tr_b16 v[76:77], v17 offset:49152
ds_read_b128 v[56:59], v11 offset:36864
v_mfma_f32_16x16x32_bf16 v[200:203], v[80:83], v[36:39], v[200:203]
ds_read_b64_tr_b16 v[78:79], v17 offset:50176
v_mfma_f32_16x16x32_bf16 v[208:211], v[80:83], v[40:43], v[208:211]
buffer_load_dwordx4 v7, s[40:43], s64 offen offset:1024 lds
v_mfma_f32_16x16x32_bf16 v[216:219], v[80:83], v[44:47], v[216:219]
ds_read_b128 v[60:63], v11 offset:38912
v_mfma_f32_16x16x32_bf16 v[196:199], v[84:87], v[32:35], v[196:199]
ds_read_b64_tr_b16 v[80:81], v18 offset:49152
v_mfma_f32_16x16x32_bf16 v[204:207], v[84:87], v[36:39], v[204:207]
ds_read_b64_tr_b16 v[82:83], v18 offset:50176
v_mfma_f32_16x16x32_bf16 v[212:215], v[84:87], v[40:43], v[212:215]
v_mfma_f32_16x16x32_bf16 v[220:223], v[84:87], v[44:47], v[220:223]
s_waitcnt lgkmcnt(9)
v_mfma_f32_16x16x32_bf16 v[96:99], v[64:67], v[48:51], v[96:99]
ds_read_b64_tr_b16 v[84:85], v19 offset:49152
s_waitcnt lgkmcnt(7)
v_mfma_f32_16x16x32_bf16 v[104:107], v[64:67], v[52:55], v[104:107]
ds_read_b64_tr_b16 v[86:87], v19 offset:50176
s_add_u32 m0, s55, 0
s_add_u32 s66, s25, 128
s_waitcnt lgkmcnt(6)
v_mfma_f32_16x16x32_bf16 v[112:115], v[64:67], v[56:59], v[112:115]
buffer_load_dwordx4 v4, s[28:31], s66 offen offset:2048 lds
s_waitcnt lgkmcnt(4)
v_mfma_f32_16x16x32_bf16 v[120:123], v[64:67], v[60:63], v[120:123]
v_mfma_f32_16x16x32_bf16 v[100:103], v[68:71], v[48:51], v[100:103]
ds_read_b64_tr_b16 v[64:65], v20 offset:49152
v_mfma_f32_16x16x32_bf16 v[108:111], v[68:71], v[52:55], v[108:111]
ds_read_b64_tr_b16 v[66:67], v20 offset:50176
v_mfma_f32_16x16x32_bf16 v[116:119], v[68:71], v[56:59], v[116:119]
v_mfma_f32_16x16x32_bf16 v[124:127], v[68:71], v[60:63], v[124:127]
v_mfma_f32_16x16x32_bf16 v[128:131], v[72:75], v[48:51], v[128:131]
ds_read_b64_tr_b16 v[68:69], v21 offset:49152
v_mfma_f32_16x16x32_bf16 v[136:139], v[72:75], v[52:55], v[136:139]
ds_read_b64_tr_b16 v[70:71], v21 offset:50176
v_mfma_f32_16x16x32_bf16 v[144:147], v[72:75], v[56:59], v[144:147]
buffer_load_dwordx4 v5, s[28:31], s66 offen offset:3072 lds
v_mfma_f32_16x16x32_bf16 v[152:155], v[72:75], v[60:63], v[152:155]
v_mfma_f32_16x16x32_bf16 v[132:135], v[76:79], v[48:51], v[132:135]
v_cvt_pk_bf16_f32 v96, v96, v97
v_cvt_pk_bf16_f32 v97, v98, v99
v_cvt_pk_bf16_f32 v98, v100, v101
v_mfma_f32_16x16x32_bf16 v[140:143], v[76:79], v[52:55], v[140:143]
v_cvt_pk_bf16_f32 v99, v102, v103
v_cvt_pk_bf16_f32 v100, v104, v105
v_cvt_pk_bf16_f32 v101, v106, v107
v_mfma_f32_16x16x32_bf16 v[148:151], v[76:79], v[56:59], v[148:151]
v_cvt_pk_bf16_f32 v102, v108, v109
v_cvt_pk_bf16_f32 v103, v110, v111
v_cvt_pk_bf16_f32 v104, v112, v113
v_mfma_f32_16x16x32_bf16 v[156:159], v[76:79], v[60:63], v[156:159]
v_cvt_pk_bf16_f32 v105, v114, v115
v_cvt_pk_bf16_f32 v106, v116, v117
v_cvt_pk_bf16_f32 v107, v118, v119
s_waitcnt vmcnt(8) lgkmcnt(0)
s_barrier
ds_read_b64_tr_b16 v[72:73], v18 offset:0
ds_read_b64_tr_b16 v[74:75], v18 offset:1024
v_mfma_f32_16x16x32_bf16 v[160:163], v[80:83], v[48:51], v[160:163]
ds_read_b64_tr_b16 v[76:77], v19 offset:0
s_add_u32 m0, s56, 49152
s_add_u32 s64, s53, 786432
v_cvt_pk_bf16_f32 v108, v120, v121
v_cvt_pk_bf16_f32 v109, v122, v123
v_cvt_pk_bf16_f32 v110, v124, v125
v_mfma_f32_16x16x32_bf16 v[168:171], v[80:83], v[52:55], v[168:171]
ds_read_b64_tr_b16 v[78:79], v19 offset:1024
buffer_load_dwordx4 v6, s[40:43], s64 offen offset:0 lds
v_cvt_pk_bf16_f32 v111, v126, v127
v_mfma_f32_16x16x32_bf16 v[176:179], v[80:83], v[56:59], v[176:179]
ds_read_b128 v[32:35], v12 offset:0
v_mfma_f32_16x16x32_bf16 v[184:187], v[80:83], v[60:63], v[184:187]
v_mfma_f32_16x16x32_bf16 v[164:167], v[84:87], v[48:51], v[164:167]
ds_read_b64_tr_b16 v[80:81], v14 offset:0
v_cvt_pk_bf16_f32 v112, v128, v129
v_cvt_pk_bf16_f32 v113, v130, v131
v_cvt_pk_bf16_f32 v114, v132, v133
v_mfma_f32_16x16x32_bf16 v[172:175], v[84:87], v[52:55], v[172:175]
ds_read_b64_tr_b16 v[82:83], v14 offset:1024
buffer_load_dwordx4 v7, s[40:43], s64 offen offset:1024 lds
ds_read_b128 v[36:39], v12 offset:2048
v_cvt_pk_bf16_f32 v115, v134, v135
v_cvt_pk_bf16_f32 v116, v136, v137
v_cvt_pk_bf16_f32 v117, v138, v139
v_mfma_f32_16x16x32_bf16 v[180:183], v[84:87], v[56:59], v[180:183]
v_cvt_pk_bf16_f32 v118, v140, v141
v_cvt_pk_bf16_f32 v119, v142, v143
v_cvt_pk_bf16_f32 v120, v144, v145
v_mfma_f32_16x16x32_bf16 v[188:191], v[84:87], v[60:63], v[188:191]
v_cvt_pk_bf16_f32 v121, v146, v147
v_cvt_pk_bf16_f32 v122, v148, v149
v_cvt_pk_bf16_f32 v123, v150, v151
v_mfma_f32_16x16x32_bf16 v[192:195], v[64:67], v[48:51], v[192:195]
ds_read_b64_tr_b16 v[84:85], v15 offset:0
s_add_u32 m0, s55, 32768
s_add_u32 s66, s25, 256
ds_read_b128 v[40:43], v12 offset:4096
v_cvt_pk_bf16_f32 v124, v152, v153
v_cvt_pk_bf16_f32 v125, v154, v155
v_cvt_pk_bf16_f32 v126, v156, v157
v_mfma_f32_16x16x32_bf16 v[200:203], v[64:67], v[52:55], v[200:203]
ds_read_b64_tr_b16 v[86:87], v15 offset:1024
buffer_load_dwordx4 v2, s[28:31], s66 offen offset:0 lds
v_cvt_pk_bf16_f32 v127, v158, v159
v_mfma_f32_16x16x32_bf16 v[208:211], v[64:67], v[56:59], v[208:211]
v_mfma_f32_16x16x32_bf16 v[216:219], v[64:67], v[60:63], v[216:219]
ds_read_b128 v[44:47], v12 offset:6144
v_mfma_f32_16x16x32_bf16 v[196:199], v[68:71], v[48:51], v[196:199]
ds_read_b64_tr_b16 v[64:65], v16 offset:0
v_cvt_pk_bf16_f32 v128, v160, v161
v_cvt_pk_bf16_f32 v129, v162, v163
v_cvt_pk_bf16_f32 v130, v164, v165
v_mfma_f32_16x16x32_bf16 v[204:207], v[68:71], v[52:55], v[204:207]
ds_read_b64_tr_b16 v[66:67], v16 offset:1024
buffer_load_dwordx4 v3, s[28:31], s66 offen offset:1024 lds
v_cvt_pk_bf16_f32 v131, v166, v167
v_cvt_pk_bf16_f32 v132, v168, v169
v_cvt_pk_bf16_f32 v133, v170, v171
v_mfma_f32_16x16x32_bf16 v[212:215], v[68:71], v[56:59], v[212:215]
v_cvt_pk_bf16_f32 v134, v172, v173
v_cvt_pk_bf16_f32 v135, v174, v175
v_cvt_pk_bf16_f32 v136, v176, v177
v_mfma_f32_16x16x32_bf16 v[220:223], v[68:71], v[60:63], v[220:223]
v_cvt_pk_bf16_f32 v137, v178, v179
v_cvt_pk_bf16_f32 v138, v180, v181
v_cvt_pk_bf16_f32 v139, v182, v183
s_waitcnt lgkmcnt(9)
v_mfma_f32_16x16x32_bf16 v[224:227], v[72:75], v[32:35], 0
ds_read_b64_tr_b16 v[68:69], v17 offset:0
v_cvt_pk_bf16_f32 v140, v184, v185
v_cvt_pk_bf16_f32 v141, v186, v187
v_cvt_pk_bf16_f32 v142, v188, v189
s_waitcnt lgkmcnt(7)
v_mfma_f32_16x16x32_bf16 v[232:235], v[72:75], v[36:39], 0
ds_read_b64_tr_b16 v[70:71], v17 offset:1024
buffer_store_dwordx4 v[96:99], v1, s[44:47], s60 offen offset:0 sc1
v_cvt_pk_bf16_f32 v143, v190, v191
v_cvt_pk_bf16_f32 v144, v192, v193
v_cvt_pk_bf16_f32 v145, v194, v195
s_waitcnt lgkmcnt(6)
v_mfma_f32_16x16x32_bf16 v[240:243], v[72:75], v[40:43], 0
v_cvt_pk_bf16_f32 v146, v196, v197
v_cvt_pk_bf16_f32 v147, v198, v199
v_cvt_pk_bf16_f32 v148, v200, v201
s_waitcnt lgkmcnt(4)
v_mfma_f32_16x16x32_bf16 v[248:251], v[72:75], v[44:47], 0
v_cvt_pk_bf16_f32 v149, v202, v203
v_cvt_pk_bf16_f32 v150, v204, v205
v_cvt_pk_bf16_f32 v151, v206, v207
v_mfma_f32_16x16x32_bf16 v[228:231], v[76:79], v[32:35], 0
v_cvt_pk_bf16_f32 v152, v208, v209
v_cvt_pk_bf16_f32 v153, v210, v211
v_cvt_pk_bf16_f32 v154, v212, v213
v_mfma_f32_16x16x32_bf16 v[236:239], v[76:79], v[36:39], 0
buffer_store_dwordx4 v[100:103], v1, s[44:47], s61 offen offset:0 sc1
v_cvt_pk_bf16_f32 v155, v214, v215
v_cvt_pk_bf16_f32 v156, v216, v217
v_cvt_pk_bf16_f32 v157, v218, v219
v_mfma_f32_16x16x32_bf16 v[244:247], v[76:79], v[40:43], 0
v_cvt_pk_bf16_f32 v158, v220, v221
v_cvt_pk_bf16_f32 v159, v222, v223
v_mfma_f32_16x16x32_bf16 v[252:255], v[76:79], v[44:47], 0
s_waitcnt vmcnt(12) lgkmcnt(0)
s_barrier
ds_read_b64_tr_b16 v[72:73], v18 offset:16384
ds_read_b64_tr_b16 v[74:75], v18 offset:17408
v_mfma_f32_16x16x32_bf16 v[160:163], v[80:83], v[32:35], 0
ds_read_b64_tr_b16 v[76:77], v19 offset:16384
s_add_u32 m0, s56, 0
s_add_u32 s64, s53, 1048576
v_mfma_f32_16x16x32_bf16 v[168:171], v[80:83], v[36:39], 0
ds_read_b64_tr_b16 v[78:79], v19 offset:17408
buffer_load_dwordx4 v6, s[40:43], s64 offen offset:0 lds
v_mfma_f32_16x16x32_bf16 v[176:179], v[80:83], v[40:43], 0
ds_read_b128 v[48:51], v13 offset:0
v_mfma_f32_16x16x32_bf16 v[184:187], v[80:83], v[44:47], 0
v_mfma_f32_16x16x32_bf16 v[164:167], v[84:87], v[32:35], 0
ds_read_b64_tr_b16 v[80:81], v14 offset:16384
v_mfma_f32_16x16x32_bf16 v[172:175], v[84:87], v[36:39], 0
ds_read_b64_tr_b16 v[82:83], v14 offset:17408
ds_read_b128 v[52:55], v13 offset:2048
v_mfma_f32_16x16x32_bf16 v[180:183], v[84:87], v[40:43], 0
buffer_load_dwordx4 v7, s[40:43], s64 offen offset:1024 lds
v_mfma_f32_16x16x32_bf16 v[188:191], v[84:87], v[44:47], 0
v_mfma_f32_16x16x32_bf16 v[192:195], v[64:67], v[32:35], 0
ds_read_b64_tr_b16 v[84:85], v15 offset:16384
ds_read_b128 v[56:59], v13 offset:4096
v_mfma_f32_16x16x32_bf16 v[200:203], v[64:67], v[36:39], 0
ds_read_b64_tr_b16 v[86:87], v15 offset:17408
s_add_u32 m0, s55, 32768
s_add_u32 s66, s25, 256
v_mfma_f32_16x16x32_bf16 v[208:211], v[64:67], v[40:43], 0
buffer_load_dwordx4 v4, s[28:31], s66 offen offset:2048 lds
v_mfma_f32_16x16x32_bf16 v[216:219], v[64:67], v[44:47], 0
ds_read_b128 v[60:63], v13 offset:6144
v_mfma_f32_16x16x32_bf16 v[196:199], v[68:71], v[32:35], 0
ds_read_b64_tr_b16 v[64:65], v16 offset:16384
v_mfma_f32_16x16x32_bf16 v[204:207], v[68:71], v[36:39], 0
ds_read_b64_tr_b16 v[66:67], v16 offset:17408
v_mfma_f32_16x16x32_bf16 v[212:215], v[68:71], v[40:43], 0
v_mfma_f32_16x16x32_bf16 v[220:223], v[68:71], v[44:47], 0
buffer_load_dwordx4 v5, s[28:31], s66 offen offset:3072 lds
s_waitcnt lgkmcnt(9)
v_mfma_f32_16x16x32_bf16 v[224:227], v[72:75], v[48:51], v[224:227]
ds_read_b64_tr_b16 v[68:69], v17 offset:16384
s_waitcnt lgkmcnt(7)
v_mfma_f32_16x16x32_bf16 v[232:235], v[72:75], v[52:55], v[232:235]
ds_read_b64_tr_b16 v[70:71], v17 offset:17408
s_waitcnt lgkmcnt(6)
v_mfma_f32_16x16x32_bf16 v[240:243], v[72:75], v[56:59], v[240:243]
s_waitcnt lgkmcnt(4)
v_mfma_f32_16x16x32_bf16 v[248:251], v[72:75], v[60:63], v[248:251]
v_mfma_f32_16x16x32_bf16 v[228:231], v[76:79], v[48:51], v[228:231]
buffer_store_dwordx4 v[104:107], v1, s[44:47], s62 offen offset:0 sc1
v_mfma_f32_16x16x32_bf16 v[236:239], v[76:79], v[52:55], v[236:239]
v_mfma_f32_16x16x32_bf16 v[244:247], v[76:79], v[56:59], v[244:247]
v_mfma_f32_16x16x32_bf16 v[252:255], v[76:79], v[60:63], v[252:255]
s_waitcnt vmcnt(11) lgkmcnt(0)
s_barrier
ds_read_b64_tr_b16 v[72:73], v18 offset:32768
ds_read_b64_tr_b16 v[74:75], v18 offset:33792
v_mfma_f32_16x16x32_bf16 v[160:163], v[80:83], v[48:51], v[160:163]
ds_read_b64_tr_b16 v[76:77], v19 offset:32768
s_add_u32 m0, s56, 16384
s_add_u32 s64, s53, 1310720
v_mfma_f32_16x16x32_bf16 v[168:171], v[80:83], v[52:55], v[168:171]
ds_read_b64_tr_b16 v[78:79], v19 offset:33792
buffer_load_dwordx4 v6, s[40:43], s64 offen offset:0 lds
v_mfma_f32_16x16x32_bf16 v[176:179], v[80:83], v[56:59], v[176:179]
ds_read_b128 v[32:35], v10 offset:0
v_mfma_f32_16x16x32_bf16 v[184:187], v[80:83], v[60:63], v[184:187]
v_mfma_f32_16x16x32_bf16 v[164:167], v[84:87], v[48:51], v[164:167]
ds_read_b64_tr_b16 v[80:81], v14 offset:32768
v_mfma_f32_16x16x32_bf16 v[172:175], v[84:87], v[52:55], v[172:175]
ds_read_b64_tr_b16 v[82:83], v14 offset:33792
buffer_load_dwordx4 v7, s[40:43], s64 offen offset:1024 lds
ds_read_b128 v[36:39], v10 offset:2048
v_mfma_f32_16x16x32_bf16 v[180:183], v[84:87], v[56:59], v[180:183]
v_mfma_f32_16x16x32_bf16 v[188:191], v[84:87], v[60:63], v[188:191]
v_mfma_f32_16x16x32_bf16 v[192:195], v[64:67], v[48:51], v[192:195]
ds_read_b64_tr_b16 v[84:85], v15 offset:32768
s_add_u32 m0, s55, 65536
s_add_u32 s66, s25, 384
ds_read_b128 v[40:43], v10 offset:4096
v_mfma_f32_16x16x32_bf16 v[200:203], v[64:67], v[52:55], v[200:203]
ds_read_b64_tr_b16 v[86:87], v15 offset:33792
buffer_load_dwordx4 v2, s[28:31], s66 offen offset:0 lds
v_mfma_f32_16x16x32_bf16 v[208:211], v[64:67], v[56:59], v[208:211]
v_mfma_f32_16x16x32_bf16 v[216:219], v[64:67], v[60:63], v[216:219]
ds_read_b128 v[44:47], v10 offset:6144
v_mfma_f32_16x16x32_bf16 v[196:199], v[68:71], v[48:51], v[196:199]
ds_read_b64_tr_b16 v[64:65], v16 offset:32768
v_mfma_f32_16x16x32_bf16 v[204:207], v[68:71], v[52:55], v[204:207]
ds_read_b64_tr_b16 v[66:67], v16 offset:33792
buffer_load_dwordx4 v3, s[28:31], s66 offen offset:1024 lds
v_mfma_f32_16x16x32_bf16 v[212:215], v[68:71], v[56:59], v[212:215]
v_mfma_f32_16x16x32_bf16 v[220:223], v[68:71], v[60:63], v[220:223]
s_waitcnt lgkmcnt(9)
v_mfma_f32_16x16x32_bf16 v[224:227], v[72:75], v[32:35], v[224:227]
ds_read_b64_tr_b16 v[68:69], v17 offset:32768
s_waitcnt lgkmcnt(7)
v_mfma_f32_16x16x32_bf16 v[232:235], v[72:75], v[36:39], v[232:235]
ds_read_b64_tr_b16 v[70:71], v17 offset:33792
buffer_store_dwordx4 v[108:111], v1, s[44:47], s63 offen offset:0 sc1
s_waitcnt lgkmcnt(6)
v_mfma_f32_16x16x32_bf16 v[240:243], v[72:75], v[40:43], v[240:243]
s_waitcnt lgkmcnt(4)
v_mfma_f32_16x16x32_bf16 v[248:251], v[72:75], v[44:47], v[248:251]
v_mfma_f32_16x16x32_bf16 v[228:231], v[76:79], v[32:35], v[228:231]
v_mfma_f32_16x16x32_bf16 v[236:239], v[76:79], v[36:39], v[236:239]
buffer_store_dwordx4 v[112:115], v1, s[44:47], s60 offen offset:1024 sc1
v_mfma_f32_16x16x32_bf16 v[244:247], v[76:79], v[40:43], v[244:247]
v_mfma_f32_16x16x32_bf16 v[252:255], v[76:79], v[44:47], v[252:255]
s_waitcnt vmcnt(15) lgkmcnt(0)
s_barrier
ds_read_b64_tr_b16 v[72:73], v18 offset:49152
ds_read_b64_tr_b16 v[74:75], v18 offset:50176
v_mfma_f32_16x16x32_bf16 v[160:163], v[80:83], v[32:35], v[160:163]
ds_read_b64_tr_b16 v[76:77], v19 offset:49152
s_add_u32 m0, s56, 32768
s_add_u32 s64, s53, 1572864
v_mfma_f32_16x16x32_bf16 v[168:171], v[80:83], v[36:39], v[168:171]
ds_read_b64_tr_b16 v[78:79], v19 offset:50176
buffer_load_dwordx4 v6, s[40:43], s64 offen offset:0 lds
v_mfma_f32_16x16x32_bf16 v[176:179], v[80:83], v[40:43], v[176:179]
ds_read_b128 v[48:51], v11 offset:0
v_mfma_f32_16x16x32_bf16 v[184:187], v[80:83], v[44:47], v[184:187]
v_mfma_f32_16x16x32_bf16 v[164:167], v[84:87], v[32:35], v[164:167]
ds_read_b64_tr_b16 v[80:81], v14 offset:49152
v_mfma_f32_16x16x32_bf16 v[172:175], v[84:87], v[36:39], v[172:175]
ds_read_b64_tr_b16 v[82:83], v14 offset:50176
ds_read_b128 v[52:55], v11 offset:2048
v_mfma_f32_16x16x32_bf16 v[180:183], v[84:87], v[40:43], v[180:183]
buffer_load_dwordx4 v7, s[40:43], s64 offen offset:1024 lds
v_mfma_f32_16x16x32_bf16 v[188:191], v[84:87], v[44:47], v[188:191]
v_mfma_f32_16x16x32_bf16 v[192:195], v[64:67], v[32:35], v[192:195]
ds_read_b64_tr_b16 v[84:85], v15 offset:49152
ds_read_b128 v[56:59], v11 offset:4096
v_mfma_f32_16x16x32_bf16 v[200:203], v[64:67], v[36:39], v[200:203]
ds_read_b64_tr_b16 v[86:87], v15 offset:50176
s_add_u32 m0, s55, 65536
s_add_u32 s66, s25, 384
v_mfma_f32_16x16x32_bf16 v[208:211], v[64:67], v[40:43], v[208:211]
buffer_load_dwordx4 v4, s[28:31], s66 offen offset:2048 lds
v_mfma_f32_16x16x32_bf16 v[216:219], v[64:67], v[44:47], v[216:219]
ds_read_b128 v[60:63], v11 offset:6144
v_mfma_f32_16x16x32_bf16 v[196:199], v[68:71], v[32:35], v[196:199]
ds_read_b64_tr_b16 v[64:65], v16 offset:49152
v_mfma_f32_16x16x32_bf16 v[204:207], v[68:71], v[36:39], v[204:207]
ds_read_b64_tr_b16 v[66:67], v16 offset:50176
v_mfma_f32_16x16x32_bf16 v[212:215], v[68:71], v[40:43], v[212:215]
v_mfma_f32_16x16x32_bf16 v[220:223], v[68:71], v[44:47], v[220:223]
buffer_load_dwordx4 v5, s[28:31], s66 offen offset:3072 lds
s_waitcnt lgkmcnt(9)
v_mfma_f32_16x16x32_bf16 v[224:227], v[72:75], v[48:51], v[224:227]
ds_read_b64_tr_b16 v[68:69], v17 offset:49152
s_waitcnt lgkmcnt(7)
v_mfma_f32_16x16x32_bf16 v[232:235], v[72:75], v[52:55], v[232:235]
ds_read_b64_tr_b16 v[70:71], v17 offset:50176
s_waitcnt lgkmcnt(6)
v_mfma_f32_16x16x32_bf16 v[240:243], v[72:75], v[56:59], v[240:243]
s_waitcnt lgkmcnt(4)
v_mfma_f32_16x16x32_bf16 v[248:251], v[72:75], v[60:63], v[248:251]
v_mfma_f32_16x16x32_bf16 v[228:231], v[76:79], v[48:51], v[228:231]
buffer_store_dwordx4 v[116:119], v1, s[44:47], s61 offen offset:1024 sc1
v_mfma_f32_16x16x32_bf16 v[236:239], v[76:79], v[52:55], v[236:239]
v_mfma_f32_16x16x32_bf16 v[244:247], v[76:79], v[56:59], v[244:247]
v_mfma_f32_16x16x32_bf16 v[252:255], v[76:79], v[60:63], v[252:255]
s_waitcnt vmcnt(12) lgkmcnt(0)
s_barrier
ds_read_b64_tr_b16 v[72:73], v18 offset:0
ds_read_b64_tr_b16 v[74:75], v18 offset:1024
v_mfma_f32_16x16x32_bf16 v[160:163], v[80:83], v[48:51], v[160:163]
ds_read_b64_tr_b16 v[76:77], v19 offset:0
s_add_u32 m0, s56, 49152
s_add_u32 s64, s53, 1835008
v_mfma_f32_16x16x32_bf16 v[168:171], v[80:83], v[52:55], v[168:171]
ds_read_b64_tr_b16 v[78:79], v19 offset:1024
buffer_load_dwordx4 v6, s[40:43], s64 offen offset:0 lds
v_mfma_f32_16x16x32_bf16 v[176:179], v[80:83], v[56:59], v[176:179]
ds_read_b128 v[32:35], v10 offset:32768
v_mfma_f32_16x16x32_bf16 v[184:187], v[80:83], v[60:63], v[184:187]
v_mfma_f32_16x16x32_bf16 v[164:167], v[84:87], v[48:51], v[164:167]
ds_read_b64_tr_b16 v[80:81], v14 offset:0
v_mfma_f32_16x16x32_bf16 v[172:175], v[84:87], v[52:55], v[172:175]
ds_read_b64_tr_b16 v[82:83], v14 offset:1024
buffer_load_dwordx4 v7, s[40:43], s64 offen offset:1024 lds
ds_read_b128 v[36:39], v10 offset:34816
v_mfma_f32_16x16x32_bf16 v[180:183], v[84:87], v[56:59], v[180:183]
v_mfma_f32_16x16x32_bf16 v[188:191], v[84:87], v[60:63], v[188:191]
v_mfma_f32_16x16x32_bf16 v[192:195], v[64:67], v[48:51], v[192:195]
ds_read_b64_tr_b16 v[84:85], v15 offset:0
s_add_u32 m0, s55, 0
s_add_u32 s66, s25, 512
ds_read_b128 v[40:43], v10 offset:36864
v_mfma_f32_16x16x32_bf16 v[200:203], v[64:67], v[52:55], v[200:203]
ds_read_b64_tr_b16 v[86:87], v15 offset:1024
buffer_load_dwordx4 v2, s[28:31], s66 offen offset:0 lds
v_mfma_f32_16x16x32_bf16 v[208:211], v[64:67], v[56:59], v[208:211]
v_mfma_f32_16x16x32_bf16 v[216:219], v[64:67], v[60:63], v[216:219]
ds_read_b128 v[44:47], v10 offset:38912
v_mfma_f32_16x16x32_bf16 v[196:199], v[68:71], v[48:51], v[196:199]
ds_read_b64_tr_b16 v[64:65], v16 offset:0
v_mfma_f32_16x16x32_bf16 v[204:207], v[68:71], v[52:55], v[204:207]
ds_read_b64_tr_b16 v[66:67], v16 offset:1024
buffer_load_dwordx4 v3, s[28:31], s66 offen offset:1024 lds
v_mfma_f32_16x16x32_bf16 v[212:215], v[68:71], v[56:59], v[212:215]
v_mfma_f32_16x16x32_bf16 v[220:223], v[68:71], v[60:63], v[220:223]
s_waitcnt lgkmcnt(9)
v_mfma_f32_16x16x32_bf16 v[224:227], v[72:75], v[32:35], v[224:227]
ds_read_b64_tr_b16 v[68:69], v17 offset:0
s_waitcnt lgkmcnt(7)
v_mfma_f32_16x16x32_bf16 v[232:235], v[72:75], v[36:39], v[232:235]
ds_read_b64_tr_b16 v[70:71], v17 offset:1024
buffer_store_dwordx4 v[120:123], v1, s[44:47], s62 offen offset:1024 sc1
s_waitcnt lgkmcnt(6)
v_mfma_f32_16x16x32_bf16 v[240:243], v[72:75], v[40:43], v[240:243]
s_waitcnt lgkmcnt(4)
v_mfma_f32_16x16x32_bf16 v[248:251], v[72:75], v[44:47], v[248:251]
v_mfma_f32_16x16x32_bf16 v[228:231], v[76:79], v[32:35], v[228:231]
v_mfma_f32_16x16x32_bf16 v[236:239], v[76:79], v[36:39], v[236:239]
buffer_store_dwordx4 v[124:127], v1, s[44:47], s63 offen offset:1024 sc1
v_mfma_f32_16x16x32_bf16 v[244:247], v[76:79], v[40:43], v[244:247]
v_mfma_f32_16x16x32_bf16 v[252:255], v[76:79], v[44:47], v[252:255]
s_waitcnt vmcnt(15) lgkmcnt(0)
s_barrier
ds_read_b64_tr_b16 v[72:73], v18 offset:16384
ds_read_b64_tr_b16 v[74:75], v18 offset:17408
v_mfma_f32_16x16x32_bf16 v[160:163], v[80:83], v[32:35], v[160:163]
ds_read_b64_tr_b16 v[76:77], v19 offset:16384
s_add_u32 m0, s56, 0
s_add_u32 s64, s53, 2097152
v_mfma_f32_16x16x32_bf16 v[168:171], v[80:83], v[36:39], v[168:171]
ds_read_b64_tr_b16 v[78:79], v19 offset:17408
buffer_load_dwordx4 v6, s[40:43], s64 offen offset:0 lds
v_mfma_f32_16x16x32_bf16 v[176:179], v[80:83], v[40:43], v[176:179]
ds_read_b128 v[48:51], v11 offset:32768
v_mfma_f32_16x16x32_bf16 v[184:187], v[80:83], v[44:47], v[184:187]
v_mfma_f32_16x16x32_bf16 v[164:167], v[84:87], v[32:35], v[164:167]
ds_read_b64_tr_b16 v[80:81], v14 offset:16384
v_mfma_f32_16x16x32_bf16 v[172:175], v[84:87], v[36:39], v[172:175]
ds_read_b64_tr_b16 v[82:83], v14 offset:17408
ds_read_b128 v[52:55], v11 offset:34816
v_mfma_f32_16x16x32_bf16 v[180:183], v[84:87], v[40:43], v[180:183]
buffer_load_dwordx4 v7, s[40:43], s64 offen offset:1024 lds
v_mfma_f32_16x16x32_bf16 v[188:191], v[84:87], v[44:47], v[188:191]
v_mfma_f32_16x16x32_bf16 v[192:195], v[64:67], v[32:35], v[192:195]
ds_read_b64_tr_b16 v[84:85], v15 offset:16384
ds_read_b128 v[56:59], v11 offset:36864
v_mfma_f32_16x16x32_bf16 v[200:203], v[64:67], v[36:39], v[200:203]
ds_read_b64_tr_b16 v[86:87], v15 offset:17408
s_add_u32 m0, s55, 0
s_add_u32 s66, s25, 512
v_mfma_f32_16x16x32_bf16 v[208:211], v[64:67], v[40:43], v[208:211]
buffer_load_dwordx4 v4, s[28:31], s66 offen offset:2048 lds
v_mfma_f32_16x16x32_bf16 v[216:219], v[64:67], v[44:47], v[216:219]
ds_read_b128 v[60:63], v11 offset:38912
v_mfma_f32_16x16x32_bf16 v[196:199], v[68:71], v[32:35], v[196:199]
ds_read_b64_tr_b16 v[64:65], v16 offset:16384
v_mfma_f32_16x16x32_bf16 v[204:207], v[68:71], v[36:39], v[204:207]
ds_read_b64_tr_b16 v[66:67], v16 offset:17408
v_mfma_f32_16x16x32_bf16 v[212:215], v[68:71], v[40:43], v[212:215]
v_mfma_f32_16x16x32_bf16 v[220:223], v[68:71], v[44:47], v[220:223]
buffer_load_dwordx4 v5, s[28:31], s66 offen offset:3072 lds
s_waitcnt lgkmcnt(9)
v_mfma_f32_16x16x32_bf16 v[224:227], v[72:75], v[48:51], v[224:227]
ds_read_b64_tr_b16 v[68:69], v17 offset:16384
s_waitcnt lgkmcnt(7)
v_mfma_f32_16x16x32_bf16 v[232:235], v[72:75], v[52:55], v[232:235]
ds_read_b64_tr_b16 v[70:71], v17 offset:17408
s_waitcnt lgkmcnt(6)
v_mfma_f32_16x16x32_bf16 v[240:243], v[72:75], v[56:59], v[240:243]
s_waitcnt lgkmcnt(4)
v_mfma_f32_16x16x32_bf16 v[248:251], v[72:75], v[60:63], v[248:251]
v_mfma_f32_16x16x32_bf16 v[228:231], v[76:79], v[48:51], v[228:231]
buffer_store_dwordx4 v[128:131], v1, s[44:47], s60 offen offset:2048 sc1
v_mfma_f32_16x16x32_bf16 v[236:239], v[76:79], v[52:55], v[236:239]
v_mfma_f32_16x16x32_bf16 v[244:247], v[76:79], v[56:59], v[244:247]
v_mfma_f32_16x16x32_bf16 v[252:255], v[76:79], v[60:63], v[252:255]
s_waitcnt vmcnt(12) lgkmcnt(0)
s_barrier
ds_read_b64_tr_b16 v[72:73], v18 offset:32768
ds_read_b64_tr_b16 v[74:75], v18 offset:33792
v_mfma_f32_16x16x32_bf16 v[160:163], v[80:83], v[48:51], v[160:163]
ds_read_b64_tr_b16 v[76:77], v19 offset:32768
s_add_u32 m0, s56, 16384
s_add_u32 s64, s53, 2359296
v_mfma_f32_16x16x32_bf16 v[168:171], v[80:83], v[52:55], v[168:171]
ds_read_b64_tr_b16 v[78:79], v19 offset:33792
buffer_load_dwordx4 v6, s[40:43], s64 offen offset:0 lds
v_mfma_f32_16x16x32_bf16 v[176:179], v[80:83], v[56:59], v[176:179]
ds_read_b128 v[32:35], v12 offset:0
v_mfma_f32_16x16x32_bf16 v[184:187], v[80:83], v[60:63], v[184:187]
v_mfma_f32_16x16x32_bf16 v[164:167], v[84:87], v[48:51], v[164:167]
ds_read_b64_tr_b16 v[80:81], v14 offset:32768
v_mfma_f32_16x16x32_bf16 v[172:175], v[84:87], v[52:55], v[172:175]
ds_read_b64_tr_b16 v[82:83], v14 offset:33792
buffer_load_dwordx4 v7, s[40:43], s64 offen offset:1024 lds
ds_read_b128 v[36:39], v12 offset:2048
v_mfma_f32_16x16x32_bf16 v[180:183], v[84:87], v[56:59], v[180:183]
v_mfma_f32_16x16x32_bf16 v[188:191], v[84:87], v[60:63], v[188:191]
v_mfma_f32_16x16x32_bf16 v[192:195], v[64:67], v[48:51], v[192:195]
ds_read_b64_tr_b16 v[84:85], v15 offset:32768
s_add_u32 m0, s55, 32768
s_add_u32 s66, s25, 640
ds_read_b128 v[40:43], v12 offset:4096
v_mfma_f32_16x16x32_bf16 v[200:203], v[64:67], v[52:55], v[200:203]
ds_read_b64_tr_b16 v[86:87], v15 offset:33792
buffer_load_dwordx4 v2, s[28:31], s66 offen offset:0 lds
v_mfma_f32_16x16x32_bf16 v[208:211], v[64:67], v[56:59], v[208:211]
v_mfma_f32_16x16x32_bf16 v[216:219], v[64:67], v[60:63], v[216:219]
ds_read_b128 v[44:47], v12 offset:6144
v_mfma_f32_16x16x32_bf16 v[196:199], v[68:71], v[48:51], v[196:199]
ds_read_b64_tr_b16 v[64:65], v16 offset:32768
v_mfma_f32_16x16x32_bf16 v[204:207], v[68:71], v[52:55], v[204:207]
ds_read_b64_tr_b16 v[66:67], v16 offset:33792
buffer_load_dwordx4 v3, s[28:31], s66 offen offset:1024 lds
v_mfma_f32_16x16x32_bf16 v[212:215], v[68:71], v[56:59], v[212:215]
v_mfma_f32_16x16x32_bf16 v[220:223], v[68:71], v[60:63], v[220:223]
s_waitcnt lgkmcnt(9)
v_mfma_f32_16x16x32_bf16 v[224:227], v[72:75], v[32:35], v[224:227]
ds_read_b64_tr_b16 v[68:69], v17 offset:32768
s_waitcnt lgkmcnt(7)
v_mfma_f32_16x16x32_bf16 v[232:235], v[72:75], v[36:39], v[232:235]
ds_read_b64_tr_b16 v[70:71], v17 offset:33792
buffer_store_dwordx4 v[132:135], v1, s[44:47], s61 offen offset:2048 sc1
s_waitcnt lgkmcnt(6)
v_mfma_f32_16x16x32_bf16 v[240:243], v[72:75], v[40:43], v[240:243]
s_waitcnt lgkmcnt(4)
v_mfma_f32_16x16x32_bf16 v[248:251], v[72:75], v[44:47], v[248:251]
v_mfma_f32_16x16x32_bf16 v[228:231], v[76:79], v[32:35], v[228:231]
v_mfma_f32_16x16x32_bf16 v[236:239], v[76:79], v[36:39], v[236:239]
buffer_store_dwordx4 v[136:139], v1, s[44:47], s62 offen offset:2048 sc1
v_mfma_f32_16x16x32_bf16 v[244:247], v[76:79], v[40:43], v[244:247]
v_mfma_f32_16x16x32_bf16 v[252:255], v[76:79], v[44:47], v[252:255]
s_waitcnt vmcnt(15) lgkmcnt(0)
s_barrier
ds_read_b64_tr_b16 v[72:73], v18 offset:49152
ds_read_b64_tr_b16 v[74:75], v18 offset:50176
v_mfma_f32_16x16x32_bf16 v[160:163], v[80:83], v[32:35], v[160:163]
ds_read_b64_tr_b16 v[76:77], v19 offset:49152
s_add_u32 m0, s56, 32768
s_add_u32 s64, s53, 2621440
v_mfma_f32_16x16x32_bf16 v[168:171], v[80:83], v[36:39], v[168:171]
ds_read_b64_tr_b16 v[78:79], v19 offset:50176
buffer_load_dwordx4 v6, s[40:43], s64 offen offset:0 lds
v_mfma_f32_16x16x32_bf16 v[176:179], v[80:83], v[40:43], v[176:179]
ds_read_b128 v[48:51], v13 offset:0
v_mfma_f32_16x16x32_bf16 v[184:187], v[80:83], v[44:47], v[184:187]
v_mfma_f32_16x16x32_bf16 v[164:167], v[84:87], v[32:35], v[164:167]
ds_read_b64_tr_b16 v[80:81], v14 offset:49152
v_mfma_f32_16x16x32_bf16 v[172:175], v[84:87], v[36:39], v[172:175]
ds_read_b64_tr_b16 v[82:83], v14 offset:50176
ds_read_b128 v[52:55], v13 offset:2048
v_mfma_f32_16x16x32_bf16 v[180:183], v[84:87], v[40:43], v[180:183]
buffer_load_dwordx4 v7, s[40:43], s64 offen offset:1024 lds
v_mfma_f32_16x16x32_bf16 v[188:191], v[84:87], v[44:47], v[188:191]
v_mfma_f32_16x16x32_bf16 v[192:195], v[64:67], v[32:35], v[192:195]
ds_read_b64_tr_b16 v[84:85], v15 offset:49152
ds_read_b128 v[56:59], v13 offset:4096
v_mfma_f32_16x16x32_bf16 v[200:203], v[64:67], v[36:39], v[200:203]
ds_read_b64_tr_b16 v[86:87], v15 offset:50176
s_add_u32 m0, s55, 32768
s_add_u32 s66, s25, 640
v_mfma_f32_16x16x32_bf16 v[208:211], v[64:67], v[40:43], v[208:211]
buffer_load_dwordx4 v4, s[28:31], s66 offen offset:2048 lds
v_mfma_f32_16x16x32_bf16 v[216:219], v[64:67], v[44:47], v[216:219]
ds_read_b128 v[60:63], v13 offset:6144
v_mfma_f32_16x16x32_bf16 v[196:199], v[68:71], v[32:35], v[196:199]
ds_read_b64_tr_b16 v[64:65], v16 offset:49152
v_mfma_f32_16x16x32_bf16 v[204:207], v[68:71], v[36:39], v[204:207]
ds_read_b64_tr_b16 v[66:67], v16 offset:50176
v_mfma_f32_16x16x32_bf16 v[212:215], v[68:71], v[40:43], v[212:215]
v_mfma_f32_16x16x32_bf16 v[220:223], v[68:71], v[44:47], v[220:223]
buffer_load_dwordx4 v5, s[28:31], s66 offen offset:3072 lds
s_waitcnt lgkmcnt(9)
v_mfma_f32_16x16x32_bf16 v[224:227], v[72:75], v[48:51], v[224:227]
ds_read_b64_tr_b16 v[68:69], v17 offset:49152
s_waitcnt lgkmcnt(7)
v_mfma_f32_16x16x32_bf16 v[232:235], v[72:75], v[52:55], v[232:235]
ds_read_b64_tr_b16 v[70:71], v17 offset:50176
s_waitcnt lgkmcnt(6)
v_mfma_f32_16x16x32_bf16 v[240:243], v[72:75], v[56:59], v[240:243]
s_waitcnt lgkmcnt(4)
v_mfma_f32_16x16x32_bf16 v[248:251], v[72:75], v[60:63], v[248:251]
v_mfma_f32_16x16x32_bf16 v[228:231], v[76:79], v[48:51], v[228:231]
buffer_store_dwordx4 v[140:143], v1, s[44:47], s63 offen offset:2048 sc1
v_mfma_f32_16x16x32_bf16 v[236:239], v[76:79], v[52:55], v[236:239]
v_mfma_f32_16x16x32_bf16 v[244:247], v[76:79], v[56:59], v[244:247]
v_mfma_f32_16x16x32_bf16 v[252:255], v[76:79], v[60:63], v[252:255]
s_waitcnt vmcnt(12) lgkmcnt(0)
s_barrier
ds_read_b64_tr_b16 v[72:73], v18 offset:0
ds_read_b64_tr_b16 v[74:75], v18 offset:1024
v_mfma_f32_16x16x32_bf16 v[160:163], v[80:83], v[48:51], v[160:163]
ds_read_b64_tr_b16 v[76:77], v19 offset:0
s_add_u32 m0, s56, 49152
s_add_u32 s64, s53, 2883584
v_mfma_f32_16x16x32_bf16 v[168:171], v[80:83], v[52:55], v[168:171]
ds_read_b64_tr_b16 v[78:79], v19 offset:1024
buffer_load_dwordx4 v6, s[40:43], s64 offen offset:0 lds
v_mfma_f32_16x16x32_bf16 v[176:179], v[80:83], v[56:59], v[176:179]
ds_read_b128 v[32:35], v10 offset:0
v_mfma_f32_16x16x32_bf16 v[184:187], v[80:83], v[60:63], v[184:187]
v_mfma_f32_16x16x32_bf16 v[164:167], v[84:87], v[48:51], v[164:167]
ds_read_b64_tr_b16 v[80:81], v14 offset:0
v_mfma_f32_16x16x32_bf16 v[172:175], v[84:87], v[52:55], v[172:175]
ds_read_b64_tr_b16 v[82:83], v14 offset:1024
buffer_load_dwordx4 v7, s[40:43], s64 offen offset:1024 lds
ds_read_b128 v[36:39], v10 offset:2048
v_mfma_f32_16x16x32_bf16 v[180:183], v[84:87], v[56:59], v[180:183]
v_mfma_f32_16x16x32_bf16 v[188:191], v[84:87], v[60:63], v[188:191]
v_mfma_f32_16x16x32_bf16 v[192:195], v[64:67], v[48:51], v[192:195]
ds_read_b64_tr_b16 v[84:85], v15 offset:0
s_add_u32 m0, s55, 65536
s_add_u32 s66, s25, 768
ds_read_b128 v[40:43], v10 offset:4096
v_mfma_f32_16x16x32_bf16 v[200:203], v[64:67], v[52:55], v[200:203]
ds_read_b64_tr_b16 v[86:87], v15 offset:1024
buffer_load_dwordx4 v2, s[28:31], s66 offen offset:0 lds
v_mfma_f32_16x16x32_bf16 v[208:211], v[64:67], v[56:59], v[208:211]
v_mfma_f32_16x16x32_bf16 v[216:219], v[64:67], v[60:63], v[216:219]
ds_read_b128 v[44:47], v10 offset:6144
v_mfma_f32_16x16x32_bf16 v[196:199], v[68:71], v[48:51], v[196:199]
ds_read_b64_tr_b16 v[64:65], v16 offset:0
v_mfma_f32_16x16x32_bf16 v[204:207], v[68:71], v[52:55], v[204:207]
ds_read_b64_tr_b16 v[66:67], v16 offset:1024
buffer_load_dwordx4 v3, s[28:31], s66 offen offset:1024 lds
v_mfma_f32_16x16x32_bf16 v[212:215], v[68:71], v[56:59], v[212:215]
v_mfma_f32_16x16x32_bf16 v[220:223], v[68:71], v[60:63], v[220:223]
s_waitcnt lgkmcnt(9)
v_mfma_f32_16x16x32_bf16 v[224:227], v[72:75], v[32:35], v[224:227]
ds_read_b64_tr_b16 v[68:69], v17 offset:0
s_waitcnt lgkmcnt(7)
v_mfma_f32_16x16x32_bf16 v[232:235], v[72:75], v[36:39], v[232:235]
ds_read_b64_tr_b16 v[70:71], v17 offset:1024
buffer_store_dwordx4 v[144:147], v1, s[44:47], s60 offen offset:3072 sc1
s_waitcnt lgkmcnt(6)
v_mfma_f32_16x16x32_bf16 v[240:243], v[72:75], v[40:43], v[240:243]
s_waitcnt lgkmcnt(4)
v_mfma_f32_16x16x32_bf16 v[248:251], v[72:75], v[44:47], v[248:251]
v_mfma_f32_16x16x32_bf16 v[228:231], v[76:79], v[32:35], v[228:231]
v_mfma_f32_16x16x32_bf16 v[236:239], v[76:79], v[36:39], v[236:239]
buffer_store_dwordx4 v[148:151], v1, s[44:47], s61 offen offset:3072 sc1
v_mfma_f32_16x16x32_bf16 v[244:247], v[76:79], v[40:43], v[244:247]
v_mfma_f32_16x16x32_bf16 v[252:255], v[76:79], v[44:47], v[252:255]
s_waitcnt vmcnt(15) lgkmcnt(0)
s_barrier
ds_read_b64_tr_b16 v[72:73], v18 offset:16384
ds_read_b64_tr_b16 v[74:75], v18 offset:17408
v_mfma_f32_16x16x32_bf16 v[160:163], v[80:83], v[32:35], v[160:163]
ds_read_b64_tr_b16 v[76:77], v19 offset:16384
s_add_u32 m0, s56, 0
s_add_u32 s64, s53, 3145728
v_mfma_f32_16x16x32_bf16 v[168:171], v[80:83], v[36:39], v[168:171]
ds_read_b64_tr_b16 v[78:79], v19 offset:17408
buffer_load_dwordx4 v6, s[40:43], s64 offen offset:0 lds
v_mfma_f32_16x16x32_bf16 v[176:179], v[80:83], v[40:43], v[176:179]
ds_read_b128 v[48:51], v11 offset:0
v_mfma_f32_16x16x32_bf16 v[184:187], v[80:83], v[44:47], v[184:187]
v_mfma_f32_16x16x32_bf16 v[164:167], v[84:87], v[32:35], v[164:167]
ds_read_b64_tr_b16 v[80:81], v14 offset:16384
v_mfma_f32_16x16x32_bf16 v[172:175], v[84:87], v[36:39], v[172:175]
ds_read_b64_tr_b16 v[82:83], v14 offset:17408
ds_read_b128 v[52:55], v11 offset:2048
v_mfma_f32_16x16x32_bf16 v[180:183], v[84:87], v[40:43], v[180:183]
buffer_load_dwordx4 v7, s[40:43], s64 offen offset:1024 lds
v_mfma_f32_16x16x32_bf16 v[188:191], v[84:87], v[44:47], v[188:191]
v_mfma_f32_16x16x32_bf16 v[192:195], v[64:67], v[32:35], v[192:195]
ds_read_b64_tr_b16 v[84:85], v15 offset:16384
ds_read_b128 v[56:59], v11 offset:4096
v_mfma_f32_16x16x32_bf16 v[200:203], v[64:67], v[36:39], v[200:203]
ds_read_b64_tr_b16 v[86:87], v15 offset:17408
s_add_u32 m0, s55, 65536
s_add_u32 s66, s25, 768
v_mfma_f32_16x16x32_bf16 v[208:211], v[64:67], v[40:43], v[208:211]
buffer_load_dwordx4 v4, s[28:31], s66 offen offset:2048 lds
v_mfma_f32_16x16x32_bf16 v[216:219], v[64:67], v[44:47], v[216:219]
ds_read_b128 v[60:63], v11 offset:6144
v_mfma_f32_16x16x32_bf16 v[196:199], v[68:71], v[32:35], v[196:199]
ds_read_b64_tr_b16 v[64:65], v16 offset:16384
v_mfma_f32_16x16x32_bf16 v[204:207], v[68:71], v[36:39], v[204:207]
ds_read_b64_tr_b16 v[66:67], v16 offset:17408
v_mfma_f32_16x16x32_bf16 v[212:215], v[68:71], v[40:43], v[212:215]
v_mfma_f32_16x16x32_bf16 v[220:223], v[68:71], v[44:47], v[220:223]
buffer_load_dwordx4 v5, s[28:31], s66 offen offset:3072 lds
s_waitcnt lgkmcnt(9)
v_mfma_f32_16x16x32_bf16 v[224:227], v[72:75], v[48:51], v[224:227]
ds_read_b64_tr_b16 v[68:69], v17 offset:16384
s_waitcnt lgkmcnt(7)
v_mfma_f32_16x16x32_bf16 v[232:235], v[72:75], v[52:55], v[232:235]
ds_read_b64_tr_b16 v[70:71], v17 offset:17408
s_waitcnt lgkmcnt(6)
v_mfma_f32_16x16x32_bf16 v[240:243], v[72:75], v[56:59], v[240:243]
s_waitcnt lgkmcnt(4)
v_mfma_f32_16x16x32_bf16 v[248:251], v[72:75], v[60:63], v[248:251]
v_mfma_f32_16x16x32_bf16 v[228:231], v[76:79], v[48:51], v[228:231]
buffer_store_dwordx4 v[152:155], v1, s[44:47], s62 offen offset:3072 sc1
v_mfma_f32_16x16x32_bf16 v[236:239], v[76:79], v[52:55], v[236:239]
v_mfma_f32_16x16x32_bf16 v[244:247], v[76:79], v[56:59], v[244:247]
v_mfma_f32_16x16x32_bf16 v[252:255], v[76:79], v[60:63], v[252:255]
s_waitcnt vmcnt(12) lgkmcnt(0)
s_barrier
ds_read_b64_tr_b16 v[72:73], v18 offset:32768
ds_read_b64_tr_b16 v[74:75], v18 offset:33792
v_mfma_f32_16x16x32_bf16 v[160:163], v[80:83], v[48:51], v[160:163]
ds_read_b64_tr_b16 v[76:77], v19 offset:32768
s_add_u32 m0, s56, 16384
s_add_u32 s64, s53, 3407872
v_mfma_f32_16x16x32_bf16 v[168:171], v[80:83], v[52:55], v[168:171]
ds_read_b64_tr_b16 v[78:79], v19 offset:33792
buffer_load_dwordx4 v6, s[40:43], s64 offen offset:0 lds
v_mfma_f32_16x16x32_bf16 v[176:179], v[80:83], v[56:59], v[176:179]
ds_read_b128 v[32:35], v10 offset:32768
v_mfma_f32_16x16x32_bf16 v[184:187], v[80:83], v[60:63], v[184:187]
v_mfma_f32_16x16x32_bf16 v[164:167], v[84:87], v[48:51], v[164:167]
ds_read_b64_tr_b16 v[80:81], v14 offset:32768
v_mfma_f32_16x16x32_bf16 v[172:175], v[84:87], v[52:55], v[172:175]
ds_read_b64_tr_b16 v[82:83], v14 offset:33792
ds_read_b128 v[36:39], v10 offset:34816
v_mfma_f32_16x16x32_bf16 v[180:183], v[84:87], v[56:59], v[180:183]
buffer_load_dwordx4 v7, s[40:43], s64 offen offset:1024 lds
v_mfma_f32_16x16x32_bf16 v[188:191], v[84:87], v[60:63], v[188:191]
v_mfma_f32_16x16x32_bf16 v[192:195], v[64:67], v[48:51], v[192:195]
ds_read_b64_tr_b16 v[84:85], v15 offset:32768
ds_read_b128 v[40:43], v10 offset:36864
v_mfma_f32_16x16x32_bf16 v[200:203], v[64:67], v[52:55], v[200:203]
ds_read_b64_tr_b16 v[86:87], v15 offset:33792
s_add_u32 m0, s55, 0
s_add_u32 s66, s25, 896
v_mfma_f32_16x16x32_bf16 v[208:211], v[64:67], v[56:59], v[208:211]
buffer_load_dwordx4 v2, s[28:31], s66 offen offset:0 lds
v_mfma_f32_16x16x32_bf16 v[216:219], v[64:67], v[60:63], v[216:219]
ds_read_b128 v[44:47], v10 offset:38912
v_mfma_f32_16x16x32_bf16 v[196:199], v[68:71], v[48:51], v[196:199]
ds_read_b64_tr_b16 v[64:65], v16 offset:32768
v_mfma_f32_16x16x32_bf16 v[204:207], v[68:71], v[52:55], v[204:207]
ds_read_b64_tr_b16 v[66:67], v16 offset:33792
v_mfma_f32_16x16x32_bf16 v[212:215], v[68:71], v[56:59], v[212:215]
v_mfma_f32_16x16x32_bf16 v[220:223], v[68:71], v[60:63], v[220:223]
buffer_load_dwordx4 v3, s[28:31], s66 offen offset:1024 lds
s_waitcnt lgkmcnt(9)
v_mfma_f32_16x16x32_bf16 v[224:227], v[72:75], v[32:35], v[224:227]
ds_read_b64_tr_b16 v[68:69], v17 offset:32768
s_waitcnt lgkmcnt(7)
v_mfma_f32_16x16x32_bf16 v[232:235], v[72:75], v[36:39], v[232:235]
ds_read_b64_tr_b16 v[70:71], v17 offset:33792
s_waitcnt lgkmcnt(6)
v_mfma_f32_16x16x32_bf16 v[240:243], v[72:75], v[40:43], v[240:243]
s_waitcnt lgkmcnt(4)
v_mfma_f32_16x16x32_bf16 v[248:251], v[72:75], v[44:47], v[248:251]
v_mfma_f32_16x16x32_bf16 v[228:231], v[76:79], v[32:35], v[228:231]
buffer_store_dwordx4 v[156:159], v1, s[44:47], s63 offen offset:3072 sc1
v_mfma_f32_16x16x32_bf16 v[236:239], v[76:79], v[36:39], v[236:239]
v_mfma_f32_16x16x32_bf16 v[244:247], v[76:79], v[40:43], v[244:247]
v_mfma_f32_16x16x32_bf16 v[252:255], v[76:79], v[44:47], v[252:255]
s_waitcnt vmcnt(14) lgkmcnt(0)
s_barrier
ds_read_b64_tr_b16 v[72:73], v18 offset:49152
ds_read_b64_tr_b16 v[74:75], v18 offset:50176
v_mfma_f32_16x16x32_bf16 v[160:163], v[80:83], v[32:35], v[160:163]
ds_read_b64_tr_b16 v[76:77], v19 offset:49152
s_add_u32 m0, s56, 32768
s_add_u32 s64, s53, 3670016
v_mfma_f32_16x16x32_bf16 v[168:171], v[80:83], v[36:39], v[168:171]
ds_read_b64_tr_b16 v[78:79], v19 offset:50176
buffer_load_dwordx4 v6, s[40:43], s64 offen offset:0 lds
v_mfma_f32_16x16x32_bf16 v[176:179], v[80:83], v[40:43], v[176:179]
ds_read_b128 v[48:51], v11 offset:32768
v_mfma_f32_16x16x32_bf16 v[184:187], v[80:83], v[44:47], v[184:187]
v_mfma_f32_16x16x32_bf16 v[164:167], v[84:87], v[32:35], v[164:167]
ds_read_b64_tr_b16 v[80:81], v14 offset:49152
v_mfma_f32_16x16x32_bf16 v[172:175], v[84:87], v[36:39], v[172:175]
ds_read_b64_tr_b16 v[82:83], v14 offset:50176
ds_read_b128 v[52:55], v11 offset:34816
v_mfma_f32_16x16x32_bf16 v[180:183], v[84:87], v[40:43], v[180:183]
v_mfma_f32_16x16x32_bf16 v[188:191], v[84:87], v[44:47], v[188:191]
buffer_load_dwordx4 v7, s[40:43], s64 offen offset:1024 lds
v_mfma_f32_16x16x32_bf16 v[192:195], v[64:67], v[32:35], v[192:195]
ds_read_b64_tr_b16 v[84:85], v15 offset:49152
ds_read_b128 v[56:59], v11 offset:36864
v_mfma_f32_16x16x32_bf16 v[200:203], v[64:67], v[36:39], v[200:203]
ds_read_b64_tr_b16 v[86:87], v15 offset:50176
v_mfma_f32_16x16x32_bf16 v[208:211], v[64:67], v[40:43], v[208:211]
v_mfma_f32_16x16x32_bf16 v[216:219], v[64:67], v[44:47], v[216:219]
ds_read_b128 v[60:63], v11 offset:38912
v_mfma_f32_16x16x32_bf16 v[196:199], v[68:71], v[32:35], v[196:199]
ds_read_b64_tr_b16 v[64:65], v16 offset:49152
s_add_u32 m0, s55, 0
s_add_u32 s66, s25, 896
v_mfma_f32_16x16x32_bf16 v[204:207], v[68:71], v[36:39], v[204:207]
ds_read_b64_tr_b16 v[66:67], v16 offset:50176
buffer_load_dwordx4 v4, s[28:31], s66 offen offset:2048 lds
v_mfma_f32_16x16x32_bf16 v[212:215], v[68:71], v[40:43], v[212:215]
v_mfma_f32_16x16x32_bf16 v[220:223], v[68:71], v[44:47], v[220:223]
s_waitcnt lgkmcnt(9)
v_mfma_f32_16x16x32_bf16 v[224:227], v[72:75], v[48:51], v[224:227]
ds_read_b64_tr_b16 v[68:69], v17 offset:49152
s_waitcnt lgkmcnt(7)
v_mfma_f32_16x16x32_bf16 v[232:235], v[72:75], v[52:55], v[232:235]
ds_read_b64_tr_b16 v[70:71], v17 offset:50176
s_waitcnt lgkmcnt(6)
v_mfma_f32_16x16x32_bf16 v[240:243], v[72:75], v[56:59], v[240:243]
s_waitcnt lgkmcnt(4)
v_mfma_f32_16x16x32_bf16 v[248:251], v[72:75], v[60:63], v[248:251]
buffer_load_dwordx4 v5, s[28:31], s66 offen offset:3072 lds
v_mfma_f32_16x16x32_bf16 v[228:231], v[76:79], v[48:51], v[228:231]
v_mfma_f32_16x16x32_bf16 v[236:239], v[76:79], v[52:55], v[236:239]
v_mfma_f32_16x16x32_bf16 v[244:247], v[76:79], v[56:59], v[244:247]
v_mfma_f32_16x16x32_bf16 v[252:255], v[76:79], v[60:63], v[252:255]
s_waitcnt vmcnt(10) lgkmcnt(0)
s_barrier
ds_read_b64_tr_b16 v[72:73], v18 offset:0
ds_read_b64_tr_b16 v[74:75], v18 offset:1024
v_mfma_f32_16x16x32_bf16 v[160:163], v[80:83], v[48:51], v[160:163]
ds_read_b64_tr_b16 v[76:77], v19 offset:0
v_mfma_f32_16x16x32_bf16 v[168:171], v[80:83], v[52:55], v[168:171]
ds_read_b64_tr_b16 v[78:79], v19 offset:1024
v_mfma_f32_16x16x32_bf16 v[176:179], v[80:83], v[56:59], v[176:179]
s_add_u32 m0, s56, 49152
s_add_u32 s64, s53, 3932160
ds_read_b128 v[32:35], v12 offset:0
v_mfma_f32_16x16x32_bf16 v[184:187], v[80:83], v[60:63], v[184:187]
buffer_load_dwordx4 v6, s[40:43], s64 offen offset:0 lds
v_mfma_f32_16x16x32_bf16 v[164:167], v[84:87], v[48:51], v[164:167]
ds_read_b64_tr_b16 v[80:81], v14 offset:0
v_mfma_f32_16x16x32_bf16 v[172:175], v[84:87], v[52:55], v[172:175]
ds_read_b64_tr_b16 v[82:83], v14 offset:1024
ds_read_b128 v[36:39], v12 offset:2048
v_mfma_f32_16x16x32_bf16 v[180:183], v[84:87], v[56:59], v[180:183]
v_mfma_f32_16x16x32_bf16 v[188:191], v[84:87], v[60:63], v[188:191]
v_mfma_f32_16x16x32_bf16 v[192:195], v[64:67], v[48:51], v[192:195]
ds_read_b64_tr_b16 v[84:85], v15 offset:0
ds_read_b128 v[40:43], v12 offset:4096
v_mfma_f32_16x16x32_bf16 v[200:203], v[64:67], v[52:55], v[200:203]
ds_read_b64_tr_b16 v[86:87], v15 offset:1024
v_mfma_f32_16x16x32_bf16 v[208:211], v[64:67], v[56:59], v[208:211]
v_mfma_f32_16x16x32_bf16 v[216:219], v[64:67], v[60:63], v[216:219]
ds_read_b128 v[44:47], v12 offset:6144
v_mfma_f32_16x16x32_bf16 v[196:199], v[68:71], v[48:51], v[196:199]
ds_read_b64_tr_b16 v[64:65], v16 offset:0
v_mfma_f32_16x16x32_bf16 v[204:207], v[68:71], v[52:55], v[204:207]
ds_read_b64_tr_b16 v[66:67], v16 offset:1024
v_mfma_f32_16x16x32_bf16 v[212:215], v[68:71], v[56:59], v[212:215]
v_mfma_f32_16x16x32_bf16 v[220:223], v[68:71], v[60:63], v[220:223]
buffer_load_dwordx4 v7, s[40:43], s64 offen offset:1024 lds
s_waitcnt lgkmcnt(9)
v_mfma_f32_16x16x32_bf16 v[224:227], v[72:75], v[32:35], v[224:227]
ds_read_b64_tr_b16 v[68:69], v17 offset:0
s_waitcnt lgkmcnt(7)
v_mfma_f32_16x16x32_bf16 v[232:235], v[72:75], v[36:39], v[232:235]
ds_read_b64_tr_b16 v[70:71], v17 offset:1024
s_waitcnt lgkmcnt(6)
v_mfma_f32_16x16x32_bf16 v[240:243], v[72:75], v[40:43], v[240:243]
s_waitcnt lgkmcnt(4)
v_mfma_f32_16x16x32_bf16 v[248:251], v[72:75], v[44:47], v[248:251]
v_mfma_f32_16x16x32_bf16 v[228:231], v[76:79], v[32:35], v[228:231]
v_mfma_f32_16x16x32_bf16 v[236:239], v[76:79], v[36:39], v[236:239]
v_mfma_f32_16x16x32_bf16 v[244:247], v[76:79], v[40:43], v[244:247]
s_cmp_lg_u32 s22, 0
s_cbranch_scc1 L_kk_kernel_c0_sk18
v_and_b32 v92, 31, v0
v_min_u32 v92, 19, v92
v_lshl_add_u32 v92, v92, 7, s98
v_min_u32 v92, L_code_end-L_pc_kk_kernel-4, v92
v_mov_b32 v93, s97
v_add_co_u32 v92, vcc, s96, v92
s_nop 1
v_addc_co_u32 v93, vcc, 0, v93, vcc
global_load_dword v94, v[92:93], off
L_kk_kernel_c0_sk18:
v_mfma_f32_16x16x32_bf16 v[252:255], v[76:79], v[44:47], v[252:255]
s_waitcnt vmcnt(6) lgkmcnt(0)
s_barrier
ds_read_b64_tr_b16 v[72:73], v18 offset:16384
ds_read_b64_tr_b16 v[74:75], v18 offset:17408
v_mfma_f32_16x16x32_bf16 v[160:163], v[80:83], v[32:35], v[160:163]
ds_read_b64_tr_b16 v[76:77], v19 offset:16384
v_mfma_f32_16x16x32_bf16 v[168:171], v[80:83], v[36:39], v[168:171]
ds_read_b64_tr_b16 v[78:79], v19 offset:17408
v_mfma_f32_16x16x32_bf16 v[176:179], v[80:83], v[40:43], v[176:179]
ds_read_b128 v[48:51], v13 offset:0
v_mfma_f32_16x16x32_bf16 v[184:187], v[80:83], v[44:47], v[184:187]
v_mfma_f32_16x16x32_bf16 v[164:167], v[84:87], v[32:35], v[164:167]
ds_read_b64_tr_b16 v[80:81], v14 offset:16384
v_mfma_f32_16x16x32_bf16 v[172:175], v[84:87], v[36:39], v[172:175]
ds_read_b64_tr_b16 v[82:83], v14 offset:17408
ds_read_b128 v[52:55], v13 offset:2048
v_mfma_f32_16x16x32_bf16 v[180:183], v[84:87], v[40:43], v[180:183]
buffer_store_dword v31, v30, s[44:47], 0 offen sc1
v_mfma_f32_16x16x32_bf16 v[188:191], v[84:87], v[44:47], v[188:191]
v_mfma_f32_16x16x32_bf16 v[192:195], v[64:67], v[32:35], v[192:195]
ds_read_b64_tr_b16 v[84:85], v15 offset:16384
ds_read_b128 v[56:59], v13 offset:4096
v_mfma_f32_16x16x32_bf16 v[200:203], v[64:67], v[36:39], v[200:203]
ds_read_b64_tr_b16 v[86:87], v15 offset:17408
v_mfma_f32_16x16x32_bf16 v[208:211], v[64:67], v[40:43], v[208:211]
v_mfma_f32_16x16x32_bf16 v[216:219], v[64:67], v[44:47], v[216:219]
ds_read_b128 v[60:63], v13 offset:6144
v_mfma_f32_16x16x32_bf16 v[196:199], v[68:71], v[32:35], v[196:199]
ds_read_b64_tr_b16 v[64:65], v16 offset:16384
v_mfma_f32_16x16x32_bf16 v[204:207], v[68:71], v[36:39], v[204:207]
ds_read_b64_tr_b16 v[66:67], v16 offset:17408
v_mfma_f32_16x16x32_bf16 v[212:215], v[68:71], v[40:43], v[212:215]
v_mfma_f32_16x16x32_bf16 v[220:223], v[68:71], v[44:47], v[220:223]
s_waitcnt lgkmcnt(9)
v_mfma_f32_16x16x32_bf16 v[224:227], v[72:75], v[48:51], v[224:227]
ds_read_b64_tr_b16 v[68:69], v17 offset:16384
s_waitcnt lgkmcnt(7)
v_mfma_f32_16x16x32_bf16 v[232:235], v[72:75], v[52:55], v[232:235]
ds_read_b64_tr_b16 v[70:71], v17 offset:17408
s_waitcnt lgkmcnt(6)
v_mfma_f32_16x16x32_bf16 v[240:243], v[72:75], v[56:59], v[240:243]
s_waitcnt lgkmcnt(4)
v_mfma_f32_16x16x32_bf16 v[248:251], v[72:75], v[60:63], v[248:251]
v_mfma_f32_16x16x32_bf16 v[228:231], v[76:79], v[48:51], v[228:231]
v_mfma_f32_16x16x32_bf16 v[236:239], v[76:79], v[52:55], v[236:239]
v_mfma_f32_16x16x32_bf16 v[244:247], v[76:79], v[56:59], v[244:247]
v_mfma_f32_16x16x32_bf16 v[252:255], v[76:79], v[60:63], v[252:255]
s_waitcnt vmcnt(3) lgkmcnt(0)
s_barrier
ds_read_b64_tr_b16 v[72:73], v18 offset:32768
ds_read_b64_tr_b16 v[74:75], v18 offset:33792
v_mfma_f32_16x16x32_bf16 v[160:163], v[80:83], v[48:51], v[160:163]
ds_read_b64_tr_b16 v[76:77], v19 offset:32768
s_lshl_b32 s4, s21, 1
s_sub_u32 s25, 32, s4
v_mfma_f32_16x16x32_bf16 v[168:171], v[80:83], v[52:55], v[168:171]
ds_read_b64_tr_b16 v[78:79], v19 offset:33792
s_lshl_b32 s4, s21, 2
v_mfma_f32_16x16x32_bf16 v[176:179], v[80:83], v[56:59], v[176:179]
s_sub_u32 s6, 60, s4
s_add_u32 s24, s6, s22
ds_read_b128 v[32:35], v10 offset:0
v_mfma_f32_16x16x32_bf16 v[184:187], v[80:83], v[60:63], v[184:187]
s_lshl_b32 s7, s20, 19
s_mov_b32 s38, 98304
v_mfma_f32_16x16x32_bf16 v[164:167], v[84:87], v[48:51], v[164:167]
ds_read_b64_tr_b16 v[80:81], v14 offset:32768
s_mov_b32 s27, 1
s_mov_b32 s26, s24
v_mfma_f32_16x16x32_bf16 v[172:175], v[84:87], v[52:55], v[172:175]
ds_read_b64_tr_b16 v[82:83], v14 offset:33792
s_mov_b32 s48, 0
s_lshl_b32 s12, s22, 13
ds_read_b128 v[36:39], v10 offset:2048
v_mfma_f32_16x16x32_bf16 v[180:183], v[84:87], v[56:59], v[180:183]
s_nop 0
v_mfma_f32_16x16x32_bf16 v[188:191], v[84:87], v[60:63], v[188:191]
v_lshrrev_b32 v27, 4, v0
v_lshlrev_b32 v27, 2, v27
v_mfma_f32_16x16x32_bf16 v[192:195], v[64:67], v[48:51], v[192:195]
ds_read_b64_tr_b16 v[84:85], v15 offset:32768
v_and_b32 v28, 15, v0
ds_read_b128 v[40:43], v10 offset:4096
v_mfma_f32_16x16x32_bf16 v[200:203], v[64:67], v[52:55], v[200:203]
ds_read_b64_tr_b16 v[86:87], v15 offset:33792
v_cmp_gt_u32 s[52:53], v27, v28
v_mfma_f32_16x16x32_bf16 v[208:211], v[64:67], v[56:59], v[208:211]
v_add_u32 v27, 1, v27
v_mfma_f32_16x16x32_bf16 v[216:219], v[64:67], v[60:63], v[216:219]
v_cmp_gt_u32 s[54:55], v27, v28
ds_read_b128 v[44:47], v10 offset:6144
v_mfma_f32_16x16x32_bf16 v[196:199], v[68:71], v[48:51], v[196:199]
ds_read_b64_tr_b16 v[64:65], v16 offset:32768
v_add_u32 v27, 1, v27
v_mfma_f32_16x16x32_bf16 v[204:207], v[68:71], v[52:55], v[204:207]
ds_read_b64_tr_b16 v[66:67], v16 offset:33792
v_cmp_gt_u32 s[56:57], v27, v28
v_mfma_f32_16x16x32_bf16 v[212:215], v[68:71], v[56:59], v[212:215]
v_add_u32 v27, 1, v27
v_mfma_f32_16x16x32_bf16 v[220:223], v[68:71], v[60:63], v[220:223]
v_cmp_gt_u32 s[58:59], v27, v28
s_waitcnt lgkmcnt(9)
v_mfma_f32_16x16x32_bf16 v[224:227], v[72:75], v[32:35], v[224:227]
ds_read_b64_tr_b16 v[68:69], v17 offset:32768
v_add_u32 v27, 1, v27
s_waitcnt lgkmcnt(7)
v_mfma_f32_16x16x32_bf16 v[232:235], v[72:75], v[36:39], v[232:235]
ds_read_b64_tr_b16 v[70:71], v17 offset:33792
s_mov_b32 s70, 0x3e0293ee
s_mov_b32 s71, s70
s_waitcnt lgkmcnt(6)
v_mfma_f32_16x16x32_bf16 v[240:243], v[72:75], v[40:43], v[240:243]
s_lshl_b32 s64, s22, 14
s_add_u32 s64, s64, 32768
s_waitcnt lgkmcnt(4)
v_mfma_f32_16x16x32_bf16 v[248:251], v[72:75], v[44:47], v[248:251]
v_add_u32 v24, s64, v1
v_mfma_f32_16x16x32_bf16 v[228:231], v[76:79], v[32:35], v[228:231]
v_mfma_f32_16x16x32_bf16 v[236:239], v[76:79], v[36:39], v[236:239]
v_mfma_f32_16x16x32_bf16 v[244:247], v[76:79], v[40:43], v[244:247]
v_mfma_f32_16x16x32_bf16 v[252:255], v[76:79], v[44:47], v[252:255]
s_waitcnt vmcnt(1) lgkmcnt(0)
s_barrier
ds_read_b64_tr_b16 v[72:73], v18 offset:49152
ds_read_b64_tr_b16 v[74:75], v18 offset:50176
v_mfma_f32_16x16x32_bf16 v[160:163], v[80:83], v[32:35], v[160:163]
ds_read_b64_tr_b16 v[76:77], v19 offset:49152
v_mfma_f32_16x16x32_bf16 v[168:171], v[80:83], v[36:39], v[168:171]
ds_read_b64_tr_b16 v[78:79], v19 offset:50176
v_mfma_f32_16x16x32_bf16 v[176:179], v[80:83], v[40:43], v[176:179]
ds_read_b128 v[48:51], v11 offset:0
v_mfma_f32_16x16x32_bf16 v[184:187], v[80:83], v[44:47], v[184:187]
v_mfma_f32_16x16x32_bf16 v[164:167], v[84:87], v[32:35], v[164:167]
ds_read_b64_tr_b16 v[80:81], v14 offset:49152
v_mfma_f32_16x16x32_bf16 v[172:175], v[84:87], v[36:39], v[172:175]
ds_read_b64_tr_b16 v[82:83], v14 offset:50176
ds_read_b128 v[52:55], v11 offset:2048
v_mfma_f32_16x16x32_bf16 v[180:183], v[84:87], v[40:43], v[180:183]
v_mfma_f32_16x16x32_bf16 v[188:191], v[84:87], v[44:47], v[188:191]
v_mfma_f32_16x16x32_bf16 v[192:195], v[64:67], v[32:35], v[192:195]
ds_read_b64_tr_b16 v[84:85], v15 offset:49152
ds_read_b128 v[56:59], v11 offset:4096
v_mfma_f32_16x16x32_bf16 v[200:203], v[64:67], v[36:39], v[200:203]
ds_read_b64_tr_b16 v[86:87], v15 offset:50176
v_mfma_f32_16x16x32_bf16 v[208:211], v[64:67], v[40:43], v[208:211]
v_mfma_f32_16x16x32_bf16 v[216:219], v[64:67], v[44:47], v[216:219]
ds_read_b128 v[60:63], v11 offset:6144
v_mfma_f32_16x16x32_bf16 v[196:199], v[68:71], v[32:35], v[196:199]
ds_read_b64_tr_b16 v[64:65], v16 offset:49152
v_mfma_f32_16x16x32_bf16 v[204:207], v[68:71], v[36:39], v[204:207]
ds_read_b64_tr_b16 v[66:67], v16 offset:50176
v_mfma_f32_16x16x32_bf16 v[212:215], v[68:71], v[40:43], v[212:215]
v_mfma_f32_16x16x32_bf16 v[220:223], v[68:71], v[44:47], v[220:223]
s_waitcnt lgkmcnt(9)
v_mfma_f32_16x16x32_bf16 v[224:227], v[72:75], v[48:51], v[224:227]
ds_read_b64_tr_b16 v[68:69], v17 offset:49152
s_waitcnt lgkmcnt(7)
v_mfma_f32_16x16x32_bf16 v[232:235], v[72:75], v[52:55], v[232:235]
ds_read_b64_tr_b16 v[70:71], v17 offset:50176
s_waitcnt lgkmcnt(6)
v_mfma_f32_16x16x32_bf16 v[240:243], v[72:75], v[56:59], v[240:243]
s_waitcnt lgkmcnt(4)
v_mfma_f32_16x16x32_bf16 v[248:251], v[72:75], v[60:63], v[248:251]
v_mfma_f32_16x16x32_bf16 v[228:231], v[76:79], v[48:51], v[228:231]
v_mfma_f32_16x16x32_bf16 v[236:239], v[76:79], v[52:55], v[236:239]
v_mfma_f32_16x16x32_bf16 v[244:247], v[76:79], v[56:59], v[244:247]
v_mfma_f32_16x16x32_bf16 v[252:255], v[76:79], v[60:63], v[252:255]
s_waitcnt lgkmcnt(0)
s_barrier
v_mfma_f32_16x16x32_bf16 v[160:163], v[80:83], v[48:51], v[160:163]
v_mfma_f32_16x16x32_bf16 v[168:171], v[80:83], v[52:55], v[168:171]
v_mfma_f32_16x16x32_bf16 v[176:179], v[80:83], v[56:59], v[176:179]
v_mfma_f32_16x16x32_bf16 v[184:187], v[80:83], v[60:63], v[184:187]
v_mfma_f32_16x16x32_bf16 v[164:167], v[84:87], v[48:51], v[164:167]
v_mfma_f32_16x16x32_bf16 v[172:175], v[84:87], v[52:55], v[172:175]
v_mfma_f32_16x16x32_bf16 v[180:183], v[84:87], v[56:59], v[180:183]
v_mfma_f32_16x16x32_bf16 v[188:191], v[84:87], v[60:63], v[188:191]
v_mfma_f32_16x16x32_bf16 v[192:195], v[64:67], v[48:51], v[192:195]
v_mfma_f32_16x16x32_bf16 v[200:203], v[64:67], v[52:55], v[200:203]
v_mfma_f32_16x16x32_bf16 v[208:211], v[64:67], v[56:59], v[208:211]
v_mfma_f32_16x16x32_bf16 v[216:219], v[64:67], v[60:63], v[216:219]
v_mfma_f32_16x16x32_bf16 v[196:199], v[68:71], v[48:51], v[196:199]
v_mfma_f32_16x16x32_bf16 v[204:207], v[68:71], v[52:55], v[204:207]
v_mfma_f32_16x16x32_bf16 v[212:215], v[68:71], v[56:59], v[212:215]
v_mfma_f32_16x16x32_bf16 v[220:223], v[68:71], v[60:63], v[220:223]
v_pk_mul_f32 v[224:225], v[224:225], s[70:71]
v_pk_mul_f32 v[226:227], v[226:227], s[70:71]
v_pk_mul_f32 v[228:229], v[228:229], s[70:71]
v_pk_mul_f32 v[230:231], v[230:231], s[70:71]
v_cvt_pk_bf16_f32 v224, v224, v225
v_cvt_pk_bf16_f32 v225, v226, v227
v_cvt_pk_bf16_f32 v226, v228, v229
v_cvt_pk_bf16_f32 v227, v230, v231
ds_write_b128 v24, v[224:227] offset:2048
v_pk_mul_f32 v[232:233], v[232:233], s[70:71]
v_pk_mul_f32 v[234:235], v[234:235], s[70:71]
v_pk_mul_f32 v[236:237], v[236:237], s[70:71]
v_pk_mul_f32 v[238:239], v[238:239], s[70:71]
v_cvt_pk_bf16_f32 v232, v232, v233
v_cvt_pk_bf16_f32 v233, v234, v235
v_cvt_pk_bf16_f32 v234, v236, v237
v_cvt_pk_bf16_f32 v235, v238, v239
ds_write_b128 v24, v[232:235] offset:6144
v_pk_mul_f32 v[240:241], v[240:241], s[70:71]
v_pk_mul_f32 v[242:243], v[242:243], s[70:71]
v_pk_mul_f32 v[244:245], v[244:245], s[70:71]
v_pk_mul_f32 v[246:247], v[246:247], s[70:71]
v_cvt_pk_bf16_f32 v240, v240, v241
v_cvt_pk_bf16_f32 v241, v242, v243
v_cvt_pk_bf16_f32 v242, v244, v245
v_cvt_pk_bf16_f32 v243, v246, v247
ds_write_b128 v24, v[240:243] offset:10240
v_pk_mul_f32 v[248:249], v[248:249], s[70:71]
v_pk_mul_f32 v[250:251], v[250:251], s[70:71]
v_pk_mul_f32 v[252:253], v[252:253], s[70:71]
v_pk_mul_f32 v[254:255], v[254:255], s[70:71]
v_cvt_pk_bf16_f32 v248, v248, v249
v_cvt_pk_bf16_f32 v249, v250, v251
v_cvt_pk_bf16_f32 v250, v252, v253
v_cvt_pk_bf16_f32 v251, v254, v255
ds_write_b128 v24, v[248:251] offset:14336
v_pk_mul_f32 v[160:161], v[160:161], s[70:71]
v_pk_mul_f32 v[162:163], v[162:163], s[70:71]
v_pk_mul_f32 v[164:165], v[164:165], s[70:71]
v_pk_mul_f32 v[166:167], v[166:167], s[70:71]
v_cvt_pk_bf16_f32 v160, v160, v161
v_cvt_pk_bf16_f32 v161, v162, v163
v_cvt_pk_bf16_f32 v162, v164, v165
v_cvt_pk_bf16_f32 v163, v166, v167
ds_write_b128 v24, v[160:163] offset:0
v_pk_mul_f32 v[168:169], v[168:169], s[70:71]
v_pk_mul_f32 v[170:171], v[170:171], s[70:71]
v_pk_mul_f32 v[172:173], v[172:173], s[70:71]
v_pk_mul_f32 v[174:175], v[174:175], s[70:71]
v_cvt_pk_bf16_f32 v168, v168, v169
v_cvt_pk_bf16_f32 v169, v170, v171
v_cvt_pk_bf16_f32 v170, v172, v173
v_cvt_pk_bf16_f32 v171, v174, v175
ds_write_b128 v24, v[168:171] offset:4096
v_pk_mul_f32 v[176:177], v[176:177], s[70:71]
v_pk_mul_f32 v[178:179], v[178:179], s[70:71]
v_pk_mul_f32 v[180:181], v[180:181], s[70:71]
v_pk_mul_f32 v[182:183], v[182:183], s[70:71]
v_cvt_pk_bf16_f32 v176, v176, v177
v_cvt_pk_bf16_f32 v177, v178, v179
v_cvt_pk_bf16_f32 v178, v180, v181
v_cvt_pk_bf16_f32 v179, v182, v183
ds_write_b128 v24, v[176:179] offset:8192
v_pk_mul_f32 v[184:185], v[184:185], s[70:71]
v_pk_mul_f32 v[186:187], v[186:187], s[70:71]
v_pk_mul_f32 v[188:189], v[188:189], s[70:71]
v_pk_mul_f32 v[190:191], v[190:191], s[70:71]
v_cvt_pk_bf16_f32 v184, v184, v185
v_cvt_pk_bf16_f32 v185, v186, v187
v_cvt_pk_bf16_f32 v186, v188, v189
v_cvt_pk_bf16_f32 v187, v190, v191
ds_write_b128 v24, v[184:187] offset:12288
v_pk_mul_f32 v[192:193], v[192:193], s[70:71]
v_pk_mul_f32 v[194:195], v[194:195], s[70:71]
v_pk_mul_f32 v[196:197], v[196:197], s[70:71]
v_pk_mul_f32 v[198:199], v[198:199], s[70:71]
v_cvt_pk_bf16_f32 v192, v192, v193
v_cvt_pk_bf16_f32 v193, v194, v195
v_cvt_pk_bf16_f32 v194, v196, v197
v_cvt_pk_bf16_f32 v195, v198, v199
ds_write_b128 v24, v[192:195] offset:1024
v_pk_mul_f32 v[200:201], v[200:201], s[70:71]
v_pk_mul_f32 v[202:203], v[202:203], s[70:71]
v_pk_mul_f32 v[204:205], v[204:205], s[70:71]
v_pk_mul_f32 v[206:207], v[206:207], s[70:71]
v_cvt_pk_bf16_f32 v200, v200, v201
v_cvt_pk_bf16_f32 v201, v202, v203
v_cvt_pk_bf16_f32 v202, v204, v205
v_cvt_pk_bf16_f32 v203, v206, v207
ds_write_b128 v24, v[200:203] offset:5120
v_pk_mul_f32 v[208:209], v[208:209], s[70:71]
v_pk_mul_f32 v[210:211], v[210:211], s[70:71]
v_pk_mul_f32 v[212:213], v[212:213], s[70:71]
v_pk_mul_f32 v[214:215], v[214:215], s[70:71]
v_cvt_pk_bf16_f32 v208, v208, v209
v_cvt_pk_bf16_f32 v209, v210, v211
v_cvt_pk_bf16_f32 v210, v212, v213
v_cvt_pk_bf16_f32 v211, v214, v215
ds_write_b128 v24, v[208:211] offset:9216
v_pk_mul_f32 v[216:217], v[216:217], s[70:71]
v_pk_mul_f32 v[218:219], v[218:219], s[70:71]
v_pk_mul_f32 v[220:221], v[220:221], s[70:71]
v_pk_mul_f32 v[222:223], v[222:223], s[70:71]
v_cvt_pk_bf16_f32 v216, v216, v217
v_cvt_pk_bf16_f32 v217, v218, v219
v_cvt_pk_bf16_f32 v218, v220, v221
v_cvt_pk_bf16_f32 v219, v222, v223
ds_write_b128 v24, v[216:219] offset:13312
s_waitcnt lgkmcnt(0)
s_barrier
v_add_u32 v3, s12, v1
v_add_u32 v2, 98304, v1
ds_read_b128 v[16:19], v3 offset:32768
ds_read_b128 v[32:35], v3 offset:36864
ds_read_b128 v[208:211], v2 offset:16384
ds_read_b128 v[20:23], v3 offset:33792
ds_read_b128 v[36:39], v3 offset:37888
ds_read_b128 v[212:215], v2 offset:17408
ds_read_b128 v[24:27], v3 offset:34816
ds_read_b128 v[40:43], v3 offset:38912
ds_read_b128 v[216:219], v2 offset:18432
ds_read_b128 v[28:31], v3 offset:35840
ds_read_b128 v[44:47], v3 offset:39936
ds_read_b128 v[220:223], v2 offset:19456
ds_read_b128 v[224:227], v2 offset:20480
ds_read_b128 v[228:231], v2 offset:21504
ds_read_b128 v[232:235], v2 offset:22528
ds_read_b128 v[236:239], v2 offset:23552
s_lshr_b32 s12, s12, 6
v_and_b32 v9, 15, v0
v_lshl_add_u32 v10, v9, 2, s12
v_mov_b32 v240, 0xff800000
v_mov_b32 v252, 0x3f803f80
v_mov_b32 v253, 0x3f803f80
v_mov_b32 v254, 0x3f803f80
v_mov_b32 v255, 0x3f803f80
s_waitcnt lgkmcnt(13)
v_mfma_f32_16x16x32_bf16 v[128:131], v[208:211], v[16:19], 0
v_mfma_f32_16x16x32_bf16 v[136:139], v[208:211], v[32:35], 0
s_waitcnt lgkmcnt(10)
v_mfma_f32_16x16x32_bf16 v[128:131], v[212:215], v[20:23], v[128:131]
v_mfma_f32_16x16x32_bf16 v[136:139], v[212:215], v[36:39], v[136:139]
s_waitcnt lgkmcnt(7)
v_mfma_f32_16x16x32_bf16 v[128:131], v[216:219], v[24:27], v[128:131]
v_mfma_f32_16x16x32_bf16 v[136:139], v[216:219], v[40:43], v[136:139]
s_waitcnt lgkmcnt(4)
v_mfma_f32_16x16x32_bf16 v[128:131], v[220:223], v[28:31], v[128:131]
v_mfma_f32_16x16x32_bf16 v[136:139], v[220:223], v[44:47], v[136:139]
s_waitcnt lgkmcnt(3)
v_mfma_f32_16x16x32_bf16 v[132:135], v[224:227], v[16:19], 0
ds_read_b128 v[176:179], v2 offset:0
v_mfma_f32_16x16x32_bf16 v[140:143], v[224:227], v[32:35], 0
ds_read_b128 v[180:183], v2 offset:1024
s_waitcnt lgkmcnt(4)
v_mfma_f32_16x16x32_bf16 v[132:135], v[228:231], v[20:23], v[132:135]
ds_read_b128 v[184:187], v2 offset:2048
v_mfma_f32_16x16x32_bf16 v[140:143], v[228:231], v[36:39], v[140:143]
ds_read_b128 v[188:191], v2 offset:3072
s_waitcnt lgkmcnt(5)
v_mfma_f32_16x16x32_bf16 v[132:135], v[232:235], v[24:27], v[132:135]
ds_read_b128 v[192:195], v2 offset:4096
v_mfma_f32_16x16x32_bf16 v[140:143], v[232:235], v[40:43], v[140:143]
ds_read_b128 v[196:199], v2 offset:5120
s_waitcnt lgkmcnt(6)
v_mfma_f32_16x16x32_bf16 v[132:135], v[236:239], v[28:31], v[132:135]
ds_read_b128 v[200:203], v2 offset:6144
v_mfma_f32_16x16x32_bf16 v[140:143], v[236:239], v[44:47], v[140:143]
ds_read_b128 v[204:207], v2 offset:7168
s_waitcnt lgkmcnt(8)
s_barrier
v_max3_f32 v12, v128, v129, v129
v_max3_f32 v12, v130, v131, v12
s_nop 0
v_max3_f32 v12, v132, v133, v12
v_max3_f32 v12, v134, v135, v12
v_max3_f32 v13, v136, v137, v137
v_max3_f32 v13, v138, v139, v13
v_max3_f32 v13, v140, v141, v13
v_max3_f32 v13, v142, v143, v13
v_mov_b32 v14, v12
s_nop 1
v_permlane16_swap_b32 v14, v12
v_max_f32 v12, v14, v12
v_mov_b32 v14, v12
s_nop 1
v_permlane32_swap_b32 v14, v12
v_max_f32 v12, v14, v12
v_mov_b32 v15, v13
s_nop 1
v_permlane16_swap_b32 v15, v13
v_max_f32 v13, v15, v13
v_mov_b32 v15, v13
s_nop 1
v_permlane32_swap_b32 v15, v13
v_max_f32 v13, v15, v13
v_sub_f32 v48, 0, v12
v_sub_f32 v49, 0, v12
v_sub_f32 v50, 0, v12
v_sub_f32 v51, 0, v12
v_sub_f32 v56, 0, v12
v_sub_f32 v57, 0, v12
v_sub_f32 v58, 0, v12
v_sub_f32 v59, 0, v12
v_sub_f32 v52, 0, v13
v_sub_f32 v53, 0, v13
v_sub_f32 v54, 0, v13
v_sub_f32 v55, 0, v13
v_sub_f32 v60, 0, v13
v_sub_f32 v61, 0, v13
v_sub_f32 v62, 0, v13
v_sub_f32 v63, 0, v13
v_sub_f32 v128, v128, v12
v_sub_f32 v129, v129, v12
v_sub_f32 v130, v130, v12
v_sub_f32 v131, v131, v12
v_sub_f32 v132, v132, v12
v_sub_f32 v133, v133, v12
v_sub_f32 v134, v134, v12
v_sub_f32 v135, v135, v12
v_sub_f32 v136, v136, v13
v_sub_f32 v137, v137, v13
v_sub_f32 v138, v138, v13
v_sub_f32 v139, v139, v13
v_sub_f32 v140, v140, v13
v_sub_f32 v141, v141, v13
v_sub_f32 v142, v142, v13
v_sub_f32 v143, v143, v13
s_waitcnt lgkmcnt(7)
v_mfma_f32_16x16x32_bf16 v[144:147], v[176:179], v[16:19], v[48:51]
v_exp_f32 v128, v128
v_mfma_f32_16x16x32_bf16 v[152:155], v[176:179], v[32:35], v[52:55]
v_exp_f32 v129, v129
ds_read_b128 v[176:179], v2 offset:8192
s_waitcnt lgkmcnt(7)
v_mfma_f32_16x16x32_bf16 v[144:147], v[180:183], v[20:23], v[144:147]
v_exp_f32 v130, v130
v_cvt_pk_bf16_f32 v160, v128, v129
v_mfma_f32_16x16x32_bf16 v[152:155], v[180:183], v[36:39], v[152:155]
v_exp_f32 v131, v131
s_add_u32 s38, s38, 32768
ds_read_b128 v[180:183], v2 offset:9216
s_waitcnt lgkmcnt(7)
v_mfma_f32_16x16x32_bf16 v[144:147], v[184:187], v[24:27], v[144:147]
v_exp_f32 v132, v132
v_cvt_pk_bf16_f32 v161, v130, v131
v_mfma_f32_16x16x32_bf16 v[152:155], v[184:187], v[40:43], v[152:155]
v_exp_f32 v133, v133
ds_read_b128 v[184:187], v2 offset:10240
s_waitcnt lgkmcnt(7)
v_mfma_f32_16x16x32_bf16 v[144:147], v[188:191], v[28:31], v[144:147]
v_exp_f32 v134, v134
v_cvt_pk_bf16_f32 v162, v132, v133
v_mfma_f32_16x16x32_bf16 v[152:155], v[188:191], v[44:47], v[152:155]
v_exp_f32 v135, v135
s_cmp_eq_u32 s38, 163840
s_cselect_b32 s38, 0, s38
ds_read_b128 v[188:191], v2 offset:11264
s_waitcnt lgkmcnt(7)
v_mfma_f32_16x16x32_bf16 v[148:151], v[192:195], v[16:19], v[56:59]
v_exp_f32 v136, v136
v_cvt_pk_bf16_f32 v163, v134, v135
v_mfma_f32_16x16x32_bf16 v[156:159], v[192:195], v[32:35], v[60:63]
v_exp_f32 v137, v137
ds_read_b128 v[192:195], v2 offset:12288
s_waitcnt lgkmcnt(7)
v_mfma_f32_16x16x32_bf16 v[148:151], v[196:199], v[20:23], v[148:151]
v_exp_f32 v138, v138
v_cvt_pk_bf16_f32 v164, v136, v137
v_mfma_f32_16x16x32_bf16 v[156:159], v[196:199], v[36:39], v[156:159]
v_exp_f32 v139, v139
v_add_u32 v3, s38, v1
ds_read_b128 v[196:199], v2 offset:13312
s_waitcnt lgkmcnt(7)
v_mfma_f32_16x16x32_bf16 v[148:151], v[200:203], v[24:27], v[148:151]
v_exp_f32 v140, v140
v_cvt_pk_bf16_f32 v165, v138, v139
v_mfma_f32_16x16x32_bf16 v[156:159], v[200:203], v[40:43], v[156:159]
v_exp_f32 v141, v141
ds_read_b128 v[200:203], v2 offset:14336
s_waitcnt lgkmcnt(7)
v_mfma_f32_16x16x32_bf16 v[148:151], v[204:207], v[28:31], v[148:151]
v_exp_f32 v142, v142
v_cvt_pk_bf16_f32 v166, v140, v141
v_mfma_f32_16x16x32_bf16 v[156:159], v[204:207], v[44:47], v[156:159]
v_exp_f32 v143, v143
ds_read_b128 v[204:207], v2 offset:15360
v_cvt_pk_bf16_f32 v167, v142, v143
s_cmp_lt_u32 s22, 2
s_cselect_b32 s72, s78, s76
s_cselect_b32 s73, s79, s77
s_mov_b32 s74, 0x80000
s_cselect_b32 s74, 0x400000, s74
s_lshl_b32 s68, s2, 1
s_and_b32 s69, s22, 1
s_add_u32 s68, s68, s69
s_lshl_b32 s68, s68, 13
s_and_b32 s73, s73, 0xffff
s_mov_b32 s75, 0x20000
v_lshlrev_b32 v242, 7, v0
v_add_u32 v242, s68, v242
buffer_load_dword v241, v242, s[72:75], 0 offen
s_waitcnt lgkmcnt(4)
v_mfma_f32_16x16x32_bf16 v[128:131], v[176:179], v[16:19], v[48:51]
v_exp_f32 v144, v144
v_mfma_f32_16x16x32_bf16 v[136:139], v[176:179], v[32:35], v[52:55]
ds_read_b128 v[208:211], v2 offset:24576
ds_read_b128 v[212:215], v2 offset:25600
v_mfma_f32_16x16x32_bf16 v[128:131], v[180:183], v[20:23], v[128:131]
v_exp_f32 v145, v145
v_mfma_f32_16x16x32_bf16 v[136:139], v[180:183], v[36:39], v[136:139]
v_cvt_pk_bf16_f32 v168, v144, v145
v_mfma_f32_16x16x32_bf16 v[128:131], v[184:187], v[24:27], v[128:131]
v_exp_f32 v146, v146
v_mfma_f32_16x16x32_bf16 v[136:139], v[184:187], v[40:43], v[136:139]
ds_read_b128 v[216:219], v2 offset:26624
ds_read_b128 v[220:223], v2 offset:27648
v_mfma_f32_16x16x32_bf16 v[128:131], v[188:191], v[28:31], v[128:131]
v_exp_f32 v147, v147
v_mfma_f32_16x16x32_bf16 v[136:139], v[188:191], v[44:47], v[136:139]
v_cvt_pk_bf16_f32 v169, v146, v147
s_waitcnt lgkmcnt(4)
v_mfma_f32_16x16x32_bf16 v[132:135], v[192:195], v[16:19], v[56:59]
v_exp_f32 v148, v148
v_mfma_f32_16x16x32_bf16 v[140:143], v[192:195], v[32:35], v[60:63]
ds_read_b128 v[224:227], v2 offset:28672
ds_read_b128 v[228:231], v2 offset:29696
v_mfma_f32_16x16x32_bf16 v[132:135], v[196:199], v[20:23], v[132:135]
v_exp_f32 v149, v149
v_mfma_f32_16x16x32_bf16 v[140:143], v[196:199], v[36:39], v[140:143]
v_cvt_pk_bf16_f32 v170, v148, v149
v_mfma_f32_16x16x32_bf16 v[132:135], v[200:203], v[24:27], v[132:135]
v_exp_f32 v150, v150
v_mfma_f32_16x16x32_bf16 v[140:143], v[200:203], v[40:43], v[140:143]
ds_read_b128 v[232:235], v2 offset:30720
ds_read_b128 v[236:239], v2 offset:31744
v_mfma_f32_16x16x32_bf16 v[132:135], v[204:207], v[28:31], v[132:135]
v_exp_f32 v151, v151
v_mfma_f32_16x16x32_bf16 v[140:143], v[204:207], v[44:47], v[140:143]
v_cvt_pk_bf16_f32 v171, v150, v151
s_waitcnt lgkmcnt(4)
v_mfma_f32_16x16x32_bf16 v[64:67], v[208:211], v[160:163], 0
v_exp_f32 v152, v152
v_mfma_f32_16x16x32_bf16 v[72:75], v[208:211], v[164:167], 0
ds_read_b128 v[176:179], v3 offset:0
ds_read_b128 v[180:183], v3 offset:1024
v_mfma_f32_16x16x32_bf16 v[68:71], v[212:215], v[160:163], 0
v_exp_f32 v153, v153
v_mfma_f32_16x16x32_bf16 v[76:79], v[212:215], v[164:167], 0
v_cvt_pk_bf16_f32 v172, v152, v153
v_mov_b32 v2, v3
v_mfma_f32_16x16x32_bf16 v[80:83], v[216:219], v[160:163], 0
v_exp_f32 v154, v154
s_add_u32 s27, s27, 1
v_mfma_f32_16x16x32_bf16 v[88:91], v[216:219], v[164:167], 0
ds_read_b128 v[184:187], v3 offset:2048
ds_read_b128 v[188:191], v3 offset:3072
v_mfma_f32_16x16x32_bf16 v[84:87], v[220:223], v[160:163], 0
v_exp_f32 v155, v155
v_mfma_f32_16x16x32_bf16 v[92:95], v[220:223], v[164:167], 0
v_cvt_pk_bf16_f32 v173, v154, v155
s_waitcnt lgkmcnt(4)
v_mfma_f32_16x16x32_bf16 v[96:99], v[224:227], v[160:163], 0
v_exp_f32 v156, v156
v_mfma_f32_16x16x32_bf16 v[104:107], v[224:227], v[164:167], 0
ds_read_b128 v[192:195], v3 offset:4096
ds_read_b128 v[196:199], v3 offset:5120
v_mfma_f32_16x16x32_bf16 v[100:103], v[228:231], v[160:163], 0
v_exp_f32 v157, v157
v_mfma_f32_16x16x32_bf16 v[108:111], v[228:231], v[164:167], 0
v_cvt_pk_bf16_f32 v174, v156, v157
v_mfma_f32_16x16x32_bf16 v[112:115], v[232:235], v[160:163], 0
v_exp_f32 v158, v158
v_mfma_f32_16x16x32_bf16 v[120:123], v[232:235], v[164:167], 0
ds_read_b128 v[200:203], v3 offset:6144
ds_read_b128 v[204:207], v3 offset:7168
v_mfma_f32_16x16x32_bf16 v[116:119], v[236:239], v[160:163], 0
v_exp_f32 v159, v159
v_mfma_f32_16x16x32_bf16 v[124:127], v[236:239], v[164:167], 0
v_cvt_pk_bf16_f32 v175, v158, v159
v_mfma_f32_16x16x32_bf16 v[244:247], v[252:255], v[160:163], 0
v_mfma_f32_16x16x32_bf16 v[248:251], v[252:255], v[164:167], 0
s_sub_u32 s26, s26, 2
s_cmp_lt_u32 s26, 3
.p2align 6
L_kk_kernel_c0_loop:
s_waitcnt lgkmcnt(4)
v_mfma_f32_16x16x32_bf16 v[144:147], v[176:179], v[16:19], v[48:51]
v_exp_f32 v128, v128
v_mfma_f32_16x16x32_bf16 v[152:155], v[176:179], v[32:35], v[52:55]
ds_read_b128 v[208:211], v2 offset:16384
ds_read_b128 v[212:215], v2 offset:17408
v_mfma_f32_16x16x32_bf16 v[144:147], v[180:183], v[20:23], v[144:147]
v_exp_f32 v129, v129
v_mfma_f32_16x16x32_bf16 v[152:155], v[180:183], v[36:39], v[152:155]
v_cvt_pk_bf16_f32 v160, v128, v129
s_add_u32 s38, s38, 32768
v_mfma_f32_16x16x32_bf16 v[144:147], v[184:187], v[24:27], v[144:147]
v_exp_f32 v130, v130
v_mfma_f32_16x16x32_bf16 v[152:155], v[184:187], v[40:43], v[152:155]
ds_read_b128 v[216:219], v2 offset:18432
ds_read_b128 v[220:223], v2 offset:19456
v_mfma_f32_16x16x32_bf16 v[144:147], v[188:191], v[28:31], v[144:147]
v_exp_f32 v131, v131
v_mfma_f32_16x16x32_bf16 v[152:155], v[188:191], v[44:47], v[152:155]
v_cvt_pk_bf16_f32 v161, v130, v131
s_waitcnt lgkmcnt(4)
v_mfma_f32_16x16x32_bf16 v[148:151], v[192:195], v[16:19], v[56:59]
v_exp_f32 v132, v132
v_mfma_f32_16x16x32_bf16 v[156:159], v[192:195], v[32:35], v[60:63]
ds_read_b128 v[224:227], v2 offset:20480
ds_read_b128 v[228:231], v2 offset:21504
v_mfma_f32_16x16x32_bf16 v[148:151], v[196:199], v[20:23], v[148:151]
v_exp_f32 v133, v133
v_mfma_f32_16x16x32_bf16 v[156:159], v[196:199], v[36:39], v[156:159]
v_cvt_pk_bf16_f32 v162, v132, v133
s_cmp_eq_u32 s38, 163840
s_cselect_b32 s38, 0, s38
v_mfma_f32_16x16x32_bf16 v[148:151], v[200:203], v[24:27], v[148:151]
v_exp_f32 v134, v134
v_mfma_f32_16x16x32_bf16 v[156:159], v[200:203], v[40:43], v[156:159]
ds_read_b128 v[232:235], v2 offset:22528
ds_read_b128 v[236:239], v2 offset:23552
v_mfma_f32_16x16x32_bf16 v[148:151], v[204:207], v[28:31], v[148:151]
v_exp_f32 v135, v135
v_mfma_f32_16x16x32_bf16 v[156:159], v[204:207], v[44:47], v[156:159]
v_cvt_pk_bf16_f32 v163, v134, v135
s_waitcnt lgkmcnt(4)
v_mfma_f32_16x16x32_bf16 v[64:67], v[208:211], v[168:171], v[64:67]
v_exp_f32 v136, v136
v_mfma_f32_16x16x32_bf16 v[72:75], v[208:211], v[172:175], v[72:75]
ds_read_b128 v[176:179], v2 offset:8192
ds_read_b128 v[180:183], v2 offset:9216
v_mfma_f32_16x16x32_bf16 v[68:71], v[212:215], v[168:171], v[68:71]
v_exp_f32 v137, v137
v_mfma_f32_16x16x32_bf16 v[76:79], v[212:215], v[172:175], v[76:79]
v_cvt_pk_bf16_f32 v164, v136, v137
v_add_u32 v3, s38, v1
v_mfma_f32_16x16x32_bf16 v[80:83], v[216:219], v[168:171], v[80:83]
v_exp_f32 v138, v138
v_mfma_f32_16x16x32_bf16 v[88:91], v[216:219], v[172:175], v[88:91]
ds_read_b128 v[184:187], v2 offset:10240
ds_read_b128 v[188:191], v2 offset:11264
v_mfma_f32_16x16x32_bf16 v[84:87], v[220:223], v[168:171], v[84:87]
v_exp_f32 v139, v139
v_mfma_f32_16x16x32_bf16 v[92:95], v[220:223], v[172:175], v[92:95]
v_cvt_pk_bf16_f32 v165, v138, v139
s_waitcnt lgkmcnt(4)
v_mfma_f32_16x16x32_bf16 v[96:99], v[224:227], v[168:171], v[96:99]
v_exp_f32 v140, v140
v_mfma_f32_16x16x32_bf16 v[104:107], v[224:227], v[172:175], v[104:107]
ds_read_b128 v[192:195], v2 offset:12288
ds_read_b128 v[196:199], v2 offset:13312
v_mfma_f32_16x16x32_bf16 v[100:103], v[228:231], v[168:171], v[100:103]
v_exp_f32 v141, v141
v_mfma_f32_16x16x32_bf16 v[108:111], v[228:231], v[172:175], v[108:111]
v_cvt_pk_bf16_f32 v166, v140, v141
v_mfma_f32_16x16x32_bf16 v[112:115], v[232:235], v[168:171], v[112:115]
v_exp_f32 v142, v142
v_mfma_f32_16x16x32_bf16 v[120:123], v[232:235], v[172:175], v[120:123]
ds_read_b128 v[200:203], v2 offset:14336
ds_read_b128 v[204:207], v2 offset:15360
v_mfma_f32_16x16x32_bf16 v[116:119], v[236:239], v[168:171], v[116:119]
v_exp_f32 v143, v143
v_mfma_f32_16x16x32_bf16 v[124:127], v[236:239], v[172:175], v[124:127]
v_cvt_pk_bf16_f32 v167, v142, v143
v_mfma_f32_16x16x32_bf16 v[244:247], v[252:255], v[168:171], v[244:247]
v_mfma_f32_16x16x32_bf16 v[248:251], v[252:255], v[172:175], v[248:251]
s_sub_u32 s26, s26, 2
s_waitcnt lgkmcnt(4)
v_mfma_f32_16x16x32_bf16 v[128:131], v[176:179], v[16:19], v[48:51]
v_exp_f32 v144, v144
v_mfma_f32_16x16x32_bf16 v[136:139], v[176:179], v[32:35], v[52:55]
ds_read_b128 v[208:211], v2 offset:24576
ds_read_b128 v[212:215], v2 offset:25600
v_mfma_f32_16x16x32_bf16 v[128:131], v[180:183], v[20:23], v[128:131]
v_exp_f32 v145, v145
v_mfma_f32_16x16x32_bf16 v[136:139], v[180:183], v[36:39], v[136:139]
v_cvt_pk_bf16_f32 v168, v144, v145
v_mfma_f32_16x16x32_bf16 v[128:131], v[184:187], v[24:27], v[128:131]
v_exp_f32 v146, v146
v_mfma_f32_16x16x32_bf16 v[136:139], v[184:187], v[40:43], v[136:139]
ds_read_b128 v[216:219], v2 offset:26624
ds_read_b128 v[220:223], v2 offset:27648
v_mfma_f32_16x16x32_bf16 v[128:131], v[188:191], v[28:31], v[128:131]
v_exp_f32 v147, v147
v_mfma_f32_16x16x32_bf16 v[136:139], v[188:191], v[44:47], v[136:139]
v_cvt_pk_bf16_f32 v169, v146, v147
s_waitcnt lgkmcnt(4)
v_mfma_f32_16x16x32_bf16 v[132:135], v[192:195], v[16:19], v[56:59]
v_exp_f32 v148, v148
v_mfma_f32_16x16x32_bf16 v[140:143], v[192:195], v[32:35], v[60:63]
ds_read_b128 v[224:227], v2 offset:28672
ds_read_b128 v[228:231], v2 offset:29696
v_mfma_f32_16x16x32_bf16 v[132:135], v[196:199], v[20:23], v[132:135]
v_exp_f32 v149, v149
v_mfma_f32_16x16x32_bf16 v[140:143], v[196:199], v[36:39], v[140:143]
v_cvt_pk_bf16_f32 v170, v148, v149
v_mfma_f32_16x16x32_bf16 v[132:135], v[200:203], v[24:27], v[132:135]
v_exp_f32 v150, v150
v_mfma_f32_16x16x32_bf16 v[140:143], v[200:203], v[40:43], v[140:143]
ds_read_b128 v[232:235], v2 offset:30720
ds_read_b128 v[236:239], v2 offset:31744
v_mfma_f32_16x16x32_bf16 v[132:135], v[204:207], v[28:31], v[132:135]
v_exp_f32 v151, v151
v_mfma_f32_16x16x32_bf16 v[140:143], v[204:207], v[44:47], v[140:143]
v_cvt_pk_bf16_f32 v171, v150, v151
s_barrier
s_waitcnt lgkmcnt(4)
v_mfma_f32_16x16x32_bf16 v[64:67], v[208:211], v[160:163], v[64:67]
v_exp_f32 v152, v152
v_mfma_f32_16x16x32_bf16 v[72:75], v[208:211], v[164:167], v[72:75]
ds_read_b128 v[176:179], v3 offset:0
ds_read_b128 v[180:183], v3 offset:1024
v_mfma_f32_16x16x32_bf16 v[68:71], v[212:215], v[160:163], v[68:71]
v_exp_f32 v153, v153
v_mov_b32 v2, v3
v_mfma_f32_16x16x32_bf16 v[76:79], v[212:215], v[164:167], v[76:79]
v_cvt_pk_bf16_f32 v172, v152, v153
s_add_u32 s27, s27, 1
v_mfma_f32_16x16x32_bf16 v[80:83], v[216:219], v[160:163], v[80:83]
v_exp_f32 v154, v154
v_mfma_f32_16x16x32_bf16 v[88:91], v[216:219], v[164:167], v[88:91]
ds_read_b128 v[184:187], v3 offset:2048
ds_read_b128 v[188:191], v3 offset:3072
v_mfma_f32_16x16x32_bf16 v[84:87], v[220:223], v[160:163], v[84:87]
v_exp_f32 v155, v155
v_mfma_f32_16x16x32_bf16 v[92:95], v[220:223], v[164:167], v[92:95]
v_cvt_pk_bf16_f32 v173, v154, v155
s_waitcnt lgkmcnt(4)
v_mfma_f32_16x16x32_bf16 v[96:99], v[224:227], v[160:163], v[96:99]
v_exp_f32 v156, v156
v_mfma_f32_16x16x32_bf16 v[104:107], v[224:227], v[164:167], v[104:107]
ds_read_b128 v[192:195], v3 offset:4096
ds_read_b128 v[196:199], v3 offset:5120
v_mfma_f32_16x16x32_bf16 v[100:103], v[228:231], v[160:163], v[100:103]
v_exp_f32 v157, v157
v_mfma_f32_16x16x32_bf16 v[108:111], v[228:231], v[164:167], v[108:111]
v_cvt_pk_bf16_f32 v174, v156, v157
v_mfma_f32_16x16x32_bf16 v[112:115], v[232:235], v[160:163], v[112:115]
v_exp_f32 v158, v158
v_mfma_f32_16x16x32_bf16 v[120:123], v[232:235], v[164:167], v[120:123]
ds_read_b128 v[200:203], v3 offset:6144
ds_read_b128 v[204:207], v3 offset:7168
v_mfma_f32_16x16x32_bf16 v[116:119], v[236:239], v[160:163], v[116:119]
v_exp_f32 v159, v159
v_mfma_f32_16x16x32_bf16 v[124:127], v[236:239], v[164:167], v[124:127]
v_cvt_pk_bf16_f32 v175, v158, v159
v_mfma_f32_16x16x32_bf16 v[244:247], v[252:255], v[160:163], v[244:247]
v_mfma_f32_16x16x32_bf16 v[248:251], v[252:255], v[164:167], v[248:251]
s_cmp_ge_u32 s26, 3
s_cbranch_scc1 L_kk_kernel_c0_loop
L_kk_kernel_c0_chk:
s_cmp_eq_u32 s26, 0
s_cbranch_scc1 L_kk_kernel_c0_tail0
s_cmp_eq_u32 s26, 1
s_cbranch_scc0 L_kk_kernel_c0_chk1
v_cndmask_b32 v48, v48, v240, s[52:53]
v_cndmask_b32 v60, v60, v240, s[52:53]
v_mov_b32 v56, v240
v_cndmask_b32 v49, v49, v240, s[54:55]
v_cndmask_b32 v61, v61, v240, s[54:55]
v_mov_b32 v57, v240
v_cndmask_b32 v50, v50, v240, s[56:57]
v_cndmask_b32 v62, v62, v240, s[56:57]
v_mov_b32 v58, v240
v_cndmask_b32 v51, v51, v240, s[58:59]
v_cndmask_b32 v63, v63, v240, s[58:59]
v_mov_b32 v59, v240
L_kk_kernel_c0_chk1:
s_waitcnt lgkmcnt(4)
v_mfma_f32_16x16x32_bf16 v[144:147], v[176:179], v[16:19], v[48:51]
v_exp_f32 v128, v128
v_mfma_f32_16x16x32_bf16 v[152:155], v[176:179], v[32:35], v[52:55]
ds_read_b128 v[208:211], v2 offset:16384
ds_read_b128 v[212:215], v2 offset:17408
v_mfma_f32_16x16x32_bf16 v[144:147], v[180:183], v[20:23], v[144:147]
v_exp_f32 v129, v129
v_mfma_f32_16x16x32_bf16 v[152:155], v[180:183], v[36:39], v[152:155]
v_cvt_pk_bf16_f32 v160, v128, v129
s_add_u32 s38, s38, 32768
v_mfma_f32_16x16x32_bf16 v[144:147], v[184:187], v[24:27], v[144:147]
v_exp_f32 v130, v130
v_mfma_f32_16x16x32_bf16 v[152:155], v[184:187], v[40:43], v[152:155]
ds_read_b128 v[216:219], v2 offset:18432
ds_read_b128 v[220:223], v2 offset:19456
v_mfma_f32_16x16x32_bf16 v[144:147], v[188:191], v[28:31], v[144:147]
v_exp_f32 v131, v131
v_mfma_f32_16x16x32_bf16 v[152:155], v[188:191], v[44:47], v[152:155]
v_cvt_pk_bf16_f32 v161, v130, v131
s_waitcnt lgkmcnt(4)
v_mfma_f32_16x16x32_bf16 v[148:151], v[192:195], v[16:19], v[56:59]
v_exp_f32 v132, v132
v_mfma_f32_16x16x32_bf16 v[156:159], v[192:195], v[32:35], v[60:63]
ds_read_b128 v[224:227], v2 offset:20480
ds_read_b128 v[228:231], v2 offset:21504
v_mfma_f32_16x16x32_bf16 v[148:151], v[196:199], v[20:23], v[148:151]
v_exp_f32 v133, v133
v_mfma_f32_16x16x32_bf16 v[156:159], v[196:199], v[36:39], v[156:159]
v_cvt_pk_bf16_f32 v162, v132, v133
s_cmp_eq_u32 s38, 163840
s_cselect_b32 s38, 0, s38
v_mfma_f32_16x16x32_bf16 v[148:151], v[200:203], v[24:27], v[148:151]
v_exp_f32 v134, v134
v_mfma_f32_16x16x32_bf16 v[156:159], v[200:203], v[40:43], v[156:159]
ds_read_b128 v[232:235], v2 offset:22528
ds_read_b128 v[236:239], v2 offset:23552
v_mfma_f32_16x16x32_bf16 v[148:151], v[204:207], v[28:31], v[148:151]
v_exp_f32 v135, v135
v_mfma_f32_16x16x32_bf16 v[156:159], v[204:207], v[44:47], v[156:159]
v_cvt_pk_bf16_f32 v163, v134, v135
s_waitcnt lgkmcnt(4)
v_mfma_f32_16x16x32_bf16 v[64:67], v[208:211], v[168:171], v[64:67]
v_exp_f32 v136, v136
v_mfma_f32_16x16x32_bf16 v[72:75], v[208:211], v[172:175], v[72:75]
ds_read_b128 v[176:179], v2 offset:8192
ds_read_b128 v[180:183], v2 offset:9216
v_mfma_f32_16x16x32_bf16 v[68:71], v[212:215], v[168:171], v[68:71]
v_exp_f32 v137, v137
v_mfma_f32_16x16x32_bf16 v[76:79], v[212:215], v[172:175], v[76:79]
v_cvt_pk_bf16_f32 v164, v136, v137
v_add_u32 v3, s38, v1
v_mfma_f32_16x16x32_bf16 v[80:83], v[216:219], v[168:171], v[80:83]
v_exp_f32 v138, v138
v_mfma_f32_16x16x32_bf16 v[88:91], v[216:219], v[172:175], v[88:91]
ds_read_b128 v[184:187], v2 offset:10240
ds_read_b128 v[188:191], v2 offset:11264
v_mfma_f32_16x16x32_bf16 v[84:87], v[220:223], v[168:171], v[84:87]
v_exp_f32 v139, v139
v_mfma_f32_16x16x32_bf16 v[92:95], v[220:223], v[172:175], v[92:95]
v_cvt_pk_bf16_f32 v165, v138, v139
s_waitcnt lgkmcnt(4)
v_mfma_f32_16x16x32_bf16 v[96:99], v[224:227], v[168:171], v[96:99]
v_exp_f32 v140, v140
v_mfma_f32_16x16x32_bf16 v[104:107], v[224:227], v[172:175], v[104:107]
ds_read_b128 v[192:195], v2 offset:12288
ds_read_b128 v[196:199], v2 offset:13312
v_mfma_f32_16x16x32_bf16 v[100:103], v[228:231], v[168:171], v[100:103]
v_exp_f32 v141, v141
v_mfma_f32_16x16x32_bf16 v[108:111], v[228:231], v[172:175], v[108:111]
v_cvt_pk_bf16_f32 v166, v140, v141
v_mfma_f32_16x16x32_bf16 v[112:115], v[232:235], v[168:171], v[112:115]
v_exp_f32 v142, v142
v_mfma_f32_16x16x32_bf16 v[120:123], v[232:235], v[172:175], v[120:123]
ds_read_b128 v[200:203], v2 offset:14336
ds_read_b128 v[204:207], v2 offset:15360
v_mfma_f32_16x16x32_bf16 v[116:119], v[236:239], v[168:171], v[116:119]
v_exp_f32 v143, v143
v_mfma_f32_16x16x32_bf16 v[124:127], v[236:239], v[172:175], v[124:127]
v_cvt_pk_bf16_f32 v167, v142, v143
v_mfma_f32_16x16x32_bf16 v[244:247], v[252:255], v[168:171], v[244:247]
v_mfma_f32_16x16x32_bf16 v[248:251], v[252:255], v[172:175], v[248:251]
s_cmp_eq_u32 s26, 1
s_cbranch_scc1 L_kk_kernel_c0_tail1
v_cndmask_b32 v48, v48, v240, s[52:53]
v_cndmask_b32 v60, v60, v240, s[52:53]
v_mov_b32 v56, v240
v_cndmask_b32 v49, v49, v240, s[54:55]
v_cndmask_b32 v61, v61, v240, s[54:55]
v_mov_b32 v57, v240
v_cndmask_b32 v50, v50, v240, s[56:57]
v_cndmask_b32 v62, v62, v240, s[56:57]
v_mov_b32 v58, v240
v_cndmask_b32 v51, v51, v240, s[58:59]
v_cndmask_b32 v63, v63, v240, s[58:59]
v_mov_b32 v59, v240
s_waitcnt lgkmcnt(4)
v_mfma_f32_16x16x32_bf16 v[128:131], v[176:179], v[16:19], v[48:51]
v_exp_f32 v144, v144
v_mfma_f32_16x16x32_bf16 v[136:139], v[176:179], v[32:35], v[52:55]
ds_read_b128 v[208:211], v2 offset:24576
ds_read_b128 v[212:215], v2 offset:25600
v_mfma_f32_16x16x32_bf16 v[128:131], v[180:183], v[20:23], v[128:131]
v_exp_f32 v145, v145
v_mfma_f32_16x16x32_bf16 v[136:139], v[180:183], v[36:39], v[136:139]
v_cvt_pk_bf16_f32 v168, v144, v145
v_mfma_f32_16x16x32_bf16 v[128:131], v[184:187], v[24:27], v[128:131]
v_exp_f32 v146, v146
v_mfma_f32_16x16x32_bf16 v[136:139], v[184:187], v[40:43], v[136:139]
ds_read_b128 v[216:219], v2 offset:26624
ds_read_b128 v[220:223], v2 offset:27648
v_mfma_f32_16x16x32_bf16 v[128:131], v[188:191], v[28:31], v[128:131]
v_exp_f32 v147, v147
v_mfma_f32_16x16x32_bf16 v[136:139], v[188:191], v[44:47], v[136:139]
v_cvt_pk_bf16_f32 v169, v146, v147
s_waitcnt lgkmcnt(4)
v_mfma_f32_16x16x32_bf16 v[132:135], v[192:195], v[16:19], v[56:59]
v_exp_f32 v148, v148
v_mfma_f32_16x16x32_bf16 v[140:143], v[192:195], v[32:35], v[60:63]
ds_read_b128 v[224:227], v2 offset:28672
ds_read_b128 v[228:231], v2 offset:29696
v_mfma_f32_16x16x32_bf16 v[132:135], v[196:199], v[20:23], v[132:135]
v_exp_f32 v149, v149
v_mfma_f32_16x16x32_bf16 v[140:143], v[196:199], v[36:39], v[140:143]
v_cvt_pk_bf16_f32 v170, v148, v149
v_mfma_f32_16x16x32_bf16 v[132:135], v[200:203], v[24:27], v[132:135]
v_exp_f32 v150, v150
v_mfma_f32_16x16x32_bf16 v[140:143], v[200:203], v[40:43], v[140:143]
ds_read_b128 v[232:235], v2 offset:30720
ds_read_b128 v[236:239], v2 offset:31744
v_mfma_f32_16x16x32_bf16 v[132:135], v[204:207], v[28:31], v[132:135]
v_exp_f32 v151, v151
v_mfma_f32_16x16x32_bf16 v[140:143], v[204:207], v[44:47], v[140:143]
v_cvt_pk_bf16_f32 v171, v150, v151
s_cmp_ge_u32 s27, s25
s_cbranch_scc1 L_kk_kernel_c0_cb1
s_barrier
L_kk_kernel_c0_cb1:
v_mov_b32 v2, v3
s_add_u32 s27, s27, 1
s_waitcnt lgkmcnt(4)
v_mfma_f32_16x16x32_bf16 v[64:67], v[208:211], v[160:163], v[64:67]
v_exp_f32 v152, v152
v_mfma_f32_16x16x32_bf16 v[72:75], v[208:211], v[164:167], v[72:75]
ds_read_b128 v[176:179], v3 offset:0
ds_read_b128 v[180:183], v3 offset:1024
v_mfma_f32_16x16x32_bf16 v[68:71], v[212:215], v[160:163], v[68:71]
v_exp_f32 v153, v153
v_mfma_f32_16x16x32_bf16 v[76:79], v[212:215], v[164:167], v[76:79]
v_cvt_pk_bf16_f32 v172, v152, v153
v_mfma_f32_16x16x32_bf16 v[80:83], v[216:219], v[160:163], v[80:83]
v_exp_f32 v154, v154
v_mfma_f32_16x16x32_bf16 v[88:91], v[216:219], v[164:167], v[88:91]
ds_read_b128 v[184:187], v3 offset:2048
ds_read_b128 v[188:191], v3 offset:3072
v_mfma_f32_16x16x32_bf16 v[84:87], v[220:223], v[160:163], v[84:87]
v_exp_f32 v155, v155
v_mfma_f32_16x16x32_bf16 v[92:95], v[220:223], v[164:167], v[92:95]
v_cvt_pk_bf16_f32 v173, v154, v155
s_waitcnt lgkmcnt(4)
v_mfma_f32_16x16x32_bf16 v[96:99], v[224:227], v[160:163], v[96:99]
v_exp_f32 v156, v156
v_mfma_f32_16x16x32_bf16 v[104:107], v[224:227], v[164:167], v[104:107]
ds_read_b128 v[192:195], v3 offset:4096
ds_read_b128 v[196:199], v3 offset:5120
v_mfma_f32_16x16x32_bf16 v[100:103], v[228:231], v[160:163], v[100:103]
v_exp_f32 v157, v157
v_mfma_f32_16x16x32_bf16 v[108:111], v[228:231], v[164:167], v[108:111]
v_cvt_pk_bf16_f32 v174, v156, v157
v_mfma_f32_16x16x32_bf16 v[112:115], v[232:235], v[160:163], v[112:115]
v_exp_f32 v158, v158
v_mfma_f32_16x16x32_bf16 v[120:123], v[232:235], v[164:167], v[120:123]
ds_read_b128 v[200:203], v3 offset:6144
ds_read_b128 v[204:207], v3 offset:7168
v_mfma_f32_16x16x32_bf16 v[116:119], v[236:239], v[160:163], v[116:119]
v_exp_f32 v159, v159
v_mfma_f32_16x16x32_bf16 v[124:127], v[236:239], v[164:167], v[124:127]
v_cvt_pk_bf16_f32 v175, v158, v159
v_mfma_f32_16x16x32_bf16 v[244:247], v[252:255], v[160:163], v[244:247]
v_mfma_f32_16x16x32_bf16 v[248:251], v[252:255], v[164:167], v[248:251]
L_kk_kernel_c0_tail0:
ds_read_b128 v[176:179], v2 offset:16384
ds_read_b128 v[180:183], v2 offset:17408
ds_read_b128 v[184:187], v2 offset:18432
ds_read_b128 v[188:191], v2 offset:19456
ds_read_b128 v[192:195], v2 offset:20480
ds_read_b128 v[196:199], v2 offset:21504
ds_read_b128 v[200:203], v2 offset:22528
ds_read_b128 v[204:207], v2 offset:23552
ds_read_b128 v[208:211], v2 offset:24576
ds_read_b128 v[212:215], v2 offset:25600
ds_read_b128 v[216:219], v2 offset:26624
ds_read_b128 v[220:223], v2 offset:27648
ds_read_b128 v[224:227], v2 offset:28672
ds_read_b128 v[228:231], v2 offset:29696
ds_read_b128 v[232:235], v2 offset:30720
ds_read_b128 v[236:239], v2 offset:31744
s_waitcnt lgkmcnt(15)
v_mfma_f32_16x16x32_bf16 v[64:67], v[176:179], v[168:171], v[64:67]
v_exp_f32 v128, v128
v_mfma_f32_16x16x32_bf16 v[72:75], v[176:179], v[172:175], v[72:75]
v_exp_f32 v129, v129
s_waitcnt lgkmcnt(14)
v_mfma_f32_16x16x32_bf16 v[68:71], v[180:183], v[168:171], v[68:71]
v_exp_f32 v130, v130
v_mfma_f32_16x16x32_bf16 v[76:79], v[180:183], v[172:175], v[76:79]
v_exp_f32 v131, v131
v_cvt_pk_bf16_f32 v160, v128, v129
s_waitcnt lgkmcnt(13)
v_mfma_f32_16x16x32_bf16 v[80:83], v[184:187], v[168:171], v[80:83]
v_exp_f32 v132, v132
v_mfma_f32_16x16x32_bf16 v[88:91], v[184:187], v[172:175], v[88:91]
v_exp_f32 v133, v133
v_cvt_pk_bf16_f32 v161, v130, v131
s_waitcnt lgkmcnt(12)
v_mfma_f32_16x16x32_bf16 v[84:87], v[188:191], v[168:171], v[84:87]
v_exp_f32 v134, v134
v_mfma_f32_16x16x32_bf16 v[92:95], v[188:191], v[172:175], v[92:95]
v_exp_f32 v135, v135
v_cvt_pk_bf16_f32 v162, v132, v133
s_waitcnt lgkmcnt(11)
v_mfma_f32_16x16x32_bf16 v[96:99], v[192:195], v[168:171], v[96:99]
v_exp_f32 v136, v136
v_mfma_f32_16x16x32_bf16 v[104:107], v[192:195], v[172:175], v[104:107]
v_exp_f32 v137, v137
v_cvt_pk_bf16_f32 v163, v134, v135
s_waitcnt lgkmcnt(10)
v_mfma_f32_16x16x32_bf16 v[100:103], v[196:199], v[168:171], v[100:103]
v_exp_f32 v138, v138
v_mfma_f32_16x16x32_bf16 v[108:111], v[196:199], v[172:175], v[108:111]
v_exp_f32 v139, v139
v_cvt_pk_bf16_f32 v164, v136, v137
s_waitcnt lgkmcnt(9)
v_mfma_f32_16x16x32_bf16 v[112:115], v[200:203], v[168:171], v[112:115]
v_exp_f32 v140, v140
v_mfma_f32_16x16x32_bf16 v[120:123], v[200:203], v[172:175], v[120:123]
v_exp_f32 v141, v141
v_cvt_pk_bf16_f32 v165, v138, v139
s_waitcnt lgkmcnt(8)
v_mfma_f32_16x16x32_bf16 v[116:119], v[204:207], v[168:171], v[116:119]
v_exp_f32 v142, v142
v_mfma_f32_16x16x32_bf16 v[124:127], v[204:207], v[172:175], v[124:127]
v_exp_f32 v143, v143
v_cvt_pk_bf16_f32 v166, v140, v141
v_mfma_f32_16x16x32_bf16 v[244:247], v[252:255], v[168:171], v[244:247]
v_mfma_f32_16x16x32_bf16 v[248:251], v[252:255], v[172:175], v[248:251]
v_cvt_pk_bf16_f32 v167, v142, v143
s_cmp_ge_u32 s27, s25
s_cbranch_scc1 L_kk_kernel_c0_cb2
s_barrier
L_kk_kernel_c0_cb2:
v_mov_b32 v2, v3
s_add_u32 s27, s27, 1
s_waitcnt lgkmcnt(7)
v_mfma_f32_16x16x32_bf16 v[64:67], v[208:211], v[160:163], v[64:67]
v_mfma_f32_16x16x32_bf16 v[72:75], v[208:211], v[164:167], v[72:75]
s_waitcnt lgkmcnt(6)
v_mfma_f32_16x16x32_bf16 v[68:71], v[212:215], v[160:163], v[68:71]
v_mfma_f32_16x16x32_bf16 v[76:79], v[212:215], v[164:167], v[76:79]
s_waitcnt lgkmcnt(5)
v_mfma_f32_16x16x32_bf16 v[80:83], v[216:219], v[160:163], v[80:83]
v_mfma_f32_16x16x32_bf16 v[88:91], v[216:219], v[164:167], v[88:91]
s_waitcnt lgkmcnt(4)
v_mfma_f32_16x16x32_bf16 v[84:87], v[220:223], v[160:163], v[84:87]
v_mfma_f32_16x16x32_bf16 v[92:95], v[220:223], v[164:167], v[92:95]
s_waitcnt lgkmcnt(3)
v_mfma_f32_16x16x32_bf16 v[96:99], v[224:227], v[160:163], v[96:99]
v_mfma_f32_16x16x32_bf16 v[104:107], v[224:227], v[164:167], v[104:107]
s_waitcnt lgkmcnt(2)
v_mfma_f32_16x16x32_bf16 v[100:103], v[228:231], v[160:163], v[100:103]
v_mfma_f32_16x16x32_bf16 v[108:111], v[228:231], v[164:167], v[108:111]
s_waitcnt lgkmcnt(1)
v_mfma_f32_16x16x32_bf16 v[112:115], v[232:235], v[160:163], v[112:115]
v_mfma_f32_16x16x32_bf16 v[120:123], v[232:235], v[164:167], v[120:123]
s_waitcnt lgkmcnt(0)
v_mfma_f32_16x16x32_bf16 v[116:119], v[236:239], v[160:163], v[116:119]
v_mfma_f32_16x16x32_bf16 v[124:127], v[236:239], v[164:167], v[124:127]
v_mfma_f32_16x16x32_bf16 v[244:247], v[252:255], v[160:163], v[244:247]
v_mfma_f32_16x16x32_bf16 v[248:251], v[252:255], v[164:167], v[248:251]
s_branch L_kk_kernel_c0_epi
L_kk_kernel_c0_tail1:
ds_read_b128 v[176:179], v2 offset:24576
ds_read_b128 v[180:183], v2 offset:25600
ds_read_b128 v[184:187], v2 offset:26624
ds_read_b128 v[188:191], v2 offset:27648
ds_read_b128 v[192:195], v2 offset:28672
ds_read_b128 v[196:199], v2 offset:29696
ds_read_b128 v[200:203], v2 offset:30720
ds_read_b128 v[204:207], v2 offset:31744
s_waitcnt lgkmcnt(7)
v_mfma_f32_16x16x32_bf16 v[64:67], v[176:179], v[160:163], v[64:67]
v_exp_f32 v144, v144
v_mfma_f32_16x16x32_bf16 v[72:75], v[176:179], v[164:167], v[72:75]
v_exp_f32 v145, v145
s_waitcnt lgkmcnt(6)
v_mfma_f32_16x16x32_bf16 v[68:71], v[180:183], v[160:163], v[68:71]
v_exp_f32 v146, v146
v_mfma_f32_16x16x32_bf16 v[76:79], v[180:183], v[164:167], v[76:79]
v_exp_f32 v147, v147
v_cvt_pk_bf16_f32 v168, v144, v145
s_waitcnt lgkmcnt(5)
v_mfma_f32_16x16x32_bf16 v[80:83], v[184:187], v[160:163], v[80:83]
v_exp_f32 v148, v148
v_mfma_f32_16x16x32_bf16 v[88:91], v[184:187], v[164:167], v[88:91]
v_exp_f32 v149, v149
v_cvt_pk_bf16_f32 v169, v146, v147
s_waitcnt lgkmcnt(4)
v_mfma_f32_16x16x32_bf16 v[84:87], v[188:191], v[160:163], v[84:87]
v_exp_f32 v150, v150
v_mfma_f32_16x16x32_bf16 v[92:95], v[188:191], v[164:167], v[92:95]
v_exp_f32 v151, v151
v_cvt_pk_bf16_f32 v170, v148, v149
s_waitcnt lgkmcnt(3)
v_mfma_f32_16x16x32_bf16 v[96:99], v[192:195], v[160:163], v[96:99]
v_exp_f32 v152, v152
v_mfma_f32_16x16x32_bf16 v[104:107], v[192:195], v[164:167], v[104:107]
v_exp_f32 v153, v153
v_cvt_pk_bf16_f32 v171, v150, v151
s_waitcnt lgkmcnt(2)
v_mfma_f32_16x16x32_bf16 v[100:103], v[196:199], v[160:163], v[100:103]
v_exp_f32 v154, v154
v_mfma_f32_16x16x32_bf16 v[108:111], v[196:199], v[164:167], v[108:111]
v_exp_f32 v155, v155
v_cvt_pk_bf16_f32 v172, v152, v153
s_waitcnt lgkmcnt(1)
v_mfma_f32_16x16x32_bf16 v[112:115], v[200:203], v[160:163], v[112:115]
v_exp_f32 v156, v156
v_mfma_f32_16x16x32_bf16 v[120:123], v[200:203], v[164:167], v[120:123]
v_exp_f32 v157, v157
v_cvt_pk_bf16_f32 v173, v154, v155
s_waitcnt lgkmcnt(0)
v_mfma_f32_16x16x32_bf16 v[116:119], v[204:207], v[160:163], v[116:119]
v_exp_f32 v158, v158
v_mfma_f32_16x16x32_bf16 v[124:127], v[204:207], v[164:167], v[124:127]
v_exp_f32 v159, v159
v_cvt_pk_bf16_f32 v174, v156, v157
v_mfma_f32_16x16x32_bf16 v[244:247], v[252:255], v[160:163], v[244:247]
v_mfma_f32_16x16x32_bf16 v[248:251], v[252:255], v[164:167], v[248:251]
v_cvt_pk_bf16_f32 v175, v158, v159
s_cmp_ge_u32 s27, s25
s_cbranch_scc1 L_kk_kernel_c0_cb3
s_barrier
L_kk_kernel_c0_cb3:
ds_read_b128 v[208:211], v3 offset:16384
ds_read_b128 v[212:215], v3 offset:17408
ds_read_b128 v[216:219], v3 offset:18432
ds_read_b128 v[220:223], v3 offset:19456
ds_read_b128 v[224:227], v3 offset:20480
ds_read_b128 v[228:231], v3 offset:21504
ds_read_b128 v[232:235], v3 offset:22528
ds_read_b128 v[236:239], v3 offset:23552
v_mov_b32 v2, v3
s_add_u32 s27, s27, 1
s_waitcnt lgkmcnt(7)
v_mfma_f32_16x16x32_bf16 v[64:67], v[208:211], v[168:171], v[64:67]
v_mfma_f32_16x16x32_bf16 v[72:75], v[208:211], v[172:175], v[72:75]
s_waitcnt lgkmcnt(6)
v_mfma_f32_16x16x32_bf16 v[68:71], v[212:215], v[168:171], v[68:71]
v_mfma_f32_16x16x32_bf16 v[76:79], v[212:215], v[172:175], v[76:79]
s_waitcnt lgkmcnt(5)
v_mfma_f32_16x16x32_bf16 v[80:83], v[216:219], v[168:171], v[80:83]
v_mfma_f32_16x16x32_bf16 v[88:91], v[216:219], v[172:175], v[88:91]
s_waitcnt lgkmcnt(4)
v_mfma_f32_16x16x32_bf16 v[84:87], v[220:223], v[168:171], v[84:87]
v_mfma_f32_16x16x32_bf16 v[92:95], v[220:223], v[172:175], v[92:95]
s_waitcnt lgkmcnt(3)
v_mfma_f32_16x16x32_bf16 v[96:99], v[224:227], v[168:171], v[96:99]
v_mfma_f32_16x16x32_bf16 v[104:107], v[224:227], v[172:175], v[104:107]
s_waitcnt lgkmcnt(2)
v_mfma_f32_16x16x32_bf16 v[100:103], v[228:231], v[168:171], v[100:103]
v_mfma_f32_16x16x32_bf16 v[108:111], v[228:231], v[172:175], v[108:111]
s_waitcnt lgkmcnt(1)
v_mfma_f32_16x16x32_bf16 v[112:115], v[232:235], v[168:171], v[112:115]
v_mfma_f32_16x16x32_bf16 v[120:123], v[232:235], v[172:175], v[120:123]
s_waitcnt lgkmcnt(0)
v_mfma_f32_16x16x32_bf16 v[116:119], v[236:239], v[168:171], v[116:119]
v_mfma_f32_16x16x32_bf16 v[124:127], v[236:239], v[172:175], v[124:127]
v_mfma_f32_16x16x32_bf16 v[244:247], v[252:255], v[168:171], v[244:247]
v_mfma_f32_16x16x32_bf16 v[248:251], v[252:255], v[172:175], v[248:251]
L_kk_kernel_c0_epi:
v_mov_b32 v11, 0x4e800000
v_mov_b32 v3, 0
s_nop 5
v_add_f32 v15, v244, v248
v_cmp_nle_f32 vcc, v15, v11
s_cmp_lg_u64 vcc, 0
s_cselect_b32 s48, 1, 0
s_cbranch_scc1 L_kk_kernel_c0_post
v_rcp_f32 v12, v244
v_rcp_f32 v13, v248
s_lshr_b32 s4, s24, 1
s_mul_i32 s4, s4, 589824
s_lshl_b32 s5, s20, 14
s_add_u32 s4, s4, s5
s_and_b32 s5, s24, 1
s_lshl_b32 s5, s5, 11
s_add_u32 s4, s4, s5
s_add_u32 s4, s4, 50331648
v_mul_f32 v64, v12, v64
v_mul_f32 v65, v12, v65
v_mul_f32 v66, v12, v66
v_mul_f32 v67, v12, v67
v_mul_f32 v68, v12, v68
v_mul_f32 v69, v12, v69
v_mul_f32 v70, v12, v70
v_mul_f32 v71, v12, v71
v_cvt_pk_bf16_f32 v64, v64, v65
v_cvt_pk_bf16_f32 v65, v66, v67
v_cvt_pk_bf16_f32 v66, v68, v69
v_cvt_pk_bf16_f32 v67, v70, v71
buffer_store_dwordx4 v[64:67], v1, s[44:47], s4 offen offset:0 sc1
v_mul_f32 v72, v13, v72
v_mul_f32 v73, v13, v73
v_mul_f32 v74, v13, v74
v_mul_f32 v75, v13, v75
v_mul_f32 v76, v13, v76
v_mul_f32 v77, v13, v77
v_mul_f32 v78, v13, v78
v_mul_f32 v79, v13, v79
v_cvt_pk_bf16_f32 v72, v72, v73
v_cvt_pk_bf16_f32 v73, v74, v75
v_cvt_pk_bf16_f32 v74, v76, v77
v_cvt_pk_bf16_f32 v75, v78, v79
buffer_store_dwordx4 v[72:75], v1, s[44:47], s4 offen offset:1024 sc1
s_add_u32 s4, s4, 4096
v_mul_f32 v80, v12, v80
v_mul_f32 v81, v12, v81
v_mul_f32 v82, v12, v82
v_mul_f32 v83, v12, v83
v_mul_f32 v84, v12, v84
v_mul_f32 v85, v12, v85
v_mul_f32 v86, v12, v86
v_mul_f32 v87, v12, v87
v_cvt_pk_bf16_f32 v80, v80, v81
v_cvt_pk_bf16_f32 v81, v82, v83
v_cvt_pk_bf16_f32 v82, v84, v85
v_cvt_pk_bf16_f32 v83, v86, v87
buffer_store_dwordx4 v[80:83], v1, s[44:47], s4 offen offset:0 sc1
v_mul_f32 v88, v13, v88
v_mul_f32 v89, v13, v89
v_mul_f32 v90, v13, v90
v_mul_f32 v91, v13, v91
v_mul_f32 v92, v13, v92
v_mul_f32 v93, v13, v93
v_mul_f32 v94, v13, v94
v_mul_f32 v95, v13, v95
v_cvt_pk_bf16_f32 v88, v88, v89
v_cvt_pk_bf16_f32 v89, v90, v91
v_cvt_pk_bf16_f32 v90, v92, v93
v_cvt_pk_bf16_f32 v91, v94, v95
buffer_store_dwordx4 v[88:91], v1, s[44:47], s4 offen offset:1024 sc1
s_add_u32 s4, s4, 4096
v_mul_f32 v96, v12, v96
v_mul_f32 v97, v12, v97
v_mul_f32 v98, v12, v98
v_mul_f32 v99, v12, v99
v_mul_f32 v100, v12, v100
v_mul_f32 v101, v12, v101
v_mul_f32 v102, v12, v102
v_mul_f32 v103, v12, v103
v_cvt_pk_bf16_f32 v96, v96, v97
v_cvt_pk_bf16_f32 v97, v98, v99
v_cvt_pk_bf16_f32 v98, v100, v101
v_cvt_pk_bf16_f32 v99, v102, v103
buffer_store_dwordx4 v[96:99], v1, s[44:47], s4 offen offset:0 sc1
v_mul_f32 v104, v13, v104
v_mul_f32 v105, v13, v105
v_mul_f32 v106, v13, v106
v_mul_f32 v107, v13, v107
v_mul_f32 v108, v13, v108
v_mul_f32 v109, v13, v109
v_mul_f32 v110, v13, v110
v_mul_f32 v111, v13, v111
v_cvt_pk_bf16_f32 v104, v104, v105
v_cvt_pk_bf16_f32 v105, v106, v107
v_cvt_pk_bf16_f32 v106, v108, v109
v_cvt_pk_bf16_f32 v107, v110, v111
buffer_store_dwordx4 v[104:107], v1, s[44:47], s4 offen offset:1024 sc1
s_add_u32 s4, s4, 4096
v_mul_f32 v112, v12, v112
v_mul_f32 v113, v12, v113
v_mul_f32 v114, v12, v114
v_mul_f32 v115, v12, v115
v_mul_f32 v116, v12, v116
v_mul_f32 v117, v12, v117
v_mul_f32 v118, v12, v118
v_mul_f32 v119, v12, v119
v_cvt_pk_bf16_f32 v112, v112, v113
v_cvt_pk_bf16_f32 v113, v114, v115
v_cvt_pk_bf16_f32 v114, v116, v117
v_cvt_pk_bf16_f32 v115, v118, v119
buffer_store_dwordx4 v[112:115], v1, s[44:47], s4 offen offset:0 sc1
v_mul_f32 v120, v13, v120
v_mul_f32 v121, v13, v121
v_mul_f32 v122, v13, v122
v_mul_f32 v123, v13, v123
v_mul_f32 v124, v13, v124
v_mul_f32 v125, v13, v125
v_mul_f32 v126, v13, v126
v_mul_f32 v127, v13, v127
v_cvt_pk_bf16_f32 v120, v120, v121
v_cvt_pk_bf16_f32 v121, v122, v123
v_cvt_pk_bf16_f32 v122, v124, v125
v_cvt_pk_bf16_f32 v123, v126, v127
buffer_store_dwordx4 v[120:123], v1, s[44:47], s4 offen offset:1024 sc1
L_kk_kernel_c0_post:
s_cmp_ge_u32 s27, s25
s_cbranch_scc1 L_kk_kernel_c0_postdone
s_cmp_ge_u32 s27, s25
s_cbranch_scc1 L_kk_kernel_c0_cb4
s_barrier
L_kk_kernel_c0_cb4:
s_add_u32 s27, s27, 1
s_branch L_kk_kernel_c0_post
L_kk_kernel_c0_postdone:
s_cmp_eq_u32 s48, 0
s_cbranch_scc1 L_kk_kernel_c0_nofb
v_mov_b32 v48, 0
v_mov_b32 v49, 0
v_mov_b32 v50, 0
v_mov_b32 v51, 0
v_mov_b32 v52, 0
v_mov_b32 v53, 0
v_mov_b32 v54, 0
v_mov_b32 v55, 0
v_mov_b32 v56, 0
v_mov_b32 v57, 0
v_mov_b32 v58, 0
v_mov_b32 v59, 0
v_mov_b32 v60, 0
v_mov_b32 v61, 0
v_mov_b32 v62, 0
v_mov_b32 v63, 0
v_mov_b32 v12, v240
v_mov_b32 v13, v240
s_add_u32 s10, s7, 16777216
s_mov_b32 s26, s24
L_kk_kernel_c0_fb1:
s_add_u32 s11, s10, 4096
buffer_load_dwordx4 v[176:179], v1, s[44:47], s10 offen offset:0 sc1
buffer_load_dwordx4 v[180:183], v1, s[44:47], s10 offen offset:1024 sc1
buffer_load_dwordx4 v[184:187], v1, s[44:47], s10 offen offset:2048 sc1
buffer_load_dwordx4 v[188:191], v1, s[44:47], s10 offen offset:3072 sc1
buffer_load_dwordx4 v[192:195], v1, s[44:47], s11 offen offset:0 sc1
buffer_load_dwordx4 v[196:199], v1, s[44:47], s11 offen offset:1024 sc1
buffer_load_dwordx4 v[200:203], v1, s[44:47], s11 offen offset:2048 sc1
buffer_load_dwordx4 v[204:207], v1, s[44:47], s11 offen offset:3072 sc1
s_cmp_eq_u32 s26, 0
s_cbranch_scc0 L_kk_kernel_c0_fb1n
v_cndmask_b32 v48, v48, v240, s[52:53]
v_cndmask_b32 v60, v60, v240, s[52:53]
v_mov_b32 v56, v240
v_cndmask_b32 v49, v49, v240, s[54:55]
v_cndmask_b32 v61, v61, v240, s[54:55]
v_mov_b32 v57, v240
v_cndmask_b32 v50, v50, v240, s[56:57]
v_cndmask_b32 v62, v62, v240, s[56:57]
v_mov_b32 v58, v240
v_cndmask_b32 v51, v51, v240, s[58:59]
v_cndmask_b32 v63, v63, v240, s[58:59]
v_mov_b32 v59, v240
L_kk_kernel_c0_fb1n:
s_waitcnt vmcnt(7)
v_mfma_f32_16x16x32_bf16 v[128:131], v[176:179], v[16:19], v[48:51]
v_mfma_f32_16x16x32_bf16 v[136:139], v[176:179], v[32:35], v[52:55]
s_waitcnt vmcnt(6)
v_mfma_f32_16x16x32_bf16 v[128:131], v[180:183], v[20:23], v[128:131]
v_mfma_f32_16x16x32_bf16 v[136:139], v[180:183], v[36:39], v[136:139]
s_waitcnt vmcnt(5)
v_mfma_f32_16x16x32_bf16 v[128:131], v[184:187], v[24:27], v[128:131]
v_mfma_f32_16x16x32_bf16 v[136:139], v[184:187], v[40:43], v[136:139]
s_waitcnt vmcnt(4)
v_mfma_f32_16x16x32_bf16 v[128:131], v[188:191], v[28:31], v[128:131]
v_mfma_f32_16x16x32_bf16 v[136:139], v[188:191], v[44:47], v[136:139]
s_waitcnt vmcnt(3)
v_mfma_f32_16x16x32_bf16 v[132:135], v[192:195], v[16:19], v[56:59]
v_mfma_f32_16x16x32_bf16 v[140:143], v[192:195], v[32:35], v[60:63]
s_waitcnt vmcnt(2)
v_mfma_f32_16x16x32_bf16 v[132:135], v[196:199], v[20:23], v[132:135]
v_mfma_f32_16x16x32_bf16 v[140:143], v[196:199], v[36:39], v[140:143]
s_waitcnt vmcnt(1)
v_mfma_f32_16x16x32_bf16 v[132:135], v[200:203], v[24:27], v[132:135]
v_mfma_f32_16x16x32_bf16 v[140:143], v[200:203], v[40:43], v[140:143]
s_waitcnt vmcnt(0)
v_mfma_f32_16x16x32_bf16 v[132:135], v[204:207], v[28:31], v[132:135]
v_mfma_f32_16x16x32_bf16 v[140:143], v[204:207], v[44:47], v[140:143]
v_max3_f32 v12, v128, v129, v12
v_max3_f32 v12, v130, v131, v12
s_nop 4
v_max3_f32 v12, v132, v133, v12
v_max3_f32 v12, v134, v135, v12
v_max3_f32 v13, v136, v137, v13
v_max3_f32 v13, v138, v139, v13
v_max3_f32 v13, v140, v141, v13
v_max3_f32 v13, v142, v143, v13
s_add_u32 s10, s10, 8192
s_cmp_eq_u32 s26, 0
s_cbranch_scc1 L_kk_kernel_c0_fb1d
s_sub_u32 s26, s26, 1
s_branch L_kk_kernel_c0_fb1
L_kk_kernel_c0_fb1d:
v_mov_b32 v14, v12
s_nop 1
v_permlane16_swap_b32 v14, v12
v_max_f32 v12, v14, v12
v_mov_b32 v14, v12
s_nop 1
v_permlane32_swap_b32 v14, v12
v_max_f32 v12, v14, v12
v_mov_b32 v14, v13
s_nop 1
v_permlane16_swap_b32 v14, v13
v_max_f32 v13, v14, v13
v_mov_b32 v14, v13
s_nop 1
v_permlane32_swap_b32 v14, v13
v_max_f32 v13, v14, v13
v_sub_f32 v48, 0, v12
v_sub_f32 v49, 0, v12
v_sub_f32 v50, 0, v12
v_sub_f32 v51, 0, v12
v_sub_f32 v56, 0, v12
v_sub_f32 v57, 0, v12
v_sub_f32 v58, 0, v12
v_sub_f32 v59, 0, v12
v_sub_f32 v52, 0, v13
v_sub_f32 v53, 0, v13
v_sub_f32 v54, 0, v13
v_sub_f32 v55, 0, v13
v_sub_f32 v60, 0, v13
v_sub_f32 v61, 0, v13
v_sub_f32 v62, 0, v13
v_sub_f32 v63, 0, v13
v_mov_b32 v64, 0
v_mov_b32 v65, 0
v_mov_b32 v66, 0
v_mov_b32 v67, 0
v_mov_b32 v68, 0
v_mov_b32 v69, 0
v_mov_b32 v70, 0
v_mov_b32 v71, 0
v_mov_b32 v72, 0
v_mov_b32 v73, 0
v_mov_b32 v74, 0
v_mov_b32 v75, 0
v_mov_b32 v76, 0
v_mov_b32 v77, 0
v_mov_b32 v78, 0
v_mov_b32 v79, 0
v_mov_b32 v80, 0
v_mov_b32 v81, 0
v_mov_b32 v82, 0
v_mov_b32 v83, 0
v_mov_b32 v84, 0
v_mov_b32 v85, 0
v_mov_b32 v86, 0
v_mov_b32 v87, 0
v_mov_b32 v88, 0
v_mov_b32 v89, 0
v_mov_b32 v90, 0
v_mov_b32 v91, 0
v_mov_b32 v92, 0
v_mov_b32 v93, 0
v_mov_b32 v94, 0
v_mov_b32 v95, 0
v_mov_b32 v96, 0
v_mov_b32 v97, 0
v_mov_b32 v98, 0
v_mov_b32 v99, 0
v_mov_b32 v100, 0
v_mov_b32 v101, 0
v_mov_b32 v102, 0
v_mov_b32 v103, 0
v_mov_b32 v104, 0
v_mov_b32 v105, 0
v_mov_b32 v106, 0
v_mov_b32 v107, 0
v_mov_b32 v108, 0
v_mov_b32 v109, 0
v_mov_b32 v110, 0
v_mov_b32 v111, 0
v_mov_b32 v112, 0
v_mov_b32 v113, 0
v_mov_b32 v114, 0
v_mov_b32 v115, 0
v_mov_b32 v116, 0
v_mov_b32 v117, 0
v_mov_b32 v118, 0
v_mov_b32 v119, 0
v_mov_b32 v120, 0
v_mov_b32 v121, 0
v_mov_b32 v122, 0
v_mov_b32 v123, 0
v_mov_b32 v124, 0
v_mov_b32 v125, 0
v_mov_b32 v126, 0
v_mov_b32 v127, 0
v_mov_b32 v244, 0
v_mov_b32 v245, 0
v_mov_b32 v246, 0
v_mov_b32 v247, 0
v_mov_b32 v248, 0
v_mov_b32 v249, 0
v_mov_b32 v250, 0
v_mov_b32 v251, 0
s_add_u32 s10, s7, 16777216
s_add_u32 s12, s7, 33554432
s_mov_b32 s26, s24
L_kk_kernel_c0_fb2:
s_add_u32 s11, s10, 4096
s_add_u32 s13, s12, 4096
buffer_load_dwordx4 v[176:179], v1, s[44:47], s10 offen offset:0 sc1
buffer_load_dwordx4 v[180:183], v1, s[44:47], s10 offen offset:1024 sc1
buffer_load_dwordx4 v[184:187], v1, s[44:47], s10 offen offset:2048 sc1
buffer_load_dwordx4 v[188:191], v1, s[44:47], s10 offen offset:3072 sc1
buffer_load_dwordx4 v[192:195], v1, s[44:47], s11 offen offset:0 sc1
buffer_load_dwordx4 v[196:199], v1, s[44:47], s11 offen offset:1024 sc1
buffer_load_dwordx4 v[200:203], v1, s[44:47], s11 offen offset:2048 sc1
buffer_load_dwordx4 v[204:207], v1, s[44:47], s11 offen offset:3072 sc1
buffer_load_dwordx4 v[208:211], v1, s[44:47], s12 offen offset:0 sc1
buffer_load_dwordx4 v[212:215], v1, s[44:47], s12 offen offset:1024 sc1
buffer_load_dwordx4 v[216:219], v1, s[44:47], s12 offen offset:2048 sc1
buffer_load_dwordx4 v[220:223], v1, s[44:47], s12 offen offset:3072 sc1
buffer_load_dwordx4 v[224:227], v1, s[44:47], s13 offen offset:0 sc1
buffer_load_dwordx4 v[228:231], v1, s[44:47], s13 offen offset:1024 sc1
buffer_load_dwordx4 v[232:235], v1, s[44:47], s13 offen offset:2048 sc1
buffer_load_dwordx4 v[236:239], v1, s[44:47], s13 offen offset:3072 sc1
s_cmp_eq_u32 s26, 0
s_cbranch_scc0 L_kk_kernel_c0_fb2n
v_cndmask_b32 v48, v48, v240, s[52:53]
v_cndmask_b32 v60, v60, v240, s[52:53]
v_mov_b32 v56, v240
v_cndmask_b32 v49, v49, v240, s[54:55]
v_cndmask_b32 v61, v61, v240, s[54:55]
v_mov_b32 v57, v240
v_cndmask_b32 v50, v50, v240, s[56:57]
v_cndmask_b32 v62, v62, v240, s[56:57]
v_mov_b32 v58, v240
v_cndmask_b32 v51, v51, v240, s[58:59]
v_cndmask_b32 v63, v63, v240, s[58:59]
v_mov_b32 v59, v240
L_kk_kernel_c0_fb2n:
s_waitcnt vmcnt(15)
v_mfma_f32_16x16x32_bf16 v[128:131], v[176:179], v[16:19], v[48:51]
v_mfma_f32_16x16x32_bf16 v[136:139], v[176:179], v[32:35], v[52:55]
s_waitcnt vmcnt(14)
v_mfma_f32_16x16x32_bf16 v[128:131], v[180:183], v[20:23], v[128:131]
v_mfma_f32_16x16x32_bf16 v[136:139], v[180:183], v[36:39], v[136:139]
s_waitcnt vmcnt(13)
v_mfma_f32_16x16x32_bf16 v[128:131], v[184:187], v[24:27], v[128:131]
v_mfma_f32_16x16x32_bf16 v[136:139], v[184:187], v[40:43], v[136:139]
s_waitcnt vmcnt(12)
v_mfma_f32_16x16x32_bf16 v[128:131], v[188:191], v[28:31], v[128:131]
v_mfma_f32_16x16x32_bf16 v[136:139], v[188:191], v[44:47], v[136:139]
s_waitcnt vmcnt(11)
v_mfma_f32_16x16x32_bf16 v[132:135], v[192:195], v[16:19], v[56:59]
v_mfma_f32_16x16x32_bf16 v[140:143], v[192:195], v[32:35], v[60:63]
s_waitcnt vmcnt(10)
v_mfma_f32_16x16x32_bf16 v[132:135], v[196:199], v[20:23], v[132:135]
v_mfma_f32_16x16x32_bf16 v[140:143], v[196:199], v[36:39], v[140:143]
s_waitcnt vmcnt(9)
v_mfma_f32_16x16x32_bf16 v[132:135], v[200:203], v[24:27], v[132:135]
v_mfma_f32_16x16x32_bf16 v[140:143], v[200:203], v[40:43], v[140:143]
s_waitcnt vmcnt(8)
v_mfma_f32_16x16x32_bf16 v[132:135], v[204:207], v[28:31], v[132:135]
v_mfma_f32_16x16x32_bf16 v[140:143], v[204:207], v[44:47], v[140:143]
v_exp_f32 v128, v128
v_exp_f32 v129, v129
v_exp_f32 v130, v130
v_exp_f32 v131, v131
s_nop 2
v_exp_f32 v132, v132
v_exp_f32 v133, v133
v_exp_f32 v134, v134
v_exp_f32 v135, v135
v_exp_f32 v136, v136
v_exp_f32 v137, v137
v_exp_f32 v138, v138
v_exp_f32 v139, v139
v_exp_f32 v140, v140
v_exp_f32 v141, v141
v_exp_f32 v142, v142
v_exp_f32 v143, v143
v_cvt_pk_bf16_f32 v160, v128, v129
v_cvt_pk_bf16_f32 v161, v130, v131
v_cvt_pk_bf16_f32 v162, v132, v133
v_cvt_pk_bf16_f32 v163, v134, v135
v_cvt_pk_bf16_f32 v164, v136, v137
v_cvt_pk_bf16_f32 v165, v138, v139
v_cvt_pk_bf16_f32 v166, v140, v141
v_cvt_pk_bf16_f32 v167, v142, v143
s_waitcnt vmcnt(7)
v_mfma_f32_16x16x32_bf16 v[64:67], v[208:211], v[160:163], v[64:67]
v_mfma_f32_16x16x32_bf16 v[72:75], v[208:211], v[164:167], v[72:75]
s_waitcnt vmcnt(6)
v_mfma_f32_16x16x32_bf16 v[68:71], v[212:215], v[160:163], v[68:71]
v_mfma_f32_16x16x32_bf16 v[76:79], v[212:215], v[164:167], v[76:79]
s_waitcnt vmcnt(5)
v_mfma_f32_16x16x32_bf16 v[80:83], v[216:219], v[160:163], v[80:83]
v_mfma_f32_16x16x32_bf16 v[88:91], v[216:219], v[164:167], v[88:91]
s_waitcnt vmcnt(4)
v_mfma_f32_16x16x32_bf16 v[84:87], v[220:223], v[160:163], v[84:87]
v_mfma_f32_16x16x32_bf16 v[92:95], v[220:223], v[164:167], v[92:95]
s_waitcnt vmcnt(3)
v_mfma_f32_16x16x32_bf16 v[96:99], v[224:227], v[160:163], v[96:99]
v_mfma_f32_16x16x32_bf16 v[104:107], v[224:227], v[164:167], v[104:107]
s_waitcnt vmcnt(2)
v_mfma_f32_16x16x32_bf16 v[100:103], v[228:231], v[160:163], v[100:103]
v_mfma_f32_16x16x32_bf16 v[108:111], v[228:231], v[164:167], v[108:111]
s_waitcnt vmcnt(1)
v_mfma_f32_16x16x32_bf16 v[112:115], v[232:235], v[160:163], v[112:115]
v_mfma_f32_16x16x32_bf16 v[120:123], v[232:235], v[164:167], v[120:123]
s_waitcnt vmcnt(0)
v_mfma_f32_16x16x32_bf16 v[116:119], v[236:239], v[160:163], v[116:119]
v_mfma_f32_16x16x32_bf16 v[124:127], v[236:239], v[164:167], v[124:127]
v_mfma_f32_16x16x32_bf16 v[244:247], v[252:255], v[160:163], v[244:247]
v_mfma_f32_16x16x32_bf16 v[248:251], v[252:255], v[164:167], v[248:251]
s_add_u32 s10, s10, 8192
s_add_u32 s12, s12, 8192
s_cmp_eq_u32 s26, 0
s_cbranch_scc1 L_kk_kernel_c0_fb2d
s_sub_u32 s26, s26, 1
s_branch L_kk_kernel_c0_fb2
L_kk_kernel_c0_fb2d:
s_nop 2
v_rcp_f32 v12, v244
v_rcp_f32 v13, v248
s_lshr_b32 s4, s24, 1
s_mul_i32 s4, s4, 589824
s_lshl_b32 s5, s20, 14
s_add_u32 s4, s4, s5
s_and_b32 s5, s24, 1
s_lshl_b32 s5, s5, 11
s_add_u32 s4, s4, s5
s_add_u32 s4, s4, 50331648
v_mul_f32 v64, v12, v64
v_mul_f32 v65, v12, v65
v_mul_f32 v66, v12, v66
v_mul_f32 v67, v12, v67
v_mul_f32 v68, v12, v68
v_mul_f32 v69, v12, v69
v_mul_f32 v70, v12, v70
v_mul_f32 v71, v12, v71
v_cvt_pk_bf16_f32 v64, v64, v65
v_cvt_pk_bf16_f32 v65, v66, v67
v_cvt_pk_bf16_f32 v66, v68, v69
v_cvt_pk_bf16_f32 v67, v70, v71
buffer_store_dwordx4 v[64:67], v1, s[44:47], s4 offen offset:0 sc1
v_mul_f32 v72, v13, v72
v_mul_f32 v73, v13, v73
v_mul_f32 v74, v13, v74
v_mul_f32 v75, v13, v75
v_mul_f32 v76, v13, v76
v_mul_f32 v77, v13, v77
v_mul_f32 v78, v13, v78
v_mul_f32 v79, v13, v79
v_cvt_pk_bf16_f32 v72, v72, v73
v_cvt_pk_bf16_f32 v73, v74, v75
v_cvt_pk_bf16_f32 v74, v76, v77
v_cvt_pk_bf16_f32 v75, v78, v79
buffer_store_dwordx4 v[72:75], v1, s[44:47], s4 offen offset:1024 sc1
s_add_u32 s4, s4, 4096
v_mul_f32 v80, v12, v80
v_mul_f32 v81, v12, v81
v_mul_f32 v82, v12, v82
v_mul_f32 v83, v12, v83
v_mul_f32 v84, v12, v84
v_mul_f32 v85, v12, v85
v_mul_f32 v86, v12, v86
v_mul_f32 v87, v12, v87
v_cvt_pk_bf16_f32 v80, v80, v81
v_cvt_pk_bf16_f32 v81, v82, v83
v_cvt_pk_bf16_f32 v82, v84, v85
v_cvt_pk_bf16_f32 v83, v86, v87
buffer_store_dwordx4 v[80:83], v1, s[44:47], s4 offen offset:0 sc1
v_mul_f32 v88, v13, v88
v_mul_f32 v89, v13, v89
v_mul_f32 v90, v13, v90
v_mul_f32 v91, v13, v91
v_mul_f32 v92, v13, v92
v_mul_f32 v93, v13, v93
v_mul_f32 v94, v13, v94
v_mul_f32 v95, v13, v95
v_cvt_pk_bf16_f32 v88, v88, v89
v_cvt_pk_bf16_f32 v89, v90, v91
v_cvt_pk_bf16_f32 v90, v92, v93
v_cvt_pk_bf16_f32 v91, v94, v95
buffer_store_dwordx4 v[88:91], v1, s[44:47], s4 offen offset:1024 sc1
s_add_u32 s4, s4, 4096
v_mul_f32 v96, v12, v96
v_mul_f32 v97, v12, v97
v_mul_f32 v98, v12, v98
v_mul_f32 v99, v12, v99
v_mul_f32 v100, v12, v100
v_mul_f32 v101, v12, v101
v_mul_f32 v102, v12, v102
v_mul_f32 v103, v12, v103
v_cvt_pk_bf16_f32 v96, v96, v97
v_cvt_pk_bf16_f32 v97, v98, v99
v_cvt_pk_bf16_f32 v98, v100, v101
v_cvt_pk_bf16_f32 v99, v102, v103
buffer_store_dwordx4 v[96:99], v1, s[44:47], s4 offen offset:0 sc1
v_mul_f32 v104, v13, v104
v_mul_f32 v105, v13, v105
v_mul_f32 v106, v13, v106
v_mul_f32 v107, v13, v107
v_mul_f32 v108, v13, v108
v_mul_f32 v109, v13, v109
v_mul_f32 v110, v13, v110
v_mul_f32 v111, v13, v111
v_cvt_pk_bf16_f32 v104, v104, v105
v_cvt_pk_bf16_f32 v105, v106, v107
v_cvt_pk_bf16_f32 v106, v108, v109
v_cvt_pk_bf16_f32 v107, v110, v111
buffer_store_dwordx4 v[104:107], v1, s[44:47], s4 offen offset:1024 sc1
s_add_u32 s4, s4, 4096
v_mul_f32 v112, v12, v112
v_mul_f32 v113, v12, v113
v_mul_f32 v114, v12, v114
v_mul_f32 v115, v12, v115
v_mul_f32 v116, v12, v116
v_mul_f32 v117, v12, v117
v_mul_f32 v118, v12, v118
v_mul_f32 v119, v12, v119
v_cvt_pk_bf16_f32 v112, v112, v113
v_cvt_pk_bf16_f32 v113, v114, v115
v_cvt_pk_bf16_f32 v114, v116, v117
v_cvt_pk_bf16_f32 v115, v118, v119
buffer_store_dwordx4 v[112:115], v1, s[44:47], s4 offen offset:0 sc1
v_mul_f32 v120, v13, v120
v_mul_f32 v121, v13, v121
v_mul_f32 v122, v13, v122
v_mul_f32 v123, v13, v123
v_mul_f32 v124, v13, v124
v_mul_f32 v125, v13, v125
v_mul_f32 v126, v13, v126
v_mul_f32 v127, v13, v127
v_cvt_pk_bf16_f32 v120, v120, v121
v_cvt_pk_bf16_f32 v121, v122, v123
v_cvt_pk_bf16_f32 v122, v124, v125
v_cvt_pk_bf16_f32 v123, v126, v127
buffer_store_dwordx4 v[120:123], v1, s[44:47], s4 offen offset:1024 sc1
L_kk_kernel_c0_nofb:
s_mov_b32 s4, s100
s_and_b32 s5, s101, 0xffff
s_mov_b32 s6, 2097152
s_mov_b32 s7, 0x20000
s_mov_b32 s8, s78
s_and_b32 s9, s79, 0xffff
s_mov_b32 s10, 4194304
s_mov_b32 s11, 0x20000
s_mov_b32 s12, s76
s_and_b32 s13, s77, 0xffff
s_mov_b32 s14, 524288
s_mov_b32 s15, 0x20000
s_and_b32 s30, s2, 6
s_lshl_b32 s30, s30, 2
s_lshr_b32 s31, s2, 3
s_and_b32 s32, s31, 7
s_add_u32 s30, s30, s32
s_lshr_b32 s31, s31, 3
s_and_b32 s33, s2, 1
s_lshl_b32 s33, s33, 2
s_add_u32 s31, s31, s33
s_lshl_b32 s28, s21, 2
s_lshr_b32 s28, 0x24130241, s28
s_and_b32 s28, s28, 7
s_lshl_b32 s28, s28, 15
s_xor_b32 s33, s3, 4
s_lshl_b32 s33, s33, 14
s_add_u32 s33, s33, s28
s_sub_u32 s29, s33, 163840
s_cmp_ge_u32 s33, 163840
s_cselect_b32 s33, s29, s33
v_lshrrev_b32 v3, 3, v0
v_lshlrev_b32 v3, 10, v3
v_lshrrev_b32 v4, 4, v0
v_lshlrev_b32 v4, 1, v4
v_and_b32 v5, 7, v0
v_xor_b32 v4, v4, v5
v_lshlrev_b32 v4, 4, v4
v_add_u32 v4, v3, v4
v_add_u32 v5, 7168, v4
v_add_u32 v6, 14336, v4
v_add_u32 v7, 21504, v4
s_mul_i32 s34, s31, 589824
s_add_u32 s34, s34, 75497472
s_lshl_b32 s39, s3, 13
s_add_u32 s35, s34, s39
s_add_u32 s35, s35, 524288
s_lshl_b32 s39, s3, 16
s_add_u32 s34, s34, s39
s_mul_i32 s37, s30, 589824
s_add_u32 s37, s37, 50331648
s_lshl_b32 s39, s3, 16
s_add_u32 s37, s37, s39
s_mul_i32 s48, s32, 0
s_and_b32 s48, s48, 15
s_mov_b32 s52, s48
s_lshr_b32 s54, s24, 1
s_lshl_b32 s54, s54, 8
s_lshl_b32 s55, s20, 3
s_add_u32 s54, s54, s55
s_and_b32 s55, s24, 1
s_lshl_b32 s55, s55, 2
s_add_u32 s54, s54, s55
s_add_u32 s54, s54, 90177536
v_mov_b32 v2, 0
v_mov_b32 v3, 1
v_lshrrev_b32 v8, 2, v0
v_lshlrev_b32 v8, 7, v8
v_lshrrev_b32 v9, 3, v0
v_and_b32 v9, 3, v9
v_lshlrev_b32 v9, 5, v9
v_and_b32 v10, 3, v0
v_lshlrev_b32 v10, 3, v10
v_add3_u32 v8, v8, v9, v10
v_add_u32 v8, s33, v8
v_xor_b32 v9, 32, v8
v_xor_b32 v10, 64, v8
v_xor_b32 v11, 96, v8
s_lshl_b32 s40, s30, 16
s_lshl_b32 s41, s3, 13
s_add_u32 s40, s40, s41
s_add_u32 s40, s40, 83886080
s_add_u32 s41, s40, 4096
s_lshl_b32 s42, s3, 12
s_add_u32 s42, s42, 87556096
s_lshl_b32 s43, s30, 10
s_add_u32 s43, s43, 87031808
s_mov_b32 s53, 0x358637bd
s_lshl_b32 s43, s30, 8
s_add_u32 s43, s43, 74448896
v_and_b32 v7, 15, v0
v_lshlrev_b32 v7, 2, v7
s_waitcnt vmcnt(0)
buffer_store_dword v3, v2, s[44:47], s54 offen sc1
s_barrier
s_add_u32 m0, s33, 0
s_lshl_b32 s49, s48, 12
s_add_u32 s49, s49, s34
s_add_u32 s48, s48, 1
s_and_b32 s48, s48, 15
buffer_load_dwordx4 v1, s[44:47], s49 offen offset:0 sc1 lds
buffer_load_dwordx4 v1, s[44:47], s49 offen offset:1024 sc1 lds
buffer_load_dwordx4 v1, s[44:47], s49 offen offset:2048 sc1 lds
buffer_load_dwordx4 v1, s[44:47], s49 offen offset:3072 sc1 lds
s_add_u32 m0, s33, 4096
s_lshl_b32 s49, s48, 12
s_add_u32 s49, s49, s34
s_add_u32 s48, s48, 1
s_and_b32 s48, s48, 15
buffer_load_dwordx4 v1, s[44:47], s49 offen offset:0 sc1 lds
buffer_load_dwordx4 v1, s[44:47], s49 offen offset:1024 sc1 lds
buffer_load_dwordx4 v1, s[44:47], s49 offen offset:2048 sc1 lds
buffer_load_dwordx4 v1, s[44:47], s49 offen offset:3072 sc1 lds
s_add_u32 m0, s33, 8192
s_lshl_b32 s49, s48, 12
s_add_u32 s49, s49, s34
s_add_u32 s48, s48, 1
s_and_b32 s48, s48, 15
buffer_load_dwordx4 v1, s[44:47], s49 offen offset:0 sc1 lds
buffer_load_dwordx4 v1, s[44:47], s49 offen offset:1024 sc1 lds
buffer_load_dwordx4 v1, s[44:47], s49 offen offset:2048 sc1 lds
buffer_load_dwordx4 v1, s[44:47], s49 offen offset:3072 sc1 lds
s_add_u32 m0, s33, 12288
s_lshl_b32 s49, s48, 12
s_add_u32 s49, s49, s34
s_add_u32 s48, s48, 1
s_and_b32 s48, s48, 15
buffer_load_dwordx4 v1, s[44:47], s49 offen offset:0 sc1 lds
buffer_load_dwordx4 v1, s[44:47], s49 offen offset:1024 sc1 lds
buffer_load_dwordx4 v1, s[44:47], s49 offen offset:2048 sc1 lds
buffer_load_dwordx4 v1, s[44:47], s49 offen offset:3072 sc1 lds
s_waitcnt vmcnt(12)
ds_read_b64_tr_b16 v[16:17], v8 offset:0
ds_read_b64_tr_b16 v[18:19], v8 offset:2048
ds_read_b64_tr_b16 v[20:21], v9 offset:0
ds_read_b64_tr_b16 v[22:23], v9 offset:2048
ds_read_b64_tr_b16 v[24:25], v10 offset:0
ds_read_b64_tr_b16 v[26:27], v10 offset:2048
ds_read_b64_tr_b16 v[28:29], v11 offset:0
ds_read_b64_tr_b16 v[30:31], v11 offset:2048
s_waitcnt lgkmcnt(0)
s_add_u32 m0, s33, 0
s_lshl_b32 s49, s48, 12
s_add_u32 s49, s49, s34
s_add_u32 s48, s48, 1
s_and_b32 s48, s48, 15
buffer_load_dwordx4 v1, s[44:47], s49 offen offset:0 sc1 lds
buffer_load_dwordx4 v1, s[44:47], s49 offen offset:1024 sc1 lds
buffer_load_dwordx4 v1, s[44:47], s49 offen offset:2048 sc1 lds
buffer_load_dwordx4 v1, s[44:47], s49 offen offset:3072 sc1 lds
s_waitcnt vmcnt(12)
ds_read_b64_tr_b16 v[32:33], v8 offset:4096
ds_read_b64_tr_b16 v[34:35], v8 offset:6144
ds_read_b64_tr_b16 v[36:37], v9 offset:4096
ds_read_b64_tr_b16 v[38:39], v9 offset:6144
ds_read_b64_tr_b16 v[40:41], v10 offset:4096
ds_read_b64_tr_b16 v[42:43], v10 offset:6144
ds_read_b64_tr_b16 v[44:45], v11 offset:4096
ds_read_b64_tr_b16 v[46:47], v11 offset:6144
s_waitcnt lgkmcnt(0)
s_add_u32 m0, s33, 4096
s_lshl_b32 s49, s48, 12
s_add_u32 s49, s49, s34
s_add_u32 s48, s48, 1
s_and_b32 s48, s48, 15
buffer_load_dwordx4 v1, s[44:47], s49 offen offset:0 sc1 lds
buffer_load_dwordx4 v1, s[44:47], s49 offen offset:1024 sc1 lds
buffer_load_dwordx4 v1, s[44:47], s49 offen offset:2048 sc1 lds
buffer_load_dwordx4 v1, s[44:47], s49 offen offset:3072 sc1 lds
s_waitcnt vmcnt(12)
ds_read_b64_tr_b16 v[48:49], v8 offset:8192
ds_read_b64_tr_b16 v[50:51], v8 offset:10240
ds_read_b64_tr_b16 v[52:53], v9 offset:8192
ds_read_b64_tr_b16 v[54:55], v9 offset:10240
ds_read_b64_tr_b16 v[56:57], v10 offset:8192
ds_read_b64_tr_b16 v[58:59], v10 offset:10240
ds_read_b64_tr_b16 v[60:61], v11 offset:8192
ds_read_b64_tr_b16 v[62:63], v11 offset:10240
s_waitcnt lgkmcnt(0)
s_add_u32 m0, s33, 8192
s_lshl_b32 s49, s48, 12
s_add_u32 s49, s49, s34
s_add_u32 s48, s48, 1
s_and_b32 s48, s48, 15
buffer_load_dwordx4 v1, s[44:47], s49 offen offset:0 sc1 lds
buffer_load_dwordx4 v1, s[44:47], s49 offen offset:1024 sc1 lds
buffer_load_dwordx4 v1, s[44:47], s49 offen offset:2048 sc1 lds
buffer_load_dwordx4 v1, s[44:47], s49 offen offset:3072 sc1 lds
s_waitcnt vmcnt(12)
ds_read_b64_tr_b16 v[192:193], v8 offset:12288
ds_read_b64_tr_b16 v[194:195], v8 offset:14336
ds_read_b64_tr_b16 v[196:197], v9 offset:12288
ds_read_b64_tr_b16 v[198:199], v9 offset:14336
ds_read_b64_tr_b16 v[200:201], v10 offset:12288
ds_read_b64_tr_b16 v[202:203], v10 offset:14336
ds_read_b64_tr_b16 v[204:205], v11 offset:12288
ds_read_b64_tr_b16 v[206:207], v11 offset:14336
s_waitcnt lgkmcnt(0)
s_add_u32 m0, s33, 12288
s_lshl_b32 s49, s48, 12
s_add_u32 s49, s49, s34
s_add_u32 s48, s48, 1
s_and_b32 s48, s48, 15
buffer_load_dwordx4 v1, s[44:47], s49 offen offset:0 sc1 lds
buffer_load_dwordx4 v1, s[44:47], s49 offen offset:1024 sc1 lds
buffer_load_dwordx4 v1, s[44:47], s49 offen offset:2048 sc1 lds
buffer_load_dwordx4 v1, s[44:47], s49 offen offset:3072 sc1 lds
s_waitcnt vmcnt(12)
ds_read_b64_tr_b16 v[208:209], v8 offset:0
ds_read_b64_tr_b16 v[210:211], v8 offset:2048
ds_read_b64_tr_b16 v[212:213], v9 offset:0
ds_read_b64_tr_b16 v[214:215], v9 offset:2048
ds_read_b64_tr_b16 v[216:217], v10 offset:0
ds_read_b64_tr_b16 v[218:219], v10 offset:2048
ds_read_b64_tr_b16 v[220:221], v11 offset:0
ds_read_b64_tr_b16 v[222:223], v11 offset:2048
s_waitcnt lgkmcnt(0)
s_add_u32 m0, s33, 0
s_lshl_b32 s49, s48, 12
s_add_u32 s49, s49, s34
s_add_u32 s48, s48, 1
s_and_b32 s48, s48, 15
buffer_load_dwordx4 v1, s[44:47], s49 offen offset:0 sc1 lds
buffer_load_dwordx4 v1, s[44:47], s49 offen offset:1024 sc1 lds
buffer_load_dwordx4 v1, s[44:47], s49 offen offset:2048 sc1 lds
buffer_load_dwordx4 v1, s[44:47], s49 offen offset:3072 sc1 lds
s_waitcnt vmcnt(12)
ds_read_b64_tr_b16 v[224:225], v8 offset:4096
ds_read_b64_tr_b16 v[226:227], v8 offset:6144
ds_read_b64_tr_b16 v[228:229], v9 offset:4096
ds_read_b64_tr_b16 v[230:231], v9 offset:6144
ds_read_b64_tr_b16 v[232:233], v10 offset:4096
ds_read_b64_tr_b16 v[234:235], v10 offset:6144
ds_read_b64_tr_b16 v[236:237], v11 offset:4096
ds_read_b64_tr_b16 v[238:239], v11 offset:6144
s_waitcnt lgkmcnt(0)
s_add_u32 m0, s33, 4096
s_lshl_b32 s49, s48, 12
s_add_u32 s49, s49, s34
s_add_u32 s48, s48, 1
s_and_b32 s48, s48, 15
buffer_load_dwordx4 v1, s[44:47], s49 offen offset:0 sc1 lds
buffer_load_dwordx4 v1, s[44:47], s49 offen offset:1024 sc1 lds
buffer_load_dwordx4 v1, s[44:47], s49 offen offset:2048 sc1 lds
buffer_load_dwordx4 v1, s[44:47], s49 offen offset:3072 sc1 lds
s_waitcnt vmcnt(12)
ds_read_b64_tr_b16 v[240:241], v8 offset:8192
ds_read_b64_tr_b16 v[242:243], v8 offset:10240
ds_read_b64_tr_b16 v[244:245], v9 offset:8192
ds_read_b64_tr_b16 v[246:247], v9 offset:10240
ds_read_b64_tr_b16 v[248:249], v10 offset:8192
ds_read_b64_tr_b16 v[250:251], v10 offset:10240
ds_read_b64_tr_b16 v[252:253], v11 offset:8192
ds_read_b64_tr_b16 v[254:255], v11 offset:10240
s_waitcnt lgkmcnt(0)
s_add_u32 m0, s33, 8192
s_lshl_b32 s49, s48, 12
s_add_u32 s49, s49, s34
s_add_u32 s48, s48, 1
s_and_b32 s48, s48, 15
buffer_load_dwordx4 v1, s[44:47], s49 offen offset:0 sc1 lds
buffer_load_dwordx4 v1, s[44:47], s49 offen offset:1024 sc1 lds
buffer_load_dwordx4 v1, s[44:47], s49 offen offset:2048 sc1 lds
buffer_load_dwordx4 v1, s[44:47], s49 offen offset:3072 sc1 lds
s_barrier
s_lshl_b32 s50, s52, 12
s_add_u32 s50, s50, s37
s_add_u32 s52, s52, 1
s_and_b32 s52, s52, 15
buffer_load_dwordx4 v[128:131], v1, s[44:47], s50 offen offset:0 sc1
buffer_load_dwordx4 v[132:135], v1, s[44:47], s50 offen offset:1024 sc1
buffer_load_dwordx4 v[136:139], v1, s[44:47], s50 offen offset:2048 sc1
buffer_load_dwordx4 v[140:143], v1, s[44:47], s50 offen offset:3072 sc1
s_lshl_b32 s50, s52, 12
s_add_u32 s50, s50, s37
s_add_u32 s52, s52, 1
s_and_b32 s52, s52, 15
buffer_load_dwordx4 v[144:147], v1, s[44:47], s50 offen offset:0 sc1
buffer_load_dwordx4 v[148:151], v1, s[44:47], s50 offen offset:1024 sc1
buffer_load_dwordx4 v[152:155], v1, s[44:47], s50 offen offset:2048 sc1
buffer_load_dwordx4 v[156:159], v1, s[44:47], s50 offen offset:3072 sc1
s_lshl_b32 s50, s52, 12
s_add_u32 s50, s50, s37
s_add_u32 s52, s52, 1
s_and_b32 s52, s52, 15
buffer_load_dwordx4 v[160:163], v1, s[44:47], s50 offen offset:0 sc1
buffer_load_dwordx4 v[164:167], v1, s[44:47], s50 offen offset:1024 sc1
buffer_load_dwordx4 v[168:171], v1, s[44:47], s50 offen offset:2048 sc1
buffer_load_dwordx4 v[172:175], v1, s[44:47], s50 offen offset:3072 sc1
s_lshl_b32 s50, s52, 12
s_add_u32 s50, s50, s37
s_add_u32 s52, s52, 1
s_and_b32 s52, s52, 15
buffer_load_dwordx4 v[176:179], v1, s[44:47], s50 offen offset:0 sc1
buffer_load_dwordx4 v[180:183], v1, s[44:47], s50 offen offset:1024 sc1
buffer_load_dwordx4 v[184:187], v1, s[44:47], s50 offen offset:2048 sc1
buffer_load_dwordx4 v[188:191], v1, s[44:47], s50 offen offset:3072 sc1
s_waitcnt vmcnt(15)
v_mfma_f32_16x16x32_bf16 v[64:67], v[16:19], v[128:131], 0
s_waitcnt vmcnt(14)
v_mfma_f32_16x16x32_bf16 v[68:71], v[16:19], v[132:135], 0
s_waitcnt vmcnt(13)
v_mfma_f32_16x16x32_bf16 v[72:75], v[16:19], v[136:139], 0
s_waitcnt vmcnt(12)
v_mfma_f32_16x16x32_bf16 v[76:79], v[16:19], v[140:143], 0
v_mfma_f32_16x16x32_bf16 v[80:83], v[20:23], v[128:131], 0
v_mfma_f32_16x16x32_bf16 v[84:87], v[20:23], v[132:135], 0
v_mfma_f32_16x16x32_bf16 v[88:91], v[20:23], v[136:139], 0
v_mfma_f32_16x16x32_bf16 v[92:95], v[20:23], v[140:143], 0
v_mfma_f32_16x16x32_bf16 v[96:99], v[24:27], v[128:131], 0
v_mfma_f32_16x16x32_bf16 v[100:103], v[24:27], v[132:135], 0
v_mfma_f32_16x16x32_bf16 v[104:107], v[24:27], v[136:139], 0
v_mfma_f32_16x16x32_bf16 v[108:111], v[24:27], v[140:143], 0
v_mfma_f32_16x16x32_bf16 v[112:115], v[28:31], v[128:131], 0
v_mfma_f32_16x16x32_bf16 v[116:119], v[28:31], v[132:135], 0
v_mfma_f32_16x16x32_bf16 v[120:123], v[28:31], v[136:139], 0
v_mfma_f32_16x16x32_bf16 v[124:127], v[28:31], v[140:143], 0
s_lshl_b32 s50, s52, 12
s_add_u32 s50, s50, s37
s_add_u32 s52, s52, 1
s_and_b32 s52, s52, 15
buffer_load_dwordx4 v[128:131], v1, s[44:47], s50 offen offset:0 sc1
buffer_load_dwordx4 v[132:135], v1, s[44:47], s50 offen offset:1024 sc1
buffer_load_dwordx4 v[136:139], v1, s[44:47], s50 offen offset:2048 sc1
buffer_load_dwordx4 v[140:143], v1, s[44:47], s50 offen offset:3072 sc1
s_waitcnt vmcnt(15)
v_mfma_f32_16x16x32_bf16 v[64:67], v[32:35], v[144:147], v[64:67]
s_waitcnt vmcnt(14)
v_mfma_f32_16x16x32_bf16 v[68:71], v[32:35], v[148:151], v[68:71]
s_waitcnt vmcnt(13)
v_mfma_f32_16x16x32_bf16 v[72:75], v[32:35], v[152:155], v[72:75]
s_waitcnt vmcnt(12)
v_mfma_f32_16x16x32_bf16 v[76:79], v[32:35], v[156:159], v[76:79]
v_mfma_f32_16x16x32_bf16 v[80:83], v[36:39], v[144:147], v[80:83]
v_mfma_f32_16x16x32_bf16 v[84:87], v[36:39], v[148:151], v[84:87]
v_mfma_f32_16x16x32_bf16 v[88:91], v[36:39], v[152:155], v[88:91]
v_mfma_f32_16x16x32_bf16 v[92:95], v[36:39], v[156:159], v[92:95]
v_mfma_f32_16x16x32_bf16 v[96:99], v[40:43], v[144:147], v[96:99]
v_mfma_f32_16x16x32_bf16 v[100:103], v[40:43], v[148:151], v[100:103]
v_mfma_f32_16x16x32_bf16 v[104:107], v[40:43], v[152:155], v[104:107]
v_mfma_f32_16x16x32_bf16 v[108:111], v[40:43], v[156:159], v[108:111]
v_mfma_f32_16x16x32_bf16 v[112:115], v[44:47], v[144:147], v[112:115]
v_mfma_f32_16x16x32_bf16 v[116:119], v[44:47], v[148:151], v[116:119]
v_mfma_f32_16x16x32_bf16 v[120:123], v[44:47], v[152:155], v[120:123]
v_mfma_f32_16x16x32_bf16 v[124:127], v[44:47], v[156:159], v[124:127]
s_lshl_b32 s50, s52, 12
s_add_u32 s50, s50, s37
s_add_u32 s52, s52, 1
s_and_b32 s52, s52, 15
buffer_load_dwordx4 v[144:147], v1, s[44:47], s50 offen offset:0 sc1
buffer_load_dwordx4 v[148:151], v1, s[44:47], s50 offen offset:1024 sc1
buffer_load_dwordx4 v[152:155], v1, s[44:47], s50 offen offset:2048 sc1
buffer_load_dwordx4 v[156:159], v1, s[44:47], s50 offen offset:3072 sc1
s_waitcnt vmcnt(15)
v_mfma_f32_16x16x32_bf16 v[64:67], v[48:51], v[160:163], v[64:67]
s_waitcnt vmcnt(14)
v_mfma_f32_16x16x32_bf16 v[68:71], v[48:51], v[164:167], v[68:71]
s_waitcnt vmcnt(13)
v_mfma_f32_16x16x32_bf16 v[72:75], v[48:51], v[168:171], v[72:75]
s_waitcnt vmcnt(12)
v_mfma_f32_16x16x32_bf16 v[76:79], v[48:51], v[172:175], v[76:79]
v_mfma_f32_16x16x32_bf16 v[80:83], v[52:55], v[160:163], v[80:83]
v_mfma_f32_16x16x32_bf16 v[84:87], v[52:55], v[164:167], v[84:87]
v_mfma_f32_16x16x32_bf16 v[88:91], v[52:55], v[168:171], v[88:91]
v_mfma_f32_16x16x32_bf16 v[92:95], v[52:55], v[172:175], v[92:95]
v_mfma_f32_16x16x32_bf16 v[96:99], v[56:59], v[160:163], v[96:99]
v_mfma_f32_16x16x32_bf16 v[100:103], v[56:59], v[164:167], v[100:103]
v_mfma_f32_16x16x32_bf16 v[104:107], v[56:59], v[168:171], v[104:107]
v_mfma_f32_16x16x32_bf16 v[108:111], v[56:59], v[172:175], v[108:111]
v_mfma_f32_16x16x32_bf16 v[112:115], v[60:63], v[160:163], v[112:115]
v_mfma_f32_16x16x32_bf16 v[116:119], v[60:63], v[164:167], v[116:119]
v_mfma_f32_16x16x32_bf16 v[120:123], v[60:63], v[168:171], v[120:123]
v_mfma_f32_16x16x32_bf16 v[124:127], v[60:63], v[172:175], v[124:127]
s_lshl_b32 s50, s52, 12
s_add_u32 s50, s50, s37
s_add_u32 s52, s52, 1
s_and_b32 s52, s52, 15
buffer_load_dwordx4 v[160:163], v1, s[44:47], s50 offen offset:0 sc1
buffer_load_dwordx4 v[164:167], v1, s[44:47], s50 offen offset:1024 sc1
buffer_load_dwordx4 v[168:171], v1, s[44:47], s50 offen offset:2048 sc1
buffer_load_dwordx4 v[172:175], v1, s[44:47], s50 offen offset:3072 sc1
buffer_load_dwordx4 v[16:19], v1, s[44:47], s40 offen offset:0 sc1
buffer_load_dwordx4 v[20:23], v1, s[44:47], s40 offen offset:1024 sc1
buffer_load_dwordx4 v[24:27], v1, s[44:47], s40 offen offset:2048 sc1
buffer_load_dwordx4 v[28:31], v1, s[44:47], s40 offen offset:3072 sc1
buffer_load_dwordx4 v[32:35], v1, s[44:47], s41 offen offset:0 sc1
buffer_load_dwordx4 v[36:39], v1, s[44:47], s41 offen offset:1024 sc1
buffer_load_dwordx4 v[40:43], v1, s[44:47], s41 offen offset:2048 sc1
buffer_load_dwordx4 v[44:47], v1, s[44:47], s41 offen offset:3072 sc1
buffer_load_dwordx4 v[48:51], v1, s[44:47], s42 offen offset:0 sc1
buffer_load_dwordx4 v[52:55], v1, s[44:47], s42 offen offset:1024 sc1
buffer_load_dwordx4 v[56:59], v1, s[44:47], s42 offen offset:2048 sc1
buffer_load_dwordx4 v[60:63], v1, s[44:47], s42 offen offset:3072 sc1
buffer_load_dword v12, v7, s[44:47], s43 offen offset:0 sc1
buffer_load_dword v13, v7, s[44:47], s43 offen offset:64 sc1
buffer_load_dword v14, v7, s[44:47], s43 offen offset:128 sc1
buffer_load_dword v15, v7, s[44:47], s43 offen offset:192 sc1
s_waitcnt vmcnt(31)
v_mfma_f32_16x16x32_bf16 v[64:67], v[192:195], v[176:179], v[64:67]
s_waitcnt vmcnt(30)
v_mfma_f32_16x16x32_bf16 v[68:71], v[192:195], v[180:183], v[68:71]
s_waitcnt vmcnt(29)
v_mfma_f32_16x16x32_bf16 v[72:75], v[192:195], v[184:187], v[72:75]
s_waitcnt vmcnt(28)
v_mfma_f32_16x16x32_bf16 v[76:79], v[192:195], v[188:191], v[76:79]
v_mfma_f32_16x16x32_bf16 v[80:83], v[196:199], v[176:179], v[80:83]
v_mfma_f32_16x16x32_bf16 v[84:87], v[196:199], v[180:183], v[84:87]
v_mfma_f32_16x16x32_bf16 v[88:91], v[196:199], v[184:187], v[88:91]
v_mfma_f32_16x16x32_bf16 v[92:95], v[196:199], v[188:191], v[92:95]
v_mfma_f32_16x16x32_bf16 v[96:99], v[200:203], v[176:179], v[96:99]
v_mfma_f32_16x16x32_bf16 v[100:103], v[200:203], v[180:183], v[100:103]
v_mfma_f32_16x16x32_bf16 v[104:107], v[200:203], v[184:187], v[104:107]
v_mfma_f32_16x16x32_bf16 v[108:111], v[200:203], v[188:191], v[108:111]
v_mfma_f32_16x16x32_bf16 v[112:115], v[204:207], v[176:179], v[112:115]
v_mfma_f32_16x16x32_bf16 v[116:119], v[204:207], v[180:183], v[116:119]
v_mfma_f32_16x16x32_bf16 v[120:123], v[204:207], v[184:187], v[120:123]
v_mfma_f32_16x16x32_bf16 v[124:127], v[204:207], v[188:191], v[124:127]
s_lshl_b32 s50, s52, 12
s_add_u32 s50, s50, s37
s_add_u32 s52, s52, 1
s_and_b32 s52, s52, 15
buffer_load_dwordx4 v[176:179], v1, s[44:47], s50 offen offset:0 sc1
buffer_load_dwordx4 v[180:183], v1, s[44:47], s50 offen offset:1024 sc1
buffer_load_dwordx4 v[184:187], v1, s[44:47], s50 offen offset:2048 sc1
buffer_load_dwordx4 v[188:191], v1, s[44:47], s50 offen offset:3072 sc1
s_waitcnt vmcnt(31)
v_mfma_f32_16x16x32_bf16 v[64:67], v[208:211], v[128:131], v[64:67]
s_waitcnt vmcnt(30)
v_mfma_f32_16x16x32_bf16 v[68:71], v[208:211], v[132:135], v[68:71]
s_waitcnt vmcnt(29)
v_mfma_f32_16x16x32_bf16 v[72:75], v[208:211], v[136:139], v[72:75]
s_waitcnt vmcnt(28)
v_mfma_f32_16x16x32_bf16 v[76:79], v[208:211], v[140:143], v[76:79]
v_mfma_f32_16x16x32_bf16 v[80:83], v[212:215], v[128:131], v[80:83]
v_mfma_f32_16x16x32_bf16 v[84:87], v[212:215], v[132:135], v[84:87]
v_mfma_f32_16x16x32_bf16 v[88:91], v[212:215], v[136:139], v[88:91]
v_mfma_f32_16x16x32_bf16 v[92:95], v[212:215], v[140:143], v[92:95]
v_mfma_f32_16x16x32_bf16 v[96:99], v[216:219], v[128:131], v[96:99]
v_mfma_f32_16x16x32_bf16 v[100:103], v[216:219], v[132:135], v[100:103]
v_mfma_f32_16x16x32_bf16 v[104:107], v[216:219], v[136:139], v[104:107]
v_mfma_f32_16x16x32_bf16 v[108:111], v[216:219], v[140:143], v[108:111]
v_mfma_f32_16x16x32_bf16 v[112:115], v[220:223], v[128:131], v[112:115]
v_mfma_f32_16x16x32_bf16 v[116:119], v[220:223], v[132:135], v[116:119]
v_mfma_f32_16x16x32_bf16 v[120:123], v[220:223], v[136:139], v[120:123]
v_mfma_f32_16x16x32_bf16 v[124:127], v[220:223], v[140:143], v[124:127]
s_lshl_b32 s50, s52, 12
s_add_u32 s50, s50, s37
s_add_u32 s52, s52, 1
s_and_b32 s52, s52, 15
buffer_load_dwordx4 v[128:131], v1, s[44:47], s50 offen offset:0 sc1
buffer_load_dwordx4 v[132:135], v1, s[44:47], s50 offen offset:1024 sc1
buffer_load_dwordx4 v[136:139], v1, s[44:47], s50 offen offset:2048 sc1
buffer_load_dwordx4 v[140:143], v1, s[44:47], s50 offen offset:3072 sc1
s_waitcnt vmcnt(31)
v_mfma_f32_16x16x32_bf16 v[64:67], v[224:227], v[144:147], v[64:67]
s_waitcnt vmcnt(30)
v_mfma_f32_16x16x32_bf16 v[68:71], v[224:227], v[148:151], v[68:71]
s_waitcnt vmcnt(29)
v_mfma_f32_16x16x32_bf16 v[72:75], v[224:227], v[152:155], v[72:75]
s_waitcnt vmcnt(28)
v_mfma_f32_16x16x32_bf16 v[76:79], v[224:227], v[156:159], v[76:79]
v_mfma_f32_16x16x32_bf16 v[80:83], v[228:231], v[144:147], v[80:83]
v_mfma_f32_16x16x32_bf16 v[84:87], v[228:231], v[148:151], v[84:87]
v_mfma_f32_16x16x32_bf16 v[88:91], v[228:231], v[152:155], v[88:91]
v_mfma_f32_16x16x32_bf16 v[92:95], v[228:231], v[156:159], v[92:95]
v_mfma_f32_16x16x32_bf16 v[96:99], v[232:235], v[144:147], v[96:99]
v_mfma_f32_16x16x32_bf16 v[100:103], v[232:235], v[148:151], v[100:103]
v_mfma_f32_16x16x32_bf16 v[104:107], v[232:235], v[152:155], v[104:107]
v_mfma_f32_16x16x32_bf16 v[108:111], v[232:235], v[156:159], v[108:111]
v_mfma_f32_16x16x32_bf16 v[112:115], v[236:239], v[144:147], v[112:115]
v_mfma_f32_16x16x32_bf16 v[116:119], v[236:239], v[148:151], v[116:119]
v_mfma_f32_16x16x32_bf16 v[120:123], v[236:239], v[152:155], v[120:123]
v_mfma_f32_16x16x32_bf16 v[124:127], v[236:239], v[156:159], v[124:127]
s_lshl_b32 s50, s52, 12
s_add_u32 s50, s50, s37
s_add_u32 s52, s52, 1
s_and_b32 s52, s52, 15
buffer_load_dwordx4 v[144:147], v1, s[44:47], s50 offen offset:0 sc1
buffer_load_dwordx4 v[148:151], v1, s[44:47], s50 offen offset:1024 sc1
buffer_load_dwordx4 v[152:155], v1, s[44:47], s50 offen offset:2048 sc1
buffer_load_dwordx4 v[156:159], v1, s[44:47], s50 offen offset:3072 sc1
s_waitcnt vmcnt(31)
v_mfma_f32_16x16x32_bf16 v[64:67], v[240:243], v[160:163], v[64:67]
s_waitcnt vmcnt(30)
v_mfma_f32_16x16x32_bf16 v[68:71], v[240:243], v[164:167], v[68:71]
s_waitcnt vmcnt(29)
v_mfma_f32_16x16x32_bf16 v[72:75], v[240:243], v[168:171], v[72:75]
s_waitcnt vmcnt(28)
v_mfma_f32_16x16x32_bf16 v[76:79], v[240:243], v[172:175], v[76:79]
v_mfma_f32_16x16x32_bf16 v[80:83], v[244:247], v[160:163], v[80:83]
v_mfma_f32_16x16x32_bf16 v[84:87], v[244:247], v[164:167], v[84:87]
v_mfma_f32_16x16x32_bf16 v[88:91], v[244:247], v[168:171], v[88:91]
v_mfma_f32_16x16x32_bf16 v[92:95], v[244:247], v[172:175], v[92:95]
v_mfma_f32_16x16x32_bf16 v[96:99], v[248:251], v[160:163], v[96:99]
v_mfma_f32_16x16x32_bf16 v[100:103], v[248:251], v[164:167], v[100:103]
v_mfma_f32_16x16x32_bf16 v[104:107], v[248:251], v[168:171], v[104:107]
v_mfma_f32_16x16x32_bf16 v[108:111], v[248:251], v[172:175], v[108:111]
v_mfma_f32_16x16x32_bf16 v[112:115], v[252:255], v[160:163], v[112:115]
v_mfma_f32_16x16x32_bf16 v[116:119], v[252:255], v[164:167], v[116:119]
v_mfma_f32_16x16x32_bf16 v[120:123], v[252:255], v[168:171], v[120:123]
v_mfma_f32_16x16x32_bf16 v[124:127], v[252:255], v[172:175], v[124:127]
s_waitcnt vmcnt(63)
ds_read_b64_tr_b16 v[208:209], v8 offset:12288
ds_read_b64_tr_b16 v[210:211], v8 offset:14336
ds_read_b64_tr_b16 v[212:213], v9 offset:12288
ds_read_b64_tr_b16 v[214:215], v9 offset:14336
ds_read_b64_tr_b16 v[216:217], v10 offset:12288
ds_read_b64_tr_b16 v[218:219], v10 offset:14336
ds_read_b64_tr_b16 v[220:221], v11 offset:12288
ds_read_b64_tr_b16 v[222:223], v11 offset:14336
s_lshl_b32 s50, s52, 12
s_add_u32 s50, s50, s37
s_add_u32 s52, s52, 1
s_and_b32 s52, s52, 15
buffer_load_dwordx4 v[160:163], v1, s[44:47], s50 offen offset:0 sc1
buffer_load_dwordx4 v[164:167], v1, s[44:47], s50 offen offset:1024 sc1
buffer_load_dwordx4 v[168:171], v1, s[44:47], s50 offen offset:2048 sc1
buffer_load_dwordx4 v[172:175], v1, s[44:47], s50 offen offset:3072 sc1
s_waitcnt vmcnt(15) lgkmcnt(6)
v_mfma_f32_16x16x32_bf16 v[64:67], v[208:211], v[176:179], v[64:67]
s_waitcnt vmcnt(14)
v_mfma_f32_16x16x32_bf16 v[68:71], v[208:211], v[180:183], v[68:71]
s_waitcnt vmcnt(13)
v_mfma_f32_16x16x32_bf16 v[72:75], v[208:211], v[184:187], v[72:75]
s_waitcnt vmcnt(12)
v_mfma_f32_16x16x32_bf16 v[76:79], v[208:211], v[188:191], v[76:79]
s_waitcnt lgkmcnt(4)
v_mfma_f32_16x16x32_bf16 v[80:83], v[212:215], v[176:179], v[80:83]
v_mfma_f32_16x16x32_bf16 v[84:87], v[212:215], v[180:183], v[84:87]
v_mfma_f32_16x16x32_bf16 v[88:91], v[212:215], v[184:187], v[88:91]
v_mfma_f32_16x16x32_bf16 v[92:95], v[212:215], v[188:191], v[92:95]
s_waitcnt lgkmcnt(2)
v_mfma_f32_16x16x32_bf16 v[96:99], v[216:219], v[176:179], v[96:99]
v_mfma_f32_16x16x32_bf16 v[100:103], v[216:219], v[180:183], v[100:103]
v_mfma_f32_16x16x32_bf16 v[104:107], v[216:219], v[184:187], v[104:107]
v_mfma_f32_16x16x32_bf16 v[108:111], v[216:219], v[188:191], v[108:111]
s_waitcnt lgkmcnt(0)
v_mfma_f32_16x16x32_bf16 v[112:115], v[220:223], v[176:179], v[112:115]
v_mfma_f32_16x16x32_bf16 v[116:119], v[220:223], v[180:183], v[116:119]
v_mfma_f32_16x16x32_bf16 v[120:123], v[220:223], v[184:187], v[120:123]
v_mfma_f32_16x16x32_bf16 v[124:127], v[220:223], v[188:191], v[124:127]
s_waitcnt vmcnt(63)
ds_read_b64_tr_b16 v[224:225], v8 offset:0
ds_read_b64_tr_b16 v[226:227], v8 offset:2048
ds_read_b64_tr_b16 v[228:229], v9 offset:0
ds_read_b64_tr_b16 v[230:231], v9 offset:2048
ds_read_b64_tr_b16 v[232:233], v10 offset:0
ds_read_b64_tr_b16 v[234:235], v10 offset:2048
ds_read_b64_tr_b16 v[236:237], v11 offset:0
ds_read_b64_tr_b16 v[238:239], v11 offset:2048
s_add_u32 m0, s33, 12288
s_lshl_b32 s49, s48, 12
s_add_u32 s49, s49, s34
s_add_u32 s48, s48, 1
s_and_b32 s48, s48, 15
buffer_load_dwordx4 v1, s[44:47], s49 offen offset:0 sc1 lds
buffer_load_dwordx4 v1, s[44:47], s49 offen offset:1024 sc1 lds
buffer_load_dwordx4 v1, s[44:47], s49 offen offset:2048 sc1 lds
buffer_load_dwordx4 v1, s[44:47], s49 offen offset:3072 sc1 lds
s_lshl_b32 s50, s52, 12
s_add_u32 s50, s50, s37
s_add_u32 s52, s52, 1
s_and_b32 s52, s52, 15
buffer_load_dwordx4 v[176:179], v1, s[44:47], s50 offen offset:0 sc1
buffer_load_dwordx4 v[180:183], v1, s[44:47], s50 offen offset:1024 sc1
buffer_load_dwordx4 v[184:187], v1, s[44:47], s50 offen offset:2048 sc1
buffer_load_dwordx4 v[188:191], v1, s[44:47], s50 offen offset:3072 sc1
s_waitcnt vmcnt(19) lgkmcnt(6)
v_mfma_f32_16x16x32_bf16 v[64:67], v[224:227], v[128:131], v[64:67]
s_waitcnt vmcnt(18)
v_mfma_f32_16x16x32_bf16 v[68:71], v[224:227], v[132:135], v[68:71]
s_waitcnt vmcnt(17)
v_mfma_f32_16x16x32_bf16 v[72:75], v[224:227], v[136:139], v[72:75]
s_waitcnt vmcnt(16)
v_mfma_f32_16x16x32_bf16 v[76:79], v[224:227], v[140:143], v[76:79]
s_waitcnt lgkmcnt(4)
v_mfma_f32_16x16x32_bf16 v[80:83], v[228:231], v[128:131], v[80:83]
v_mfma_f32_16x16x32_bf16 v[84:87], v[228:231], v[132:135], v[84:87]
v_mfma_f32_16x16x32_bf16 v[88:91], v[228:231], v[136:139], v[88:91]
v_mfma_f32_16x16x32_bf16 v[92:95], v[228:231], v[140:143], v[92:95]
s_waitcnt lgkmcnt(2)
v_mfma_f32_16x16x32_bf16 v[96:99], v[232:235], v[128:131], v[96:99]
v_mfma_f32_16x16x32_bf16 v[100:103], v[232:235], v[132:135], v[100:103]
v_mfma_f32_16x16x32_bf16 v[104:107], v[232:235], v[136:139], v[104:107]
v_mfma_f32_16x16x32_bf16 v[108:111], v[232:235], v[140:143], v[108:111]
s_waitcnt lgkmcnt(0)
v_mfma_f32_16x16x32_bf16 v[112:115], v[236:239], v[128:131], v[112:115]
v_mfma_f32_16x16x32_bf16 v[116:119], v[236:239], v[132:135], v[116:119]
v_mfma_f32_16x16x32_bf16 v[120:123], v[236:239], v[136:139], v[120:123]
v_mfma_f32_16x16x32_bf16 v[124:127], v[236:239], v[140:143], v[124:127]
v_mfma_f32_16x16x16_bf16 v[192:195], v[48:49], v[16:17], 0
v_mfma_f32_16x16x16_bf16 v[240:243], v[50:51], v[16:17], 0
v_mfma_f32_16x16x16_bf16 v[196:199], v[48:49], v[18:19], 0
v_mfma_f32_16x16x16_bf16 v[244:247], v[50:51], v[18:19], 0
v_mfma_f32_16x16x16_bf16 v[200:203], v[48:49], v[20:21], 0
v_mfma_f32_16x16x16_bf16 v[248:251], v[50:51], v[20:21], 0
v_mfma_f32_16x16x16_bf16 v[204:207], v[48:49], v[22:23], 0
v_mfma_f32_16x16x16_bf16 v[252:255], v[50:51], v[22:23], 0
s_nop 1
v_add_f32 v240, s53, v240
s_nop 0
v_add_f32 v244, s53, v244
s_nop 0
v_add_f32 v248, s53, v248
s_nop 0
v_add_f32 v252, s53, v252
v_rcp_f32 v240, v240
v_rcp_f32 v244, v244
v_rcp_f32 v248, v248
v_rcp_f32 v252, v252
v_mul_f32 v240, v12, v240
v_mul_f32 v244, v13, v244
v_mul_f32 v248, v14, v248
v_mul_f32 v252, v15, v252
v_mul_f32 v192, v240, v192
v_mul_f32 v193, v240, v193
v_mul_f32 v194, v240, v194
v_mul_f32 v195, v240, v195
v_mul_f32 v196, v244, v196
v_mul_f32 v197, v244, v197
v_mul_f32 v198, v244, v198
v_mul_f32 v199, v244, v199
v_mul_f32 v200, v248, v200
v_mul_f32 v201, v248, v201
v_mul_f32 v202, v248, v202
v_mul_f32 v203, v248, v203
v_mul_f32 v204, v252, v204
v_mul_f32 v205, v252, v205
v_mul_f32 v206, v252, v206
v_mul_f32 v207, v252, v207
v_cvt_pk_bf16_f32 v16, v192, v193
v_cvt_pk_bf16_f32 v17, v194, v195
v_cvt_pk_bf16_f32 v18, v196, v197
v_cvt_pk_bf16_f32 v19, v198, v199
v_cvt_pk_bf16_f32 v20, v200, v201
v_cvt_pk_bf16_f32 v21, v202, v203
v_cvt_pk_bf16_f32 v22, v204, v205
v_cvt_pk_bf16_f32 v23, v206, v207
s_waitcnt vmcnt(63)
ds_read_b64_tr_b16 v[208:209], v8 offset:4096
ds_read_b64_tr_b16 v[210:211], v8 offset:6144
ds_read_b64_tr_b16 v[212:213], v9 offset:4096
ds_read_b64_tr_b16 v[214:215], v9 offset:6144
ds_read_b64_tr_b16 v[216:217], v10 offset:4096
ds_read_b64_tr_b16 v[218:219], v10 offset:6144
ds_read_b64_tr_b16 v[220:221], v11 offset:4096
ds_read_b64_tr_b16 v[222:223], v11 offset:6144
s_add_u32 m0, s33, 0
s_lshl_b32 s49, s48, 12
s_add_u32 s49, s49, s34
s_add_u32 s48, s48, 1
s_and_b32 s48, s48, 15
buffer_load_dwordx4 v1, s[44:47], s49 offen offset:0 sc1 lds
buffer_load_dwordx4 v1, s[44:47], s49 offen offset:1024 sc1 lds
buffer_load_dwordx4 v1, s[44:47], s49 offen offset:2048 sc1 lds
buffer_load_dwordx4 v1, s[44:47], s49 offen offset:3072 sc1 lds
s_lshl_b32 s50, s52, 12
s_add_u32 s50, s50, s37
s_add_u32 s52, s52, 1
s_and_b32 s52, s52, 15
buffer_load_dwordx4 v[128:131], v1, s[44:47], s50 offen offset:0 sc1
buffer_load_dwordx4 v[132:135], v1, s[44:47], s50 offen offset:1024 sc1
buffer_load_dwordx4 v[136:139], v1, s[44:47], s50 offen offset:2048 sc1
buffer_load_dwordx4 v[140:143], v1, s[44:47], s50 offen offset:3072 sc1
s_waitcnt vmcnt(23) lgkmcnt(6)
v_mfma_f32_16x16x32_bf16 v[64:67], v[208:211], v[144:147], v[64:67]
s_waitcnt vmcnt(22)
v_mfma_f32_16x16x32_bf16 v[68:71], v[208:211], v[148:151], v[68:71]
s_waitcnt vmcnt(21)
v_mfma_f32_16x16x32_bf16 v[72:75], v[208:211], v[152:155], v[72:75]
s_waitcnt vmcnt(20)
v_mfma_f32_16x16x32_bf16 v[76:79], v[208:211], v[156:159], v[76:79]
s_waitcnt lgkmcnt(4)
v_mfma_f32_16x16x32_bf16 v[80:83], v[212:215], v[144:147], v[80:83]
v_mfma_f32_16x16x32_bf16 v[84:87], v[212:215], v[148:151], v[84:87]
v_mfma_f32_16x16x32_bf16 v[88:91], v[212:215], v[152:155], v[88:91]
v_mfma_f32_16x16x32_bf16 v[92:95], v[212:215], v[156:159], v[92:95]
s_waitcnt lgkmcnt(2)
v_mfma_f32_16x16x32_bf16 v[96:99], v[216:219], v[144:147], v[96:99]
v_mfma_f32_16x16x32_bf16 v[100:103], v[216:219], v[148:151], v[100:103]
v_mfma_f32_16x16x32_bf16 v[104:107], v[216:219], v[152:155], v[104:107]
v_mfma_f32_16x16x32_bf16 v[108:111], v[216:219], v[156:159], v[108:111]
s_waitcnt lgkmcnt(0)
v_mfma_f32_16x16x32_bf16 v[112:115], v[220:223], v[144:147], v[112:115]
v_mfma_f32_16x16x32_bf16 v[116:119], v[220:223], v[148:151], v[116:119]
v_mfma_f32_16x16x32_bf16 v[120:123], v[220:223], v[152:155], v[120:123]
v_mfma_f32_16x16x32_bf16 v[124:127], v[220:223], v[156:159], v[124:127]
s_waitcnt vmcnt(63)
ds_read_b64_tr_b16 v[224:225], v8 offset:8192
ds_read_b64_tr_b16 v[226:227], v8 offset:10240
ds_read_b64_tr_b16 v[228:229], v9 offset:8192
ds_read_b64_tr_b16 v[230:231], v9 offset:10240
ds_read_b64_tr_b16 v[232:233], v10 offset:8192
ds_read_b64_tr_b16 v[234:235], v10 offset:10240
ds_read_b64_tr_b16 v[236:237], v11 offset:8192
ds_read_b64_tr_b16 v[238:239], v11 offset:10240
s_add_u32 m0, s33, 4096
s_lshl_b32 s49, s48, 12
s_add_u32 s49, s49, s34
s_add_u32 s48, s48, 1
s_and_b32 s48, s48, 15
buffer_load_dwordx4 v1, s[44:47], s49 offen offset:0 sc1 lds
buffer_load_dwordx4 v1, s[44:47], s49 offen offset:1024 sc1 lds
buffer_load_dwordx4 v1, s[44:47], s49 offen offset:2048 sc1 lds
buffer_load_dwordx4 v1, s[44:47], s49 offen offset:3072 sc1 lds
s_lshl_b32 s50, s52, 12
s_add_u32 s50, s50, s37
s_add_u32 s52, s52, 1
s_and_b32 s52, s52, 15
buffer_load_dwordx4 v[144:147], v1, s[44:47], s50 offen offset:0 sc1
buffer_load_dwordx4 v[148:151], v1, s[44:47], s50 offen offset:1024 sc1
buffer_load_dwordx4 v[152:155], v1, s[44:47], s50 offen offset:2048 sc1
buffer_load_dwordx4 v[156:159], v1, s[44:47], s50 offen offset:3072 sc1
s_waitcnt vmcnt(27) lgkmcnt(6)
v_mfma_f32_16x16x32_bf16 v[64:67], v[224:227], v[160:163], v[64:67]
s_waitcnt vmcnt(26)
v_mfma_f32_16x16x32_bf16 v[68:71], v[224:227], v[164:167], v[68:71]
s_waitcnt vmcnt(25)
v_mfma_f32_16x16x32_bf16 v[72:75], v[224:227], v[168:171], v[72:75]
s_waitcnt vmcnt(24)
v_mfma_f32_16x16x32_bf16 v[76:79], v[224:227], v[172:175], v[76:79]
s_waitcnt lgkmcnt(4)
v_mfma_f32_16x16x32_bf16 v[80:83], v[228:231], v[160:163], v[80:83]
v_mfma_f32_16x16x32_bf16 v[84:87], v[228:231], v[164:167], v[84:87]
v_mfma_f32_16x16x32_bf16 v[88:91], v[228:231], v[168:171], v[88:91]
v_mfma_f32_16x16x32_bf16 v[92:95], v[228:231], v[172:175], v[92:95]
s_waitcnt lgkmcnt(2)
v_mfma_f32_16x16x32_bf16 v[96:99], v[232:235], v[160:163], v[96:99]
v_mfma_f32_16x16x32_bf16 v[100:103], v[232:235], v[164:167], v[100:103]
v_mfma_f32_16x16x32_bf16 v[104:107], v[232:235], v[168:171], v[104:107]
v_mfma_f32_16x16x32_bf16 v[108:111], v[232:235], v[172:175], v[108:111]
s_waitcnt lgkmcnt(0)
v_mfma_f32_16x16x32_bf16 v[112:115], v[236:239], v[160:163], v[112:115]
v_mfma_f32_16x16x32_bf16 v[116:119], v[236:239], v[164:167], v[116:119]
v_mfma_f32_16x16x32_bf16 v[120:123], v[236:239], v[168:171], v[120:123]
v_mfma_f32_16x16x32_bf16 v[124:127], v[236:239], v[172:175], v[124:127]
v_mfma_f32_16x16x16_bf16 v[192:195], v[52:53], v[24:25], 0
v_mfma_f32_16x16x16_bf16 v[240:243], v[54:55], v[24:25], 0
v_mfma_f32_16x16x16_bf16 v[196:199], v[52:53], v[26:27], 0
v_mfma_f32_16x16x16_bf16 v[244:247], v[54:55], v[26:27], 0
v_mfma_f32_16x16x16_bf16 v[200:203], v[52:53], v[28:29], 0
v_mfma_f32_16x16x16_bf16 v[248:251], v[54:55], v[28:29], 0
v_mfma_f32_16x16x16_bf16 v[204:207], v[52:53], v[30:31], 0
v_mfma_f32_16x16x16_bf16 v[252:255], v[54:55], v[30:31], 0
s_nop 1
v_add_f32 v240, s53, v240
s_nop 0
v_add_f32 v244, s53, v244
s_nop 0
v_add_f32 v248, s53, v248
s_nop 0
v_add_f32 v252, s53, v252
v_rcp_f32 v240, v240
v_rcp_f32 v244, v244
v_rcp_f32 v248, v248
v_rcp_f32 v252, v252
v_mul_f32 v240, v12, v240
v_mul_f32 v244, v13, v244
v_mul_f32 v248, v14, v248
v_mul_f32 v252, v15, v252
v_mul_f32 v192, v240, v192
v_mul_f32 v193, v240, v193
v_mul_f32 v194, v240, v194
v_mul_f32 v195, v240, v195
v_mul_f32 v196, v244, v196
v_mul_f32 v197, v244, v197
v_mul_f32 v198, v244, v198
v_mul_f32 v199, v244, v199
v_mul_f32 v200, v248, v200
v_mul_f32 v201, v248, v201
v_mul_f32 v202, v248, v202
v_mul_f32 v203, v248, v203
v_mul_f32 v204, v252, v204
v_mul_f32 v205, v252, v205
v_mul_f32 v206, v252, v206
v_mul_f32 v207, v252, v207
v_mov_b32 v28, v22
v_mov_b32 v29, v23
v_mov_b32 v24, v20
v_mov_b32 v25, v21
v_mov_b32 v20, v18
v_mov_b32 v21, v19
v_cvt_pk_bf16_f32 v18, v192, v193
v_cvt_pk_bf16_f32 v19, v194, v195
v_cvt_pk_bf16_f32 v22, v196, v197
v_cvt_pk_bf16_f32 v23, v198, v199
v_cvt_pk_bf16_f32 v26, v200, v201
v_cvt_pk_bf16_f32 v27, v202, v203
v_cvt_pk_bf16_f32 v30, v204, v205
v_cvt_pk_bf16_f32 v31, v206, v207
s_waitcnt vmcnt(20)
ds_read_b64_tr_b16 v[208:209], v8 offset:12288
ds_read_b64_tr_b16 v[210:211], v8 offset:14336
ds_read_b64_tr_b16 v[212:213], v9 offset:12288
ds_read_b64_tr_b16 v[214:215], v9 offset:14336
ds_read_b64_tr_b16 v[216:217], v10 offset:12288
ds_read_b64_tr_b16 v[218:219], v10 offset:14336
ds_read_b64_tr_b16 v[220:221], v11 offset:12288
ds_read_b64_tr_b16 v[222:223], v11 offset:14336
s_add_u32 m0, s33, 8192
s_lshl_b32 s49, s48, 12
s_add_u32 s49, s49, s34
s_add_u32 s48, s48, 1
s_and_b32 s48, s48, 15
buffer_load_dwordx4 v1, s[44:47], s49 offen offset:0 sc1 lds
buffer_load_dwordx4 v1, s[44:47], s49 offen offset:1024 sc1 lds
buffer_load_dwordx4 v1, s[44:47], s49 offen offset:2048 sc1 lds
buffer_load_dwordx4 v1, s[44:47], s49 offen offset:3072 sc1 lds
s_lshl_b32 s50, s52, 12
s_add_u32 s50, s50, s37
s_add_u32 s52, s52, 1
s_and_b32 s52, s52, 15
buffer_load_dwordx4 v[160:163], v1, s[44:47], s50 offen offset:0 sc1
buffer_load_dwordx4 v[164:167], v1, s[44:47], s50 offen offset:1024 sc1
buffer_load_dwordx4 v[168:171], v1, s[44:47], s50 offen offset:2048 sc1
buffer_load_dwordx4 v[172:175], v1, s[44:47], s50 offen offset:3072 sc1
s_waitcnt vmcnt(27) lgkmcnt(6)
v_mfma_f32_16x16x32_bf16 v[64:67], v[208:211], v[176:179], v[64:67]
s_waitcnt vmcnt(26)
v_mfma_f32_16x16x32_bf16 v[68:71], v[208:211], v[180:183], v[68:71]
s_waitcnt vmcnt(25)
v_mfma_f32_16x16x32_bf16 v[72:75], v[208:211], v[184:187], v[72:75]
s_waitcnt vmcnt(24)
v_mfma_f32_16x16x32_bf16 v[76:79], v[208:211], v[188:191], v[76:79]
s_waitcnt lgkmcnt(4)
v_mfma_f32_16x16x32_bf16 v[80:83], v[212:215], v[176:179], v[80:83]
v_mfma_f32_16x16x32_bf16 v[84:87], v[212:215], v[180:183], v[84:87]
v_mfma_f32_16x16x32_bf16 v[88:91], v[212:215], v[184:187], v[88:91]
v_mfma_f32_16x16x32_bf16 v[92:95], v[212:215], v[188:191], v[92:95]
s_waitcnt lgkmcnt(2)
v_mfma_f32_16x16x32_bf16 v[96:99], v[216:219], v[176:179], v[96:99]
v_mfma_f32_16x16x32_bf16 v[100:103], v[216:219], v[180:183], v[100:103]
v_mfma_f32_16x16x32_bf16 v[104:107], v[216:219], v[184:187], v[104:107]
v_mfma_f32_16x16x32_bf16 v[108:111], v[216:219], v[188:191], v[108:111]
s_waitcnt lgkmcnt(0)
v_mfma_f32_16x16x32_bf16 v[112:115], v[220:223], v[176:179], v[112:115]
v_mfma_f32_16x16x32_bf16 v[116:119], v[220:223], v[180:183], v[116:119]
v_mfma_f32_16x16x32_bf16 v[120:123], v[220:223], v[184:187], v[120:123]
v_mfma_f32_16x16x32_bf16 v[124:127], v[220:223], v[188:191], v[124:127]
s_waitcnt vmcnt(20)
ds_read_b64_tr_b16 v[224:225], v8 offset:0
ds_read_b64_tr_b16 v[226:227], v8 offset:2048
ds_read_b64_tr_b16 v[228:229], v9 offset:0
ds_read_b64_tr_b16 v[230:231], v9 offset:2048
ds_read_b64_tr_b16 v[232:233], v10 offset:0
ds_read_b64_tr_b16 v[234:235], v10 offset:2048
ds_read_b64_tr_b16 v[236:237], v11 offset:0
ds_read_b64_tr_b16 v[238:239], v11 offset:2048
s_add_u32 m0, s33, 12288
s_lshl_b32 s49, s48, 12
s_add_u32 s49, s49, s34
s_add_u32 s48, s48, 1
s_and_b32 s48, s48, 15
buffer_load_dwordx4 v1, s[44:47], s49 offen offset:0 sc1 lds
buffer_load_dwordx4 v1, s[44:47], s49 offen offset:1024 sc1 lds
buffer_load_dwordx4 v1, s[44:47], s49 offen offset:2048 sc1 lds
buffer_load_dwordx4 v1, s[44:47], s49 offen offset:3072 sc1 lds
s_lshl_b32 s50, s52, 12
s_add_u32 s50, s50, s37
s_add_u32 s52, s52, 1
s_and_b32 s52, s52, 15
buffer_load_dwordx4 v[176:179], v1, s[44:47], s50 offen offset:0 sc1
buffer_load_dwordx4 v[180:183], v1, s[44:47], s50 offen offset:1024 sc1
buffer_load_dwordx4 v[184:187], v1, s[44:47], s50 offen offset:2048 sc1
buffer_load_dwordx4 v[188:191], v1, s[44:47], s50 offen offset:3072 sc1
s_waitcnt vmcnt(27) lgkmcnt(6)
v_mfma_f32_16x16x32_bf16 v[64:67], v[224:227], v[128:131], v[64:67]
s_waitcnt vmcnt(26)
v_mfma_f32_16x16x32_bf16 v[68:71], v[224:227], v[132:135], v[68:71]
s_waitcnt vmcnt(25)
v_mfma_f32_16x16x32_bf16 v[72:75], v[224:227], v[136:139], v[72:75]
s_waitcnt vmcnt(24)
v_mfma_f32_16x16x32_bf16 v[76:79], v[224:227], v[140:143], v[76:79]
s_waitcnt lgkmcnt(4)
v_mfma_f32_16x16x32_bf16 v[80:83], v[228:231], v[128:131], v[80:83]
v_mfma_f32_16x16x32_bf16 v[84:87], v[228:231], v[132:135], v[84:87]
v_mfma_f32_16x16x32_bf16 v[88:91], v[228:231], v[136:139], v[88:91]
v_mfma_f32_16x16x32_bf16 v[92:95], v[228:231], v[140:143], v[92:95]
s_waitcnt lgkmcnt(2)
v_mfma_f32_16x16x32_bf16 v[96:99], v[232:235], v[128:131], v[96:99]
v_mfma_f32_16x16x32_bf16 v[100:103], v[232:235], v[132:135], v[100:103]
v_mfma_f32_16x16x32_bf16 v[104:107], v[232:235], v[136:139], v[104:107]
v_mfma_f32_16x16x32_bf16 v[108:111], v[232:235], v[140:143], v[108:111]
s_waitcnt lgkmcnt(0)
v_mfma_f32_16x16x32_bf16 v[112:115], v[236:239], v[128:131], v[112:115]
v_mfma_f32_16x16x32_bf16 v[116:119], v[236:239], v[132:135], v[116:119]
v_mfma_f32_16x16x32_bf16 v[120:123], v[236:239], v[136:139], v[120:123]
v_mfma_f32_16x16x32_bf16 v[124:127], v[236:239], v[140:143], v[124:127]
v_mfma_f32_16x16x16_bf16 v[192:195], v[56:57], v[32:33], 0
v_mfma_f32_16x16x16_bf16 v[240:243], v[58:59], v[32:33], 0
v_mfma_f32_16x16x16_bf16 v[196:199], v[56:57], v[34:35], 0
v_mfma_f32_16x16x16_bf16 v[244:247], v[58:59], v[34:35], 0
v_mfma_f32_16x16x16_bf16 v[200:203], v[56:57], v[36:37], 0
v_mfma_f32_16x16x16_bf16 v[248:251], v[58:59], v[36:37], 0
v_mfma_f32_16x16x16_bf16 v[204:207], v[56:57], v[38:39], 0
v_mfma_f32_16x16x16_bf16 v[252:255], v[58:59], v[38:39], 0
s_nop 1
v_add_f32 v240, s53, v240
s_nop 0
v_add_f32 v244, s53, v244
s_nop 0
v_add_f32 v248, s53, v248
s_nop 0
v_add_f32 v252, s53, v252
v_rcp_f32 v240, v240
v_rcp_f32 v244, v244
v_rcp_f32 v248, v248
v_rcp_f32 v252, v252
v_mul_f32 v240, v12, v240
v_mul_f32 v244, v13, v244
v_mul_f32 v248, v14, v248
v_mul_f32 v252, v15, v252
v_mul_f32 v192, v240, v192
v_mul_f32 v193, v240, v193
v_mul_f32 v194, v240, v194
v_mul_f32 v195, v240, v195
v_mul_f32 v196, v244, v196
v_mul_f32 v197, v244, v197
v_mul_f32 v198, v244, v198
v_mul_f32 v199, v244, v199
v_mul_f32 v200, v248, v200
v_mul_f32 v201, v248, v201
v_mul_f32 v202, v248, v202
v_mul_f32 v203, v248, v203
v_mul_f32 v204, v252, v204
v_mul_f32 v205, v252, v205
v_mul_f32 v206, v252, v206
v_mul_f32 v207, v252, v207
v_cvt_pk_bf16_f32 v32, v192, v193
v_cvt_pk_bf16_f32 v33, v194, v195
v_cvt_pk_bf16_f32 v34, v196, v197
v_cvt_pk_bf16_f32 v35, v198, v199
v_cvt_pk_bf16_f32 v36, v200, v201
v_cvt_pk_bf16_f32 v37, v202, v203
v_cvt_pk_bf16_f32 v38, v204, v205
v_cvt_pk_bf16_f32 v39, v206, v207
s_waitcnt vmcnt(20)
ds_read_b64_tr_b16 v[208:209], v8 offset:4096
ds_read_b64_tr_b16 v[210:211], v8 offset:6144
ds_read_b64_tr_b16 v[212:213], v9 offset:4096
ds_read_b64_tr_b16 v[214:215], v9 offset:6144
ds_read_b64_tr_b16 v[216:217], v10 offset:4096
ds_read_b64_tr_b16 v[218:219], v10 offset:6144
ds_read_b64_tr_b16 v[220:221], v11 offset:4096
ds_read_b64_tr_b16 v[222:223], v11 offset:6144
s_add_u32 m0, s33, 0
s_nop 0
buffer_load_dwordx4 v1, s[44:47], s35 offen offset:0 sc1 lds
buffer_load_dwordx4 v1, s[44:47], s35 offen offset:1024 sc1 lds
buffer_load_dwordx4 v1, s[44:47], s35 offen offset:2048 sc1 lds
buffer_load_dwordx4 v1, s[44:47], s35 offen offset:3072 sc1 lds
s_add_u32 s35, s35, 4096
s_waitcnt vmcnt(23) lgkmcnt(6)
v_mfma_f32_16x16x32_bf16 v[64:67], v[208:211], v[144:147], v[64:67]
s_waitcnt vmcnt(22)
v_mfma_f32_16x16x32_bf16 v[68:71], v[208:211], v[148:151], v[68:71]
s_waitcnt vmcnt(21)
v_mfma_f32_16x16x32_bf16 v[72:75], v[208:211], v[152:155], v[72:75]
s_waitcnt vmcnt(20)
v_mfma_f32_16x16x32_bf16 v[76:79], v[208:211], v[156:159], v[76:79]
s_waitcnt lgkmcnt(4)
v_mfma_f32_16x16x32_bf16 v[80:83], v[212:215], v[144:147], v[80:83]
v_mfma_f32_16x16x32_bf16 v[84:87], v[212:215], v[148:151], v[84:87]
v_mfma_f32_16x16x32_bf16 v[88:91], v[212:215], v[152:155], v[88:91]
v_mfma_f32_16x16x32_bf16 v[92:95], v[212:215], v[156:159], v[92:95]
s_waitcnt lgkmcnt(2)
v_mfma_f32_16x16x32_bf16 v[96:99], v[216:219], v[144:147], v[96:99]
v_mfma_f32_16x16x32_bf16 v[100:103], v[216:219], v[148:151], v[100:103]
v_mfma_f32_16x16x32_bf16 v[104:107], v[216:219], v[152:155], v[104:107]
v_mfma_f32_16x16x32_bf16 v[108:111], v[216:219], v[156:159], v[108:111]
s_waitcnt lgkmcnt(0)
v_mfma_f32_16x16x32_bf16 v[112:115], v[220:223], v[144:147], v[112:115]
v_mfma_f32_16x16x32_bf16 v[116:119], v[220:223], v[148:151], v[116:119]
v_mfma_f32_16x16x32_bf16 v[120:123], v[220:223], v[152:155], v[120:123]
v_mfma_f32_16x16x32_bf16 v[124:127], v[220:223], v[156:159], v[124:127]
s_waitcnt vmcnt(16)
ds_read_b64_tr_b16 v[224:225], v8 offset:8192
ds_read_b64_tr_b16 v[226:227], v8 offset:10240
ds_read_b64_tr_b16 v[228:229], v9 offset:8192
ds_read_b64_tr_b16 v[230:231], v9 offset:10240
ds_read_b64_tr_b16 v[232:233], v10 offset:8192
ds_read_b64_tr_b16 v[234:235], v10 offset:10240
ds_read_b64_tr_b16 v[236:237], v11 offset:8192
ds_read_b64_tr_b16 v[238:239], v11 offset:10240
s_add_u32 m0, s33, 4096
s_nop 0
buffer_load_dwordx4 v1, s[44:47], s35 offen offset:0 sc1 lds
buffer_load_dwordx4 v1, s[44:47], s35 offen offset:1024 sc1 lds
buffer_load_dwordx4 v1, s[44:47], s35 offen offset:2048 sc1 lds
buffer_load_dwordx4 v1, s[44:47], s35 offen offset:3072 sc1 lds
s_add_u32 s35, s35, 4096
s_waitcnt vmcnt(19) lgkmcnt(6)
v_mfma_f32_16x16x32_bf16 v[64:67], v[224:227], v[160:163], v[64:67]
s_waitcnt vmcnt(18)
v_mfma_f32_16x16x32_bf16 v[68:71], v[224:227], v[164:167], v[68:71]
s_waitcnt vmcnt(17)
v_mfma_f32_16x16x32_bf16 v[72:75], v[224:227], v[168:171], v[72:75]
s_waitcnt vmcnt(16)
v_mfma_f32_16x16x32_bf16 v[76:79], v[224:227], v[172:175], v[76:79]
s_waitcnt lgkmcnt(4)
v_mfma_f32_16x16x32_bf16 v[80:83], v[228:231], v[160:163], v[80:83]
v_mfma_f32_16x16x32_bf16 v[84:87], v[228:231], v[164:167], v[84:87]
v_mfma_f32_16x16x32_bf16 v[88:91], v[228:231], v[168:171], v[88:91]
v_mfma_f32_16x16x32_bf16 v[92:95], v[228:231], v[172:175], v[92:95]
s_waitcnt lgkmcnt(2)
v_mfma_f32_16x16x32_bf16 v[96:99], v[232:235], v[160:163], v[96:99]
v_mfma_f32_16x16x32_bf16 v[100:103], v[232:235], v[164:167], v[100:103]
v_mfma_f32_16x16x32_bf16 v[104:107], v[232:235], v[168:171], v[104:107]
v_mfma_f32_16x16x32_bf16 v[108:111], v[232:235], v[172:175], v[108:111]
s_waitcnt lgkmcnt(0)
v_mfma_f32_16x16x32_bf16 v[112:115], v[236:239], v[160:163], v[112:115]
v_mfma_f32_16x16x32_bf16 v[116:119], v[236:239], v[164:167], v[116:119]
v_mfma_f32_16x16x32_bf16 v[120:123], v[236:239], v[168:171], v[120:123]
v_mfma_f32_16x16x32_bf16 v[124:127], v[236:239], v[172:175], v[124:127]
v_mfma_f32_16x16x16_bf16 v[192:195], v[60:61], v[40:41], 0
v_mfma_f32_16x16x16_bf16 v[240:243], v[62:63], v[40:41], 0
v_mfma_f32_16x16x16_bf16 v[196:199], v[60:61], v[42:43], 0
v_mfma_f32_16x16x16_bf16 v[244:247], v[62:63], v[42:43], 0
v_mfma_f32_16x16x16_bf16 v[200:203], v[60:61], v[44:45], 0
v_mfma_f32_16x16x16_bf16 v[248:251], v[62:63], v[44:45], 0
v_mfma_f32_16x16x16_bf16 v[204:207], v[60:61], v[46:47], 0
v_mfma_f32_16x16x16_bf16 v[252:255], v[62:63], v[46:47], 0
s_nop 1
v_add_f32 v240, s53, v240
s_nop 0
v_add_f32 v244, s53, v244
s_nop 0
v_add_f32 v248, s53, v248
s_nop 0
v_add_f32 v252, s53, v252
v_rcp_f32 v240, v240
v_rcp_f32 v244, v244
v_rcp_f32 v248, v248
v_rcp_f32 v252, v252
v_mul_f32 v240, v12, v240
v_mul_f32 v244, v13, v244
v_mul_f32 v248, v14, v248
v_mul_f32 v252, v15, v252
v_mul_f32 v192, v240, v192
v_mul_f32 v193, v240, v193
v_mul_f32 v194, v240, v194
v_mul_f32 v195, v240, v195
v_mul_f32 v196, v244, v196
v_mul_f32 v197, v244, v197
v_mul_f32 v198, v244, v198
v_mul_f32 v199, v244, v199
v_mul_f32 v200, v248, v200
v_mul_f32 v201, v248, v201
v_mul_f32 v202, v248, v202
v_mul_f32 v203, v248, v203
v_mul_f32 v204, v252, v204
v_mul_f32 v205, v252, v205
v_mul_f32 v206, v252, v206
v_mul_f32 v207, v252, v207
v_mov_b32 v44, v38
v_mov_b32 v45, v39
v_mov_b32 v40, v36
v_mov_b32 v41, v37
v_mov_b32 v36, v34
v_mov_b32 v37, v35
v_cvt_pk_bf16_f32 v34, v192, v193
v_cvt_pk_bf16_f32 v35, v194, v195
v_cvt_pk_bf16_f32 v38, v196, v197
v_cvt_pk_bf16_f32 v39, v198, v199
v_cvt_pk_bf16_f32 v42, v200, v201
v_cvt_pk_bf16_f32 v43, v202, v203
v_cvt_pk_bf16_f32 v46, v204, v205
v_cvt_pk_bf16_f32 v47, v206, v207
s_waitcnt vmcnt(12)
ds_read_b64_tr_b16 v[208:209], v8 offset:12288
ds_read_b64_tr_b16 v[210:211], v8 offset:14336
ds_read_b64_tr_b16 v[212:213], v9 offset:12288
ds_read_b64_tr_b16 v[214:215], v9 offset:14336
ds_read_b64_tr_b16 v[216:217], v10 offset:12288
ds_read_b64_tr_b16 v[218:219], v10 offset:14336
ds_read_b64_tr_b16 v[220:221], v11 offset:12288
ds_read_b64_tr_b16 v[222:223], v11 offset:14336
s_waitcnt vmcnt(11) lgkmcnt(6)
v_mfma_f32_16x16x32_bf16 v[64:67], v[208:211], v[176:179], v[64:67]
s_waitcnt vmcnt(10)
v_mfma_f32_16x16x32_bf16 v[68:71], v[208:211], v[180:183], v[68:71]
s_waitcnt vmcnt(9)
v_mfma_f32_16x16x32_bf16 v[72:75], v[208:211], v[184:187], v[72:75]
s_waitcnt vmcnt(8)
v_mfma_f32_16x16x32_bf16 v[76:79], v[208:211], v[188:191], v[76:79]
s_waitcnt lgkmcnt(4)
v_mfma_f32_16x16x32_bf16 v[80:83], v[212:215], v[176:179], v[80:83]
v_mfma_f32_16x16x32_bf16 v[84:87], v[212:215], v[180:183], v[84:87]
v_mfma_f32_16x16x32_bf16 v[88:91], v[212:215], v[184:187], v[88:91]
v_mfma_f32_16x16x32_bf16 v[92:95], v[212:215], v[188:191], v[92:95]
s_waitcnt lgkmcnt(2)
v_mfma_f32_16x16x32_bf16 v[96:99], v[216:219], v[176:179], v[96:99]
v_mfma_f32_16x16x32_bf16 v[100:103], v[216:219], v[180:183], v[100:103]
v_mfma_f32_16x16x32_bf16 v[104:107], v[216:219], v[184:187], v[104:107]
v_mfma_f32_16x16x32_bf16 v[108:111], v[216:219], v[188:191], v[108:111]
s_waitcnt lgkmcnt(0)
v_mfma_f32_16x16x32_bf16 v[112:115], v[220:223], v[176:179], v[112:115]
v_mfma_f32_16x16x32_bf16 v[116:119], v[220:223], v[180:183], v[116:119]
v_mfma_f32_16x16x32_bf16 v[120:123], v[220:223], v[184:187], v[120:123]
v_mfma_f32_16x16x32_bf16 v[124:127], v[220:223], v[188:191], v[124:127]
s_waitcnt vmcnt(4)
ds_read_b64_tr_b16 v[224:225], v8 offset:0
ds_read_b64_tr_b16 v[226:227], v8 offset:2048
ds_read_b64_tr_b16 v[228:229], v9 offset:0
ds_read_b64_tr_b16 v[230:231], v9 offset:2048
ds_read_b64_tr_b16 v[232:233], v10 offset:0
ds_read_b64_tr_b16 v[234:235], v10 offset:2048
ds_read_b64_tr_b16 v[236:237], v11 offset:0
ds_read_b64_tr_b16 v[238:239], v11 offset:2048
v_sub_f32 v192, 1.0, v12
v_sub_f32 v194, 1.0, v13
v_sub_f32 v196, 1.0, v14
v_sub_f32 v198, 1.0, v15
v_pk_mul_f32 v[64:65], v[64:65], v[192:193] op_sel_hi:[1,0]
v_pk_mul_f32 v[66:67], v[66:67], v[192:193] op_sel_hi:[1,0]
v_pk_mul_f32 v[68:69], v[68:69], v[194:195] op_sel_hi:[1,0]
v_pk_mul_f32 v[70:71], v[70:71], v[194:195] op_sel_hi:[1,0]
v_pk_mul_f32 v[72:73], v[72:73], v[196:197] op_sel_hi:[1,0]
v_pk_mul_f32 v[74:75], v[74:75], v[196:197] op_sel_hi:[1,0]
v_pk_mul_f32 v[76:77], v[76:77], v[198:199] op_sel_hi:[1,0]
v_pk_mul_f32 v[78:79], v[78:79], v[198:199] op_sel_hi:[1,0]
v_pk_mul_f32 v[80:81], v[80:81], v[192:193] op_sel_hi:[1,0]
v_pk_mul_f32 v[82:83], v[82:83], v[192:193] op_sel_hi:[1,0]
v_pk_mul_f32 v[84:85], v[84:85], v[194:195] op_sel_hi:[1,0]
v_pk_mul_f32 v[86:87], v[86:87], v[194:195] op_sel_hi:[1,0]
v_pk_mul_f32 v[88:89], v[88:89], v[196:197] op_sel_hi:[1,0]
v_pk_mul_f32 v[90:91], v[90:91], v[196:197] op_sel_hi:[1,0]
v_pk_mul_f32 v[92:93], v[92:93], v[198:199] op_sel_hi:[1,0]
v_pk_mul_f32 v[94:95], v[94:95], v[198:199] op_sel_hi:[1,0]
v_pk_mul_f32 v[96:97], v[96:97], v[192:193] op_sel_hi:[1,0]
v_pk_mul_f32 v[98:99], v[98:99], v[192:193] op_sel_hi:[1,0]
v_pk_mul_f32 v[100:101], v[100:101], v[194:195] op_sel_hi:[1,0]
v_pk_mul_f32 v[102:103], v[102:103], v[194:195] op_sel_hi:[1,0]
v_pk_mul_f32 v[104:105], v[104:105], v[196:197] op_sel_hi:[1,0]
v_pk_mul_f32 v[106:107], v[106:107], v[196:197] op_sel_hi:[1,0]
v_pk_mul_f32 v[108:109], v[108:109], v[198:199] op_sel_hi:[1,0]
v_pk_mul_f32 v[110:111], v[110:111], v[198:199] op_sel_hi:[1,0]
v_pk_mul_f32 v[112:113], v[112:113], v[192:193] op_sel_hi:[1,0]
v_pk_mul_f32 v[114:115], v[114:115], v[192:193] op_sel_hi:[1,0]
v_pk_mul_f32 v[116:117], v[116:117], v[194:195] op_sel_hi:[1,0]
v_pk_mul_f32 v[118:119], v[118:119], v[194:195] op_sel_hi:[1,0]
v_pk_mul_f32 v[120:121], v[120:121], v[196:197] op_sel_hi:[1,0]
v_pk_mul_f32 v[122:123], v[122:123], v[196:197] op_sel_hi:[1,0]
v_pk_mul_f32 v[124:125], v[124:125], v[198:199] op_sel_hi:[1,0]
v_pk_mul_f32 v[126:127], v[126:127], v[198:199] op_sel_hi:[1,0]
s_waitcnt lgkmcnt(6)
v_mfma_f32_16x16x32_bf16 v[64:67], v[224:227], v[16:19], v[64:67]
v_mfma_f32_16x16x32_bf16 v[68:71], v[224:227], v[20:23], v[68:71]
v_mfma_f32_16x16x32_bf16 v[72:75], v[224:227], v[24:27], v[72:75]
v_mfma_f32_16x16x32_bf16 v[76:79], v[224:227], v[28:31], v[76:79]
s_waitcnt lgkmcnt(4)
v_mfma_f32_16x16x32_bf16 v[80:83], v[228:231], v[16:19], v[80:83]
v_mfma_f32_16x16x32_bf16 v[84:87], v[228:231], v[20:23], v[84:87]
v_mfma_f32_16x16x32_bf16 v[88:91], v[228:231], v[24:27], v[88:91]
v_mfma_f32_16x16x32_bf16 v[92:95], v[228:231], v[28:31], v[92:95]
s_waitcnt lgkmcnt(2)
v_mfma_f32_16x16x32_bf16 v[96:99], v[232:235], v[16:19], v[96:99]
v_mfma_f32_16x16x32_bf16 v[100:103], v[232:235], v[20:23], v[100:103]
v_mfma_f32_16x16x32_bf16 v[104:107], v[232:235], v[24:27], v[104:107]
v_mfma_f32_16x16x32_bf16 v[108:111], v[232:235], v[28:31], v[108:111]
s_waitcnt lgkmcnt(0)
v_mfma_f32_16x16x32_bf16 v[112:115], v[236:239], v[16:19], v[112:115]
v_mfma_f32_16x16x32_bf16 v[116:119], v[236:239], v[20:23], v[116:119]
v_mfma_f32_16x16x32_bf16 v[120:123], v[236:239], v[24:27], v[120:123]
v_mfma_f32_16x16x32_bf16 v[124:127], v[236:239], v[28:31], v[124:127]
s_waitcnt vmcnt(0)
ds_read_b64_tr_b16 v[208:209], v8 offset:4096
ds_read_b64_tr_b16 v[210:211], v8 offset:6144
ds_read_b64_tr_b16 v[212:213], v9 offset:4096
ds_read_b64_tr_b16 v[214:215], v9 offset:6144
ds_read_b64_tr_b16 v[216:217], v10 offset:4096
ds_read_b64_tr_b16 v[218:219], v10 offset:6144
ds_read_b64_tr_b16 v[220:221], v11 offset:4096
ds_read_b64_tr_b16 v[222:223], v11 offset:6144
s_waitcnt lgkmcnt(6)
v_mfma_f32_16x16x32_bf16 v[64:67], v[208:211], v[32:35], v[64:67]
v_mfma_f32_16x16x32_bf16 v[68:71], v[208:211], v[36:39], v[68:71]
v_mfma_f32_16x16x32_bf16 v[72:75], v[208:211], v[40:43], v[72:75]
v_mfma_f32_16x16x32_bf16 v[76:79], v[208:211], v[44:47], v[76:79]
s_waitcnt lgkmcnt(4)
v_mfma_f32_16x16x32_bf16 v[80:83], v[212:215], v[32:35], v[80:83]
v_mfma_f32_16x16x32_bf16 v[84:87], v[212:215], v[36:39], v[84:87]
v_mfma_f32_16x16x32_bf16 v[88:91], v[212:215], v[40:43], v[88:91]
v_mfma_f32_16x16x32_bf16 v[92:95], v[212:215], v[44:47], v[92:95]
s_waitcnt lgkmcnt(2)
v_mfma_f32_16x16x32_bf16 v[96:99], v[216:219], v[32:35], v[96:99]
v_mfma_f32_16x16x32_bf16 v[100:103], v[216:219], v[36:39], v[100:103]
v_mfma_f32_16x16x32_bf16 v[104:107], v[216:219], v[40:43], v[104:107]
v_mfma_f32_16x16x32_bf16 v[108:111], v[216:219], v[44:47], v[108:111]
s_waitcnt lgkmcnt(0)
v_mfma_f32_16x16x32_bf16 v[112:115], v[220:223], v[32:35], v[112:115]
v_mfma_f32_16x16x32_bf16 v[116:119], v[220:223], v[36:39], v[116:119]
v_mfma_f32_16x16x32_bf16 v[120:123], v[220:223], v[40:43], v[120:123]
v_mfma_f32_16x16x32_bf16 v[124:127], v[220:223], v[44:47], v[124:127]
v_add_u32 v12, s33, v1
ds_write_b128 v12, v[64:67] offset:0
ds_write_b128 v12, v[68:71] offset:1024
ds_write_b128 v12, v[72:75] offset:2048
ds_write_b128 v12, v[76:79] offset:3072
ds_write_b128 v12, v[80:83] offset:4096
ds_write_b128 v12, v[84:87] offset:5120
ds_write_b128 v12, v[88:91] offset:6144
ds_write_b128 v12, v[92:95] offset:7168
ds_write_b128 v12, v[96:99] offset:8192
ds_write_b128 v12, v[100:103] offset:9216
ds_write_b128 v12, v[104:107] offset:10240
ds_write_b128 v12, v[108:111] offset:11264
ds_write_b128 v12, v[112:115] offset:12288
ds_write_b128 v12, v[116:119] offset:13312
ds_write_b128 v12, v[120:123] offset:14336
ds_write_b128 v12, v[124:127] offset:15360
s_lshr_b32 s41, s3, 1
s_and_b32 s42, s3, 1
v_lshrrev_b32 v13, 5, v0
v_lshlrev_b32 v13, 12, v13
v_and_b32 v14, 15, v0
v_lshlrev_b32 v14, 4, v14
v_and_b32 v15, 16, v0
v_lshlrev_b32 v15, 5, v15
v_add3_u32 v13, v13, v14, v15
s_lshl_b32 s43, s42, 13
s_lshl_b32 s40, s41, 10
s_add_u32 s43, s43, s40
v_add_u32 v13, s43, v13
v_add_u32 v24, s28, v13
s_add_u32 s28, s28, 32768
s_cmp_eq_u32 s28, 163840
s_cselect_b32 s28, 0, s28
v_add_u32 v25, s28, v13
s_add_u32 s28, s28, 32768
s_cmp_eq_u32 s28, 163840
s_cselect_b32 s28, 0, s28
v_add_u32 v26, s28, v13
s_add_u32 s28, s28, 32768
s_cmp_eq_u32 s28, 163840
s_cselect_b32 s28, 0, s28
v_add_u32 v27, s28, v13
v_and_b32 v20, 15, v0
v_lshlrev_b32 v20, 10, v20
v_lshrrev_b32 v21, 4, v0
v_lshlrev_b32 v21, 4, v21
v_add_u32 v20, v20, v21
s_lshl_b32 s43, s30, 16
s_lshl_b32 s40, s41, 14
s_add_u32 s43, s43, s40
s_lshl_b32 s40, s31, 7
s_add_u32 s43, s43, s40
s_lshl_b32 s40, s42, 6
s_add_u32 s43, s43, s40
s_waitcnt lgkmcnt(0)
s_barrier
ds_read_b128 v[128:131], v24 offset:0
ds_read_b128 v[132:135], v24 offset:256
ds_read_b128 v[136:139], v24 offset:16384
ds_read_b128 v[140:143], v24 offset:16640
ds_read_b128 v[144:147], v25 offset:0
ds_read_b128 v[148:151], v25 offset:256
ds_read_b128 v[152:155], v25 offset:16384
ds_read_b128 v[156:159], v25 offset:16640
ds_read_b128 v[160:163], v26 offset:0
ds_read_b128 v[164:167], v26 offset:256
ds_read_b128 v[168:171], v26 offset:16384
ds_read_b128 v[172:175], v26 offset:16640
ds_read_b128 v[176:179], v27 offset:0
ds_read_b128 v[180:183], v27 offset:256
ds_read_b128 v[184:187], v27 offset:16384
ds_read_b128 v[188:191], v27 offset:16640
s_waitcnt lgkmcnt(13)
v_add_f32 v128, v128, v136
v_add_f32 v129, v129, v137
v_add_f32 v130, v130, v138
v_add_f32 v131, v131, v139
s_waitcnt lgkmcnt(12)
v_add_f32 v132, v132, v140
v_add_f32 v133, v133, v141
v_add_f32 v134, v134, v142
v_add_f32 v135, v135, v143
s_waitcnt lgkmcnt(11)
v_add_f32 v128, v128, v144
v_add_f32 v129, v129, v145
v_add_f32 v130, v130, v146
v_add_f32 v131, v131, v147
s_waitcnt lgkmcnt(10)
v_add_f32 v132, v132, v148
v_add_f32 v133, v133, v149
v_add_f32 v134, v134, v150
v_add_f32 v135, v135, v151
s_waitcnt lgkmcnt(9)
v_add_f32 v128, v128, v152
v_add_f32 v129, v129, v153
v_add_f32 v130, v130, v154
v_add_f32 v131, v131, v155
s_waitcnt lgkmcnt(8)
v_add_f32 v132, v132, v156
v_add_f32 v133, v133, v157
v_add_f32 v134, v134, v158
v_add_f32 v135, v135, v159
s_waitcnt lgkmcnt(7)
v_add_f32 v128, v128, v160
v_add_f32 v129, v129, v161
v_add_f32 v130, v130, v162
v_add_f32 v131, v131, v163
s_waitcnt lgkmcnt(6)
v_add_f32 v132, v132, v164
v_add_f32 v133, v133, v165
v_add_f32 v134, v134, v166
v_add_f32 v135, v135, v167
s_waitcnt lgkmcnt(5)
v_add_f32 v128, v128, v168
v_add_f32 v129, v129, v169
v_add_f32 v130, v130, v170
v_add_f32 v131, v131, v171
s_waitcnt lgkmcnt(4)
v_add_f32 v132, v132, v172
v_add_f32 v133, v133, v173
v_add_f32 v134, v134, v174
v_add_f32 v135, v135, v175
s_waitcnt lgkmcnt(3)
v_add_f32 v128, v128, v176
v_add_f32 v129, v129, v177
v_add_f32 v130, v130, v178
v_add_f32 v131, v131, v179
s_waitcnt lgkmcnt(2)
v_add_f32 v132, v132, v180
v_add_f32 v133, v133, v181
v_add_f32 v134, v134, v182
v_add_f32 v135, v135, v183
s_waitcnt lgkmcnt(1)
v_add_f32 v128, v128, v184
v_add_f32 v129, v129, v185
v_add_f32 v130, v130, v186
v_add_f32 v131, v131, v187
s_waitcnt lgkmcnt(0)
v_add_f32 v132, v132, v188
v_add_f32 v133, v133, v189
v_add_f32 v134, v134, v190
v_add_f32 v135, v135, v191
v_cvt_pk_bf16_f32 v16, v128, v129
v_cvt_pk_bf16_f32 v17, v130, v131
v_cvt_pk_bf16_f32 v18, v132, v133
v_cvt_pk_bf16_f32 v19, v134, v135
buffer_store_dwordx4 v[16:19], v20, s[4:7], s43 offen
s_endpgm
L_kk_kernel_ch1:
s_add_u32 m0, s56, 0
s_add_u32 s64, s53, 0
buffer_load_dwordx4 v6, s[36:39], s64 offen offset:0 lds
buffer_load_dwordx4 v7, s[36:39], s64 offen offset:1024 lds
s_add_u32 m0, s55, 0
s_add_u32 s66, s52, 0
buffer_load_dwordx4 v2, s[32:35], s66 offen offset:0 lds
buffer_load_dwordx4 v3, s[32:35], s66 offen offset:1024 lds
s_add_u32 m0, s55, 0
s_add_u32 s66, s52, 0
buffer_load_dwordx4 v4, s[32:35], s66 offen offset:2048 lds
buffer_load_dwordx4 v5, s[32:35], s66 offen offset:3072 lds
s_add_u32 m0, s56, 16384
s_add_u32 s64, s53, 262144
buffer_load_dwordx4 v6, s[36:39], s64 offen offset:0 lds
buffer_load_dwordx4 v7, s[36:39], s64 offen offset:1024 lds
s_add_u32 m0, s55, 32768
s_add_u32 s66, s52, 128
buffer_load_dwordx4 v2, s[32:35], s66 offen offset:0 lds
buffer_load_dwordx4 v3, s[32:35], s66 offen offset:1024 lds
s_add_u32 m0, s56, 32768
s_add_u32 s64, s53, 524288
buffer_load_dwordx4 v6, s[36:39], s64 offen offset:0 lds
buffer_load_dwordx4 v7, s[36:39], s64 offen offset:1024 lds
s_add_u32 m0, s55, 32768
s_add_u32 s66, s52, 128
buffer_load_dwordx4 v4, s[32:35], s66 offen offset:2048 lds
buffer_load_dwordx4 v5, s[32:35], s66 offen offset:3072 lds
s_mov_b32 s28, s4
s_and_b32 s29, s5, 0xffff
s_mov_b32 s30, 2097152
s_mov_b32 s31, 0x20000
s_mov_b32 s44, s70
s_and_b32 s45, s71, 0xffff
s_mov_b32 s46, 268435456
s_mov_b32 s47, 0x20000
s_mov_b32 s16, s68
s_and_b32 s17, s69, 0xffff
s_mov_b32 s18, 256
s_mov_b32 s19, 0x20000
s_cmp_eq_u32 s22, 3
s_cselect_b32 s40, s72, s6
s_cselect_b32 s41, s73, s7
s_mov_b32 s42, 1572864
s_cselect_b32 s42, 0, s42
s_cselect_b32 s54, 0, s54
s_cselect_b32 s67, 64, 98304
s_cselect_b64 vcc, -1, 0
s_and_b32 s41, s41, 0xffff
s_mov_b32 s43, 0x20000
s_lshl_b32 s65, s22, 10
s_add_u32 s65, s65, 8192
v_lshrrev_b32 v24, 1, v0
v_lshrrev_b32 v25, 2, v0
v_and_b32 v25, 4, v25
v_xor_b32 v24, v24, v25
v_mul_u32_u24 v24, 3072, v24
v_and_b32 v25, 1, v0
v_lshlrev_b32 v25, 4, v25
s_lshl_b32 s24, s22, 10
v_add3_u32 v8, v24, v25, s24
v_and_b32 v24, 48, v0
v_cndmask_b32 v8, v8, v24, vcc
s_mul_i32 s74, s21, 196608
s_add_u32 s74, s74, s54
s_add_u32 s75, s74, 98304
v_bfe_u32 v24, v0, 1, 4
v_lshrrev_b32 v25, 1, v24
v_and_b32 v25, 4, v25
v_xor_b32 v24, v24, v25
v_mul_u32_u24 v24, 3072, v24
v_and_b32 v25, 1, v0
v_lshlrev_b32 v25, 4, v25
v_and_b32 v26, 32, v0
v_add3_u32 v24, v24, v25, v26
s_lshl_b32 s24, s22, 10
v_add_u32 v8, s24, v24
s_and_b32 s99, s20, 3
s_lshl_b32 s99, s99, 3
s_add_u32 s99, s99, s21
s_mul_i32 s74, s99, 49152
s_lshr_b32 s24, s20, 2
s_lshl_b32 s24, s24, 7
s_add_u32 s74, s74, s24
s_add_u32 s75, s74, 64
s_sub_u32 s26, 15, s21
s_lshl_b32 s25, s21, 17
s_lshl_b32 s24, s22, 15
s_add_u32 s25, s25, s24
s_mov_b32 s48, s72
s_and_b32 s49, s73, 0xffff
s_mov_b32 s50, 1024
s_mov_b32 s51, 0x20000
s_lshl_b32 s58, s20, 3
s_add_u32 s58, s58, s3
s_cmp_lt_u32 s58, 128
s_cselect_b32 s59, s26, s21
s_and_b32 s58, s58, 127
s_lshl_b32 s59, s59, 7
s_add_u32 s58, s58, s59
s_lshl_b32 s59, s58, 10
buffer_load_dwordx4 v[228:231], v1, s[48:51], 0 offen
v_and_b32 v24, 15, v0
v_lshrrev_b32 v25, 1, v24
v_lshrrev_b32 v26, 4, v0
v_xor_b32 v25, v25, v26
v_lshlrev_b32 v25, 4, v25
v_lshlrev_b32 v24, 7, v24
s_lshl_b32 s24, s22, 13
s_add_u32 s24, s24, 65536
v_add3_u32 v10, v24, v25, s24
v_xor_b32 v11, 64, v10
v_add_u32 v12, 0x10000, v10
v_add_u32 v13, 0x10000, v11
v_lshrrev_b32 v24, 4, v0
v_bfe_u32 v25, v0, 2, 2
v_lshl_add_u32 v26, v24, 3, v25
v_lshlrev_b32 v26, 8, v26
v_and_b32 v27, 1, v24
v_lshl_add_u32 v27, v27, 2, v25
v_lshlrev_b32 v27, 5, v27
v_and_b32 v28, 3, v0
v_lshlrev_b32 v28, 3, v28
v_add3_u32 v14, v26, v27, v28
v_xor_b32 v15, 32, v14
v_xor_b32 v16, 64, v14
v_xor_b32 v17, 96, v14
v_xor_b32 v18, 128, v14
v_xor_b32 v19, 160, v14
v_xor_b32 v20, 192, v14
v_xor_b32 v21, 224, v14
v_lshlrev_b32 v26, 8, v24
v_add3_u32 v22, v26, v27, v28
v_xor_b32 v23, 128, v22
s_lshl_b32 s57, s20, 19
s_lshl_b32 s24, s21, 2
s_add_u32 s24, s24, s22
s_lshl_b32 s24, s24, 14
s_add_u32 s57, s57, s24
s_add_u32 s60, s57, 33554432
s_add_u32 s61, s57, 33558528
s_add_u32 s62, s57, 33562624
s_add_u32 s63, s57, 33566720
s_lshl_b32 s51, s20, 15
s_add_u32 s51, s51, 88096768
v_mov_b32 v31, 1
s_lshl_b32 s24, s20, 2
v_mov_b32 v29, s24
s_movk_i32 s24, 128
v_writelane_b32 v29, s24, 1
v_min_u32 v29, 32, v0
v_lshlrev_b32 v29, 2, v29
v_lshlrev_b32 v9, 2, v0
s_waitcnt vmcnt(9) lgkmcnt(0)
s_barrier
ds_read_b128 v[32:35], v10 offset:0
ds_read_b128 v[36:39], v10 offset:2048
ds_read_b128 v[40:43], v10 offset:4096
ds_read_b128 v[44:47], v10 offset:6144
ds_read_b64_tr_b16 v[64:65], v14 offset:8192
ds_read_b64_tr_b16 v[66:67], v14 offset:9216
ds_read_b64_tr_b16 v[68:69], v15 offset:8192
ds_read_b64_tr_b16 v[70:71], v15 offset:9216
ds_read_b64_tr_b16 v[72:73], v16 offset:8192
ds_read_b64_tr_b16 v[74:75], v16 offset:9216
ds_read_b64_tr_b16 v[76:77], v17 offset:8192
ds_read_b64_tr_b16 v[78:79], v17 offset:9216
ds_read_b64_tr_b16 v[80:81], v18 offset:8192
ds_read_b64_tr_b16 v[82:83], v18 offset:9216
s_waitcnt lgkmcnt(8)
v_mfma_f32_16x16x32_bf16 v[96:99], v[32:35], v[64:67], 0
ds_read_b64_tr_b16 v[84:85], v19 offset:8192
v_mfma_f32_16x16x32_bf16 v[100:103], v[36:39], v[64:67], 0
ds_read_b64_tr_b16 v[86:87], v19 offset:9216
v_mfma_f32_16x16x32_bf16 v[104:107], v[40:43], v[64:67], 0
s_add_u32 m0, s56, 49152
s_add_u32 s64, s53, 786432
v_mfma_f32_16x16x32_bf16 v[108:111], v[44:47], v[64:67], 0
buffer_load_dwordx4 v6, s[36:39], s64 offen offset:0 lds
s_waitcnt lgkmcnt(8)
v_mfma_f32_16x16x32_bf16 v[112:115], v[32:35], v[68:71], 0
ds_read_b64_tr_b16 v[64:65], v20 offset:8192
v_mfma_f32_16x16x32_bf16 v[116:119], v[36:39], v[68:71], 0
ds_read_b64_tr_b16 v[66:67], v20 offset:9216
v_mfma_f32_16x16x32_bf16 v[120:123], v[40:43], v[68:71], 0
s_cmp_lg_u32 s22, 2
s_cbranch_scc1 L_kk_kernel_c1_sk3
v_bfe_u32 v92, v0, 1, 2
v_lshlrev_b32 v92, 13, v92
v_and_b32 v235, 1, v0
v_lshl_add_u32 v92, v235, 7, v92
s_lshl_b32 s68, s21, 15
s_add_u32 s68, s68, s53
s_add_u32 s68, s68, 2097152
buffer_load_dword v94, v92, s[36:39], s68 offen
L_kk_kernel_c1_sk3:
v_mfma_f32_16x16x32_bf16 v[124:127], v[44:47], v[68:71], 0
buffer_load_dwordx4 v7, s[36:39], s64 offen offset:1024 lds
s_waitcnt lgkmcnt(8)
v_mfma_f32_16x16x32_bf16 v[128:131], v[32:35], v[72:75], 0
ds_read_b64_tr_b16 v[68:69], v21 offset:8192
v_mfma_f32_16x16x32_bf16 v[132:135], v[36:39], v[72:75], 0
ds_read_b64_tr_b16 v[70:71], v21 offset:9216
v_mfma_f32_16x16x32_bf16 v[136:139], v[40:43], v[72:75], 0
s_add_u32 m0, s55, 65536
s_add_u32 s66, s52, 256
s_cmp_lg_u32 s22, 0
s_cbranch_scc1 L_kk_kernel_c1_sk2
buffer_load_dwordx4 v[224:227], v1, s[28:31], s59 offen
L_kk_kernel_c1_sk2:
v_mfma_f32_16x16x32_bf16 v[140:143], v[44:47], v[72:75], 0
buffer_load_dwordx4 v2, s[32:35], s66 offen offset:0 lds
s_waitcnt lgkmcnt(8)
v_mfma_f32_16x16x32_bf16 v[144:147], v[32:35], v[76:79], 0
v_mfma_f32_16x16x32_bf16 v[148:151], v[36:39], v[76:79], 0
v_mfma_f32_16x16x32_bf16 v[152:155], v[40:43], v[76:79], 0
s_cmp_lg_u32 s22, 0
s_cbranch_scc1 L_kk_kernel_c1_sk1
buffer_load_dwordx4 v[240:243], v8, s[40:43], s74 offen
buffer_load_dwordx4 v[244:247], v8, s[40:43], s75 offen
L_kk_kernel_c1_sk1:
v_mfma_f32_16x16x32_bf16 v[156:159], v[44:47], v[76:79], 0
buffer_load_dwordx4 v3, s[32:35], s66 offen offset:1024 lds
s_waitcnt vmcnt(11) lgkmcnt(0)
s_barrier
ds_read_b64_tr_b16 v[72:73], v14 offset:24576
ds_read_b64_tr_b16 v[74:75], v14 offset:25600
v_mfma_f32_16x16x32_bf16 v[160:163], v[32:35], v[80:83], 0
ds_read_b64_tr_b16 v[76:77], v15 offset:24576
v_mfma_f32_16x16x32_bf16 v[164:167], v[36:39], v[80:83], 0
ds_read_b64_tr_b16 v[78:79], v15 offset:25600
v_mfma_f32_16x16x32_bf16 v[168:171], v[40:43], v[80:83], 0
ds_read_b128 v[48:51], v11 offset:0
v_mfma_f32_16x16x32_bf16 v[172:175], v[44:47], v[80:83], 0
v_mfma_f32_16x16x32_bf16 v[176:179], v[32:35], v[84:87], 0
ds_read_b64_tr_b16 v[80:81], v16 offset:24576
v_mfma_f32_16x16x32_bf16 v[180:183], v[36:39], v[84:87], 0
ds_read_b64_tr_b16 v[82:83], v16 offset:25600
s_add_u32 m0, s56, 0
s_add_u32 s64, s53, 1048576
ds_read_b128 v[52:55], v11 offset:2048
v_mfma_f32_16x16x32_bf16 v[184:187], v[40:43], v[84:87], 0
buffer_load_dwordx4 v6, s[36:39], s64 offen offset:0 lds
v_mfma_f32_16x16x32_bf16 v[188:191], v[44:47], v[84:87], 0
v_mfma_f32_16x16x32_bf16 v[192:195], v[32:35], v[64:67], 0
ds_read_b64_tr_b16 v[84:85], v17 offset:24576
ds_read_b128 v[56:59], v11 offset:4096
v_mfma_f32_16x16x32_bf16 v[196:199], v[36:39], v[64:67], 0
ds_read_b64_tr_b16 v[86:87], v17 offset:25600
v_mfma_f32_16x16x32_bf16 v[200:203], v[40:43], v[64:67], 0
v_mfma_f32_16x16x32_bf16 v[204:207], v[44:47], v[64:67], 0
ds_read_b128 v[60:63], v11 offset:6144
v_mfma_f32_16x16x32_bf16 v[208:211], v[32:35], v[68:71], 0
ds_read_b64_tr_b16 v[64:65], v18 offset:24576
v_mfma_f32_16x16x32_bf16 v[212:215], v[36:39], v[68:71], 0
ds_read_b64_tr_b16 v[66:67], v18 offset:25600
v_mfma_f32_16x16x32_bf16 v[216:219], v[40:43], v[68:71], 0
buffer_load_dwordx4 v7, s[36:39], s64 offen offset:1024 lds
v_mfma_f32_16x16x32_bf16 v[220:223], v[44:47], v[68:71], 0
s_waitcnt lgkmcnt(9)
v_mfma_f32_16x16x32_bf16 v[96:99], v[48:51], v[72:75], v[96:99]
ds_read_b64_tr_b16 v[68:69], v19 offset:24576
s_waitcnt lgkmcnt(7)
v_mfma_f32_16x16x32_bf16 v[100:103], v[52:55], v[72:75], v[100:103]
ds_read_b64_tr_b16 v[70:71], v19 offset:25600
s_waitcnt lgkmcnt(6)
v_mfma_f32_16x16x32_bf16 v[104:107], v[56:59], v[72:75], v[104:107]
s_waitcnt lgkmcnt(4)
v_mfma_f32_16x16x32_bf16 v[108:111], v[60:63], v[72:75], v[108:111]
v_mfma_f32_16x16x32_bf16 v[112:115], v[48:51], v[76:79], v[112:115]
ds_read_b64_tr_b16 v[72:73], v20 offset:24576
v_mfma_f32_16x16x32_bf16 v[116:119], v[52:55], v[76:79], v[116:119]
ds_read_b64_tr_b16 v[74:75], v20 offset:25600
s_add_u32 m0, s55, 65536
s_add_u32 s66, s52, 256
v_mfma_f32_16x16x32_bf16 v[120:123], v[56:59], v[76:79], v[120:123]
buffer_load_dwordx4 v4, s[32:35], s66 offen offset:2048 lds
s_cmp_lg_u32 s22, 3
s_cbranch_scc1 L_kk_kernel_c1_sk6
v_bfe_u32 v92, v0, 1, 2
v_lshlrev_b32 v92, 13, v92
v_and_b32 v235, 1, v0
v_lshl_add_u32 v92, v235, 7, v92
s_lshl_b32 s68, s21, 15
s_add_u32 s68, s68, s53
s_add_u32 s68, s68, 2359296
buffer_load_dword v94, v92, s[36:39], s68 offen
L_kk_kernel_c1_sk6:
v_mfma_f32_16x16x32_bf16 v[124:127], v[60:63], v[76:79], v[124:127]
v_mfma_f32_16x16x32_bf16 v[128:131], v[48:51], v[80:83], v[128:131]
ds_read_b64_tr_b16 v[76:77], v21 offset:24576
v_mfma_f32_16x16x32_bf16 v[132:135], v[52:55], v[80:83], v[132:135]
ds_read_b64_tr_b16 v[78:79], v21 offset:25600
v_mfma_f32_16x16x32_bf16 v[136:139], v[56:59], v[80:83], v[136:139]
s_cmp_lg_u32 s22, 1
s_cbranch_scc1 L_kk_kernel_c1_sk5
buffer_load_dwordx4 v[224:227], v1, s[28:31], s59 offen
L_kk_kernel_c1_sk5:
v_mfma_f32_16x16x32_bf16 v[140:143], v[60:63], v[80:83], v[140:143]
v_mfma_f32_16x16x32_bf16 v[144:147], v[48:51], v[84:87], v[144:147]
v_mfma_f32_16x16x32_bf16 v[148:151], v[52:55], v[84:87], v[148:151]
v_mfma_f32_16x16x32_bf16 v[152:155], v[56:59], v[84:87], v[152:155]
buffer_load_dwordx4 v5, s[32:35], s66 offen offset:3072 lds
s_cmp_lg_u32 s22, 1
s_cbranch_scc1 L_kk_kernel_c1_sk4
buffer_load_dwordx4 v[240:243], v8, s[40:43], s74 offen
buffer_load_dwordx4 v[244:247], v8, s[40:43], s75 offen
L_kk_kernel_c1_sk4:
v_mfma_f32_16x16x32_bf16 v[156:159], v[60:63], v[84:87], v[156:159]
s_waitcnt vmcnt(9) lgkmcnt(0)
s_barrier
ds_read_b64_tr_b16 v[80:81], v14 offset:40960
ds_read_b64_tr_b16 v[82:83], v14 offset:41984
v_mfma_f32_16x16x32_bf16 v[160:163], v[48:51], v[64:67], v[160:163]
ds_read_b64_tr_b16 v[84:85], v15 offset:40960
v_mfma_f32_16x16x32_bf16 v[164:167], v[52:55], v[64:67], v[164:167]
ds_read_b64_tr_b16 v[86:87], v15 offset:41984
v_mfma_f32_16x16x32_bf16 v[168:171], v[56:59], v[64:67], v[168:171]
ds_read_b128 v[32:35], v10 offset:32768
v_mfma_f32_16x16x32_bf16 v[172:175], v[60:63], v[64:67], v[172:175]
v_mfma_f32_16x16x32_bf16 v[176:179], v[48:51], v[68:71], v[176:179]
ds_read_b64_tr_b16 v[64:65], v16 offset:40960
v_mfma_f32_16x16x32_bf16 v[180:183], v[52:55], v[68:71], v[180:183]
ds_read_b64_tr_b16 v[66:67], v16 offset:41984
s_add_u32 m0, s56, 16384
s_add_u32 s64, s53, 1310720
ds_read_b128 v[36:39], v10 offset:34816
v_mfma_f32_16x16x32_bf16 v[184:187], v[56:59], v[68:71], v[184:187]
buffer_load_dwordx4 v6, s[36:39], s64 offen offset:0 lds
v_mfma_f32_16x16x32_bf16 v[188:191], v[60:63], v[68:71], v[188:191]
v_mfma_f32_16x16x32_bf16 v[192:195], v[48:51], v[72:75], v[192:195]
ds_read_b64_tr_b16 v[68:69], v17 offset:40960
ds_read_b128 v[40:43], v10 offset:36864
v_mfma_f32_16x16x32_bf16 v[196:199], v[52:55], v[72:75], v[196:199]
ds_read_b64_tr_b16 v[70:71], v17 offset:41984
v_mfma_f32_16x16x32_bf16 v[200:203], v[56:59], v[72:75], v[200:203]
v_mfma_f32_16x16x32_bf16 v[204:207], v[60:63], v[72:75], v[204:207]
ds_read_b128 v[44:47], v10 offset:38912
v_mfma_f32_16x16x32_bf16 v[208:211], v[48:51], v[76:79], v[208:211]
ds_read_b64_tr_b16 v[72:73], v18 offset:40960
v_mfma_f32_16x16x32_bf16 v[212:215], v[52:55], v[76:79], v[212:215]
ds_read_b64_tr_b16 v[74:75], v18 offset:41984
v_mfma_f32_16x16x32_bf16 v[216:219], v[56:59], v[76:79], v[216:219]
buffer_load_dwordx4 v7, s[36:39], s64 offen offset:1024 lds
v_mfma_f32_16x16x32_bf16 v[220:223], v[60:63], v[76:79], v[220:223]
s_waitcnt lgkmcnt(9)
v_mfma_f32_16x16x32_bf16 v[96:99], v[32:35], v[80:83], v[96:99]
ds_read_b64_tr_b16 v[76:77], v19 offset:40960
s_waitcnt lgkmcnt(7)
v_mfma_f32_16x16x32_bf16 v[100:103], v[36:39], v[80:83], v[100:103]
ds_read_b64_tr_b16 v[78:79], v19 offset:41984
s_waitcnt lgkmcnt(6)
v_mfma_f32_16x16x32_bf16 v[104:107], v[40:43], v[80:83], v[104:107]
s_waitcnt lgkmcnt(4)
v_mfma_f32_16x16x32_bf16 v[108:111], v[44:47], v[80:83], v[108:111]
v_mfma_f32_16x16x32_bf16 v[112:115], v[32:35], v[84:87], v[112:115]
ds_read_b64_tr_b16 v[80:81], v20 offset:40960
v_mfma_f32_16x16x32_bf16 v[116:119], v[36:39], v[84:87], v[116:119]
ds_read_b64_tr_b16 v[82:83], v20 offset:41984
s_add_u32 m0, s55, 0
s_add_u32 s66, s52, 384
v_mfma_f32_16x16x32_bf16 v[120:123], v[40:43], v[84:87], v[120:123]
buffer_load_dwordx4 v2, s[32:35], s66 offen offset:0 lds
s_cmp_lg_u32 s22, 0
s_cbranch_scc1 L_kk_kernel_c1_sk9
v_bfe_u32 v92, v0, 1, 2
v_lshlrev_b32 v92, 13, v92
v_and_b32 v235, 1, v0
v_lshl_add_u32 v92, v235, 7, v92
s_lshl_b32 s68, s21, 15
s_add_u32 s68, s68, s53
s_add_u32 s68, s68, 2621440
buffer_load_dword v94, v92, s[36:39], s68 offen
L_kk_kernel_c1_sk9:
v_mfma_f32_16x16x32_bf16 v[124:127], v[44:47], v[84:87], v[124:127]
v_mfma_f32_16x16x32_bf16 v[128:131], v[32:35], v[64:67], v[128:131]
ds_read_b64_tr_b16 v[84:85], v21 offset:40960
v_mfma_f32_16x16x32_bf16 v[132:135], v[36:39], v[64:67], v[132:135]
ds_read_b64_tr_b16 v[86:87], v21 offset:41984
v_mfma_f32_16x16x32_bf16 v[136:139], v[40:43], v[64:67], v[136:139]
s_cmp_lg_u32 s22, 2
s_cbranch_scc1 L_kk_kernel_c1_sk8
buffer_load_dwordx4 v[224:227], v1, s[28:31], s59 offen
L_kk_kernel_c1_sk8:
v_mfma_f32_16x16x32_bf16 v[140:143], v[44:47], v[64:67], v[140:143]
v_mfma_f32_16x16x32_bf16 v[144:147], v[32:35], v[68:71], v[144:147]
v_mfma_f32_16x16x32_bf16 v[148:151], v[36:39], v[68:71], v[148:151]
v_mfma_f32_16x16x32_bf16 v[152:155], v[40:43], v[68:71], v[152:155]
buffer_load_dwordx4 v3, s[32:35], s66 offen offset:1024 lds
s_cmp_lg_u32 s22, 2
s_cbranch_scc1 L_kk_kernel_c1_sk7
buffer_load_dwordx4 v[240:243], v8, s[40:43], s74 offen
buffer_load_dwordx4 v[244:247], v8, s[40:43], s75 offen
L_kk_kernel_c1_sk7:
v_mfma_f32_16x16x32_bf16 v[156:159], v[44:47], v[68:71], v[156:159]
s_waitcnt vmcnt(10) lgkmcnt(0)
s_barrier
ds_read_b64_tr_b16 v[64:65], v14 offset:57344
ds_read_b64_tr_b16 v[66:67], v14 offset:58368
v_mfma_f32_16x16x32_bf16 v[160:163], v[32:35], v[72:75], v[160:163]
ds_read_b64_tr_b16 v[68:69], v15 offset:57344
v_mfma_f32_16x16x32_bf16 v[164:167], v[36:39], v[72:75], v[164:167]
ds_read_b64_tr_b16 v[70:71], v15 offset:58368
v_mfma_f32_16x16x32_bf16 v[168:171], v[40:43], v[72:75], v[168:171]
ds_read_b128 v[48:51], v11 offset:32768
v_mfma_f32_16x16x32_bf16 v[172:175], v[44:47], v[72:75], v[172:175]
v_mfma_f32_16x16x32_bf16 v[176:179], v[32:35], v[76:79], v[176:179]
ds_read_b64_tr_b16 v[72:73], v16 offset:57344
v_mfma_f32_16x16x32_bf16 v[180:183], v[36:39], v[76:79], v[180:183]
ds_read_b64_tr_b16 v[74:75], v16 offset:58368
s_add_u32 m0, s56, 32768
s_add_u32 s64, s53, 1572864
ds_read_b128 v[52:55], v11 offset:34816
v_mfma_f32_16x16x32_bf16 v[184:187], v[40:43], v[76:79], v[184:187]
buffer_load_dwordx4 v6, s[36:39], s64 offen offset:0 lds
v_mfma_f32_16x16x32_bf16 v[188:191], v[44:47], v[76:79], v[188:191]
v_mfma_f32_16x16x32_bf16 v[192:195], v[32:35], v[80:83], v[192:195]
ds_read_b64_tr_b16 v[76:77], v17 offset:57344
ds_read_b128 v[56:59], v11 offset:36864
v_mfma_f32_16x16x32_bf16 v[196:199], v[36:39], v[80:83], v[196:199]
ds_read_b64_tr_b16 v[78:79], v17 offset:58368
v_mfma_f32_16x16x32_bf16 v[200:203], v[40:43], v[80:83], v[200:203]
v_mfma_f32_16x16x32_bf16 v[204:207], v[44:47], v[80:83], v[204:207]
ds_read_b128 v[60:63], v11 offset:38912
v_mfma_f32_16x16x32_bf16 v[208:211], v[32:35], v[84:87], v[208:211]
ds_read_b64_tr_b16 v[80:81], v18 offset:57344
v_mfma_f32_16x16x32_bf16 v[212:215], v[36:39], v[84:87], v[212:215]
ds_read_b64_tr_b16 v[82:83], v18 offset:58368
v_mfma_f32_16x16x32_bf16 v[216:219], v[40:43], v[84:87], v[216:219]
buffer_load_dwordx4 v7, s[36:39], s64 offen offset:1024 lds
v_mfma_f32_16x16x32_bf16 v[220:223], v[44:47], v[84:87], v[220:223]
s_waitcnt lgkmcnt(9)
v_mfma_f32_16x16x32_bf16 v[96:99], v[48:51], v[64:67], v[96:99]
ds_read_b64_tr_b16 v[84:85], v19 offset:57344
s_waitcnt lgkmcnt(7)
v_mfma_f32_16x16x32_bf16 v[100:103], v[52:55], v[64:67], v[100:103]
ds_read_b64_tr_b16 v[86:87], v19 offset:58368
s_waitcnt lgkmcnt(6)
v_mfma_f32_16x16x32_bf16 v[104:107], v[56:59], v[64:67], v[104:107]
s_waitcnt lgkmcnt(4)
v_mfma_f32_16x16x32_bf16 v[108:111], v[60:63], v[64:67], v[108:111]
v_mfma_f32_16x16x32_bf16 v[112:115], v[48:51], v[68:71], v[112:115]
ds_read_b64_tr_b16 v[64:65], v20 offset:57344
v_mfma_f32_16x16x32_bf16 v[116:119], v[52:55], v[68:71], v[116:119]
ds_read_b64_tr_b16 v[66:67], v20 offset:58368
s_add_u32 m0, s55, 0
s_add_u32 s66, s52, 384
v_mfma_f32_16x16x32_bf16 v[120:123], v[56:59], v[68:71], v[120:123]
buffer_load_dwordx4 v4, s[32:35], s66 offen offset:2048 lds
v_mfma_f32_16x16x32_bf16 v[124:127], v[60:63], v[68:71], v[124:127]
v_mfma_f32_16x16x32_bf16 v[128:131], v[48:51], v[72:75], v[128:131]
ds_read_b64_tr_b16 v[68:69], v21 offset:57344
v_mfma_f32_16x16x32_bf16 v[132:135], v[52:55], v[72:75], v[132:135]
ds_read_b64_tr_b16 v[70:71], v21 offset:58368
v_mfma_f32_16x16x32_bf16 v[136:139], v[56:59], v[72:75], v[136:139]
s_cmp_lg_u32 s22, 1
s_cbranch_scc1 L_kk_kernel_c1_sk11
v_bfe_u32 v92, v0, 1, 2
v_lshlrev_b32 v92, 13, v92
v_and_b32 v235, 1, v0
v_lshl_add_u32 v92, v235, 7, v92
s_lshl_b32 s68, s21, 15
s_add_u32 s68, s68, s53
s_add_u32 s68, s68, 2883584
buffer_load_dword v94, v92, s[36:39], s68 offen
L_kk_kernel_c1_sk11:
v_mfma_f32_16x16x32_bf16 v[140:143], v[60:63], v[72:75], v[140:143]
v_mfma_f32_16x16x32_bf16 v[144:147], v[48:51], v[76:79], v[144:147]
v_mfma_f32_16x16x32_bf16 v[148:151], v[52:55], v[76:79], v[148:151]
v_mfma_f32_16x16x32_bf16 v[152:155], v[56:59], v[76:79], v[152:155]
buffer_load_dwordx4 v5, s[32:35], s66 offen offset:3072 lds
s_cmp_lg_u32 s22, 3
s_cbranch_scc1 L_kk_kernel_c1_sk10
buffer_load_dwordx4 v[224:227], v1, s[28:31], s59 offen
L_kk_kernel_c1_sk10:
v_mfma_f32_16x16x32_bf16 v[156:159], v[60:63], v[76:79], v[156:159]
s_waitcnt vmcnt(8) lgkmcnt(0)
s_barrier
ds_read_b64_tr_b16 v[72:73], v14 offset:8192
ds_read_b64_tr_b16 v[74:75], v14 offset:9216
v_mfma_f32_16x16x32_bf16 v[160:163], v[48:51], v[80:83], v[160:163]
ds_read_b64_tr_b16 v[76:77], v15 offset:8192
v_mfma_f32_16x16x32_bf16 v[164:167], v[52:55], v[80:83], v[164:167]
ds_read_b64_tr_b16 v[78:79], v15 offset:9216
v_mfma_f32_16x16x32_bf16 v[168:171], v[56:59], v[80:83], v[168:171]
ds_read_b128 v[32:35], v12 offset:0
v_mfma_f32_16x16x32_bf16 v[172:175], v[60:63], v[80:83], v[172:175]
v_mfma_f32_16x16x32_bf16 v[176:179], v[48:51], v[84:87], v[176:179]
ds_read_b64_tr_b16 v[80:81], v16 offset:8192
v_mfma_f32_16x16x32_bf16 v[180:183], v[52:55], v[84:87], v[180:183]
ds_read_b64_tr_b16 v[82:83], v16 offset:9216
s_add_u32 m0, s56, 49152
s_add_u32 s64, s53, 1835008
ds_read_b128 v[36:39], v12 offset:2048
v_mfma_f32_16x16x32_bf16 v[184:187], v[56:59], v[84:87], v[184:187]
buffer_load_dwordx4 v6, s[36:39], s64 offen offset:0 lds
v_mfma_f32_16x16x32_bf16 v[188:191], v[60:63], v[84:87], v[188:191]
v_mfma_f32_16x16x32_bf16 v[192:195], v[48:51], v[64:67], v[192:195]
ds_read_b64_tr_b16 v[84:85], v17 offset:8192
ds_read_b128 v[40:43], v12 offset:4096
v_mfma_f32_16x16x32_bf16 v[196:199], v[52:55], v[64:67], v[196:199]
ds_read_b64_tr_b16 v[86:87], v17 offset:9216
v_mfma_f32_16x16x32_bf16 v[200:203], v[56:59], v[64:67], v[200:203]
v_mfma_f32_16x16x32_bf16 v[204:207], v[60:63], v[64:67], v[204:207]
ds_read_b128 v[44:47], v12 offset:6144
v_mfma_f32_16x16x32_bf16 v[208:211], v[48:51], v[68:71], v[208:211]
ds_read_b64_tr_b16 v[64:65], v18 offset:8192
v_mfma_f32_16x16x32_bf16 v[212:215], v[52:55], v[68:71], v[212:215]
ds_read_b64_tr_b16 v[66:67], v18 offset:9216
v_mfma_f32_16x16x32_bf16 v[216:219], v[56:59], v[68:71], v[216:219]
buffer_load_dwordx4 v7, s[36:39], s64 offen offset:1024 lds
v_mfma_f32_16x16x32_bf16 v[220:223], v[60:63], v[68:71], v[220:223]
s_waitcnt lgkmcnt(9)
v_mfma_f32_16x16x32_bf16 v[96:99], v[32:35], v[72:75], v[96:99]
ds_read_b64_tr_b16 v[68:69], v19 offset:8192
s_waitcnt lgkmcnt(7)
v_mfma_f32_16x16x32_bf16 v[100:103], v[36:39], v[72:75], v[100:103]
ds_read_b64_tr_b16 v[70:71], v19 offset:9216
s_waitcnt lgkmcnt(6)
v_mfma_f32_16x16x32_bf16 v[104:107], v[40:43], v[72:75], v[104:107]
s_waitcnt lgkmcnt(4)
v_mfma_f32_16x16x32_bf16 v[108:111], v[44:47], v[72:75], v[108:111]
v_mfma_f32_16x16x32_bf16 v[112:115], v[32:35], v[76:79], v[112:115]
ds_read_b64_tr_b16 v[72:73], v20 offset:8192
v_mfma_f32_16x16x32_bf16 v[116:119], v[36:39], v[76:79], v[116:119]
ds_read_b64_tr_b16 v[74:75], v20 offset:9216
s_add_u32 m0, s55, 32768
s_add_u32 s66, s52, 512
v_mfma_f32_16x16x32_bf16 v[120:123], v[40:43], v[76:79], v[120:123]
buffer_load_dwordx4 v2, s[32:35], s66 offen offset:0 lds
v_mfma_f32_16x16x32_bf16 v[124:127], v[44:47], v[76:79], v[124:127]
v_mfma_f32_16x16x32_bf16 v[128:131], v[32:35], v[80:83], v[128:131]
ds_read_b64_tr_b16 v[76:77], v21 offset:8192
v_mfma_f32_16x16x32_bf16 v[132:135], v[36:39], v[80:83], v[132:135]
ds_read_b64_tr_b16 v[78:79], v21 offset:9216
v_mfma_f32_16x16x32_bf16 v[136:139], v[40:43], v[80:83], v[136:139]
v_mfma_f32_16x16x32_bf16 v[140:143], v[44:47], v[80:83], v[140:143]
v_mfma_f32_16x16x32_bf16 v[144:147], v[32:35], v[84:87], v[144:147]
v_mfma_f32_16x16x32_bf16 v[148:151], v[36:39], v[84:87], v[148:151]
v_mfma_f32_16x16x32_bf16 v[152:155], v[40:43], v[84:87], v[152:155]
buffer_load_dwordx4 v3, s[32:35], s66 offen offset:1024 lds
s_cmp_lg_u32 s22, 2
s_cbranch_scc1 L_kk_kernel_c1_sk12
v_bfe_u32 v92, v0, 1, 2
v_lshlrev_b32 v92, 13, v92
v_and_b32 v235, 1, v0
v_lshl_add_u32 v92, v235, 7, v92
s_lshl_b32 s68, s21, 15
s_add_u32 s68, s68, s53
s_add_u32 s68, s68, 3145728
buffer_load_dword v94, v92, s[36:39], s68 offen
L_kk_kernel_c1_sk12:
v_mfma_f32_16x16x32_bf16 v[156:159], v[44:47], v[84:87], v[156:159]
s_waitcnt vmcnt(10) lgkmcnt(0)
s_barrier
ds_read_b64_tr_b16 v[80:81], v14 offset:24576
ds_read_b64_tr_b16 v[82:83], v14 offset:25600
v_mfma_f32_16x16x32_bf16 v[160:163], v[32:35], v[64:67], v[160:163]
ds_read_b64_tr_b16 v[84:85], v15 offset:24576
v_mfma_f32_16x16x32_bf16 v[164:167], v[36:39], v[64:67], v[164:167]
ds_read_b64_tr_b16 v[86:87], v15 offset:25600
v_mfma_f32_16x16x32_bf16 v[168:171], v[40:43], v[64:67], v[168:171]
ds_read_b128 v[48:51], v13 offset:0
v_mfma_f32_16x16x32_bf16 v[172:175], v[44:47], v[64:67], v[172:175]
s_add_u32 m0, s56, 0
s_add_u32 s64, s53, 2097152
v_mfma_f32_16x16x32_bf16 v[176:179], v[32:35], v[68:71], v[176:179]
ds_read_b64_tr_b16 v[64:65], v16 offset:24576
buffer_load_dwordx4 v6, s[36:39], s64 offen offset:0 lds
v_mfma_f32_16x16x32_bf16 v[180:183], v[36:39], v[68:71], v[180:183]
ds_read_b64_tr_b16 v[66:67], v16 offset:25600
ds_read_b128 v[52:55], v13 offset:2048
v_mfma_f32_16x16x32_bf16 v[184:187], v[40:43], v[68:71], v[184:187]
v_mfma_f32_16x16x32_bf16 v[188:191], v[44:47], v[68:71], v[188:191]
v_mfma_f32_16x16x32_bf16 v[192:195], v[32:35], v[72:75], v[192:195]
ds_read_b64_tr_b16 v[68:69], v17 offset:24576
ds_read_b128 v[56:59], v13 offset:4096
v_mfma_f32_16x16x32_bf16 v[196:199], v[36:39], v[72:75], v[196:199]
ds_read_b64_tr_b16 v[70:71], v17 offset:25600
buffer_load_dwordx4 v7, s[36:39], s64 offen offset:1024 lds
v_mfma_f32_16x16x32_bf16 v[200:203], v[40:43], v[72:75], v[200:203]
v_mfma_f32_16x16x32_bf16 v[204:207], v[44:47], v[72:75], v[204:207]
ds_read_b128 v[60:63], v13 offset:6144
v_mfma_f32_16x16x32_bf16 v[208:211], v[32:35], v[76:79], v[208:211]
ds_read_b64_tr_b16 v[72:73], v18 offset:24576
v_mfma_f32_16x16x32_bf16 v[212:215], v[36:39], v[76:79], v[212:215]
ds_read_b64_tr_b16 v[74:75], v18 offset:25600
s_add_u32 m0, s55, 32768
s_add_u32 s66, s52, 512
v_mfma_f32_16x16x32_bf16 v[216:219], v[40:43], v[76:79], v[216:219]
buffer_load_dwordx4 v4, s[32:35], s66 offen offset:2048 lds
v_mfma_f32_16x16x32_bf16 v[220:223], v[44:47], v[76:79], v[220:223]
s_waitcnt lgkmcnt(9)
v_mfma_f32_16x16x32_bf16 v[96:99], v[48:51], v[80:83], v[96:99]
ds_read_b64_tr_b16 v[76:77], v19 offset:24576
s_waitcnt lgkmcnt(7)
v_mfma_f32_16x16x32_bf16 v[100:103], v[52:55], v[80:83], v[100:103]
ds_read_b64_tr_b16 v[78:79], v19 offset:25600
s_waitcnt lgkmcnt(6)
v_mfma_f32_16x16x32_bf16 v[104:107], v[56:59], v[80:83], v[104:107]
s_waitcnt lgkmcnt(4)
v_mfma_f32_16x16x32_bf16 v[108:111], v[60:63], v[80:83], v[108:111]
v_mfma_f32_16x16x32_bf16 v[112:115], v[48:51], v[84:87], v[112:115]
ds_read_b64_tr_b16 v[80:81], v20 offset:24576
buffer_load_dwordx4 v5, s[32:35], s66 offen offset:3072 lds
v_mfma_f32_16x16x32_bf16 v[116:119], v[52:55], v[84:87], v[116:119]
ds_read_b64_tr_b16 v[82:83], v20 offset:25600
v_mfma_f32_16x16x32_bf16 v[120:123], v[56:59], v[84:87], v[120:123]
v_mfma_f32_16x16x32_bf16 v[124:127], v[60:63], v[84:87], v[124:127]
v_mfma_f32_16x16x32_bf16 v[128:131], v[48:51], v[64:67], v[128:131]
ds_read_b64_tr_b16 v[84:85], v21 offset:24576
s_mov_b32 s40, s44
s_mov_b32 s41, s45
s_cmp_eq_u32 s22, 3
s_cselect_b32 s42, 0, 268435456
s_mov_b32 s43, 0x20000
s_mul_i32 s54, s20, 49152
s_lshl_b32 s24, s22, 10
s_add_u32 s54, s54, s24
s_add_u32 s54, s54, 92274688
s_movk_i32 s67, 3072
s_mul_i32 s24, s21, 6144
s_add_u32 s24, s24, s54
v_lshrrev_b32 v8, 5, v0
v_mul_u32_u24 v8, 49152, v8
v_and_b32 v235, 31, v0
v_lshl_add_u32 v8, v235, 4, v8
s_andn2_b32 s74, s20, 3
s_mul_i32 s74, s74, 49152
s_lshr_b32 s75, s99, 1
s_mul_i32 s75, s75, 3072
s_add_u32 s74, s74, s75
s_and_b32 s75, s99, 1
s_lshl_b32 s75, s75, 9
s_add_u32 s74, s74, s75
s_lshl_b32 s75, s22, 10
s_add_u32 s74, s74, s75
s_add_u32 s74, s74, 92274688
s_add_u32 s75, s74, 98304
v_mfma_f32_16x16x32_bf16 v[132:135], v[52:55], v[64:67], v[132:135]
ds_read_b64_tr_b16 v[86:87], v21 offset:25600
s_waitcnt vmcnt(13)
buffer_store_dwordx4 v[240:243], v8, s[40:43], s74 offen sc1
v_mfma_f32_16x16x32_bf16 v[136:139], v[56:59], v[64:67], v[136:139]
v_mfma_f32_16x16x32_bf16 v[140:143], v[60:63], v[64:67], v[140:143]
v_mfma_f32_16x16x32_bf16 v[144:147], v[48:51], v[68:71], v[144:147]
v_mfma_f32_16x16x32_bf16 v[148:151], v[52:55], v[68:71], v[148:151]
v_mfma_f32_16x16x32_bf16 v[152:155], v[56:59], v[68:71], v[152:155]
s_waitcnt vmcnt(13)
buffer_store_dwordx4 v[244:247], v8, s[40:43], s75 offen sc1
s_cmp_lg_u32 s22, 3
s_cbranch_scc1 L_kk_kernel_c1_sk13
v_bfe_u32 v92, v0, 1, 2
v_lshlrev_b32 v92, 13, v92
v_and_b32 v235, 1, v0
v_lshl_add_u32 v92, v235, 7, v92
s_lshl_b32 s68, s21, 15
s_add_u32 s68, s68, s53
s_add_u32 s68, s68, 3407872
buffer_load_dword v94, v92, s[36:39], s68 offen
L_kk_kernel_c1_sk13:
v_mfma_f32_16x16x32_bf16 v[156:159], v[60:63], v[68:71], v[156:159]
s_waitcnt vmcnt(10) lgkmcnt(0)
s_barrier
ds_read_b64_tr_b16 v[64:65], v14 offset:40960
ds_read_b64_tr_b16 v[66:67], v14 offset:41984
v_mfma_f32_16x16x32_bf16 v[160:163], v[48:51], v[72:75], v[160:163]
ds_read_b64_tr_b16 v[68:69], v15 offset:40960
v_mfma_f32_16x16x32_bf16 v[164:167], v[52:55], v[72:75], v[164:167]
ds_read_b64_tr_b16 v[70:71], v15 offset:41984
v_mfma_f32_16x16x32_bf16 v[168:171], v[56:59], v[72:75], v[168:171]
ds_read_b128 v[32:35], v10 offset:0
v_mfma_f32_16x16x32_bf16 v[172:175], v[60:63], v[72:75], v[172:175]
v_mfma_f32_16x16x32_bf16 v[176:179], v[48:51], v[76:79], v[176:179]
ds_read_b64_tr_b16 v[72:73], v16 offset:40960
buffer_load_dword v93, v29, s[16:19], 0 offen sc1
v_mfma_f32_16x16x32_bf16 v[180:183], v[52:55], v[76:79], v[180:183]
ds_read_b64_tr_b16 v[74:75], v16 offset:41984
ds_read_b128 v[36:39], v10 offset:2048
v_mfma_f32_16x16x32_bf16 v[184:187], v[56:59], v[76:79], v[184:187]
v_mfma_f32_16x16x32_bf16 v[188:191], v[60:63], v[76:79], v[188:191]
v_mfma_f32_16x16x32_bf16 v[192:195], v[48:51], v[80:83], v[192:195]
ds_read_b64_tr_b16 v[76:77], v17 offset:40960
ds_read_b128 v[40:43], v10 offset:4096
v_mfma_f32_16x16x32_bf16 v[196:199], v[52:55], v[80:83], v[196:199]
ds_read_b64_tr_b16 v[78:79], v17 offset:41984
v_mfma_f32_16x16x32_bf16 v[200:203], v[56:59], v[80:83], v[200:203]
s_add_u32 m0, s56, 16384
s_add_u32 s64, s53, 2359296
v_mfma_f32_16x16x32_bf16 v[204:207], v[60:63], v[80:83], v[204:207]
buffer_load_dwordx4 v6, s[36:39], s64 offen offset:0 lds
ds_read_b128 v[44:47], v10 offset:6144
v_mfma_f32_16x16x32_bf16 v[208:211], v[48:51], v[84:87], v[208:211]
ds_read_b64_tr_b16 v[80:81], v18 offset:40960
v_mfma_f32_16x16x32_bf16 v[212:215], v[52:55], v[84:87], v[212:215]
ds_read_b64_tr_b16 v[82:83], v18 offset:41984
v_mfma_f32_16x16x32_bf16 v[216:219], v[56:59], v[84:87], v[216:219]
v_mfma_f32_16x16x32_bf16 v[220:223], v[60:63], v[84:87], v[220:223]
s_waitcnt lgkmcnt(9)
v_mfma_f32_16x16x32_bf16 v[96:99], v[32:35], v[64:67], v[96:99]
ds_read_b64_tr_b16 v[84:85], v19 offset:40960
s_waitcnt lgkmcnt(7)
v_mfma_f32_16x16x32_bf16 v[100:103], v[36:39], v[64:67], v[100:103]
ds_read_b64_tr_b16 v[86:87], v19 offset:41984
buffer_load_dwordx4 v7, s[36:39], s64 offen offset:1024 lds
s_waitcnt lgkmcnt(6)
v_mfma_f32_16x16x32_bf16 v[104:107], v[40:43], v[64:67], v[104:107]
s_waitcnt lgkmcnt(4)
v_mfma_f32_16x16x32_bf16 v[108:111], v[44:47], v[64:67], v[108:111]
v_mfma_f32_16x16x32_bf16 v[112:115], v[32:35], v[68:71], v[112:115]
ds_read_b64_tr_b16 v[64:65], v20 offset:40960
v_mfma_f32_16x16x32_bf16 v[116:119], v[36:39], v[68:71], v[116:119]
ds_read_b64_tr_b16 v[66:67], v20 offset:41984
v_mfma_f32_16x16x32_bf16 v[120:123], v[40:43], v[68:71], v[120:123]
v_mfma_f32_16x16x32_bf16 v[124:127], v[44:47], v[68:71], v[124:127]
s_add_u32 m0, s55, 65536
s_add_u32 s66, s52, 640
v_mfma_f32_16x16x32_bf16 v[128:131], v[32:35], v[72:75], v[128:131]
ds_read_b64_tr_b16 v[68:69], v21 offset:40960
buffer_load_dwordx4 v2, s[32:35], s66 offen offset:0 lds
v_mfma_f32_16x16x32_bf16 v[132:135], v[36:39], v[72:75], v[132:135]
ds_read_b64_tr_b16 v[70:71], v21 offset:41984
v_mfma_f32_16x16x32_bf16 v[136:139], v[40:43], v[72:75], v[136:139]
v_mfma_f32_16x16x32_bf16 v[140:143], v[44:47], v[72:75], v[140:143]
v_mfma_f32_16x16x32_bf16 v[144:147], v[32:35], v[76:79], v[144:147]
v_mfma_f32_16x16x32_bf16 v[148:151], v[36:39], v[76:79], v[148:151]
v_mfma_f32_16x16x32_bf16 v[152:155], v[40:43], v[76:79], v[152:155]
buffer_load_dwordx4 v3, s[32:35], s66 offen offset:1024 lds
s_cmp_lg_u32 s22, 0
s_cbranch_scc1 L_kk_kernel_c1_sk14
v_bfe_u32 v92, v0, 1, 2
v_lshlrev_b32 v92, 13, v92
v_and_b32 v235, 1, v0
v_lshl_add_u32 v92, v235, 7, v92
s_lshl_b32 s68, s21, 15
s_add_u32 s68, s68, s53
s_add_u32 s68, s68, 3670016
buffer_load_dword v94, v92, s[36:39], s68 offen
L_kk_kernel_c1_sk14:
v_mfma_f32_16x16x32_bf16 v[156:159], v[44:47], v[76:79], v[156:159]
s_waitcnt vmcnt(13) lgkmcnt(0)
s_barrier
ds_read_b64_tr_b16 v[72:73], v14 offset:57344
ds_read_b64_tr_b16 v[74:75], v14 offset:58368
v_mfma_f32_16x16x32_bf16 v[160:163], v[32:35], v[80:83], v[160:163]
ds_read_b64_tr_b16 v[76:77], v15 offset:57344
v_mfma_f32_16x16x32_bf16 v[164:167], v[36:39], v[80:83], v[164:167]
ds_read_b64_tr_b16 v[78:79], v15 offset:58368
v_mfma_f32_16x16x32_bf16 v[168:171], v[40:43], v[80:83], v[168:171]
ds_read_b128 v[48:51], v11 offset:0
v_mfma_f32_16x16x32_bf16 v[172:175], v[44:47], v[80:83], v[172:175]
v_mfma_f32_16x16x32_bf16 v[176:179], v[32:35], v[84:87], v[176:179]
ds_read_b64_tr_b16 v[80:81], v16 offset:57344
v_mfma_f32_16x16x32_bf16 v[180:183], v[36:39], v[84:87], v[180:183]
ds_read_b64_tr_b16 v[82:83], v16 offset:58368
s_add_u32 m0, s56, 32768
s_add_u32 s64, s53, 2621440
ds_read_b128 v[52:55], v11 offset:2048
v_mfma_f32_16x16x32_bf16 v[184:187], v[40:43], v[84:87], v[184:187]
buffer_load_dwordx4 v6, s[36:39], s64 offen offset:0 lds
v_mfma_f32_16x16x32_bf16 v[188:191], v[44:47], v[84:87], v[188:191]
v_mfma_f32_16x16x32_bf16 v[192:195], v[32:35], v[64:67], v[192:195]
ds_read_b64_tr_b16 v[84:85], v17 offset:57344
ds_read_b128 v[56:59], v11 offset:4096
v_mfma_f32_16x16x32_bf16 v[196:199], v[36:39], v[64:67], v[196:199]
ds_read_b64_tr_b16 v[86:87], v17 offset:58368
v_mfma_f32_16x16x32_bf16 v[200:203], v[40:43], v[64:67], v[200:203]
v_mfma_f32_16x16x32_bf16 v[204:207], v[44:47], v[64:67], v[204:207]
ds_read_b128 v[60:63], v11 offset:6144
v_mfma_f32_16x16x32_bf16 v[208:211], v[32:35], v[68:71], v[208:211]
ds_read_b64_tr_b16 v[64:65], v18 offset:57344
v_mfma_f32_16x16x32_bf16 v[212:215], v[36:39], v[68:71], v[212:215]
ds_read_b64_tr_b16 v[66:67], v18 offset:58368
v_mfma_f32_16x16x32_bf16 v[216:219], v[40:43], v[68:71], v[216:219]
buffer_load_dwordx4 v7, s[36:39], s64 offen offset:1024 lds
v_mfma_f32_16x16x32_bf16 v[220:223], v[44:47], v[68:71], v[220:223]
s_waitcnt lgkmcnt(9)
v_mfma_f32_16x16x32_bf16 v[96:99], v[48:51], v[72:75], v[96:99]
ds_read_b64_tr_b16 v[68:69], v19 offset:57344
s_waitcnt lgkmcnt(7)
v_mfma_f32_16x16x32_bf16 v[100:103], v[52:55], v[72:75], v[100:103]
ds_read_b64_tr_b16 v[70:71], v19 offset:58368
s_waitcnt lgkmcnt(6)
v_mfma_f32_16x16x32_bf16 v[104:107], v[56:59], v[72:75], v[104:107]
s_waitcnt lgkmcnt(4)
v_mfma_f32_16x16x32_bf16 v[108:111], v[60:63], v[72:75], v[108:111]
v_mfma_f32_16x16x32_bf16 v[112:115], v[48:51], v[76:79], v[112:115]
ds_read_b64_tr_b16 v[72:73], v20 offset:57344
v_mfma_f32_16x16x32_bf16 v[116:119], v[52:55], v[76:79], v[116:119]
ds_read_b64_tr_b16 v[74:75], v20 offset:58368
s_add_u32 m0, s55, 65536
s_add_u32 s66, s52, 640
v_mfma_f32_16x16x32_bf16 v[120:123], v[56:59], v[76:79], v[120:123]
buffer_load_dwordx4 v4, s[32:35], s66 offen offset:2048 lds
v_mfma_f32_16x16x32_bf16 v[124:127], v[60:63], v[76:79], v[124:127]
v_mfma_f32_16x16x32_bf16 v[128:131], v[48:51], v[80:83], v[128:131]
ds_read_b64_tr_b16 v[76:77], v21 offset:57344
v_mfma_f32_16x16x32_bf16 v[132:135], v[52:55], v[80:83], v[132:135]
ds_read_b64_tr_b16 v[78:79], v21 offset:58368
v_mfma_f32_16x16x32_bf16 v[136:139], v[56:59], v[80:83], v[136:139]
v_mfma_f32_16x16x32_bf16 v[140:143], v[60:63], v[80:83], v[140:143]
v_mfma_f32_16x16x32_bf16 v[144:147], v[48:51], v[84:87], v[144:147]
v_mfma_f32_16x16x32_bf16 v[148:151], v[52:55], v[84:87], v[148:151]
v_mfma_f32_16x16x32_bf16 v[152:155], v[56:59], v[84:87], v[152:155]
buffer_load_dwordx4 v5, s[32:35], s66 offen offset:3072 lds
s_cmp_lg_u32 s22, 1
s_cbranch_scc1 L_kk_kernel_c1_sk15
v_bfe_u32 v92, v0, 1, 2
v_lshlrev_b32 v92, 13, v92
v_and_b32 v235, 1, v0
v_lshl_add_u32 v92, v235, 7, v92
s_lshl_b32 s68, s21, 15
s_add_u32 s68, s68, s53
s_add_u32 s68, s68, 3932160
buffer_load_dword v94, v92, s[36:39], s68 offen
L_kk_kernel_c1_sk15:
v_mfma_f32_16x16x32_bf16 v[156:159], v[60:63], v[84:87], v[156:159]
s_waitcnt vmcnt(9) lgkmcnt(0)
s_barrier
ds_read_b64_tr_b16 v[80:81], v14 offset:8192
ds_read_b64_tr_b16 v[82:83], v14 offset:9216
s_waitcnt vmcnt(8)
v_cmp_ne_u32 vcc, 0, v93
s_cmp_eq_u64 vcc, -1
s_cbranch_scc1 L_kk_kernel_c1_cok
s_mov_b32 s66, 0x20000
L_kk_kernel_c1_cspin:
s_sleep 8
buffer_load_dword v93, v29, s[16:19], 0 offen sc1
s_waitcnt vmcnt(0)
v_cmp_ne_u32 vcc, 0, v93
s_cmp_eq_u64 vcc, -1
s_cbranch_scc1 L_kk_kernel_c1_cok
s_sub_u32 s66, s66, 1
s_cmp_lg_u32 s66, 0
s_cbranch_scc1 L_kk_kernel_c1_cspin
L_kk_kernel_c1_cok:
v_mfma_f32_16x16x32_bf16 v[160:163], v[48:51], v[64:67], v[160:163]
ds_read_b64_tr_b16 v[84:85], v15 offset:8192
v_mfma_f32_16x16x32_bf16 v[164:167], v[52:55], v[64:67], v[164:167]
ds_read_b64_tr_b16 v[86:87], v15 offset:9216
v_mfma_f32_16x16x32_bf16 v[168:171], v[56:59], v[64:67], v[168:171]
ds_read_b128 v[32:35], v10 offset:32768
v_mfma_f32_16x16x32_bf16 v[172:175], v[60:63], v[64:67], v[172:175]
v_mfma_f32_16x16x32_bf16 v[176:179], v[48:51], v[68:71], v[176:179]
ds_read_b64_tr_b16 v[64:65], v16 offset:8192
v_mfma_f32_16x16x32_bf16 v[180:183], v[52:55], v[68:71], v[180:183]
ds_read_b64_tr_b16 v[66:67], v16 offset:9216
s_add_u32 m0, s56, 49152
s_add_u32 s64, s53, 2883584
ds_read_b128 v[36:39], v10 offset:34816
v_mfma_f32_16x16x32_bf16 v[184:187], v[56:59], v[68:71], v[184:187]
buffer_load_dwordx4 v6, s[36:39], s64 offen offset:0 lds
v_mfma_f32_16x16x32_bf16 v[188:191], v[60:63], v[68:71], v[188:191]
v_mfma_f32_16x16x32_bf16 v[192:195], v[48:51], v[72:75], v[192:195]
ds_read_b64_tr_b16 v[68:69], v17 offset:8192
ds_read_b128 v[40:43], v10 offset:36864
v_mfma_f32_16x16x32_bf16 v[196:199], v[52:55], v[72:75], v[196:199]
ds_read_b64_tr_b16 v[70:71], v17 offset:9216
v_mfma_f32_16x16x32_bf16 v[200:203], v[56:59], v[72:75], v[200:203]
v_mfma_f32_16x16x32_bf16 v[204:207], v[60:63], v[72:75], v[204:207]
ds_read_b128 v[44:47], v10 offset:38912
v_mfma_f32_16x16x32_bf16 v[208:211], v[48:51], v[76:79], v[208:211]
ds_read_b64_tr_b16 v[72:73], v18 offset:8192
v_mfma_f32_16x16x32_bf16 v[212:215], v[52:55], v[76:79], v[212:215]
ds_read_b64_tr_b16 v[74:75], v18 offset:9216
v_mfma_f32_16x16x32_bf16 v[216:219], v[56:59], v[76:79], v[216:219]
buffer_load_dwordx4 v7, s[36:39], s64 offen offset:1024 lds
v_mfma_f32_16x16x32_bf16 v[220:223], v[60:63], v[76:79], v[220:223]
s_waitcnt lgkmcnt(9)
v_mfma_f32_16x16x32_bf16 v[96:99], v[32:35], v[80:83], v[96:99]
ds_read_b64_tr_b16 v[76:77], v19 offset:8192
s_waitcnt lgkmcnt(7)
v_mfma_f32_16x16x32_bf16 v[100:103], v[36:39], v[80:83], v[100:103]
ds_read_b64_tr_b16 v[78:79], v19 offset:9216
s_waitcnt lgkmcnt(6)
v_mfma_f32_16x16x32_bf16 v[104:107], v[40:43], v[80:83], v[104:107]
s_waitcnt lgkmcnt(4)
v_mfma_f32_16x16x32_bf16 v[108:111], v[44:47], v[80:83], v[108:111]
v_mfma_f32_16x16x32_bf16 v[112:115], v[32:35], v[84:87], v[112:115]
ds_read_b64_tr_b16 v[80:81], v20 offset:8192
v_mfma_f32_16x16x32_bf16 v[116:119], v[36:39], v[84:87], v[116:119]
ds_read_b64_tr_b16 v[82:83], v20 offset:9216
s_add_u32 m0, s55, 0
s_add_u32 s66, s52, 768
v_mfma_f32_16x16x32_bf16 v[120:123], v[40:43], v[84:87], v[120:123]
buffer_load_dwordx4 v2, s[32:35], s66 offen offset:0 lds
v_mfma_f32_16x16x32_bf16 v[124:127], v[44:47], v[84:87], v[124:127]
v_mfma_f32_16x16x32_bf16 v[128:131], v[32:35], v[64:67], v[128:131]
ds_read_b64_tr_b16 v[84:85], v21 offset:8192
v_mfma_f32_16x16x32_bf16 v[132:135], v[36:39], v[64:67], v[132:135]
ds_read_b64_tr_b16 v[86:87], v21 offset:9216
v_mfma_f32_16x16x32_bf16 v[136:139], v[40:43], v[64:67], v[136:139]
v_mfma_f32_16x16x32_bf16 v[140:143], v[44:47], v[64:67], v[140:143]
v_mfma_f32_16x16x32_bf16 v[144:147], v[32:35], v[68:71], v[144:147]
v_mfma_f32_16x16x32_bf16 v[148:151], v[36:39], v[68:71], v[148:151]
v_mfma_f32_16x16x32_bf16 v[152:155], v[40:43], v[68:71], v[152:155]
buffer_load_dwordx4 v3, s[32:35], s66 offen offset:1024 lds
v_mfma_f32_16x16x32_bf16 v[156:159], v[44:47], v[68:71], v[156:159]
s_waitcnt vmcnt(10) lgkmcnt(0)
s_barrier
ds_read_b64_tr_b16 v[64:65], v14 offset:24576
ds_read_b64_tr_b16 v[66:67], v14 offset:25600
v_mfma_f32_16x16x32_bf16 v[160:163], v[32:35], v[72:75], v[160:163]
ds_read_b64_tr_b16 v[68:69], v15 offset:24576
v_mfma_f32_16x16x32_bf16 v[164:167], v[36:39], v[72:75], v[164:167]
ds_read_b64_tr_b16 v[70:71], v15 offset:25600
v_mfma_f32_16x16x32_bf16 v[168:171], v[40:43], v[72:75], v[168:171]
ds_read_b128 v[48:51], v11 offset:32768
v_mfma_f32_16x16x32_bf16 v[172:175], v[44:47], v[72:75], v[172:175]
v_mfma_f32_16x16x32_bf16 v[176:179], v[32:35], v[76:79], v[176:179]
ds_read_b64_tr_b16 v[72:73], v16 offset:24576
v_mfma_f32_16x16x32_bf16 v[180:183], v[36:39], v[76:79], v[180:183]
ds_read_b64_tr_b16 v[74:75], v16 offset:25600
s_add_u32 m0, s56, 0
s_add_u32 s64, s53, 3145728
ds_read_b128 v[52:55], v11 offset:34816
v_mfma_f32_16x16x32_bf16 v[184:187], v[40:43], v[76:79], v[184:187]
buffer_load_dwordx4 v6, s[36:39], s64 offen offset:0 lds
v_mfma_f32_16x16x32_bf16 v[188:191], v[44:47], v[76:79], v[188:191]
v_mfma_f32_16x16x32_bf16 v[192:195], v[32:35], v[80:83], v[192:195]
ds_read_b64_tr_b16 v[76:77], v17 offset:24576
ds_read_b128 v[56:59], v11 offset:36864
v_mfma_f32_16x16x32_bf16 v[196:199], v[36:39], v[80:83], v[196:199]
ds_read_b64_tr_b16 v[78:79], v17 offset:25600
v_mfma_f32_16x16x32_bf16 v[200:203], v[40:43], v[80:83], v[200:203]
v_mfma_f32_16x16x32_bf16 v[204:207], v[44:47], v[80:83], v[204:207]
ds_read_b128 v[60:63], v11 offset:38912
v_mfma_f32_16x16x32_bf16 v[208:211], v[32:35], v[84:87], v[208:211]
ds_read_b64_tr_b16 v[80:81], v18 offset:24576
v_mfma_f32_16x16x32_bf16 v[212:215], v[36:39], v[84:87], v[212:215]
ds_read_b64_tr_b16 v[82:83], v18 offset:25600
v_mfma_f32_16x16x32_bf16 v[216:219], v[40:43], v[84:87], v[216:219]
buffer_load_dwordx4 v7, s[36:39], s64 offen offset:1024 lds
v_mfma_f32_16x16x32_bf16 v[220:223], v[44:47], v[84:87], v[220:223]
s_waitcnt lgkmcnt(9)
v_mfma_f32_16x16x32_bf16 v[96:99], v[48:51], v[64:67], v[96:99]
ds_read_b64_tr_b16 v[84:85], v19 offset:24576
s_waitcnt lgkmcnt(7)
v_mfma_f32_16x16x32_bf16 v[100:103], v[52:55], v[64:67], v[100:103]
ds_read_b64_tr_b16 v[86:87], v19 offset:25600
s_waitcnt lgkmcnt(6)
v_mfma_f32_16x16x32_bf16 v[104:107], v[56:59], v[64:67], v[104:107]
s_waitcnt lgkmcnt(4)
v_mfma_f32_16x16x32_bf16 v[108:111], v[60:63], v[64:67], v[108:111]
v_mfma_f32_16x16x32_bf16 v[112:115], v[48:51], v[68:71], v[112:115]
ds_read_b64_tr_b16 v[64:65], v20 offset:24576
v_mfma_f32_16x16x32_bf16 v[116:119], v[52:55], v[68:71], v[116:119]
ds_read_b64_tr_b16 v[66:67], v20 offset:25600
s_add_u32 m0, s55, 0
s_add_u32 s66, s52, 768
v_mfma_f32_16x16x32_bf16 v[120:123], v[56:59], v[68:71], v[120:123]
buffer_load_dwordx4 v4, s[32:35], s66 offen offset:2048 lds
v_mfma_f32_16x16x32_bf16 v[124:127], v[60:63], v[68:71], v[124:127]
v_mfma_f32_16x16x32_bf16 v[128:131], v[48:51], v[72:75], v[128:131]
ds_read_b64_tr_b16 v[68:69], v21 offset:24576
v_mfma_f32_16x16x32_bf16 v[132:135], v[52:55], v[72:75], v[132:135]
ds_read_b64_tr_b16 v[70:71], v21 offset:25600
v_mfma_f32_16x16x32_bf16 v[136:139], v[56:59], v[72:75], v[136:139]
v_mfma_f32_16x16x32_bf16 v[140:143], v[60:63], v[72:75], v[140:143]
v_mfma_f32_16x16x32_bf16 v[144:147], v[48:51], v[76:79], v[144:147]
v_mfma_f32_16x16x32_bf16 v[148:151], v[52:55], v[76:79], v[148:151]
v_mfma_f32_16x16x32_bf16 v[152:155], v[56:59], v[76:79], v[152:155]
buffer_load_dwordx4 v5, s[32:35], s66 offen offset:3072 lds
v_mfma_f32_16x16x32_bf16 v[156:159], v[60:63], v[76:79], v[156:159]
s_waitcnt vmcnt(8) lgkmcnt(0)
s_barrier
ds_read_b64_tr_b16 v[72:73], v14 offset:40960
ds_read_b64_tr_b16 v[74:75], v14 offset:41984
v_mfma_f32_16x16x32_bf16 v[160:163], v[48:51], v[80:83], v[160:163]
ds_read_b64_tr_b16 v[76:77], v15 offset:40960
v_mfma_f32_16x16x32_bf16 v[164:167], v[52:55], v[80:83], v[164:167]
ds_read_b64_tr_b16 v[78:79], v15 offset:41984
v_mfma_f32_16x16x32_bf16 v[168:171], v[56:59], v[80:83], v[168:171]
ds_read_b128 v[32:35], v12 offset:0
v_mfma_f32_16x16x32_bf16 v[172:175], v[60:63], v[80:83], v[172:175]
v_mfma_f32_16x16x32_bf16 v[176:179], v[48:51], v[84:87], v[176:179]
ds_read_b64_tr_b16 v[80:81], v16 offset:40960
v_mfma_f32_16x16x32_bf16 v[180:183], v[52:55], v[84:87], v[180:183]
ds_read_b64_tr_b16 v[82:83], v16 offset:41984
s_add_u32 m0, s56, 16384
s_add_u32 s64, s53, 3407872
ds_read_b128 v[36:39], v12 offset:2048
v_mfma_f32_16x16x32_bf16 v[184:187], v[56:59], v[84:87], v[184:187]
buffer_load_dwordx4 v6, s[36:39], s64 offen offset:0 lds
v_mfma_f32_16x16x32_bf16 v[188:191], v[60:63], v[84:87], v[188:191]
v_mfma_f32_16x16x32_bf16 v[192:195], v[48:51], v[64:67], v[192:195]
ds_read_b64_tr_b16 v[84:85], v17 offset:40960
ds_read_b128 v[40:43], v12 offset:4096
v_mfma_f32_16x16x32_bf16 v[196:199], v[52:55], v[64:67], v[196:199]
ds_read_b64_tr_b16 v[86:87], v17 offset:41984
v_mfma_f32_16x16x32_bf16 v[200:203], v[56:59], v[64:67], v[200:203]
v_mfma_f32_16x16x32_bf16 v[204:207], v[60:63], v[64:67], v[204:207]
ds_read_b128 v[44:47], v12 offset:6144
v_mfma_f32_16x16x32_bf16 v[208:211], v[48:51], v[68:71], v[208:211]
ds_read_b64_tr_b16 v[64:65], v18 offset:40960
v_mfma_f32_16x16x32_bf16 v[212:215], v[52:55], v[68:71], v[212:215]
ds_read_b64_tr_b16 v[66:67], v18 offset:41984
v_mfma_f32_16x16x32_bf16 v[216:219], v[56:59], v[68:71], v[216:219]
buffer_load_dwordx4 v7, s[36:39], s64 offen offset:1024 lds
v_mfma_f32_16x16x32_bf16 v[220:223], v[60:63], v[68:71], v[220:223]
s_waitcnt lgkmcnt(9)
v_mfma_f32_16x16x32_bf16 v[96:99], v[32:35], v[72:75], v[96:99]
ds_read_b64_tr_b16 v[68:69], v19 offset:40960
s_waitcnt lgkmcnt(7)
v_mfma_f32_16x16x32_bf16 v[100:103], v[36:39], v[72:75], v[100:103]
ds_read_b64_tr_b16 v[70:71], v19 offset:41984
s_waitcnt lgkmcnt(6)
v_mfma_f32_16x16x32_bf16 v[104:107], v[40:43], v[72:75], v[104:107]
s_waitcnt lgkmcnt(4)
v_mfma_f32_16x16x32_bf16 v[108:111], v[44:47], v[72:75], v[108:111]
v_mfma_f32_16x16x32_bf16 v[112:115], v[32:35], v[76:79], v[112:115]
ds_read_b64_tr_b16 v[72:73], v20 offset:40960
v_mfma_f32_16x16x32_bf16 v[116:119], v[36:39], v[76:79], v[116:119]
ds_read_b64_tr_b16 v[74:75], v20 offset:41984
s_add_u32 m0, s55, 32768
s_add_u32 s66, s52, 896
v_mfma_f32_16x16x32_bf16 v[120:123], v[40:43], v[76:79], v[120:123]
buffer_load_dwordx4 v2, s[32:35], s66 offen offset:0 lds
v_mfma_f32_16x16x32_bf16 v[124:127], v[44:47], v[76:79], v[124:127]
v_mfma_f32_16x16x32_bf16 v[128:131], v[32:35], v[80:83], v[128:131]
ds_read_b64_tr_b16 v[76:77], v21 offset:40960
v_mfma_f32_16x16x32_bf16 v[132:135], v[36:39], v[80:83], v[132:135]
ds_read_b64_tr_b16 v[78:79], v21 offset:41984
v_mfma_f32_16x16x32_bf16 v[136:139], v[40:43], v[80:83], v[136:139]
v_mfma_f32_16x16x32_bf16 v[140:143], v[44:47], v[80:83], v[140:143]
v_mfma_f32_16x16x32_bf16 v[144:147], v[32:35], v[84:87], v[144:147]
v_mfma_f32_16x16x32_bf16 v[148:151], v[36:39], v[84:87], v[148:151]
v_mfma_f32_16x16x32_bf16 v[152:155], v[40:43], v[84:87], v[152:155]
buffer_load_dwordx4 v3, s[32:35], s66 offen offset:1024 lds
v_mfma_f32_16x16x32_bf16 v[156:159], v[44:47], v[84:87], v[156:159]
s_waitcnt vmcnt(10) lgkmcnt(0)
s_barrier
ds_read_b64_tr_b16 v[80:81], v14 offset:57344
ds_read_b64_tr_b16 v[82:83], v14 offset:58368
v_mfma_f32_16x16x32_bf16 v[160:163], v[32:35], v[64:67], v[160:163]
ds_read_b64_tr_b16 v[84:85], v15 offset:57344
v_mfma_f32_16x16x32_bf16 v[164:167], v[36:39], v[64:67], v[164:167]
ds_read_b64_tr_b16 v[86:87], v15 offset:58368
v_mfma_f32_16x16x32_bf16 v[168:171], v[40:43], v[64:67], v[168:171]
ds_read_b128 v[48:51], v13 offset:0
v_mfma_f32_16x16x32_bf16 v[172:175], v[44:47], v[64:67], v[172:175]
v_mfma_f32_16x16x32_bf16 v[176:179], v[32:35], v[68:71], v[176:179]
ds_read_b64_tr_b16 v[64:65], v16 offset:57344
buffer_load_dword v30, v9, s[44:47], s51 offen sc1
v_mfma_f32_16x16x32_bf16 v[180:183], v[36:39], v[68:71], v[180:183]
ds_read_b64_tr_b16 v[66:67], v16 offset:58368
ds_read_b128 v[52:55], v13 offset:2048
v_mfma_f32_16x16x32_bf16 v[184:187], v[40:43], v[68:71], v[184:187]
v_mfma_f32_16x16x32_bf16 v[188:191], v[44:47], v[68:71], v[188:191]
v_mfma_f32_16x16x32_bf16 v[192:195], v[32:35], v[72:75], v[192:195]
ds_read_b64_tr_b16 v[68:69], v17 offset:57344
ds_read_b128 v[56:59], v13 offset:4096
v_mfma_f32_16x16x32_bf16 v[196:199], v[36:39], v[72:75], v[196:199]
ds_read_b64_tr_b16 v[70:71], v17 offset:58368
v_mfma_f32_16x16x32_bf16 v[200:203], v[40:43], v[72:75], v[200:203]
s_add_u32 m0, s56, 32768
s_add_u32 s64, s53, 3670016
v_mfma_f32_16x16x32_bf16 v[204:207], v[44:47], v[72:75], v[204:207]
buffer_load_dwordx4 v6, s[36:39], s64 offen offset:0 lds
ds_read_b128 v[60:63], v13 offset:6144
v_mfma_f32_16x16x32_bf16 v[208:211], v[32:35], v[76:79], v[208:211]
ds_read_b64_tr_b16 v[72:73], v18 offset:57344
v_mfma_f32_16x16x32_bf16 v[212:215], v[36:39], v[76:79], v[212:215]
ds_read_b64_tr_b16 v[74:75], v18 offset:58368
v_mfma_f32_16x16x32_bf16 v[216:219], v[40:43], v[76:79], v[216:219]
v_mfma_f32_16x16x32_bf16 v[220:223], v[44:47], v[76:79], v[220:223]
s_waitcnt lgkmcnt(9)
v_mfma_f32_16x16x32_bf16 v[96:99], v[48:51], v[80:83], v[96:99]
ds_read_b64_tr_b16 v[76:77], v19 offset:57344
s_waitcnt lgkmcnt(7)
v_mfma_f32_16x16x32_bf16 v[100:103], v[52:55], v[80:83], v[100:103]
ds_read_b64_tr_b16 v[78:79], v19 offset:58368
buffer_load_dwordx4 v7, s[36:39], s64 offen offset:1024 lds
s_waitcnt lgkmcnt(6)
v_mfma_f32_16x16x32_bf16 v[104:107], v[56:59], v[80:83], v[104:107]
s_waitcnt lgkmcnt(4)
v_mfma_f32_16x16x32_bf16 v[108:111], v[60:63], v[80:83], v[108:111]
v_mfma_f32_16x16x32_bf16 v[112:115], v[48:51], v[84:87], v[112:115]
ds_read_b64_tr_b16 v[80:81], v20 offset:57344
v_mfma_f32_16x16x32_bf16 v[116:119], v[52:55], v[84:87], v[116:119]
ds_read_b64_tr_b16 v[82:83], v20 offset:58368
v_mfma_f32_16x16x32_bf16 v[120:123], v[56:59], v[84:87], v[120:123]
v_mfma_f32_16x16x32_bf16 v[124:127], v[60:63], v[84:87], v[124:127]
s_add_u32 m0, s55, 32768
s_add_u32 s66, s52, 896
v_mfma_f32_16x16x32_bf16 v[128:131], v[48:51], v[64:67], v[128:131]
ds_read_b64_tr_b16 v[84:85], v21 offset:57344
buffer_load_dwordx4 v4, s[32:35], s66 offen offset:2048 lds
v_mfma_f32_16x16x32_bf16 v[132:135], v[52:55], v[64:67], v[132:135]
ds_read_b64_tr_b16 v[86:87], v21 offset:58368
v_mfma_f32_16x16x32_bf16 v[136:139], v[56:59], v[64:67], v[136:139]
v_mfma_f32_16x16x32_bf16 v[140:143], v[60:63], v[64:67], v[140:143]
v_mfma_f32_16x16x32_bf16 v[144:147], v[48:51], v[68:71], v[144:147]
v_mfma_f32_16x16x32_bf16 v[148:151], v[52:55], v[68:71], v[148:151]
v_mfma_f32_16x16x32_bf16 v[152:155], v[56:59], v[68:71], v[152:155]
buffer_load_dwordx4 v5, s[32:35], s66 offen offset:3072 lds
v_mfma_f32_16x16x32_bf16 v[156:159], v[60:63], v[68:71], v[156:159]
s_waitcnt vmcnt(9) lgkmcnt(0)
s_barrier
ds_read_b64_tr_b16 v[64:65], v14 offset:8192
ds_read_b64_tr_b16 v[66:67], v14 offset:9216
v_mfma_f32_16x16x32_bf16 v[160:163], v[48:51], v[72:75], v[160:163]
ds_read_b64_tr_b16 v[68:69], v15 offset:8192
v_mov_b32 v232, 0
v_mfma_f32_16x16x32_bf16 v[164:167], v[52:55], v[72:75], v[164:167]
ds_read_b64_tr_b16 v[70:71], v15 offset:9216
v_lshlrev_b32 v233, 16, v224
v_lshlrev_b32 v234, 16, v228
v_mfma_f32_16x16x32_bf16 v[168:171], v[56:59], v[72:75], v[168:171]
v_fmac_f32 v232, v233, v234
v_and_b32 v233, 0xffff0000, v224
ds_read_b128 v[32:35], v10 offset:0
v_mfma_f32_16x16x32_bf16 v[172:175], v[60:63], v[72:75], v[172:175]
v_and_b32 v234, 0xffff0000, v228
v_fmac_f32 v232, v233, v234
v_mfma_f32_16x16x32_bf16 v[176:179], v[48:51], v[76:79], v[176:179]
ds_read_b64_tr_b16 v[72:73], v16 offset:8192
v_lshlrev_b32 v233, 16, v225
v_lshlrev_b32 v234, 16, v229
v_mfma_f32_16x16x32_bf16 v[180:183], v[52:55], v[76:79], v[180:183]
ds_read_b64_tr_b16 v[74:75], v16 offset:9216
v_fmac_f32 v232, v233, v234
v_and_b32 v233, 0xffff0000, v225
s_add_u32 m0, s56, 49152
s_add_u32 s64, s53, 3932160
ds_read_b128 v[36:39], v10 offset:2048
v_mfma_f32_16x16x32_bf16 v[184:187], v[56:59], v[76:79], v[184:187]
v_and_b32 v234, 0xffff0000, v229
v_fmac_f32 v232, v233, v234
buffer_load_dwordx4 v6, s[36:39], s64 offen offset:0 lds
v_mfma_f32_16x16x32_bf16 v[188:191], v[60:63], v[76:79], v[188:191]
v_lshlrev_b32 v233, 16, v226
v_lshlrev_b32 v234, 16, v230
v_mfma_f32_16x16x32_bf16 v[192:195], v[48:51], v[80:83], v[192:195]
ds_read_b64_tr_b16 v[76:77], v17 offset:8192
v_fmac_f32 v232, v233, v234
v_and_b32 v233, 0xffff0000, v226
ds_read_b128 v[40:43], v10 offset:4096
v_mfma_f32_16x16x32_bf16 v[196:199], v[52:55], v[80:83], v[196:199]
ds_read_b64_tr_b16 v[78:79], v17 offset:9216
v_and_b32 v234, 0xffff0000, v230
v_fmac_f32 v232, v233, v234
v_mfma_f32_16x16x32_bf16 v[200:203], v[56:59], v[80:83], v[200:203]
v_lshlrev_b32 v233, 16, v227
v_lshlrev_b32 v234, 16, v231
v_mfma_f32_16x16x32_bf16 v[204:207], v[60:63], v[80:83], v[204:207]
v_fmac_f32 v232, v233, v234
v_and_b32 v233, 0xffff0000, v227
ds_read_b128 v[44:47], v10 offset:6144
v_mfma_f32_16x16x32_bf16 v[208:211], v[48:51], v[84:87], v[208:211]
ds_read_b64_tr_b16 v[80:81], v18 offset:8192
v_and_b32 v234, 0xffff0000, v231
v_fmac_f32 v232, v233, v234
v_mfma_f32_16x16x32_bf16 v[212:215], v[52:55], v[84:87], v[212:215]
ds_read_b64_tr_b16 v[82:83], v18 offset:9216
v_add_f32_dpp v232, v232, v232 row_shr:1 row_mask:0xf bank_mask:0xf bound_ctrl:0
v_mfma_f32_16x16x32_bf16 v[216:219], v[56:59], v[84:87], v[216:219]
s_nop 0
v_add_f32_dpp v232, v232, v232 row_shr:2 row_mask:0xf bank_mask:0xf bound_ctrl:0
buffer_load_dwordx4 v7, s[36:39], s64 offen offset:1024 lds
v_mfma_f32_16x16x32_bf16 v[220:223], v[60:63], v[84:87], v[220:223]
v_add_f32_dpp v232, v232, v232 row_shr:4 row_mask:0xf bank_mask:0xf bound_ctrl:0
s_waitcnt lgkmcnt(9)
v_mfma_f32_16x16x32_bf16 v[96:99], v[32:35], v[64:67], v[96:99]
ds_read_b64_tr_b16 v[84:85], v19 offset:8192
v_add_f32_dpp v232, v232, v232 row_shr:8 row_mask:0xf bank_mask:0xf bound_ctrl:0
s_waitcnt lgkmcnt(7)
v_mfma_f32_16x16x32_bf16 v[100:103], v[36:39], v[64:67], v[100:103]
ds_read_b64_tr_b16 v[86:87], v19 offset:9216
v_add_f32_dpp v232, v232, v232 row_bcast:15 row_mask:0xa bank_mask:0xf
s_waitcnt lgkmcnt(6)
v_mfma_f32_16x16x32_bf16 v[104:107], v[40:43], v[64:67], v[104:107]
v_add_f32_dpp v232, v232, v232 row_bcast:31 row_mask:0xc bank_mask:0xf
s_waitcnt lgkmcnt(4)
v_mfma_f32_16x16x32_bf16 v[108:111], v[44:47], v[64:67], v[108:111]
v_mul_f32 v232, 0xbfb8aa3b, v232
v_mfma_f32_16x16x32_bf16 v[112:115], v[32:35], v[68:71], v[112:115]
ds_read_b64_tr_b16 v[64:65], v20 offset:8192
v_exp_f32 v232, v232
v_mfma_f32_16x16x32_bf16 v[116:119], v[36:39], v[68:71], v[116:119]
ds_read_b64_tr_b16 v[66:67], v20 offset:9216
v_add_f32 v232, 1.0, v232
s_add_u32 m0, s55, 65536
s_add_u32 s66, s25, 0
v_mfma_f32_16x16x32_bf16 v[120:123], v[40:43], v[68:71], v[120:123]
v_rcp_f32 v232, v232
buffer_load_dwordx4 v2, s[28:31], s66 offen offset:0 lds
v_mfma_f32_16x16x32_bf16 v[124:127], v[44:47], v[68:71], v[124:127]
s_lshl_b32 s58, s58, 2
s_add_u32 s58, s58, 74448896
v_mfma_f32_16x16x32_bf16 v[128:131], v[32:35], v[72:75], v[128:131]
ds_read_b64_tr_b16 v[68:69], v21 offset:8192
v_readlane_b32 s59, v232, 63
v_mfma_f32_16x16x32_bf16 v[132:135], v[36:39], v[72:75], v[132:135]
ds_read_b64_tr_b16 v[70:71], v21 offset:9216
v_mov_b32 v234, 0
v_mfma_f32_16x16x32_bf16 v[136:139], v[40:43], v[72:75], v[136:139]
v_mov_b32 v233, s59
v_mfma_f32_16x16x32_bf16 v[140:143], v[44:47], v[72:75], v[140:143]
buffer_store_dword v233, v234, s[44:47], s58 offen sc1
v_mfma_f32_16x16x32_bf16 v[144:147], v[32:35], v[76:79], v[144:147]
v_mfma_f32_16x16x32_bf16 v[148:151], v[36:39], v[76:79], v[148:151]
v_mfma_f32_16x16x32_bf16 v[152:155], v[40:43], v[76:79], v[152:155]
buffer_load_dwordx4 v3, s[28:31], s66 offen offset:1024 lds
v_mfma_f32_16x16x32_bf16 v[156:159], v[44:47], v[76:79], v[156:159]
s_waitcnt vmcnt(12) lgkmcnt(0)
s_barrier
ds_read_b64_tr_b16 v[72:73], v14 offset:24576
ds_read_b64_tr_b16 v[74:75], v14 offset:25600
s_waitcnt vmcnt(9)
v_cmp_eq_u32 vcc, 1, v30
s_lshr_b64 vcc, vcc, 16
s_cmp_eq_u32 vcc_lo, -1
s_cbranch_scc1 L_kk_kernel_c1_aok
s_mov_b32 s66, 0x20000
L_kk_kernel_c1_aspin:
s_sleep 8
buffer_load_dword v30, v9, s[44:47], s51 offen sc1
s_waitcnt vmcnt(0)
v_cmp_eq_u32 vcc, 1, v30
s_lshr_b64 vcc, vcc, 16
s_cmp_eq_u32 vcc_lo, -1
s_cbranch_scc1 L_kk_kernel_c1_aok
s_sub_u32 s66, s66, 1
s_cmp_lg_u32 s66, 0
s_cbranch_scc1 L_kk_kernel_c1_aspin
L_kk_kernel_c1_aok:
v_mfma_f32_16x16x32_bf16 v[160:163], v[32:35], v[80:83], v[160:163]
ds_read_b64_tr_b16 v[76:77], v15 offset:24576
v_mfma_f32_16x16x32_bf16 v[164:167], v[36:39], v[80:83], v[164:167]
ds_read_b64_tr_b16 v[78:79], v15 offset:25600
v_mfma_f32_16x16x32_bf16 v[168:171], v[40:43], v[80:83], v[168:171]
ds_read_b128 v[48:51], v11 offset:0
v_mfma_f32_16x16x32_bf16 v[172:175], v[44:47], v[80:83], v[172:175]
v_mfma_f32_16x16x32_bf16 v[176:179], v[32:35], v[84:87], v[176:179]
ds_read_b64_tr_b16 v[80:81], v16 offset:24576
v_mfma_f32_16x16x32_bf16 v[180:183], v[36:39], v[84:87], v[180:183]
ds_read_b64_tr_b16 v[82:83], v16 offset:25600
ds_read_b128 v[52:55], v11 offset:2048
v_mfma_f32_16x16x32_bf16 v[184:187], v[40:43], v[84:87], v[184:187]
v_mfma_f32_16x16x32_bf16 v[188:191], v[44:47], v[84:87], v[188:191]
s_add_u32 m0, s65, 0
s_mov_b32 s64, s54
s_add_u32 s54, s54, s67
v_mfma_f32_16x16x32_bf16 v[192:195], v[32:35], v[64:67], v[192:195]
ds_read_b64_tr_b16 v[84:85], v17 offset:24576
buffer_load_dwordx4 v1, s[40:43], s64 offen sc1 lds
ds_read_b128 v[56:59], v11 offset:4096
v_mfma_f32_16x16x32_bf16 v[196:199], v[36:39], v[64:67], v[196:199]
ds_read_b64_tr_b16 v[86:87], v17 offset:25600
v_mfma_f32_16x16x32_bf16 v[200:203], v[40:43], v[64:67], v[200:203]
v_mfma_f32_16x16x32_bf16 v[204:207], v[44:47], v[64:67], v[204:207]
ds_read_b128 v[60:63], v11 offset:6144
v_mfma_f32_16x16x32_bf16 v[208:211], v[32:35], v[68:71], v[208:211]
ds_read_b64_tr_b16 v[64:65], v18 offset:24576
v_mfma_f32_16x16x32_bf16 v[212:215], v[36:39], v[68:71], v[212:215]
ds_read_b64_tr_b16 v[66:67], v18 offset:25600
v_mfma_f32_16x16x32_bf16 v[216:219], v[40:43], v[68:71], v[216:219]
v_mfma_f32_16x16x32_bf16 v[220:223], v[44:47], v[68:71], v[220:223]
s_waitcnt lgkmcnt(9)
v_mfma_f32_16x16x32_bf16 v[96:99], v[48:51], v[72:75], v[96:99]
ds_read_b64_tr_b16 v[68:69], v19 offset:24576
s_waitcnt lgkmcnt(7)
v_mfma_f32_16x16x32_bf16 v[100:103], v[52:55], v[72:75], v[100:103]
ds_read_b64_tr_b16 v[70:71], v19 offset:25600
s_add_u32 m0, s55, 65536
s_add_u32 s66, s25, 0
s_waitcnt lgkmcnt(6)
v_mfma_f32_16x16x32_bf16 v[104:107], v[56:59], v[72:75], v[104:107]
buffer_load_dwordx4 v4, s[28:31], s66 offen offset:2048 lds
s_waitcnt lgkmcnt(4)
v_mfma_f32_16x16x32_bf16 v[108:111], v[60:63], v[72:75], v[108:111]
v_mfma_f32_16x16x32_bf16 v[112:115], v[48:51], v[76:79], v[112:115]
ds_read_b64_tr_b16 v[72:73], v20 offset:24576
v_mfma_f32_16x16x32_bf16 v[116:119], v[52:55], v[76:79], v[116:119]
ds_read_b64_tr_b16 v[74:75], v20 offset:25600
v_mfma_f32_16x16x32_bf16 v[120:123], v[56:59], v[76:79], v[120:123]
v_mfma_f32_16x16x32_bf16 v[124:127], v[60:63], v[76:79], v[124:127]
v_mfma_f32_16x16x32_bf16 v[128:131], v[48:51], v[80:83], v[128:131]
ds_read_b64_tr_b16 v[76:77], v21 offset:24576
v_mfma_f32_16x16x32_bf16 v[132:135], v[52:55], v[80:83], v[132:135]
ds_read_b64_tr_b16 v[78:79], v21 offset:25600
v_mfma_f32_16x16x32_bf16 v[136:139], v[56:59], v[80:83], v[136:139]
v_mfma_f32_16x16x32_bf16 v[140:143], v[60:63], v[80:83], v[140:143]
v_mfma_f32_16x16x32_bf16 v[144:147], v[48:51], v[84:87], v[144:147]
v_mfma_f32_16x16x32_bf16 v[148:151], v[52:55], v[84:87], v[148:151]
buffer_load_dwordx4 v5, s[28:31], s66 offen offset:3072 lds
v_mfma_f32_16x16x32_bf16 v[152:155], v[56:59], v[84:87], v[152:155]
v_mfma_f32_16x16x32_bf16 v[156:159], v[60:63], v[84:87], v[156:159]
s_waitcnt vmcnt(8) lgkmcnt(0)
s_barrier
ds_read_b64_tr_b16 v[80:81], v14 offset:40960
ds_read_b64_tr_b16 v[82:83], v14 offset:41984
v_mfma_f32_16x16x32_bf16 v[160:163], v[48:51], v[64:67], v[160:163]
ds_read_b64_tr_b16 v[84:85], v15 offset:40960
v_mfma_f32_16x16x32_bf16 v[164:167], v[52:55], v[64:67], v[164:167]
ds_read_b64_tr_b16 v[86:87], v15 offset:41984
v_mfma_f32_16x16x32_bf16 v[168:171], v[56:59], v[64:67], v[168:171]
ds_read_b128 v[32:35], v10 offset:32768
v_mfma_f32_16x16x32_bf16 v[172:175], v[60:63], v[64:67], v[172:175]
v_mfma_f32_16x16x32_bf16 v[176:179], v[48:51], v[68:71], v[176:179]
ds_read_b64_tr_b16 v[64:65], v16 offset:40960
v_mfma_f32_16x16x32_bf16 v[180:183], v[52:55], v[68:71], v[180:183]
ds_read_b64_tr_b16 v[66:67], v16 offset:41984
ds_read_b128 v[36:39], v10 offset:34816
v_mfma_f32_16x16x32_bf16 v[184:187], v[56:59], v[68:71], v[184:187]
v_mfma_f32_16x16x32_bf16 v[188:191], v[60:63], v[68:71], v[188:191]
s_add_u32 m0, s65, 16384
s_mov_b32 s64, s54
s_add_u32 s54, s54, s67
v_mfma_f32_16x16x32_bf16 v[192:195], v[48:51], v[72:75], v[192:195]
ds_read_b64_tr_b16 v[68:69], v17 offset:40960
buffer_load_dwordx4 v1, s[40:43], s64 offen sc1 lds
ds_read_b128 v[40:43], v10 offset:36864
v_mfma_f32_16x16x32_bf16 v[196:199], v[52:55], v[72:75], v[196:199]
ds_read_b64_tr_b16 v[70:71], v17 offset:41984
v_mfma_f32_16x16x32_bf16 v[200:203], v[56:59], v[72:75], v[200:203]
v_mfma_f32_16x16x32_bf16 v[204:207], v[60:63], v[72:75], v[204:207]
ds_read_b128 v[44:47], v10 offset:38912
v_mfma_f32_16x16x32_bf16 v[208:211], v[48:51], v[76:79], v[208:211]
ds_read_b64_tr_b16 v[72:73], v18 offset:40960
v_mfma_f32_16x16x32_bf16 v[212:215], v[52:55], v[76:79], v[212:215]
ds_read_b64_tr_b16 v[74:75], v18 offset:41984
v_mfma_f32_16x16x32_bf16 v[216:219], v[56:59], v[76:79], v[216:219]
v_mfma_f32_16x16x32_bf16 v[220:223], v[60:63], v[76:79], v[220:223]
s_waitcnt lgkmcnt(9)
v_mfma_f32_16x16x32_bf16 v[96:99], v[32:35], v[80:83], v[96:99]
ds_read_b64_tr_b16 v[76:77], v19 offset:40960
s_waitcnt lgkmcnt(7)
v_mfma_f32_16x16x32_bf16 v[100:103], v[36:39], v[80:83], v[100:103]
ds_read_b64_tr_b16 v[78:79], v19 offset:41984
s_add_u32 m0, s55, 0
s_add_u32 s66, s25, 128
s_waitcnt lgkmcnt(6)
v_mfma_f32_16x16x32_bf16 v[104:107], v[40:43], v[80:83], v[104:107]
buffer_load_dwordx4 v2, s[28:31], s66 offen offset:0 lds
s_waitcnt lgkmcnt(4)
v_mfma_f32_16x16x32_bf16 v[108:111], v[44:47], v[80:83], v[108:111]
v_mfma_f32_16x16x32_bf16 v[112:115], v[32:35], v[84:87], v[112:115]
ds_read_b64_tr_b16 v[80:81], v20 offset:40960
v_mfma_f32_16x16x32_bf16 v[116:119], v[36:39], v[84:87], v[116:119]
ds_read_b64_tr_b16 v[82:83], v20 offset:41984
v_mfma_f32_16x16x32_bf16 v[120:123], v[40:43], v[84:87], v[120:123]
v_mfma_f32_16x16x32_bf16 v[124:127], v[44:47], v[84:87], v[124:127]
v_mfma_f32_16x16x32_bf16 v[128:131], v[32:35], v[64:67], v[128:131]
ds_read_b64_tr_b16 v[84:85], v21 offset:40960
v_mfma_f32_16x16x32_bf16 v[132:135], v[36:39], v[64:67], v[132:135]
ds_read_b64_tr_b16 v[86:87], v21 offset:41984
v_mfma_f32_16x16x32_bf16 v[136:139], v[40:43], v[64:67], v[136:139]
v_mfma_f32_16x16x32_bf16 v[140:143], v[44:47], v[64:67], v[140:143]
v_mfma_f32_16x16x32_bf16 v[144:147], v[32:35], v[68:71], v[144:147]
v_mfma_f32_16x16x32_bf16 v[148:151], v[36:39], v[68:71], v[148:151]
buffer_load_dwordx4 v3, s[28:31], s66 offen offset:1024 lds
v_mfma_f32_16x16x32_bf16 v[152:155], v[40:43], v[68:71], v[152:155]
v_mfma_f32_16x16x32_bf16 v[156:159], v[44:47], v[68:71], v[156:159]
s_waitcnt vmcnt(9) lgkmcnt(0)
s_barrier
ds_read_b64_tr_b16 v[64:65], v14 offset:57344
ds_read_b64_tr_b16 v[66:67], v14 offset:58368
v_mfma_f32_16x16x32_bf16 v[160:163], v[32:35], v[72:75], v[160:163]
ds_read_b64_tr_b16 v[68:69], v15 offset:57344
v_mfma_f32_16x16x32_bf16 v[164:167], v[36:39], v[72:75], v[164:167]
ds_read_b64_tr_b16 v[70:71], v15 offset:58368
v_mfma_f32_16x16x32_bf16 v[168:171], v[40:43], v[72:75], v[168:171]
ds_read_b128 v[48:51], v11 offset:32768
v_mfma_f32_16x16x32_bf16 v[172:175], v[44:47], v[72:75], v[172:175]
v_mfma_f32_16x16x32_bf16 v[176:179], v[32:35], v[76:79], v[176:179]
ds_read_b64_tr_b16 v[72:73], v16 offset:57344
v_mfma_f32_16x16x32_bf16 v[180:183], v[36:39], v[76:79], v[180:183]
ds_read_b64_tr_b16 v[74:75], v16 offset:58368
ds_read_b128 v[52:55], v11 offset:34816
v_mfma_f32_16x16x32_bf16 v[184:187], v[40:43], v[76:79], v[184:187]
v_mfma_f32_16x16x32_bf16 v[188:191], v[44:47], v[76:79], v[188:191]
s_add_u32 m0, s65, 32768
s_mov_b32 s64, s54
s_add_u32 s54, s54, s67
v_mfma_f32_16x16x32_bf16 v[192:195], v[32:35], v[80:83], v[192:195]
ds_read_b64_tr_b16 v[76:77], v17 offset:57344
buffer_load_dwordx4 v1, s[40:43], s64 offen sc1 lds
ds_read_b128 v[56:59], v11 offset:36864
v_mfma_f32_16x16x32_bf16 v[196:199], v[36:39], v[80:83], v[196:199]
ds_read_b64_tr_b16 v[78:79], v17 offset:58368
v_mfma_f32_16x16x32_bf16 v[200:203], v[40:43], v[80:83], v[200:203]
v_mfma_f32_16x16x32_bf16 v[204:207], v[44:47], v[80:83], v[204:207]
ds_read_b128 v[60:63], v11 offset:38912
v_mfma_f32_16x16x32_bf16 v[208:211], v[32:35], v[84:87], v[208:211]
ds_read_b64_tr_b16 v[80:81], v18 offset:57344
v_mfma_f32_16x16x32_bf16 v[212:215], v[36:39], v[84:87], v[212:215]
ds_read_b64_tr_b16 v[82:83], v18 offset:58368
v_mfma_f32_16x16x32_bf16 v[216:219], v[40:43], v[84:87], v[216:219]
v_mfma_f32_16x16x32_bf16 v[220:223], v[44:47], v[84:87], v[220:223]
s_waitcnt lgkmcnt(9)
v_mfma_f32_16x16x32_bf16 v[96:99], v[48:51], v[64:67], v[96:99]
ds_read_b64_tr_b16 v[84:85], v19 offset:57344
s_waitcnt lgkmcnt(7)
v_mfma_f32_16x16x32_bf16 v[100:103], v[52:55], v[64:67], v[100:103]
ds_read_b64_tr_b16 v[86:87], v19 offset:58368
s_add_u32 m0, s55, 0
s_add_u32 s66, s25, 128
s_waitcnt lgkmcnt(6)
v_mfma_f32_16x16x32_bf16 v[104:107], v[56:59], v[64:67], v[104:107]
buffer_load_dwordx4 v4, s[28:31], s66 offen offset:2048 lds
s_waitcnt lgkmcnt(4)
v_mfma_f32_16x16x32_bf16 v[108:111], v[60:63], v[64:67], v[108:111]
v_mfma_f32_16x16x32_bf16 v[112:115], v[48:51], v[68:71], v[112:115]
ds_read_b64_tr_b16 v[64:65], v20 offset:57344
v_mfma_f32_16x16x32_bf16 v[116:119], v[52:55], v[68:71], v[116:119]
ds_read_b64_tr_b16 v[66:67], v20 offset:58368
v_mfma_f32_16x16x32_bf16 v[120:123], v[56:59], v[68:71], v[120:123]
v_mfma_f32_16x16x32_bf16 v[124:127], v[60:63], v[68:71], v[124:127]
v_mfma_f32_16x16x32_bf16 v[128:131], v[48:51], v[72:75], v[128:131]
ds_read_b64_tr_b16 v[68:69], v21 offset:57344
v_cvt_pk_bf16_f32 v96, v96, v97
v_cvt_pk_bf16_f32 v97, v98, v99
v_cvt_pk_bf16_f32 v98, v100, v101
v_mfma_f32_16x16x32_bf16 v[132:135], v[52:55], v[72:75], v[132:135]
ds_read_b64_tr_b16 v[70:71], v21 offset:58368
v_cvt_pk_bf16_f32 v99, v102, v103
v_cvt_pk_bf16_f32 v100, v104, v105
v_cvt_pk_bf16_f32 v101, v106, v107
v_mfma_f32_16x16x32_bf16 v[136:139], v[56:59], v[72:75], v[136:139]
v_cvt_pk_bf16_f32 v102, v108, v109
v_cvt_pk_bf16_f32 v103, v110, v111
v_mfma_f32_16x16x32_bf16 v[140:143], v[60:63], v[72:75], v[140:143]
v_mfma_f32_16x16x32_bf16 v[144:147], v[48:51], v[76:79], v[144:147]
v_cvt_pk_bf16_f32 v104, v112, v113
v_cvt_pk_bf16_f32 v105, v114, v115
v_cvt_pk_bf16_f32 v106, v116, v117
v_mfma_f32_16x16x32_bf16 v[148:151], v[52:55], v[76:79], v[148:151]
buffer_load_dwordx4 v5, s[28:31], s66 offen offset:3072 lds
v_cvt_pk_bf16_f32 v107, v118, v119
v_cvt_pk_bf16_f32 v108, v120, v121
v_cvt_pk_bf16_f32 v109, v122, v123
v_mfma_f32_16x16x32_bf16 v[152:155], v[56:59], v[76:79], v[152:155]
v_cvt_pk_bf16_f32 v110, v124, v125
v_cvt_pk_bf16_f32 v111, v126, v127
v_mfma_f32_16x16x32_bf16 v[156:159], v[60:63], v[76:79], v[156:159]
s_waitcnt vmcnt(6) lgkmcnt(0)
s_barrier
ds_read_b64_tr_b16 v[72:73], v20 offset:0
ds_read_b64_tr_b16 v[74:75], v20 offset:1024
v_mfma_f32_16x16x32_bf16 v[160:163], v[48:51], v[80:83], v[160:163]
ds_read_b64_tr_b16 v[76:77], v21 offset:0
v_cvt_pk_bf16_f32 v112, v128, v129
v_cvt_pk_bf16_f32 v113, v130, v131
v_cvt_pk_bf16_f32 v114, v132, v133
v_mfma_f32_16x16x32_bf16 v[164:167], v[52:55], v[80:83], v[164:167]
ds_read_b64_tr_b16 v[78:79], v21 offset:1024
v_cvt_pk_bf16_f32 v115, v134, v135
v_cvt_pk_bf16_f32 v116, v136, v137
v_cvt_pk_bf16_f32 v117, v138, v139
v_mfma_f32_16x16x32_bf16 v[168:171], v[56:59], v[80:83], v[168:171]
s_add_u32 m0, s65, 49152
s_mov_b32 s64, s54
s_add_u32 s54, s54, s67
ds_read_b128 v[32:35], v12 offset:0
v_cvt_pk_bf16_f32 v118, v140, v141
v_cvt_pk_bf16_f32 v119, v142, v143
v_mfma_f32_16x16x32_bf16 v[172:175], v[60:63], v[80:83], v[172:175]
buffer_load_dwordx4 v1, s[40:43], s64 offen sc1 lds
v_mfma_f32_16x16x32_bf16 v[176:179], v[48:51], v[84:87], v[176:179]
ds_read_b64_tr_b16 v[80:81], v22 offset:8192
v_cvt_pk_bf16_f32 v120, v144, v145
v_cvt_pk_bf16_f32 v121, v146, v147
v_cvt_pk_bf16_f32 v122, v148, v149
v_mfma_f32_16x16x32_bf16 v[180:183], v[52:55], v[84:87], v[180:183]
ds_read_b64_tr_b16 v[82:83], v23 offset:8192
ds_read_b128 v[36:39], v12 offset:2048
v_cvt_pk_bf16_f32 v123, v150, v151
v_cvt_pk_bf16_f32 v124, v152, v153
v_cvt_pk_bf16_f32 v125, v154, v155
v_mfma_f32_16x16x32_bf16 v[184:187], v[56:59], v[84:87], v[184:187]
s_add_u32 m0, s55, 32768
s_add_u32 s66, s25, 256
v_cvt_pk_bf16_f32 v126, v156, v157
v_cvt_pk_bf16_f32 v127, v158, v159
v_mfma_f32_16x16x32_bf16 v[188:191], v[60:63], v[84:87], v[188:191]
buffer_load_dwordx4 v2, s[28:31], s66 offen offset:0 lds
v_mfma_f32_16x16x32_bf16 v[192:195], v[48:51], v[64:67], v[192:195]
ds_read_b64_tr_b16 v[84:85], v22 offset:9216
ds_read_b128 v[40:43], v12 offset:4096
v_cvt_pk_bf16_f32 v128, v160, v161
v_cvt_pk_bf16_f32 v129, v162, v163
v_cvt_pk_bf16_f32 v130, v164, v165
v_mfma_f32_16x16x32_bf16 v[196:199], v[52:55], v[64:67], v[196:199]
ds_read_b64_tr_b16 v[86:87], v23 offset:9216
v_cvt_pk_bf16_f32 v131, v166, v167
v_cvt_pk_bf16_f32 v132, v168, v169
v_cvt_pk_bf16_f32 v133, v170, v171
v_mfma_f32_16x16x32_bf16 v[200:203], v[56:59], v[64:67], v[200:203]
v_cvt_pk_bf16_f32 v134, v172, v173
v_cvt_pk_bf16_f32 v135, v174, v175
v_mfma_f32_16x16x32_bf16 v[204:207], v[60:63], v[64:67], v[204:207]
buffer_load_dwordx4 v3, s[28:31], s66 offen offset:1024 lds
ds_read_b128 v[44:47], v12 offset:6144
v_mfma_f32_16x16x32_bf16 v[208:211], v[48:51], v[68:71], v[208:211]
ds_read_b64_tr_b16 v[64:65], v22 offset:10240
v_cvt_pk_bf16_f32 v136, v176, v177
v_cvt_pk_bf16_f32 v137, v178, v179
v_cvt_pk_bf16_f32 v138, v180, v181
v_mfma_f32_16x16x32_bf16 v[212:215], v[52:55], v[68:71], v[212:215]
ds_read_b64_tr_b16 v[66:67], v23 offset:10240
v_cvt_pk_bf16_f32 v139, v182, v183
v_cvt_pk_bf16_f32 v140, v184, v185
v_cvt_pk_bf16_f32 v141, v186, v187
v_mfma_f32_16x16x32_bf16 v[216:219], v[56:59], v[68:71], v[216:219]
v_cvt_pk_bf16_f32 v142, v188, v189
v_cvt_pk_bf16_f32 v143, v190, v191
v_mfma_f32_16x16x32_bf16 v[220:223], v[60:63], v[68:71], v[220:223]
buffer_store_dwordx4 v[96:99], v1, s[44:47], s60 offen offset:0 sc1
s_waitcnt lgkmcnt(9)
v_mfma_f32_16x16x32_bf16 v[224:227], v[72:75], v[32:35], 0
v_cvt_pk_bf16_f32 v144, v192, v193
v_cvt_pk_bf16_f32 v145, v194, v195
v_cvt_pk_bf16_f32 v146, v196, v197
s_waitcnt lgkmcnt(6)
v_mfma_f32_16x16x32_bf16 v[232:235], v[72:75], v[36:39], 0
v_cvt_pk_bf16_f32 v147, v198, v199
v_cvt_pk_bf16_f32 v148, v200, v201
v_cvt_pk_bf16_f32 v149, v202, v203
s_waitcnt lgkmcnt(4)
v_mfma_f32_16x16x32_bf16 v[240:243], v[72:75], v[40:43], 0
v_cvt_pk_bf16_f32 v150, v204, v205
v_cvt_pk_bf16_f32 v151, v206, v207
v_cvt_pk_bf16_f32 v152, v208, v209
s_waitcnt lgkmcnt(2)
v_mfma_f32_16x16x32_bf16 v[248:251], v[72:75], v[44:47], 0
buffer_store_dwordx4 v[100:103], v1, s[44:47], s62 offen offset:0 sc1
s_mov_b32 s32, s44
s_mov_b32 s33, s45
s_mov_b32 s34, 268435456
s_mov_b32 s35, 0x20000
s_lshl_b32 s39, s22, 12
s_lshl_b32 s7, s20, 19
s_add_u32 s36, s7, s39
s_add_u32 s37, s36, 33546240
s_add_u32 s13, s36, 16777216
s_cmp_lt_u32 s22, 2
s_cselect_b32 s13, s13, s37
s_add_u32 s36, s36, 16785408
s_add_u32 s14, s39, 98304
s_add_u32 s15, s39, 131072
v_cvt_pk_bf16_f32 v153, v210, v211
v_cvt_pk_bf16_f32 v154, v212, v213
v_cvt_pk_bf16_f32 v155, v214, v215
s_waitcnt vmcnt(10) lgkmcnt(0)
s_barrier
ds_read_b64_tr_b16 v[68:69], v20 offset:16384
ds_read_b64_tr_b16 v[70:71], v20 offset:17408
v_mfma_f32_16x16x32_bf16 v[228:231], v[76:79], v[32:35], 0
ds_read_b64_tr_b16 v[72:73], v21 offset:16384
v_cvt_pk_bf16_f32 v156, v216, v217
v_cvt_pk_bf16_f32 v157, v218, v219
v_cvt_pk_bf16_f32 v158, v220, v221
v_mfma_f32_16x16x32_bf16 v[236:239], v[76:79], v[36:39], 0
ds_read_b64_tr_b16 v[74:75], v21 offset:17408
v_cvt_pk_bf16_f32 v159, v222, v223
v_mfma_f32_16x16x32_bf16 v[244:247], v[76:79], v[40:43], 0
s_add_u32 m0, s65, 0
s_mov_b32 s64, s54
s_add_u32 s54, s54, s67
ds_read_b128 v[48:51], v13 offset:0
v_mfma_f32_16x16x32_bf16 v[252:255], v[76:79], v[44:47], 0
buffer_load_dwordx4 v1, s[40:43], s64 offen sc1 lds
v_mfma_f32_16x16x32_bf16 v[160:163], v[80:83], v[32:35], 0
ds_read_b64_tr_b16 v[76:77], v22 offset:24576
v_mfma_f32_16x16x32_bf16 v[164:167], v[80:83], v[36:39], 0
ds_read_b64_tr_b16 v[78:79], v23 offset:24576
ds_read_b128 v[52:55], v13 offset:2048
v_mfma_f32_16x16x32_bf16 v[168:171], v[80:83], v[40:43], 0
v_mfma_f32_16x16x32_bf16 v[172:175], v[80:83], v[44:47], 0
s_add_u32 m0, s55, 32768
s_add_u32 s66, s25, 256
v_mfma_f32_16x16x32_bf16 v[176:179], v[32:35], v[84:87], 0
ds_read_b64_tr_b16 v[80:81], v22 offset:25600
buffer_load_dwordx4 v4, s[28:31], s66 offen offset:2048 lds
ds_read_b128 v[56:59], v13 offset:4096
v_mfma_f32_16x16x32_bf16 v[180:183], v[36:39], v[84:87], 0
ds_read_b64_tr_b16 v[82:83], v23 offset:25600
v_mfma_f32_16x16x32_bf16 v[184:187], v[40:43], v[84:87], 0
v_mfma_f32_16x16x32_bf16 v[188:191], v[44:47], v[84:87], 0
ds_read_b128 v[60:63], v13 offset:6144
v_mfma_f32_16x16x32_bf16 v[192:195], v[32:35], v[64:67], 0
ds_read_b64_tr_b16 v[84:85], v22 offset:26624
v_mfma_f32_16x16x32_bf16 v[196:199], v[36:39], v[64:67], 0
ds_read_b64_tr_b16 v[86:87], v23 offset:26624
buffer_load_dwordx4 v5, s[28:31], s66 offen offset:3072 lds
v_mfma_f32_16x16x32_bf16 v[200:203], v[40:43], v[64:67], 0
v_mfma_f32_16x16x32_bf16 v[204:207], v[44:47], v[64:67], 0
s_waitcnt lgkmcnt(9)
v_mfma_f32_16x16x32_bf16 v[224:227], v[68:71], v[48:51], v[224:227]
s_waitcnt lgkmcnt(6)
v_mfma_f32_16x16x32_bf16 v[232:235], v[68:71], v[52:55], v[232:235]
s_waitcnt lgkmcnt(4)
v_mfma_f32_16x16x32_bf16 v[240:243], v[68:71], v[56:59], v[240:243]
buffer_store_dwordx4 v[104:107], v1, s[44:47], s60 offen offset:1024 sc1
s_waitcnt lgkmcnt(2)
v_mfma_f32_16x16x32_bf16 v[248:251], v[68:71], v[60:63], v[248:251]
s_waitcnt vmcnt(9) lgkmcnt(0)
s_barrier
ds_read_b64_tr_b16 v[64:65], v20 offset:32768
ds_read_b64_tr_b16 v[66:67], v20 offset:33792
v_mfma_f32_16x16x32_bf16 v[228:231], v[72:75], v[48:51], v[228:231]
ds_read_b64_tr_b16 v[68:69], v21 offset:32768
v_mfma_f32_16x16x32_bf16 v[236:239], v[72:75], v[52:55], v[236:239]
ds_read_b64_tr_b16 v[70:71], v21 offset:33792
v_mfma_f32_16x16x32_bf16 v[244:247], v[72:75], v[56:59], v[244:247]
s_add_u32 m0, s65, 16384
s_mov_b32 s64, s54
s_add_u32 s54, s54, s67
ds_read_b128 v[32:35], v10 offset:0
v_mfma_f32_16x16x32_bf16 v[252:255], v[72:75], v[60:63], v[252:255]
buffer_load_dwordx4 v1, s[40:43], s64 offen sc1 lds
v_mfma_f32_16x16x32_bf16 v[160:163], v[76:79], v[48:51], v[160:163]
ds_read_b64_tr_b16 v[72:73], v22 offset:40960
v_mfma_f32_16x16x32_bf16 v[164:167], v[76:79], v[52:55], v[164:167]
ds_read_b64_tr_b16 v[74:75], v23 offset:40960
ds_read_b128 v[36:39], v10 offset:2048
v_mfma_f32_16x16x32_bf16 v[168:171], v[76:79], v[56:59], v[168:171]
s_add_u32 m0, s55, 65536
s_add_u32 s66, s25, 384
v_mfma_f32_16x16x32_bf16 v[172:175], v[76:79], v[60:63], v[172:175]
buffer_load_dwordx4 v2, s[28:31], s66 offen offset:0 lds
v_mfma_f32_16x16x32_bf16 v[176:179], v[48:51], v[80:83], v[176:179]
ds_read_b64_tr_b16 v[76:77], v22 offset:41984
ds_read_b128 v[40:43], v10 offset:4096
v_mfma_f32_16x16x32_bf16 v[180:183], v[52:55], v[80:83], v[180:183]
ds_read_b64_tr_b16 v[78:79], v23 offset:41984
v_mfma_f32_16x16x32_bf16 v[184:187], v[56:59], v[80:83], v[184:187]
v_mfma_f32_16x16x32_bf16 v[188:191], v[60:63], v[80:83], v[188:191]
buffer_load_dwordx4 v3, s[28:31], s66 offen offset:1024 lds
ds_read_b128 v[44:47], v10 offset:6144
v_mfma_f32_16x16x32_bf16 v[192:195], v[48:51], v[84:87], v[192:195]
ds_read_b64_tr_b16 v[80:81], v22 offset:43008
v_mfma_f32_16x16x32_bf16 v[196:199], v[52:55], v[84:87], v[196:199]
ds_read_b64_tr_b16 v[82:83], v23 offset:43008
v_mfma_f32_16x16x32_bf16 v[200:203], v[56:59], v[84:87], v[200:203]
v_mfma_f32_16x16x32_bf16 v[204:207], v[60:63], v[84:87], v[204:207]
buffer_store_dwordx4 v[108:111], v1, s[44:47], s62 offen offset:1024 sc1
s_waitcnt lgkmcnt(9)
v_mfma_f32_16x16x32_bf16 v[224:227], v[64:67], v[32:35], v[224:227]
s_waitcnt lgkmcnt(6)
v_mfma_f32_16x16x32_bf16 v[232:235], v[64:67], v[36:39], v[232:235]
s_waitcnt lgkmcnt(4)
v_mfma_f32_16x16x32_bf16 v[240:243], v[64:67], v[40:43], v[240:243]
s_waitcnt lgkmcnt(2)
v_mfma_f32_16x16x32_bf16 v[248:251], v[64:67], v[44:47], v[248:251]
buffer_store_dwordx4 v[112:115], v1, s[44:47], s60 offen offset:2048 sc1
s_waitcnt vmcnt(13) lgkmcnt(0)
s_barrier
ds_read_b64_tr_b16 v[84:85], v20 offset:49152
ds_read_b64_tr_b16 v[86:87], v20 offset:50176
v_mfma_f32_16x16x32_bf16 v[228:231], v[68:71], v[32:35], v[228:231]
ds_read_b64_tr_b16 v[64:65], v21 offset:49152
v_mfma_f32_16x16x32_bf16 v[236:239], v[68:71], v[36:39], v[236:239]
ds_read_b64_tr_b16 v[66:67], v21 offset:50176
v_mfma_f32_16x16x32_bf16 v[244:247], v[68:71], v[40:43], v[244:247]
s_add_u32 m0, s65, 32768
s_mov_b32 s64, s54
s_add_u32 s54, s54, s67
ds_read_b128 v[48:51], v11 offset:0
v_mfma_f32_16x16x32_bf16 v[252:255], v[68:71], v[44:47], v[252:255]
buffer_load_dwordx4 v1, s[40:43], s64 offen sc1 lds
v_mfma_f32_16x16x32_bf16 v[160:163], v[72:75], v[32:35], v[160:163]
ds_read_b64_tr_b16 v[68:69], v22 offset:57344
v_mfma_f32_16x16x32_bf16 v[164:167], v[72:75], v[36:39], v[164:167]
ds_read_b64_tr_b16 v[70:71], v23 offset:57344
ds_read_b128 v[52:55], v11 offset:2048
v_mfma_f32_16x16x32_bf16 v[168:171], v[72:75], v[40:43], v[168:171]
v_mfma_f32_16x16x32_bf16 v[172:175], v[72:75], v[44:47], v[172:175]
s_add_u32 m0, s55, 65536
s_add_u32 s66, s25, 384
v_mfma_f32_16x16x32_bf16 v[176:179], v[32:35], v[76:79], v[176:179]
ds_read_b64_tr_b16 v[72:73], v22 offset:58368
buffer_load_dwordx4 v4, s[28:31], s66 offen offset:2048 lds
ds_read_b128 v[56:59], v11 offset:4096
v_mfma_f32_16x16x32_bf16 v[180:183], v[36:39], v[76:79], v[180:183]
ds_read_b64_tr_b16 v[74:75], v23 offset:58368
v_mfma_f32_16x16x32_bf16 v[184:187], v[40:43], v[76:79], v[184:187]
v_mfma_f32_16x16x32_bf16 v[188:191], v[44:47], v[76:79], v[188:191]
ds_read_b128 v[60:63], v11 offset:6144
v_mfma_f32_16x16x32_bf16 v[192:195], v[32:35], v[80:83], v[192:195]
ds_read_b64_tr_b16 v[76:77], v22 offset:59392
v_mfma_f32_16x16x32_bf16 v[196:199], v[36:39], v[80:83], v[196:199]
ds_read_b64_tr_b16 v[78:79], v23 offset:59392
buffer_load_dwordx4 v5, s[28:31], s66 offen offset:3072 lds
v_mfma_f32_16x16x32_bf16 v[200:203], v[40:43], v[80:83], v[200:203]
v_mfma_f32_16x16x32_bf16 v[204:207], v[44:47], v[80:83], v[204:207]
s_waitcnt lgkmcnt(9)
v_mfma_f32_16x16x32_bf16 v[224:227], v[84:87], v[48:51], v[224:227]
s_waitcnt lgkmcnt(6)
v_mfma_f32_16x16x32_bf16 v[232:235], v[84:87], v[52:55], v[232:235]
s_waitcnt lgkmcnt(4)
v_mfma_f32_16x16x32_bf16 v[240:243], v[84:87], v[56:59], v[240:243]
buffer_store_dwordx4 v[116:119], v1, s[44:47], s62 offen offset:2048 sc1
s_waitcnt lgkmcnt(2)
v_mfma_f32_16x16x32_bf16 v[248:251], v[84:87], v[60:63], v[248:251]
s_waitcnt vmcnt(10) lgkmcnt(0)
s_barrier
ds_read_b64_tr_b16 v[80:81], v20 offset:0
ds_read_b64_tr_b16 v[82:83], v20 offset:1024
v_mfma_f32_16x16x32_bf16 v[228:231], v[64:67], v[48:51], v[228:231]
ds_read_b64_tr_b16 v[84:85], v21 offset:0
v_mfma_f32_16x16x32_bf16 v[236:239], v[64:67], v[52:55], v[236:239]
ds_read_b64_tr_b16 v[86:87], v21 offset:1024
v_mfma_f32_16x16x32_bf16 v[244:247], v[64:67], v[56:59], v[244:247]
s_add_u32 m0, s65, 49152
s_mov_b32 s64, s54
s_add_u32 s54, s54, s67
ds_read_b128 v[32:35], v10 offset:32768
v_mfma_f32_16x16x32_bf16 v[252:255], v[64:67], v[60:63], v[252:255]
buffer_load_dwordx4 v1, s[40:43], s64 offen sc1 lds
v_mfma_f32_16x16x32_bf16 v[160:163], v[68:71], v[48:51], v[160:163]
ds_read_b64_tr_b16 v[64:65], v22 offset:8192
v_mfma_f32_16x16x32_bf16 v[164:167], v[68:71], v[52:55], v[164:167]
ds_read_b64_tr_b16 v[66:67], v23 offset:8192
ds_read_b128 v[36:39], v10 offset:34816
v_mfma_f32_16x16x32_bf16 v[168:171], v[68:71], v[56:59], v[168:171]
s_add_u32 m0, s55, 0
s_add_u32 s66, s25, 512
v_mfma_f32_16x16x32_bf16 v[172:175], v[68:71], v[60:63], v[172:175]
buffer_load_dwordx4 v2, s[28:31], s66 offen offset:0 lds
v_mfma_f32_16x16x32_bf16 v[176:179], v[48:51], v[72:75], v[176:179]
ds_read_b64_tr_b16 v[68:69], v22 offset:9216
ds_read_b128 v[40:43], v10 offset:36864
v_mfma_f32_16x16x32_bf16 v[180:183], v[52:55], v[72:75], v[180:183]
ds_read_b64_tr_b16 v[70:71], v23 offset:9216
v_mfma_f32_16x16x32_bf16 v[184:187], v[56:59], v[72:75], v[184:187]
v_mfma_f32_16x16x32_bf16 v[188:191], v[60:63], v[72:75], v[188:191]
buffer_load_dwordx4 v3, s[28:31], s66 offen offset:1024 lds
ds_read_b128 v[44:47], v10 offset:38912
v_mfma_f32_16x16x32_bf16 v[192:195], v[48:51], v[76:79], v[192:195]
ds_read_b64_tr_b16 v[72:73], v22 offset:10240
v_mfma_f32_16x16x32_bf16 v[196:199], v[52:55], v[76:79], v[196:199]
ds_read_b64_tr_b16 v[74:75], v23 offset:10240
v_mfma_f32_16x16x32_bf16 v[200:203], v[56:59], v[76:79], v[200:203]
v_mfma_f32_16x16x32_bf16 v[204:207], v[60:63], v[76:79], v[204:207]
buffer_store_dwordx4 v[120:123], v1, s[44:47], s60 offen offset:3072 sc1
s_waitcnt lgkmcnt(9)
v_mfma_f32_16x16x32_bf16 v[224:227], v[80:83], v[32:35], v[224:227]
s_waitcnt lgkmcnt(6)
v_mfma_f32_16x16x32_bf16 v[232:235], v[80:83], v[36:39], v[232:235]
s_waitcnt lgkmcnt(4)
v_mfma_f32_16x16x32_bf16 v[240:243], v[80:83], v[40:43], v[240:243]
s_waitcnt lgkmcnt(2)
v_mfma_f32_16x16x32_bf16 v[248:251], v[80:83], v[44:47], v[248:251]
buffer_store_dwordx4 v[124:127], v1, s[44:47], s62 offen offset:3072 sc1
s_waitcnt vmcnt(13) lgkmcnt(0)
s_barrier
ds_read_b64_tr_b16 v[76:77], v20 offset:16384
ds_read_b64_tr_b16 v[78:79], v20 offset:17408
v_mfma_f32_16x16x32_bf16 v[228:231], v[84:87], v[32:35], v[228:231]
ds_read_b64_tr_b16 v[80:81], v21 offset:16384
v_mfma_f32_16x16x32_bf16 v[236:239], v[84:87], v[36:39], v[236:239]
ds_read_b64_tr_b16 v[82:83], v21 offset:17408
v_mfma_f32_16x16x32_bf16 v[244:247], v[84:87], v[40:43], v[244:247]
s_add_u32 m0, s65, 0
s_mov_b32 s64, s54
s_add_u32 s54, s54, s67
ds_read_b128 v[48:51], v11 offset:32768
v_mfma_f32_16x16x32_bf16 v[252:255], v[84:87], v[44:47], v[252:255]
buffer_load_dwordx4 v1, s[40:43], s64 offen sc1 lds
v_mfma_f32_16x16x32_bf16 v[160:163], v[64:67], v[32:35], v[160:163]
ds_read_b64_tr_b16 v[84:85], v22 offset:24576
v_mfma_f32_16x16x32_bf16 v[164:167], v[64:67], v[36:39], v[164:167]
ds_read_b64_tr_b16 v[86:87], v23 offset:24576
ds_read_b128 v[52:55], v11 offset:34816
v_mfma_f32_16x16x32_bf16 v[168:171], v[64:67], v[40:43], v[168:171]
v_mfma_f32_16x16x32_bf16 v[172:175], v[64:67], v[44:47], v[172:175]
s_add_u32 m0, s55, 0
s_add_u32 s66, s25, 512
v_mfma_f32_16x16x32_bf16 v[176:179], v[32:35], v[68:71], v[176:179]
ds_read_b64_tr_b16 v[64:65], v22 offset:25600
buffer_load_dwordx4 v4, s[28:31], s66 offen offset:2048 lds
ds_read_b128 v[56:59], v11 offset:36864
v_mfma_f32_16x16x32_bf16 v[180:183], v[36:39], v[68:71], v[180:183]
ds_read_b64_tr_b16 v[66:67], v23 offset:25600
v_mfma_f32_16x16x32_bf16 v[184:187], v[40:43], v[68:71], v[184:187]
v_mfma_f32_16x16x32_bf16 v[188:191], v[44:47], v[68:71], v[188:191]
ds_read_b128 v[60:63], v11 offset:38912
v_mfma_f32_16x16x32_bf16 v[192:195], v[32:35], v[72:75], v[192:195]
ds_read_b64_tr_b16 v[68:69], v22 offset:26624
v_mfma_f32_16x16x32_bf16 v[196:199], v[36:39], v[72:75], v[196:199]
ds_read_b64_tr_b16 v[70:71], v23 offset:26624
buffer_load_dwordx4 v5, s[28:31], s66 offen offset:3072 lds
v_mfma_f32_16x16x32_bf16 v[200:203], v[40:43], v[72:75], v[200:203]
v_mfma_f32_16x16x32_bf16 v[204:207], v[44:47], v[72:75], v[204:207]
s_waitcnt lgkmcnt(9)
v_mfma_f32_16x16x32_bf16 v[224:227], v[76:79], v[48:51], v[224:227]
s_waitcnt lgkmcnt(6)
v_mfma_f32_16x16x32_bf16 v[232:235], v[76:79], v[52:55], v[232:235]
s_waitcnt lgkmcnt(4)
v_mfma_f32_16x16x32_bf16 v[240:243], v[76:79], v[56:59], v[240:243]
buffer_store_dwordx4 v[128:131], v1, s[44:47], s61 offen offset:0 sc1
s_waitcnt lgkmcnt(2)
v_mfma_f32_16x16x32_bf16 v[248:251], v[76:79], v[60:63], v[248:251]
s_waitcnt vmcnt(10) lgkmcnt(0)
s_barrier
ds_read_b64_tr_b16 v[72:73], v20 offset:32768
ds_read_b64_tr_b16 v[74:75], v20 offset:33792
v_mfma_f32_16x16x32_bf16 v[228:231], v[80:83], v[48:51], v[228:231]
ds_read_b64_tr_b16 v[76:77], v21 offset:32768
v_mfma_f32_16x16x32_bf16 v[236:239], v[80:83], v[52:55], v[236:239]
ds_read_b64_tr_b16 v[78:79], v21 offset:33792
v_mfma_f32_16x16x32_bf16 v[244:247], v[80:83], v[56:59], v[244:247]
s_add_u32 m0, s65, 16384
s_mov_b32 s64, s54
s_add_u32 s54, s54, s67
ds_read_b128 v[32:35], v12 offset:0
v_mfma_f32_16x16x32_bf16 v[252:255], v[80:83], v[60:63], v[252:255]
buffer_load_dwordx4 v1, s[40:43], s64 offen sc1 lds
v_mfma_f32_16x16x32_bf16 v[160:163], v[84:87], v[48:51], v[160:163]
ds_read_b64_tr_b16 v[80:81], v22 offset:40960
v_mfma_f32_16x16x32_bf16 v[164:167], v[84:87], v[52:55], v[164:167]
ds_read_b64_tr_b16 v[82:83], v23 offset:40960
ds_read_b128 v[36:39], v12 offset:2048
v_mfma_f32_16x16x32_bf16 v[168:171], v[84:87], v[56:59], v[168:171]
s_add_u32 m0, s55, 32768
s_add_u32 s66, s25, 640
v_mfma_f32_16x16x32_bf16 v[172:175], v[84:87], v[60:63], v[172:175]
buffer_load_dwordx4 v2, s[28:31], s66 offen offset:0 lds
v_mfma_f32_16x16x32_bf16 v[176:179], v[48:51], v[64:67], v[176:179]
ds_read_b64_tr_b16 v[84:85], v22 offset:41984
ds_read_b128 v[40:43], v12 offset:4096
v_mfma_f32_16x16x32_bf16 v[180:183], v[52:55], v[64:67], v[180:183]
ds_read_b64_tr_b16 v[86:87], v23 offset:41984
v_mfma_f32_16x16x32_bf16 v[184:187], v[56:59], v[64:67], v[184:187]
v_mfma_f32_16x16x32_bf16 v[188:191], v[60:63], v[64:67], v[188:191]
buffer_load_dwordx4 v3, s[28:31], s66 offen offset:1024 lds
ds_read_b128 v[44:47], v12 offset:6144
v_mfma_f32_16x16x32_bf16 v[192:195], v[48:51], v[68:71], v[192:195]
ds_read_b64_tr_b16 v[64:65], v22 offset:43008
v_mfma_f32_16x16x32_bf16 v[196:199], v[52:55], v[68:71], v[196:199]
ds_read_b64_tr_b16 v[66:67], v23 offset:43008
v_mfma_f32_16x16x32_bf16 v[200:203], v[56:59], v[68:71], v[200:203]
v_mfma_f32_16x16x32_bf16 v[204:207], v[60:63], v[68:71], v[204:207]
buffer_store_dwordx4 v[132:135], v1, s[44:47], s63 offen offset:0 sc1
s_waitcnt lgkmcnt(9)
v_mfma_f32_16x16x32_bf16 v[224:227], v[72:75], v[32:35], v[224:227]
s_waitcnt lgkmcnt(6)
v_mfma_f32_16x16x32_bf16 v[232:235], v[72:75], v[36:39], v[232:235]
s_waitcnt lgkmcnt(4)
v_mfma_f32_16x16x32_bf16 v[240:243], v[72:75], v[40:43], v[240:243]
s_waitcnt lgkmcnt(2)
v_mfma_f32_16x16x32_bf16 v[248:251], v[72:75], v[44:47], v[248:251]
buffer_store_dwordx4 v[136:139], v1, s[44:47], s61 offen offset:1024 sc1
s_waitcnt vmcnt(13) lgkmcnt(0)
s_barrier
ds_read_b64_tr_b16 v[68:69], v20 offset:49152
ds_read_b64_tr_b16 v[70:71], v20 offset:50176
v_mfma_f32_16x16x32_bf16 v[228:231], v[76:79], v[32:35], v[228:231]
ds_read_b64_tr_b16 v[72:73], v21 offset:49152
v_mfma_f32_16x16x32_bf16 v[236:239], v[76:79], v[36:39], v[236:239]
ds_read_b64_tr_b16 v[74:75], v21 offset:50176
v_mfma_f32_16x16x32_bf16 v[244:247], v[76:79], v[40:43], v[244:247]
s_add_u32 m0, s65, 32768
s_mov_b32 s64, s54
s_add_u32 s54, s54, s67
ds_read_b128 v[48:51], v13 offset:0
v_mfma_f32_16x16x32_bf16 v[252:255], v[76:79], v[44:47], v[252:255]
buffer_load_dwordx4 v1, s[40:43], s64 offen sc1 lds
v_mfma_f32_16x16x32_bf16 v[160:163], v[80:83], v[32:35], v[160:163]
ds_read_b64_tr_b16 v[76:77], v22 offset:57344
v_mfma_f32_16x16x32_bf16 v[164:167], v[80:83], v[36:39], v[164:167]
ds_read_b64_tr_b16 v[78:79], v23 offset:57344
ds_read_b128 v[52:55], v13 offset:2048
v_mfma_f32_16x16x32_bf16 v[168:171], v[80:83], v[40:43], v[168:171]
v_mfma_f32_16x16x32_bf16 v[172:175], v[80:83], v[44:47], v[172:175]
s_add_u32 m0, s55, 32768
s_add_u32 s66, s25, 640
v_mfma_f32_16x16x32_bf16 v[176:179], v[32:35], v[84:87], v[176:179]
ds_read_b64_tr_b16 v[80:81], v22 offset:58368
buffer_load_dwordx4 v4, s[28:31], s66 offen offset:2048 lds
ds_read_b128 v[56:59], v13 offset:4096
v_mfma_f32_16x16x32_bf16 v[180:183], v[36:39], v[84:87], v[180:183]
ds_read_b64_tr_b16 v[82:83], v23 offset:58368
v_mfma_f32_16x16x32_bf16 v[184:187], v[40:43], v[84:87], v[184:187]
v_mfma_f32_16x16x32_bf16 v[188:191], v[44:47], v[84:87], v[188:191]
ds_read_b128 v[60:63], v13 offset:6144
v_mfma_f32_16x16x32_bf16 v[192:195], v[32:35], v[64:67], v[192:195]
ds_read_b64_tr_b16 v[84:85], v22 offset:59392
v_mfma_f32_16x16x32_bf16 v[196:199], v[36:39], v[64:67], v[196:199]
ds_read_b64_tr_b16 v[86:87], v23 offset:59392
buffer_load_dwordx4 v5, s[28:31], s66 offen offset:3072 lds
v_mfma_f32_16x16x32_bf16 v[200:203], v[40:43], v[64:67], v[200:203]
v_mfma_f32_16x16x32_bf16 v[204:207], v[44:47], v[64:67], v[204:207]
s_waitcnt lgkmcnt(9)
v_mfma_f32_16x16x32_bf16 v[224:227], v[68:71], v[48:51], v[224:227]
s_waitcnt lgkmcnt(6)
v_mfma_f32_16x16x32_bf16 v[232:235], v[68:71], v[52:55], v[232:235]
s_waitcnt lgkmcnt(4)
v_mfma_f32_16x16x32_bf16 v[240:243], v[68:71], v[56:59], v[240:243]
buffer_store_dwordx4 v[140:143], v1, s[44:47], s63 offen offset:1024 sc1
s_waitcnt lgkmcnt(2)
v_mfma_f32_16x16x32_bf16 v[248:251], v[68:71], v[60:63], v[248:251]
s_waitcnt vmcnt(10) lgkmcnt(0)
s_barrier
ds_read_b64_tr_b16 v[64:65], v20 offset:0
ds_read_b64_tr_b16 v[66:67], v20 offset:1024
v_mfma_f32_16x16x32_bf16 v[228:231], v[72:75], v[48:51], v[228:231]
ds_read_b64_tr_b16 v[68:69], v21 offset:0
v_mfma_f32_16x16x32_bf16 v[236:239], v[72:75], v[52:55], v[236:239]
ds_read_b64_tr_b16 v[70:71], v21 offset:1024
v_mfma_f32_16x16x32_bf16 v[244:247], v[72:75], v[56:59], v[244:247]
s_add_u32 m0, s65, 49152
s_mov_b32 s64, s54
s_add_u32 s54, s54, s67
ds_read_b128 v[32:35], v10 offset:0
v_mfma_f32_16x16x32_bf16 v[252:255], v[72:75], v[60:63], v[252:255]
buffer_load_dwordx4 v1, s[40:43], s64 offen sc1 lds
v_mfma_f32_16x16x32_bf16 v[160:163], v[76:79], v[48:51], v[160:163]
ds_read_b64_tr_b16 v[72:73], v22 offset:8192
v_mfma_f32_16x16x32_bf16 v[164:167], v[76:79], v[52:55], v[164:167]
ds_read_b64_tr_b16 v[74:75], v23 offset:8192
ds_read_b128 v[36:39], v10 offset:2048
v_mfma_f32_16x16x32_bf16 v[168:171], v[76:79], v[56:59], v[168:171]
s_add_u32 m0, s55, 65536
s_add_u32 s66, s25, 768
v_mfma_f32_16x16x32_bf16 v[172:175], v[76:79], v[60:63], v[172:175]
buffer_load_dwordx4 v2, s[28:31], s66 offen offset:0 lds
v_mfma_f32_16x16x32_bf16 v[176:179], v[48:51], v[80:83], v[176:179]
ds_read_b64_tr_b16 v[76:77], v22 offset:9216
ds_read_b128 v[40:43], v10 offset:4096
v_mfma_f32_16x16x32_bf16 v[180:183], v[52:55], v[80:83], v[180:183]
ds_read_b64_tr_b16 v[78:79], v23 offset:9216
v_mfma_f32_16x16x32_bf16 v[184:187], v[56:59], v[80:83], v[184:187]
v_mfma_f32_16x16x32_bf16 v[188:191], v[60:63], v[80:83], v[188:191]
buffer_load_dwordx4 v3, s[28:31], s66 offen offset:1024 lds
ds_read_b128 v[44:47], v10 offset:6144
v_mfma_f32_16x16x32_bf16 v[192:195], v[48:51], v[84:87], v[192:195]
ds_read_b64_tr_b16 v[80:81], v22 offset:10240
v_mfma_f32_16x16x32_bf16 v[196:199], v[52:55], v[84:87], v[196:199]
ds_read_b64_tr_b16 v[82:83], v23 offset:10240
v_mfma_f32_16x16x32_bf16 v[200:203], v[56:59], v[84:87], v[200:203]
v_mfma_f32_16x16x32_bf16 v[204:207], v[60:63], v[84:87], v[204:207]
buffer_store_dwordx4 v[144:147], v1, s[44:47], s61 offen offset:2048 sc1
s_waitcnt lgkmcnt(9)
v_mfma_f32_16x16x32_bf16 v[224:227], v[64:67], v[32:35], v[224:227]
s_waitcnt lgkmcnt(6)
v_mfma_f32_16x16x32_bf16 v[232:235], v[64:67], v[36:39], v[232:235]
s_waitcnt lgkmcnt(4)
v_mfma_f32_16x16x32_bf16 v[240:243], v[64:67], v[40:43], v[240:243]
s_waitcnt lgkmcnt(2)
v_mfma_f32_16x16x32_bf16 v[248:251], v[64:67], v[44:47], v[248:251]
buffer_store_dwordx4 v[148:151], v1, s[44:47], s63 offen offset:2048 sc1
s_waitcnt vmcnt(13) lgkmcnt(0)
s_barrier
ds_read_b64_tr_b16 v[84:85], v20 offset:16384
ds_read_b64_tr_b16 v[86:87], v20 offset:17408
v_mfma_f32_16x16x32_bf16 v[228:231], v[68:71], v[32:35], v[228:231]
ds_read_b64_tr_b16 v[64:65], v21 offset:16384
v_mfma_f32_16x16x32_bf16 v[236:239], v[68:71], v[36:39], v[236:239]
ds_read_b64_tr_b16 v[66:67], v21 offset:17408
v_mfma_f32_16x16x32_bf16 v[244:247], v[68:71], v[40:43], v[244:247]
s_add_u32 m0, s65, 0
s_mov_b32 s64, s54
s_add_u32 s54, s54, s67
ds_read_b128 v[48:51], v11 offset:0
v_mfma_f32_16x16x32_bf16 v[252:255], v[68:71], v[44:47], v[252:255]
buffer_load_dwordx4 v1, s[40:43], s64 offen sc1 lds
v_mfma_f32_16x16x32_bf16 v[160:163], v[72:75], v[32:35], v[160:163]
ds_read_b64_tr_b16 v[68:69], v22 offset:24576
v_mfma_f32_16x16x32_bf16 v[164:167], v[72:75], v[36:39], v[164:167]
ds_read_b64_tr_b16 v[70:71], v23 offset:24576
ds_read_b128 v[52:55], v11 offset:2048
v_mfma_f32_16x16x32_bf16 v[168:171], v[72:75], v[40:43], v[168:171]
v_mfma_f32_16x16x32_bf16 v[172:175], v[72:75], v[44:47], v[172:175]
s_add_u32 m0, s55, 65536
s_add_u32 s66, s25, 768
v_mfma_f32_16x16x32_bf16 v[176:179], v[32:35], v[76:79], v[176:179]
ds_read_b64_tr_b16 v[72:73], v22 offset:25600
buffer_load_dwordx4 v4, s[28:31], s66 offen offset:2048 lds
ds_read_b128 v[56:59], v11 offset:4096
v_mfma_f32_16x16x32_bf16 v[180:183], v[36:39], v[76:79], v[180:183]
ds_read_b64_tr_b16 v[74:75], v23 offset:25600
v_mfma_f32_16x16x32_bf16 v[184:187], v[40:43], v[76:79], v[184:187]
v_mfma_f32_16x16x32_bf16 v[188:191], v[44:47], v[76:79], v[188:191]
ds_read_b128 v[60:63], v11 offset:6144
v_mfma_f32_16x16x32_bf16 v[192:195], v[32:35], v[80:83], v[192:195]
ds_read_b64_tr_b16 v[76:77], v22 offset:26624
v_mfma_f32_16x16x32_bf16 v[196:199], v[36:39], v[80:83], v[196:199]
ds_read_b64_tr_b16 v[78:79], v23 offset:26624
buffer_load_dwordx4 v5, s[28:31], s66 offen offset:3072 lds
v_mfma_f32_16x16x32_bf16 v[200:203], v[40:43], v[80:83], v[200:203]
v_mfma_f32_16x16x32_bf16 v[204:207], v[44:47], v[80:83], v[204:207]
s_waitcnt lgkmcnt(9)
v_mfma_f32_16x16x32_bf16 v[224:227], v[84:87], v[48:51], v[224:227]
s_waitcnt lgkmcnt(6)
v_mfma_f32_16x16x32_bf16 v[232:235], v[84:87], v[52:55], v[232:235]
s_waitcnt lgkmcnt(4)
v_mfma_f32_16x16x32_bf16 v[240:243], v[84:87], v[56:59], v[240:243]
buffer_store_dwordx4 v[152:155], v1, s[44:47], s61 offen offset:3072 sc1
s_waitcnt lgkmcnt(2)
v_mfma_f32_16x16x32_bf16 v[248:251], v[84:87], v[60:63], v[248:251]
s_waitcnt vmcnt(10) lgkmcnt(0)
s_barrier
ds_read_b64_tr_b16 v[80:81], v20 offset:32768
ds_read_b64_tr_b16 v[82:83], v20 offset:33792
v_mfma_f32_16x16x32_bf16 v[228:231], v[64:67], v[48:51], v[228:231]
ds_read_b64_tr_b16 v[84:85], v21 offset:32768
v_mfma_f32_16x16x32_bf16 v[236:239], v[64:67], v[52:55], v[236:239]
ds_read_b64_tr_b16 v[86:87], v21 offset:33792
v_mfma_f32_16x16x32_bf16 v[244:247], v[64:67], v[56:59], v[244:247]
s_add_u32 m0, s65, 16384
s_mov_b32 s64, s54
s_add_u32 s54, s54, s67
ds_read_b128 v[32:35], v10 offset:32768
v_mfma_f32_16x16x32_bf16 v[252:255], v[64:67], v[60:63], v[252:255]
buffer_load_dwordx4 v1, s[40:43], s64 offen sc1 lds
v_mfma_f32_16x16x32_bf16 v[160:163], v[68:71], v[48:51], v[160:163]
ds_read_b64_tr_b16 v[64:65], v22 offset:40960
v_mfma_f32_16x16x32_bf16 v[164:167], v[68:71], v[52:55], v[164:167]
ds_read_b64_tr_b16 v[66:67], v23 offset:40960
ds_read_b128 v[36:39], v10 offset:34816
v_mfma_f32_16x16x32_bf16 v[168:171], v[68:71], v[56:59], v[168:171]
v_mfma_f32_16x16x32_bf16 v[172:175], v[68:71], v[60:63], v[172:175]
s_add_u32 m0, s55, 0
s_add_u32 s66, s25, 896
v_mfma_f32_16x16x32_bf16 v[176:179], v[48:51], v[72:75], v[176:179]
ds_read_b64_tr_b16 v[68:69], v22 offset:41984
buffer_load_dwordx4 v2, s[28:31], s66 offen offset:0 lds
ds_read_b128 v[40:43], v10 offset:36864
v_mfma_f32_16x16x32_bf16 v[180:183], v[52:55], v[72:75], v[180:183]
ds_read_b64_tr_b16 v[70:71], v23 offset:41984
v_mfma_f32_16x16x32_bf16 v[184:187], v[56:59], v[72:75], v[184:187]
v_mfma_f32_16x16x32_bf16 v[188:191], v[60:63], v[72:75], v[188:191]
ds_read_b128 v[44:47], v10 offset:38912
v_mfma_f32_16x16x32_bf16 v[192:195], v[48:51], v[76:79], v[192:195]
ds_read_b64_tr_b16 v[72:73], v22 offset:43008
v_mfma_f32_16x16x32_bf16 v[196:199], v[52:55], v[76:79], v[196:199]
ds_read_b64_tr_b16 v[74:75], v23 offset:43008
buffer_load_dwordx4 v3, s[28:31], s66 offen offset:1024 lds
v_mfma_f32_16x16x32_bf16 v[200:203], v[56:59], v[76:79], v[200:203]
v_mfma_f32_16x16x32_bf16 v[204:207], v[60:63], v[76:79], v[204:207]
s_waitcnt lgkmcnt(9)
v_mfma_f32_16x16x32_bf16 v[224:227], v[80:83], v[32:35], v[224:227]
s_waitcnt lgkmcnt(6)
v_mfma_f32_16x16x32_bf16 v[232:235], v[80:83], v[36:39], v[232:235]
s_waitcnt lgkmcnt(4)
v_mfma_f32_16x16x32_bf16 v[240:243], v[80:83], v[40:43], v[240:243]
buffer_store_dwordx4 v[156:159], v1, s[44:47], s63 offen offset:3072 sc1
s_waitcnt lgkmcnt(2)
v_mfma_f32_16x16x32_bf16 v[248:251], v[80:83], v[44:47], v[248:251]
s_waitcnt vmcnt(12) lgkmcnt(0)
s_barrier
ds_read_b64_tr_b16 v[76:77], v20 offset:49152
ds_read_b64_tr_b16 v[78:79], v20 offset:50176
v_mfma_f32_16x16x32_bf16 v[228:231], v[84:87], v[32:35], v[228:231]
ds_read_b64_tr_b16 v[80:81], v21 offset:49152
v_mfma_f32_16x16x32_bf16 v[236:239], v[84:87], v[36:39], v[236:239]
ds_read_b64_tr_b16 v[82:83], v21 offset:50176
v_mfma_f32_16x16x32_bf16 v[244:247], v[84:87], v[40:43], v[244:247]
ds_read_b128 v[48:51], v11 offset:32768
v_mfma_f32_16x16x32_bf16 v[252:255], v[84:87], v[44:47], v[252:255]
v_mfma_f32_16x16x32_bf16 v[160:163], v[64:67], v[32:35], v[160:163]
ds_read_b64_tr_b16 v[84:85], v22 offset:57344
s_add_u32 m0, s65, 32768
s_mov_b32 s64, s54
s_add_u32 s54, s54, s67
v_mfma_f32_16x16x32_bf16 v[164:167], v[64:67], v[36:39], v[164:167]
ds_read_b64_tr_b16 v[86:87], v23 offset:57344
buffer_load_dwordx4 v1, s[40:43], s64 offen sc1 lds
ds_read_b128 v[52:55], v11 offset:34816
v_mfma_f32_16x16x32_bf16 v[168:171], v[64:67], v[40:43], v[168:171]
v_mfma_f32_16x16x32_bf16 v[172:175], v[64:67], v[44:47], v[172:175]
v_mfma_f32_16x16x32_bf16 v[176:179], v[32:35], v[68:71], v[176:179]
ds_read_b64_tr_b16 v[64:65], v22 offset:58368
ds_read_b128 v[56:59], v11 offset:36864
v_mfma_f32_16x16x32_bf16 v[180:183], v[36:39], v[68:71], v[180:183]
ds_read_b64_tr_b16 v[66:67], v23 offset:58368
v_mfma_f32_16x16x32_bf16 v[184:187], v[40:43], v[68:71], v[184:187]
s_add_u32 m0, s55, 0
s_add_u32 s66, s25, 896
v_mfma_f32_16x16x32_bf16 v[188:191], v[44:47], v[68:71], v[188:191]
buffer_load_dwordx4 v4, s[28:31], s66 offen offset:2048 lds
ds_read_b128 v[60:63], v11 offset:38912
v_mfma_f32_16x16x32_bf16 v[192:195], v[32:35], v[72:75], v[192:195]
ds_read_b64_tr_b16 v[68:69], v22 offset:59392
v_mfma_f32_16x16x32_bf16 v[196:199], v[36:39], v[72:75], v[196:199]
ds_read_b64_tr_b16 v[70:71], v23 offset:59392
v_mfma_f32_16x16x32_bf16 v[200:203], v[40:43], v[72:75], v[200:203]
v_mfma_f32_16x16x32_bf16 v[204:207], v[44:47], v[72:75], v[204:207]
s_waitcnt lgkmcnt(9)
v_mfma_f32_16x16x32_bf16 v[224:227], v[76:79], v[48:51], v[224:227]
s_waitcnt lgkmcnt(6)
v_mfma_f32_16x16x32_bf16 v[232:235], v[76:79], v[52:55], v[232:235]
s_waitcnt lgkmcnt(4)
v_mfma_f32_16x16x32_bf16 v[240:243], v[76:79], v[56:59], v[240:243]
buffer_load_dwordx4 v5, s[28:31], s66 offen offset:3072 lds
s_waitcnt lgkmcnt(2)
v_mfma_f32_16x16x32_bf16 v[248:251], v[76:79], v[60:63], v[248:251]
s_waitcnt vmcnt(8) lgkmcnt(0)
s_barrier
ds_read_b64_tr_b16 v[72:73], v20 offset:0
ds_read_b64_tr_b16 v[74:75], v20 offset:1024
v_mfma_f32_16x16x32_bf16 v[228:231], v[80:83], v[48:51], v[228:231]
ds_read_b64_tr_b16 v[76:77], v21 offset:0
v_mfma_f32_16x16x32_bf16 v[236:239], v[80:83], v[52:55], v[236:239]
ds_read_b64_tr_b16 v[78:79], v21 offset:1024
v_mfma_f32_16x16x32_bf16 v[244:247], v[80:83], v[56:59], v[244:247]
ds_read_b128 v[32:35], v12 offset:0
v_mfma_f32_16x16x32_bf16 v[252:255], v[80:83], v[60:63], v[252:255]
v_mfma_f32_16x16x32_bf16 v[160:163], v[84:87], v[48:51], v[160:163]
ds_read_b64_tr_b16 v[80:81], v22 offset:8192
v_mfma_f32_16x16x32_bf16 v[164:167], v[84:87], v[52:55], v[164:167]
ds_read_b64_tr_b16 v[82:83], v23 offset:8192
ds_read_b128 v[36:39], v12 offset:2048
v_mfma_f32_16x16x32_bf16 v[168:171], v[84:87], v[56:59], v[168:171]
v_mfma_f32_16x16x32_bf16 v[172:175], v[84:87], v[60:63], v[172:175]
v_mfma_f32_16x16x32_bf16 v[176:179], v[48:51], v[64:67], v[176:179]
ds_read_b64_tr_b16 v[84:85], v22 offset:9216
ds_read_b128 v[40:43], v12 offset:4096
v_mfma_f32_16x16x32_bf16 v[180:183], v[52:55], v[64:67], v[180:183]
ds_read_b64_tr_b16 v[86:87], v23 offset:9216
v_mfma_f32_16x16x32_bf16 v[184:187], v[56:59], v[64:67], v[184:187]
v_mfma_f32_16x16x32_bf16 v[188:191], v[60:63], v[64:67], v[188:191]
ds_read_b128 v[44:47], v12 offset:6144
v_mfma_f32_16x16x32_bf16 v[192:195], v[48:51], v[68:71], v[192:195]
ds_read_b64_tr_b16 v[64:65], v22 offset:10240
v_mfma_f32_16x16x32_bf16 v[196:199], v[52:55], v[68:71], v[196:199]
ds_read_b64_tr_b16 v[66:67], v23 offset:10240
v_mfma_f32_16x16x32_bf16 v[200:203], v[56:59], v[68:71], v[200:203]
s_add_u32 m0, s65, 49152
s_mov_b32 s64, s54
s_add_u32 s54, s54, s67
v_mfma_f32_16x16x32_bf16 v[204:207], v[60:63], v[68:71], v[204:207]
buffer_load_dwordx4 v1, s[40:43], s64 offen sc1 lds
s_waitcnt lgkmcnt(9)
v_mfma_f32_16x16x32_bf16 v[224:227], v[72:75], v[32:35], v[224:227]
s_waitcnt lgkmcnt(6)
v_mfma_f32_16x16x32_bf16 v[232:235], v[72:75], v[36:39], v[232:235]
s_waitcnt lgkmcnt(4)
v_mfma_f32_16x16x32_bf16 v[240:243], v[72:75], v[40:43], v[240:243]
s_waitcnt lgkmcnt(2)
v_mfma_f32_16x16x32_bf16 v[248:251], v[72:75], v[44:47], v[248:251]
s_waitcnt vmcnt(4) lgkmcnt(0)
s_barrier
ds_read_b64_tr_b16 v[68:69], v20 offset:16384
ds_read_b64_tr_b16 v[70:71], v20 offset:17408
v_mfma_f32_16x16x32_bf16 v[228:231], v[76:79], v[32:35], v[228:231]
ds_read_b64_tr_b16 v[72:73], v21 offset:16384
v_mfma_f32_16x16x32_bf16 v[236:239], v[76:79], v[36:39], v[236:239]
ds_read_b64_tr_b16 v[74:75], v21 offset:17408
v_mfma_f32_16x16x32_bf16 v[244:247], v[76:79], v[40:43], v[244:247]
ds_read_b128 v[48:51], v13 offset:0
v_mfma_f32_16x16x32_bf16 v[252:255], v[76:79], v[44:47], v[252:255]
v_mfma_f32_16x16x32_bf16 v[160:163], v[80:83], v[32:35], v[160:163]
ds_read_b64_tr_b16 v[76:77], v22 offset:24576
v_mfma_f32_16x16x32_bf16 v[164:167], v[80:83], v[36:39], v[164:167]
ds_read_b64_tr_b16 v[78:79], v23 offset:24576
ds_read_b128 v[52:55], v13 offset:2048
v_mfma_f32_16x16x32_bf16 v[168:171], v[80:83], v[40:43], v[168:171]
v_mfma_f32_16x16x32_bf16 v[172:175], v[80:83], v[44:47], v[172:175]
v_mfma_f32_16x16x32_bf16 v[176:179], v[32:35], v[84:87], v[176:179]
ds_read_b64_tr_b16 v[80:81], v22 offset:25600
ds_read_b128 v[56:59], v13 offset:4096
v_mfma_f32_16x16x32_bf16 v[180:183], v[36:39], v[84:87], v[180:183]
ds_read_b64_tr_b16 v[82:83], v23 offset:25600
v_mfma_f32_16x16x32_bf16 v[184:187], v[40:43], v[84:87], v[184:187]
v_mfma_f32_16x16x32_bf16 v[188:191], v[44:47], v[84:87], v[188:191]
ds_read_b128 v[60:63], v13 offset:6144
v_mfma_f32_16x16x32_bf16 v[192:195], v[32:35], v[64:67], v[192:195]
ds_read_b64_tr_b16 v[84:85], v22 offset:26624
v_mfma_f32_16x16x32_bf16 v[196:199], v[36:39], v[64:67], v[196:199]
ds_read_b64_tr_b16 v[86:87], v23 offset:26624
v_mfma_f32_16x16x32_bf16 v[200:203], v[40:43], v[64:67], v[200:203]
v_mfma_f32_16x16x32_bf16 v[204:207], v[44:47], v[64:67], v[204:207]
s_waitcnt lgkmcnt(9)
v_mfma_f32_16x16x32_bf16 v[224:227], v[68:71], v[48:51], v[224:227]
s_waitcnt lgkmcnt(6)
v_mfma_f32_16x16x32_bf16 v[232:235], v[68:71], v[52:55], v[232:235]
s_waitcnt lgkmcnt(4)
v_mfma_f32_16x16x32_bf16 v[240:243], v[68:71], v[56:59], v[240:243]
s_waitcnt lgkmcnt(2)
v_mfma_f32_16x16x32_bf16 v[248:251], v[68:71], v[60:63], v[248:251]
s_waitcnt vmcnt(1) lgkmcnt(0)
s_barrier
ds_read_b64_tr_b16 v[64:65], v20 offset:32768
ds_read_b64_tr_b16 v[66:67], v20 offset:33792
v_mfma_f32_16x16x32_bf16 v[228:231], v[72:75], v[48:51], v[228:231]
ds_read_b64_tr_b16 v[68:69], v21 offset:32768
s_lshl_b32 s4, s21, 1
s_sub_u32 s25, 32, s4
v_mfma_f32_16x16x32_bf16 v[236:239], v[72:75], v[52:55], v[236:239]
ds_read_b64_tr_b16 v[70:71], v21 offset:33792
s_lshl_b32 s4, s21, 2
v_mfma_f32_16x16x32_bf16 v[244:247], v[72:75], v[56:59], v[244:247]
s_add_u32 s5, s4, 3
s_sub_u32 s24, s5, s22
ds_read_b128 v[32:35], v10 offset:0
v_mfma_f32_16x16x32_bf16 v[252:255], v[72:75], v[60:63], v[252:255]
s_lshl_b32 s7, s20, 19
s_mov_b32 s38, 98304
v_mfma_f32_16x16x32_bf16 v[160:163], v[76:79], v[48:51], v[160:163]
ds_read_b64_tr_b16 v[72:73], v22 offset:40960
s_mov_b32 s27, 1
s_mov_b32 s26, s24
v_mfma_f32_16x16x32_bf16 v[164:167], v[76:79], v[52:55], v[164:167]
ds_read_b64_tr_b16 v[74:75], v23 offset:40960
s_mov_b32 s48, 0
s_lshl_b32 s12, s22, 13
ds_read_b128 v[36:39], v10 offset:2048
v_mfma_f32_16x16x32_bf16 v[168:171], v[76:79], v[56:59], v[168:171]
s_sub_u32 s12, 57344, s12
v_mfma_f32_16x16x32_bf16 v[172:175], v[76:79], v[60:63], v[172:175]
v_lshrrev_b32 v27, 4, v0
v_lshlrev_b32 v27, 2, v27
v_mfma_f32_16x16x32_bf16 v[176:179], v[48:51], v[80:83], v[176:179]
ds_read_b64_tr_b16 v[76:77], v22 offset:41984
v_and_b32 v28, 15, v0
ds_read_b128 v[40:43], v10 offset:4096
v_mfma_f32_16x16x32_bf16 v[180:183], v[52:55], v[80:83], v[180:183]
ds_read_b64_tr_b16 v[78:79], v23 offset:41984
v_cmp_gt_u32 s[52:53], v27, v28
v_mfma_f32_16x16x32_bf16 v[184:187], v[56:59], v[80:83], v[184:187]
v_add_u32 v27, 1, v27
v_mfma_f32_16x16x32_bf16 v[188:191], v[60:63], v[80:83], v[188:191]
v_cmp_gt_u32 s[54:55], v27, v28
ds_read_b128 v[44:47], v10 offset:6144
v_mfma_f32_16x16x32_bf16 v[192:195], v[48:51], v[84:87], v[192:195]
ds_read_b64_tr_b16 v[80:81], v22 offset:43008
v_add_u32 v27, 1, v27
v_mfma_f32_16x16x32_bf16 v[196:199], v[52:55], v[84:87], v[196:199]
ds_read_b64_tr_b16 v[82:83], v23 offset:43008
v_cmp_gt_u32 s[56:57], v27, v28
v_mfma_f32_16x16x32_bf16 v[200:203], v[56:59], v[84:87], v[200:203]
v_add_u32 v27, 1, v27
v_mfma_f32_16x16x32_bf16 v[204:207], v[60:63], v[84:87], v[204:207]
v_cmp_gt_u32 s[58:59], v27, v28
buffer_load_dword v30, v9, s[44:47], s51 offen sc1
s_waitcnt lgkmcnt(9)
v_mfma_f32_16x16x32_bf16 v[224:227], v[64:67], v[32:35], v[224:227]
v_add_u32 v27, 1, v27
s_waitcnt lgkmcnt(6)
v_mfma_f32_16x16x32_bf16 v[232:235], v[64:67], v[36:39], v[232:235]
s_mov_b32 s70, 0x3e0293ee
s_mov_b32 s71, s70
s_waitcnt lgkmcnt(4)
v_mfma_f32_16x16x32_bf16 v[240:243], v[64:67], v[40:43], v[240:243]
s_lshl_b32 s64, s22, 14
s_add_u32 s64, s64, 32768
s_waitcnt lgkmcnt(2)
v_mfma_f32_16x16x32_bf16 v[248:251], v[64:67], v[44:47], v[248:251]
v_add_u32 v24, s64, v1
s_mov_b32 s72, 0x3fb8aa3b
s_mov_b32 s73, s72
s_lshl_b32 s74, s21, 1
s_sub_u32 s75, 30, s74
s_sub_u32 s74, s74, 2
s_cmp_lt_u32 s22, 2
s_cselect_b32 s74, s75, s74
s_add_u32 s74, s74, s22
s_lshl_b32 s49, s74, 16
s_lshl_b32 s75, s20, 11
s_add_u32 s49, s49, s75
s_add_u32 s49, s49, 83886080
s_lshl_b32 s75, s74, 10
s_add_u32 s75, s75, 87031808
s_cmp_eq_u32 s20, 0
s_cselect_b32 s75, s75, 268435456
v_add_u32 v26, s75, v1
s_mov_b32 s74, 0x358637bd
s_mov_b32 s75, s74
s_waitcnt vmcnt(1) lgkmcnt(0)
s_barrier
ds_read_b64_tr_b16 v[84:85], v20 offset:49152
ds_read_b64_tr_b16 v[86:87], v20 offset:50176
s_waitcnt vmcnt(0)
v_cmp_eq_u32 vcc, 1, v30
s_and_b32 s64, vcc_lo, 0xff
s_cmp_eq_u32 s64, 0xff
s_cbranch_scc1 L_kk_kernel_c1_fok
s_mov_b32 s66, 0x20000
L_kk_kernel_c1_fspin:
s_sleep 8
buffer_load_dword v30, v9, s[44:47], s51 offen sc1
s_waitcnt vmcnt(0)
v_cmp_eq_u32 vcc, 1, v30
s_and_b32 s64, vcc_lo, 0xff
s_cmp_eq_u32 s64, 0xff
s_cbranch_scc1 L_kk_kernel_c1_fok
s_sub_u32 s66, s66, 1
s_cmp_lg_u32 s66, 0
s_cbranch_scc1 L_kk_kernel_c1_fspin
L_kk_kernel_c1_fok:
v_mfma_f32_16x16x32_bf16 v[228:231], v[68:71], v[32:35], v[228:231]
ds_read_b64_tr_b16 v[64:65], v21 offset:49152
s_mov_b32 m0, s14
s_nop 0
buffer_load_dwordx4 v1, s[32:35], s36 offen offset:0 sc1 lds
v_mfma_f32_16x16x32_bf16 v[236:239], v[68:71], v[36:39], v[236:239]
ds_read_b64_tr_b16 v[66:67], v21 offset:50176
v_mfma_f32_16x16x32_bf16 v[244:247], v[68:71], v[40:43], v[244:247]
buffer_load_dwordx4 v1, s[32:35], s36 offen offset:1024 sc1 lds
ds_read_b128 v[48:51], v11 offset:0
v_mfma_f32_16x16x32_bf16 v[252:255], v[68:71], v[44:47], v[252:255]
buffer_load_dwordx4 v1, s[32:35], s36 offen offset:2048 sc1 lds
v_mfma_f32_16x16x32_bf16 v[160:163], v[72:75], v[32:35], v[160:163]
ds_read_b64_tr_b16 v[68:69], v22 offset:57344
buffer_load_dwordx4 v1, s[32:35], s36 offen offset:3072 sc1 lds
s_add_u32 m0, s14, 16384
v_mfma_f32_16x16x32_bf16 v[164:167], v[72:75], v[36:39], v[164:167]
ds_read_b64_tr_b16 v[70:71], v23 offset:57344
buffer_load_dwordx4 v1, s[32:35], s13 offen offset:0 sc1 lds
ds_read_b128 v[52:55], v11 offset:2048
v_mfma_f32_16x16x32_bf16 v[168:171], v[72:75], v[40:43], v[168:171]
v_mfma_f32_16x16x32_bf16 v[172:175], v[72:75], v[44:47], v[172:175]
buffer_load_dwordx4 v1, s[32:35], s13 offen offset:1024 sc1 lds
v_mfma_f32_16x16x32_bf16 v[176:179], v[32:35], v[76:79], v[176:179]
ds_read_b64_tr_b16 v[72:73], v22 offset:58368
buffer_load_dwordx4 v1, s[32:35], s13 offen offset:2048 sc1 lds
ds_read_b128 v[56:59], v11 offset:4096
v_mfma_f32_16x16x32_bf16 v[180:183], v[36:39], v[76:79], v[180:183]
ds_read_b64_tr_b16 v[74:75], v23 offset:58368
buffer_load_dwordx4 v1, s[32:35], s13 offen offset:3072 sc1 lds
s_add_u32 s36, s36, 16384
s_add_u32 s37, s37, 16384
s_mov_b32 m0, s15
v_mfma_f32_16x16x32_bf16 v[184:187], v[40:43], v[76:79], v[184:187]
buffer_load_dwordx4 v1, s[32:35], s36 offen offset:0 sc1 lds
v_mfma_f32_16x16x32_bf16 v[188:191], v[44:47], v[76:79], v[188:191]
ds_read_b128 v[60:63], v11 offset:6144
v_mfma_f32_16x16x32_bf16 v[192:195], v[32:35], v[80:83], v[192:195]
ds_read_b64_tr_b16 v[76:77], v22 offset:59392
buffer_load_dwordx4 v1, s[32:35], s36 offen offset:1024 sc1 lds
v_mfma_f32_16x16x32_bf16 v[196:199], v[36:39], v[80:83], v[196:199]
ds_read_b64_tr_b16 v[78:79], v23 offset:59392
buffer_load_dwordx4 v1, s[32:35], s36 offen offset:2048 sc1 lds
v_mfma_f32_16x16x32_bf16 v[200:203], v[40:43], v[80:83], v[200:203]
buffer_load_dwordx4 v1, s[32:35], s36 offen offset:3072 sc1 lds
s_add_u32 m0, s15, 16384
v_mfma_f32_16x16x32_bf16 v[204:207], v[44:47], v[80:83], v[204:207]
buffer_load_dwordx4 v1, s[32:35], s37 offen offset:0 sc1 lds
s_waitcnt lgkmcnt(9)
v_mfma_f32_16x16x32_bf16 v[224:227], v[84:87], v[48:51], v[224:227]
s_waitcnt lgkmcnt(6)
v_mfma_f32_16x16x32_bf16 v[232:235], v[84:87], v[52:55], v[232:235]
buffer_load_dwordx4 v1, s[32:35], s37 offen offset:1024 sc1 lds
s_waitcnt lgkmcnt(4)
v_mfma_f32_16x16x32_bf16 v[240:243], v[84:87], v[56:59], v[240:243]
buffer_load_dwordx4 v1, s[32:35], s37 offen offset:2048 sc1 lds
s_waitcnt lgkmcnt(2)
v_mfma_f32_16x16x32_bf16 v[248:251], v[84:87], v[60:63], v[248:251]
buffer_load_dwordx4 v1, s[32:35], s37 offen offset:3072 sc1 lds
s_add_u32 s36, s36, 16384
s_add_u32 s37, s37, 16384
s_waitcnt lgkmcnt(0)
s_barrier
v_mfma_f32_16x16x32_bf16 v[228:231], v[64:67], v[48:51], v[228:231]
v_mfma_f32_16x16x32_bf16 v[236:239], v[64:67], v[52:55], v[236:239]
v_mfma_f32_16x16x32_bf16 v[244:247], v[64:67], v[56:59], v[244:247]
v_mfma_f32_16x16x32_bf16 v[252:255], v[64:67], v[60:63], v[252:255]
v_mfma_f32_16x16x32_bf16 v[160:163], v[68:71], v[48:51], v[160:163]
v_mfma_f32_16x16x32_bf16 v[164:167], v[68:71], v[52:55], v[164:167]
v_mfma_f32_16x16x32_bf16 v[168:171], v[68:71], v[56:59], v[168:171]
v_mfma_f32_16x16x32_bf16 v[172:175], v[68:71], v[60:63], v[172:175]
v_mfma_f32_16x16x32_bf16 v[176:179], v[48:51], v[72:75], v[176:179]
v_mfma_f32_16x16x32_bf16 v[180:183], v[52:55], v[72:75], v[180:183]
v_mfma_f32_16x16x32_bf16 v[184:187], v[56:59], v[72:75], v[184:187]
v_mfma_f32_16x16x32_bf16 v[188:191], v[60:63], v[72:75], v[188:191]
v_mfma_f32_16x16x32_bf16 v[192:195], v[48:51], v[76:79], v[192:195]
v_mfma_f32_16x16x32_bf16 v[196:199], v[52:55], v[76:79], v[196:199]
v_mfma_f32_16x16x32_bf16 v[200:203], v[56:59], v[76:79], v[200:203]
v_mfma_f32_16x16x32_bf16 v[204:207], v[60:63], v[76:79], v[204:207]
v_pk_mul_f32 v[224:225], v[224:225], s[70:71]
v_pk_mul_f32 v[226:227], v[226:227], s[70:71]
v_pk_mul_f32 v[228:229], v[228:229], s[70:71]
v_pk_mul_f32 v[230:231], v[230:231], s[70:71]
v_cvt_pk_bf16_f32 v224, v224, v225
v_cvt_pk_bf16_f32 v225, v226, v227
v_cvt_pk_bf16_f32 v226, v228, v229
v_cvt_pk_bf16_f32 v227, v230, v231
ds_write_b128 v24, v[224:227] offset:3072
v_pk_mul_f32 v[232:233], v[232:233], s[70:71]
v_pk_mul_f32 v[234:235], v[234:235], s[70:71]
v_pk_mul_f32 v[236:237], v[236:237], s[70:71]
v_pk_mul_f32 v[238:239], v[238:239], s[70:71]
v_cvt_pk_bf16_f32 v232, v232, v233
v_cvt_pk_bf16_f32 v233, v234, v235
v_cvt_pk_bf16_f32 v234, v236, v237
v_cvt_pk_bf16_f32 v235, v238, v239
ds_write_b128 v24, v[232:235] offset:7168
v_pk_mul_f32 v[240:241], v[240:241], s[70:71]
v_pk_mul_f32 v[242:243], v[242:243], s[70:71]
v_pk_mul_f32 v[244:245], v[244:245], s[70:71]
v_pk_mul_f32 v[246:247], v[246:247], s[70:71]
v_cvt_pk_bf16_f32 v240, v240, v241
v_cvt_pk_bf16_f32 v241, v242, v243
v_cvt_pk_bf16_f32 v242, v244, v245
v_cvt_pk_bf16_f32 v243, v246, v247
ds_write_b128 v24, v[240:243] offset:11264
v_pk_mul_f32 v[248:249], v[248:249], s[70:71]
v_pk_mul_f32 v[250:251], v[250:251], s[70:71]
v_pk_mul_f32 v[252:253], v[252:253], s[70:71]
v_pk_mul_f32 v[254:255], v[254:255], s[70:71]
v_cvt_pk_bf16_f32 v248, v248, v249
v_cvt_pk_bf16_f32 v249, v250, v251
v_cvt_pk_bf16_f32 v250, v252, v253
v_cvt_pk_bf16_f32 v251, v254, v255
ds_write_b128 v24, v[248:251] offset:15360
v_pk_mul_f32 v[96:97], v[176:177], s[72:73]
v_pk_mul_f32 v[98:99], v[178:179], s[72:73]
v_pk_mul_f32 v[100:101], v[180:181], s[72:73]
v_pk_mul_f32 v[102:103], v[182:183], s[72:73]
v_pk_mul_f32 v[104:105], v[184:185], s[72:73]
v_pk_mul_f32 v[106:107], v[186:187], s[72:73]
v_pk_mul_f32 v[108:109], v[188:189], s[72:73]
v_pk_mul_f32 v[110:111], v[190:191], s[72:73]
v_exp_f32 v96, v96
v_exp_f32 v97, v97
v_exp_f32 v98, v98
v_exp_f32 v99, v99
v_exp_f32 v100, v100
v_exp_f32 v101, v101
v_exp_f32 v102, v102
v_exp_f32 v103, v103
v_exp_f32 v104, v104
v_exp_f32 v105, v105
v_exp_f32 v106, v106
v_exp_f32 v107, v107
v_exp_f32 v108, v108
v_exp_f32 v109, v109
v_exp_f32 v110, v110
v_exp_f32 v111, v111
v_pk_add_f32 v[176:177], v[176:177], 1.0 op_sel_hi:[1,0]
v_pk_add_f32 v[178:179], v[178:179], 1.0 op_sel_hi:[1,0]
v_pk_add_f32 v[180:181], v[180:181], 1.0 op_sel_hi:[1,0]
v_pk_add_f32 v[182:183], v[182:183], 1.0 op_sel_hi:[1,0]
v_pk_add_f32 v[184:185], v[184:185], 1.0 op_sel_hi:[1,0]
v_pk_add_f32 v[186:187], v[186:187], 1.0 op_sel_hi:[1,0]
v_pk_add_f32 v[188:189], v[188:189], 1.0 op_sel_hi:[1,0]
v_pk_add_f32 v[190:191], v[190:191], 1.0 op_sel_hi:[1,0]
v_med3_f32 v176, v96, v176, 1.0
v_med3_f32 v177, v97, v177, 1.0
v_med3_f32 v178, v98, v178, 1.0
v_med3_f32 v179, v99, v179, 1.0
v_med3_f32 v180, v100, v180, 1.0
v_med3_f32 v181, v101, v181, 1.0
v_med3_f32 v182, v102, v182, 1.0
v_med3_f32 v183, v103, v183, 1.0
v_med3_f32 v184, v104, v184, 1.0
v_med3_f32 v185, v105, v185, 1.0
v_med3_f32 v186, v106, v186, 1.0
v_med3_f32 v187, v107, v187, 1.0
v_med3_f32 v188, v108, v188, 1.0
v_med3_f32 v189, v109, v189, 1.0
v_med3_f32 v190, v110, v190, 1.0
v_med3_f32 v191, v111, v191, 1.0
v_pk_add_f32 v[176:177], v[176:177], s[74:75]
v_pk_add_f32 v[178:179], v[178:179], s[74:75]
v_pk_add_f32 v[180:181], v[180:181], s[74:75]
v_pk_add_f32 v[182:183], v[182:183], s[74:75]
v_pk_add_f32 v[184:185], v[184:185], s[74:75]
v_pk_add_f32 v[186:187], v[186:187], s[74:75]
v_pk_add_f32 v[188:189], v[188:189], s[74:75]
v_pk_add_f32 v[190:191], v[190:191], s[74:75]
v_cvt_pk_bf16_f32 v176, v176, v177
v_cvt_pk_bf16_f32 v177, v178, v179
v_cvt_pk_bf16_f32 v178, v180, v181
v_cvt_pk_bf16_f32 v179, v182, v183
v_cvt_pk_bf16_f32 v180, v184, v185
v_cvt_pk_bf16_f32 v181, v186, v187
v_cvt_pk_bf16_f32 v182, v188, v189
v_cvt_pk_bf16_f32 v183, v190, v191
v_cvt_pk_bf16_f32 v192, v192, v193
v_cvt_pk_bf16_f32 v193, v194, v195
v_cvt_pk_bf16_f32 v194, v196, v197
v_cvt_pk_bf16_f32 v195, v198, v199
v_cvt_pk_bf16_f32 v196, v200, v201
v_cvt_pk_bf16_f32 v197, v202, v203
v_cvt_pk_bf16_f32 v198, v204, v205
v_cvt_pk_bf16_f32 v199, v206, v207
v_mov_b32 v252, 0x3f803f80
v_mov_b32 v253, 0x3f803f80
v_mov_b32 v254, 0x3f803f80
v_mov_b32 v255, 0x3f803f80
v_mfma_f32_16x16x32_bf16 v[112:115], v[176:179], v[192:195], 0
s_nop 0
v_mfma_f32_16x16x32_bf16 v[116:119], v[176:179], v[252:255], 0
v_mfma_f32_16x16x32_bf16 v[112:115], v[180:183], v[196:199], v[112:115]
v_mfma_f32_16x16x32_bf16 v[116:119], v[180:183], v[252:255], v[116:119]
s_lshl_b32 s64, s22, 11
v_add_u32 v25, s64, v1
s_nop 4
ds_write_b128 v25, v[112:115] offset:1024
ds_write_b128 v25, v[116:119] offset:2048
s_waitcnt vmcnt(8) lgkmcnt(0)
s_barrier
s_setprio 1
v_add_u32 v3, s12, v1
v_add_u32 v2, 98304, v1
ds_read_b128 v[16:19], v3 offset:32768
ds_read_b128 v[32:35], v3 offset:36864
ds_read_b128 v[208:211], v2 offset:16384
ds_read_b128 v[20:23], v3 offset:33792
ds_read_b128 v[36:39], v3 offset:37888
ds_read_b128 v[212:215], v2 offset:17408
ds_read_b128 v[24:27], v3 offset:34816
ds_read_b128 v[40:43], v3 offset:38912
ds_read_b128 v[216:219], v2 offset:18432
ds_read_b128 v[28:31], v3 offset:35840
ds_read_b128 v[44:47], v3 offset:39936
ds_read_b128 v[220:223], v2 offset:19456
ds_read_b128 v[224:227], v2 offset:20480
ds_read_b128 v[228:231], v2 offset:21504
ds_read_b128 v[232:235], v2 offset:22528
ds_read_b128 v[236:239], v2 offset:23552
s_lshr_b32 s12, s12, 6
v_and_b32 v9, 15, v0
v_lshl_add_u32 v10, v9, 2, s12
ds_read_b128 v[64:67], v1 offset:1024
ds_read_b128 v[68:71], v1 offset:2048
ds_read_b128 v[72:75], v1 offset:3072
ds_read_b128 v[76:79], v1 offset:4096
ds_read_b128 v[80:83], v1 offset:5120
ds_read_b128 v[84:87], v1 offset:6144
ds_read_b128 v[88:91], v1 offset:7168
ds_read_b128 v[92:95], v1 offset:8192
v_mov_b32 v240, 0xff800000
s_waitcnt lgkmcnt(15)
v_mfma_f32_16x16x32_bf16 v[128:131], v[208:211], v[16:19], 0
v_mfma_f32_16x16x32_bf16 v[136:139], v[208:211], v[32:35], 0
v_mfma_f32_16x16x32_bf16 v[128:131], v[212:215], v[20:23], v[128:131]
v_mfma_f32_16x16x32_bf16 v[136:139], v[212:215], v[36:39], v[136:139]
v_mfma_f32_16x16x32_bf16 v[128:131], v[216:219], v[24:27], v[128:131]
v_mfma_f32_16x16x32_bf16 v[136:139], v[216:219], v[40:43], v[136:139]
s_waitcnt lgkmcnt(12)
v_mfma_f32_16x16x32_bf16 v[128:131], v[220:223], v[28:31], v[128:131]
v_mfma_f32_16x16x32_bf16 v[136:139], v[220:223], v[44:47], v[136:139]
s_waitcnt lgkmcnt(11)
v_mfma_f32_16x16x32_bf16 v[132:135], v[224:227], v[16:19], 0
ds_read_b128 v[176:179], v2 offset:0
v_mfma_f32_16x16x32_bf16 v[140:143], v[224:227], v[32:35], 0
ds_read_b128 v[180:183], v2 offset:1024
s_waitcnt lgkmcnt(12)
v_mfma_f32_16x16x32_bf16 v[132:135], v[228:231], v[20:23], v[132:135]
ds_read_b128 v[184:187], v2 offset:2048
v_mfma_f32_16x16x32_bf16 v[140:143], v[228:231], v[36:39], v[140:143]
ds_read_b128 v[188:191], v2 offset:3072
s_waitcnt lgkmcnt(13)
v_mfma_f32_16x16x32_bf16 v[132:135], v[232:235], v[24:27], v[132:135]
ds_read_b128 v[192:195], v2 offset:4096
v_mfma_f32_16x16x32_bf16 v[140:143], v[232:235], v[40:43], v[140:143]
ds_read_b128 v[196:199], v2 offset:5120
s_waitcnt lgkmcnt(14)
v_mfma_f32_16x16x32_bf16 v[132:135], v[236:239], v[28:31], v[132:135]
ds_read_b128 v[200:203], v2 offset:6144
v_mfma_f32_16x16x32_bf16 v[140:143], v[236:239], v[44:47], v[140:143]
ds_read_b128 v[204:207], v2 offset:7168
s_waitcnt vmcnt(0) lgkmcnt(8)
s_barrier
s_add_u32 s14, s39, 0
s_mov_b32 m0, s14
s_nop 0
buffer_load_dwordx4 v1, s[32:35], s36 offen offset:0 sc1 lds
buffer_load_dwordx4 v1, s[32:35], s36 offen offset:1024 sc1 lds
buffer_load_dwordx4 v1, s[32:35], s36 offen offset:2048 sc1 lds
buffer_load_dwordx4 v1, s[32:35], s36 offen offset:3072 sc1 lds
s_add_u32 m0, s14, 16384
s_nop 0
buffer_load_dwordx4 v1, s[32:35], s37 offen offset:0 sc1 lds
buffer_load_dwordx4 v1, s[32:35], s37 offen offset:1024 sc1 lds
buffer_load_dwordx4 v1, s[32:35], s37 offen offset:2048 sc1 lds
buffer_load_dwordx4 v1, s[32:35], s37 offen offset:3072 sc1 lds
s_add_u32 s36, s36, 16384
s_add_u32 s37, s37, 16384
v_add_f32 v64, v64, v72
v_add_f32 v65, v65, v73
v_add_f32 v66, v66, v74
v_add_f32 v67, v67, v75
v_add_f32 v68, v68, v76
v_add_f32 v69, v69, v77
v_add_f32 v70, v70, v78
v_add_f32 v71, v71, v79
v_add_f32 v64, v64, v80
v_add_f32 v65, v65, v81
v_add_f32 v66, v66, v82
v_add_f32 v67, v67, v83
v_add_f32 v68, v68, v84
v_add_f32 v69, v69, v85
v_add_f32 v70, v70, v86
v_add_f32 v71, v71, v87
v_add_f32 v64, v64, v88
v_add_f32 v65, v65, v89
v_add_f32 v66, v66, v90
v_add_f32 v67, v67, v91
v_add_f32 v68, v68, v92
v_add_f32 v69, v69, v93
v_add_f32 v70, v70, v94
v_add_f32 v71, v71, v95
s_lshl_b32 s64, s21, 11
s_add_u32 s64, s64, s51
s_sub_u32 s64, s64, 16384
s_cmp_eq_u32 s22, 0
s_cselect_b32 s64, s64, 268435456
v_add_u32 v8, s64, v1
buffer_store_dwordx4 v[64:67], v8, s[44:47], 0 offen offset:0 sc1
buffer_store_dwordx4 v[68:71], v8, s[44:47], 0 offen offset:1024 sc1
v_pk_mul_f32 v[96:97], v[160:161], s[72:73]
v_pk_mul_f32 v[98:99], v[162:163], s[72:73]
v_pk_mul_f32 v[100:101], v[164:165], s[72:73]
v_pk_mul_f32 v[102:103], v[166:167], s[72:73]
v_pk_mul_f32 v[104:105], v[168:169], s[72:73]
v_pk_mul_f32 v[106:107], v[170:171], s[72:73]
v_pk_mul_f32 v[108:109], v[172:173], s[72:73]
v_pk_mul_f32 v[110:111], v[174:175], s[72:73]
v_exp_f32 v96, v96
v_exp_f32 v97, v97
v_exp_f32 v98, v98
v_exp_f32 v99, v99
v_exp_f32 v100, v100
v_exp_f32 v101, v101
v_exp_f32 v102, v102
v_exp_f32 v103, v103
v_exp_f32 v104, v104
v_exp_f32 v105, v105
v_exp_f32 v106, v106
v_exp_f32 v107, v107
v_exp_f32 v108, v108
v_exp_f32 v109, v109
v_exp_f32 v110, v110
v_exp_f32 v111, v111
v_pk_add_f32 v[160:161], v[160:161], 1.0 op_sel_hi:[1,0]
v_pk_add_f32 v[162:163], v[162:163], 1.0 op_sel_hi:[1,0]
v_pk_add_f32 v[164:165], v[164:165], 1.0 op_sel_hi:[1,0]
v_pk_add_f32 v[166:167], v[166:167], 1.0 op_sel_hi:[1,0]
v_pk_add_f32 v[168:169], v[168:169], 1.0 op_sel_hi:[1,0]
v_pk_add_f32 v[170:171], v[170:171], 1.0 op_sel_hi:[1,0]
v_pk_add_f32 v[172:173], v[172:173], 1.0 op_sel_hi:[1,0]
v_pk_add_f32 v[174:175], v[174:175], 1.0 op_sel_hi:[1,0]
v_med3_f32 v160, v96, v160, 1.0
v_med3_f32 v161, v97, v161, 1.0
v_med3_f32 v162, v98, v162, 1.0
v_med3_f32 v163, v99, v163, 1.0
v_med3_f32 v164, v100, v164, 1.0
v_med3_f32 v165, v101, v165, 1.0
v_med3_f32 v166, v102, v166, 1.0
v_med3_f32 v167, v103, v167, 1.0
v_med3_f32 v168, v104, v168, 1.0
v_med3_f32 v169, v105, v169, 1.0
v_med3_f32 v170, v106, v170, 1.0
v_med3_f32 v171, v107, v171, 1.0
v_med3_f32 v172, v108, v172, 1.0
v_med3_f32 v173, v109, v173, 1.0
v_med3_f32 v174, v110, v174, 1.0
v_med3_f32 v175, v111, v175, 1.0
v_pk_add_f32 v[160:161], v[160:161], s[74:75]
v_pk_add_f32 v[162:163], v[162:163], s[74:75]
v_pk_add_f32 v[164:165], v[164:165], s[74:75]
v_pk_add_f32 v[166:167], v[166:167], s[74:75]
v_pk_add_f32 v[168:169], v[168:169], s[74:75]
v_pk_add_f32 v[170:171], v[170:171], s[74:75]
v_pk_add_f32 v[172:173], v[172:173], s[74:75]
v_pk_add_f32 v[174:175], v[174:175], s[74:75]
v_cvt_pk_bf16_f32 v160, v160, v161
v_cvt_pk_bf16_f32 v161, v162, v163
v_cvt_pk_bf16_f32 v162, v164, v165
v_cvt_pk_bf16_f32 v163, v166, v167
v_cvt_pk_bf16_f32 v164, v168, v169
v_cvt_pk_bf16_f32 v165, v170, v171
v_cvt_pk_bf16_f32 v166, v172, v173
v_cvt_pk_bf16_f32 v167, v174, v175
buffer_store_dwordx4 v[160:163], v1, s[44:47], s49 offen offset:0 sc1
buffer_store_dwordx4 v[164:167], v1, s[44:47], s49 offen offset:1024 sc1
s_add_u32 s50, s39, 98304
s_mov_b32 s16, s44
s_mov_b32 s17, s45
s_mov_b32 s18, 0
s_mov_b32 s19, 0x20000
s_lshl_b32 s64, s21, 2
s_add_u32 s64, s64, 32
s_add_u32 s64, s64, s51
s_cmp_eq_u32 s22, 0
s_cselect_b32 s64, s64, 268435456
v_mov_b32 v4, s64
v_mov_b32 v5, 1
s_mov_b32 s65, 2
s_cmp_eq_u32 s24, 0
s_cbranch_scc0 L_kk_kernel_c1_nomask0
v_cndmask_b32 v128, v128, v240, s[52:53]
v_cndmask_b32 v140, v140, v240, s[52:53]
v_mov_b32 v132, v240
v_cndmask_b32 v129, v129, v240, s[54:55]
v_cndmask_b32 v141, v141, v240, s[54:55]
v_mov_b32 v133, v240
v_cndmask_b32 v130, v130, v240, s[56:57]
v_cndmask_b32 v142, v142, v240, s[56:57]
v_mov_b32 v134, v240
v_cndmask_b32 v131, v131, v240, s[58:59]
v_cndmask_b32 v143, v143, v240, s[58:59]
v_mov_b32 v135, v240
L_kk_kernel_c1_nomask0:
v_max3_f32 v12, v128, v129, v129
v_max3_f32 v12, v130, v131, v12
v_max3_f32 v12, v132, v133, v12
v_max3_f32 v12, v134, v135, v12
v_max3_f32 v13, v136, v137, v137
v_max3_f32 v13, v138, v139, v13
v_max3_f32 v13, v140, v141, v13
v_max3_f32 v13, v142, v143, v13
v_mov_b32 v14, v12
s_nop 1
v_permlane16_swap_b32 v14, v12
v_max_f32 v12, v14, v12
v_mov_b32 v14, v12
s_nop 1
v_permlane32_swap_b32 v14, v12
v_max_f32 v12, v14, v12
v_mov_b32 v15, v13
s_nop 1
v_permlane16_swap_b32 v15, v13
v_max_f32 v13, v15, v13
v_mov_b32 v15, v13
s_nop 1
v_permlane32_swap_b32 v15, v13
v_max_f32 v13, v15, v13
s_add_u32 s14, s39, 32768
s_mov_b32 m0, s14
s_nop 0
buffer_load_dwordx4 v1, s[32:35], s36 offen offset:0 sc1 lds
buffer_load_dwordx4 v1, s[32:35], s36 offen offset:1024 sc1 lds
buffer_load_dwordx4 v1, s[32:35], s36 offen offset:2048 sc1 lds
buffer_load_dwordx4 v1, s[32:35], s36 offen offset:3072 sc1 lds
s_add_u32 m0, s14, 16384
s_nop 0
buffer_load_dwordx4 v1, s[32:35], s37 offen offset:0 sc1 lds
buffer_load_dwordx4 v1, s[32:35], s37 offen offset:1024 sc1 lds
buffer_load_dwordx4 v1, s[32:35], s37 offen offset:2048 sc1 lds
buffer_load_dwordx4 v1, s[32:35], s37 offen offset:3072 sc1 lds
s_add_u32 s36, s36, 16384
s_add_u32 s37, s37, 16384
v_sub_f32 v48, 0, v12
v_sub_f32 v49, 0, v12
v_sub_f32 v50, 0, v12
v_sub_f32 v51, 0, v12
v_sub_f32 v56, 0, v12
v_sub_f32 v57, 0, v12
v_sub_f32 v58, 0, v12
v_sub_f32 v59, 0, v12
v_sub_f32 v52, 0, v13
v_sub_f32 v53, 0, v13
v_sub_f32 v54, 0, v13
v_sub_f32 v55, 0, v13
v_sub_f32 v60, 0, v13
v_sub_f32 v61, 0, v13
v_sub_f32 v62, 0, v13
v_sub_f32 v63, 0, v13
v_sub_f32 v128, v128, v12
v_sub_f32 v129, v129, v12
v_sub_f32 v130, v130, v12
v_sub_f32 v131, v131, v12
v_sub_f32 v132, v132, v12
v_sub_f32 v133, v133, v12
v_sub_f32 v134, v134, v12
v_sub_f32 v135, v135, v12
v_sub_f32 v136, v136, v13
v_sub_f32 v137, v137, v13
v_sub_f32 v138, v138, v13
v_sub_f32 v139, v139, v13
v_sub_f32 v140, v140, v13
v_sub_f32 v141, v141, v13
v_sub_f32 v142, v142, v13
v_sub_f32 v143, v143, v13
s_add_u32 s14, s39, 65536
s_mov_b32 m0, s14
s_nop 0
buffer_load_dwordx4 v1, s[32:35], s36 offen offset:0 sc1 lds
buffer_load_dwordx4 v1, s[32:35], s36 offen offset:1024 sc1 lds
buffer_load_dwordx4 v1, s[32:35], s36 offen offset:2048 sc1 lds
buffer_load_dwordx4 v1, s[32:35], s36 offen offset:3072 sc1 lds
s_add_u32 m0, s14, 16384
s_nop 0
buffer_load_dwordx4 v1, s[32:35], s37 offen offset:0 sc1 lds
buffer_load_dwordx4 v1, s[32:35], s37 offen offset:1024 sc1 lds
buffer_load_dwordx4 v1, s[32:35], s37 offen offset:2048 sc1 lds
buffer_load_dwordx4 v1, s[32:35], s37 offen offset:3072 sc1 lds
s_add_u32 s36, s36, 16384
s_add_u32 s37, s37, 16384
s_setprio 0
s_lshl_b32 s64, s22, 8
s_add_u32 s64, s64, 90177536
v_lshl_add_u32 v243, v0, 2, s64
v_mov_b32 v241, 0
v_mov_b32 v242, 0
s_cmp_lt_u32 s26, 3
s_cbranch_scc0 L_kk_kernel_c1_big
v_mov_b32 v64, 0
v_mov_b32 v65, 0
v_mov_b32 v66, 0
v_mov_b32 v67, 0
v_mov_b32 v68, 0
v_mov_b32 v69, 0
v_mov_b32 v70, 0
v_mov_b32 v71, 0
v_mov_b32 v72, 0
v_mov_b32 v73, 0
v_mov_b32 v74, 0
v_mov_b32 v75, 0
v_mov_b32 v76, 0
v_mov_b32 v77, 0
v_mov_b32 v78, 0
v_mov_b32 v79, 0
v_mov_b32 v80, 0
v_mov_b32 v81, 0
v_mov_b32 v82, 0
v_mov_b32 v83, 0
v_mov_b32 v84, 0
v_mov_b32 v85, 0
v_mov_b32 v86, 0
v_mov_b32 v87, 0
v_mov_b32 v88, 0
v_mov_b32 v89, 0
v_mov_b32 v90, 0
v_mov_b32 v91, 0
v_mov_b32 v92, 0
v_mov_b32 v93, 0
v_mov_b32 v94, 0
v_mov_b32 v95, 0
v_mov_b32 v96, 0
v_mov_b32 v97, 0
v_mov_b32 v98, 0
v_mov_b32 v99, 0
v_mov_b32 v100, 0
v_mov_b32 v101, 0
v_mov_b32 v102, 0
v_mov_b32 v103, 0
v_mov_b32 v104, 0
v_mov_b32 v105, 0
v_mov_b32 v106, 0
v_mov_b32 v107, 0
v_mov_b32 v108, 0
v_mov_b32 v109, 0
v_mov_b32 v110, 0
v_mov_b32 v111, 0
v_mov_b32 v112, 0
v_mov_b32 v113, 0
v_mov_b32 v114, 0
v_mov_b32 v115, 0
v_mov_b32 v116, 0
v_mov_b32 v117, 0
v_mov_b32 v118, 0
v_mov_b32 v119, 0
v_mov_b32 v120, 0
v_mov_b32 v121, 0
v_mov_b32 v122, 0
v_mov_b32 v123, 0
v_mov_b32 v124, 0
v_mov_b32 v125, 0
v_mov_b32 v126, 0
v_mov_b32 v127, 0
v_mov_b32 v168, 0
v_mov_b32 v244, 0
v_mov_b32 v169, 0
v_mov_b32 v245, 0
v_mov_b32 v170, 0
v_mov_b32 v246, 0
v_mov_b32 v171, 0
v_mov_b32 v247, 0
v_mov_b32 v172, 0
v_mov_b32 v248, 0
v_mov_b32 v173, 0
v_mov_b32 v249, 0
v_mov_b32 v174, 0
v_mov_b32 v250, 0
v_mov_b32 v175, 0
v_mov_b32 v251, 0
s_branch L_kk_kernel_c1_chk
L_kk_kernel_c1_big:
s_waitcnt lgkmcnt(7)
v_mfma_f32_16x16x32_bf16 v[144:147], v[176:179], v[16:19], v[48:51]
v_exp_f32 v128, v128
v_mfma_f32_16x16x32_bf16 v[152:155], v[176:179], v[32:35], v[52:55]
v_exp_f32 v129, v129
ds_read_b128 v[176:179], v2 offset:8192
s_waitcnt lgkmcnt(7)
v_mfma_f32_16x16x32_bf16 v[144:147], v[180:183], v[20:23], v[144:147]
v_exp_f32 v130, v130
v_cvt_pk_bf16_f32 v160, v128, v129
v_mfma_f32_16x16x32_bf16 v[152:155], v[180:183], v[36:39], v[152:155]
v_exp_f32 v131, v131
s_add_u32 s38, s38, 32768
ds_read_b128 v[180:183], v2 offset:9216
s_waitcnt lgkmcnt(7)
v_mfma_f32_16x16x32_bf16 v[144:147], v[184:187], v[24:27], v[144:147]
v_exp_f32 v132, v132
v_cvt_pk_bf16_f32 v161, v130, v131
v_mfma_f32_16x16x32_bf16 v[152:155], v[184:187], v[40:43], v[152:155]
v_exp_f32 v133, v133
ds_read_b128 v[184:187], v2 offset:10240
s_waitcnt lgkmcnt(7)
v_mfma_f32_16x16x32_bf16 v[144:147], v[188:191], v[28:31], v[144:147]
v_exp_f32 v134, v134
v_cvt_pk_bf16_f32 v162, v132, v133
v_mfma_f32_16x16x32_bf16 v[152:155], v[188:191], v[44:47], v[152:155]
v_exp_f32 v135, v135
s_cmp_eq_u32 s38, 163840
s_cselect_b32 s38, 0, s38
ds_read_b128 v[188:191], v2 offset:11264
s_waitcnt lgkmcnt(7)
v_mfma_f32_16x16x32_bf16 v[148:151], v[192:195], v[16:19], v[56:59]
v_exp_f32 v136, v136
v_cvt_pk_bf16_f32 v163, v134, v135
v_mfma_f32_16x16x32_bf16 v[156:159], v[192:195], v[32:35], v[60:63]
v_exp_f32 v137, v137
ds_read_b128 v[192:195], v2 offset:12288
s_waitcnt lgkmcnt(7)
v_mfma_f32_16x16x32_bf16 v[148:151], v[196:199], v[20:23], v[148:151]
v_exp_f32 v138, v138
v_cvt_pk_bf16_f32 v164, v136, v137
v_mfma_f32_16x16x32_bf16 v[156:159], v[196:199], v[36:39], v[156:159]
v_exp_f32 v139, v139
v_add_u32 v3, s38, v1
ds_read_b128 v[196:199], v2 offset:13312
s_waitcnt lgkmcnt(7)
v_mfma_f32_16x16x32_bf16 v[148:151], v[200:203], v[24:27], v[148:151]
v_exp_f32 v140, v140
v_cvt_pk_bf16_f32 v165, v138, v139
v_mfma_f32_16x16x32_bf16 v[156:159], v[200:203], v[40:43], v[156:159]
v_exp_f32 v141, v141
ds_read_b128 v[200:203], v2 offset:14336
s_waitcnt lgkmcnt(7)
v_mfma_f32_16x16x32_bf16 v[148:151], v[204:207], v[28:31], v[148:151]
v_exp_f32 v142, v142
v_cvt_pk_bf16_f32 v166, v140, v141
v_mfma_f32_16x16x32_bf16 v[156:159], v[204:207], v[44:47], v[156:159]
v_exp_f32 v143, v143
ds_read_b128 v[204:207], v2 offset:15360
v_cvt_pk_bf16_f32 v167, v142, v143
s_waitcnt lgkmcnt(4)
v_mfma_f32_16x16x32_bf16 v[128:131], v[176:179], v[16:19], v[48:51]
v_exp_f32 v144, v144
v_mfma_f32_16x16x32_bf16 v[136:139], v[176:179], v[32:35], v[52:55]
ds_read_b128 v[208:211], v2 offset:24576
ds_read_b128 v[212:215], v2 offset:25600
v_mfma_f32_16x16x32_bf16 v[128:131], v[180:183], v[20:23], v[128:131]
v_exp_f32 v145, v145
v_mfma_f32_16x16x32_bf16 v[136:139], v[180:183], v[36:39], v[136:139]
v_cvt_pk_bf16_f32 v168, v144, v145
v_mfma_f32_16x16x32_bf16 v[128:131], v[184:187], v[24:27], v[128:131]
v_exp_f32 v146, v146
v_mfma_f32_16x16x32_bf16 v[136:139], v[184:187], v[40:43], v[136:139]
ds_read_b128 v[216:219], v2 offset:26624
ds_read_b128 v[220:223], v2 offset:27648
v_mfma_f32_16x16x32_bf16 v[128:131], v[188:191], v[28:31], v[128:131]
v_exp_f32 v147, v147
v_mfma_f32_16x16x32_bf16 v[136:139], v[188:191], v[44:47], v[136:139]
v_cvt_pk_bf16_f32 v169, v146, v147
s_waitcnt lgkmcnt(4)
v_mfma_f32_16x16x32_bf16 v[132:135], v[192:195], v[16:19], v[56:59]
v_exp_f32 v148, v148
v_mfma_f32_16x16x32_bf16 v[140:143], v[192:195], v[32:35], v[60:63]
ds_read_b128 v[224:227], v2 offset:28672
ds_read_b128 v[228:231], v2 offset:29696
v_mfma_f32_16x16x32_bf16 v[132:135], v[196:199], v[20:23], v[132:135]
v_exp_f32 v149, v149
v_mfma_f32_16x16x32_bf16 v[140:143], v[196:199], v[36:39], v[140:143]
v_cvt_pk_bf16_f32 v170, v148, v149
v_mfma_f32_16x16x32_bf16 v[132:135], v[200:203], v[24:27], v[132:135]
v_exp_f32 v150, v150
v_mfma_f32_16x16x32_bf16 v[140:143], v[200:203], v[40:43], v[140:143]
ds_read_b128 v[232:235], v2 offset:30720
ds_read_b128 v[236:239], v2 offset:31744
v_mfma_f32_16x16x32_bf16 v[132:135], v[204:207], v[28:31], v[132:135]
v_exp_f32 v151, v151
v_mfma_f32_16x16x32_bf16 v[140:143], v[204:207], v[44:47], v[140:143]
v_cvt_pk_bf16_f32 v171, v150, v151
s_waitcnt lgkmcnt(4)
v_mfma_f32_16x16x32_bf16 v[64:67], v[208:211], v[160:163], 0
v_exp_f32 v152, v152
v_mfma_f32_16x16x32_bf16 v[72:75], v[208:211], v[164:167], 0
ds_read_b128 v[176:179], v3 offset:0
ds_read_b128 v[180:183], v3 offset:1024
v_mfma_f32_16x16x32_bf16 v[68:71], v[212:215], v[160:163], 0
v_exp_f32 v153, v153
v_mfma_f32_16x16x32_bf16 v[76:79], v[212:215], v[164:167], 0
v_cvt_pk_bf16_f32 v172, v152, v153
v_mov_b32 v2, v3
v_mfma_f32_16x16x32_bf16 v[80:83], v[216:219], v[160:163], 0
v_exp_f32 v154, v154
s_add_u32 s27, s27, 1
v_mfma_f32_16x16x32_bf16 v[88:91], v[216:219], v[164:167], 0
ds_read_b128 v[184:187], v3 offset:2048
ds_read_b128 v[188:191], v3 offset:3072
v_mfma_f32_16x16x32_bf16 v[84:87], v[220:223], v[160:163], 0
v_exp_f32 v155, v155
v_mfma_f32_16x16x32_bf16 v[92:95], v[220:223], v[164:167], 0
v_cvt_pk_bf16_f32 v173, v154, v155
s_waitcnt lgkmcnt(4)
v_mfma_f32_16x16x32_bf16 v[96:99], v[224:227], v[160:163], 0
v_exp_f32 v156, v156
v_mfma_f32_16x16x32_bf16 v[104:107], v[224:227], v[164:167], 0
ds_read_b128 v[192:195], v3 offset:4096
ds_read_b128 v[196:199], v3 offset:5120
v_mfma_f32_16x16x32_bf16 v[100:103], v[228:231], v[160:163], 0
v_exp_f32 v157, v157
v_mfma_f32_16x16x32_bf16 v[108:111], v[228:231], v[164:167], 0
v_cvt_pk_bf16_f32 v174, v156, v157
v_mfma_f32_16x16x32_bf16 v[112:115], v[232:235], v[160:163], 0
v_exp_f32 v158, v158
v_mfma_f32_16x16x32_bf16 v[120:123], v[232:235], v[164:167], 0
ds_read_b128 v[200:203], v3 offset:6144
ds_read_b128 v[204:207], v3 offset:7168
v_mfma_f32_16x16x32_bf16 v[116:119], v[236:239], v[160:163], 0
v_exp_f32 v159, v159
v_mfma_f32_16x16x32_bf16 v[124:127], v[236:239], v[164:167], 0
v_cvt_pk_bf16_f32 v175, v158, v159
v_mfma_f32_16x16x32_bf16 v[244:247], v[252:255], v[160:163], 0
v_mfma_f32_16x16x32_bf16 v[248:251], v[252:255], v[164:167], 0
s_sub_u32 s26, s26, 2
s_cmp_lt_u32 s26, 3
s_cbranch_scc1 L_kk_kernel_c1_chk
s_movk_i32 s66, 0x7fff
.p2align 6
L_kk_kernel_c1_loop:
s_waitcnt lgkmcnt(4)
v_mfma_f32_16x16x32_bf16 v[144:147], v[176:179], v[16:19], v[48:51]
v_exp_f32 v128, v128
v_mfma_f32_16x16x32_bf16 v[152:155], v[176:179], v[32:35], v[52:55]
ds_read_b128 v[208:211], v2 offset:16384
ds_read_b128 v[212:215], v2 offset:17408
v_mfma_f32_16x16x32_bf16 v[144:147], v[180:183], v[20:23], v[144:147]
v_exp_f32 v129, v129
v_mfma_f32_16x16x32_bf16 v[152:155], v[180:183], v[36:39], v[152:155]
v_cvt_pk_bf16_f32 v160, v128, v129
s_add_u32 s38, s38, 32768
v_mfma_f32_16x16x32_bf16 v[144:147], v[184:187], v[24:27], v[144:147]
v_exp_f32 v130, v130
v_mfma_f32_16x16x32_bf16 v[152:155], v[184:187], v[40:43], v[152:155]
ds_read_b128 v[216:219], v2 offset:18432
ds_read_b128 v[220:223], v2 offset:19456
v_mfma_f32_16x16x32_bf16 v[144:147], v[188:191], v[28:31], v[144:147]
v_exp_f32 v131, v131
v_mfma_f32_16x16x32_bf16 v[152:155], v[188:191], v[44:47], v[152:155]
v_cvt_pk_bf16_f32 v161, v130, v131
s_waitcnt lgkmcnt(4)
v_mfma_f32_16x16x32_bf16 v[148:151], v[192:195], v[16:19], v[56:59]
v_exp_f32 v132, v132
v_mfma_f32_16x16x32_bf16 v[156:159], v[192:195], v[32:35], v[60:63]
ds_read_b128 v[224:227], v2 offset:20480
ds_read_b128 v[228:231], v2 offset:21504
v_mfma_f32_16x16x32_bf16 v[148:151], v[196:199], v[20:23], v[148:151]
v_exp_f32 v133, v133
v_mfma_f32_16x16x32_bf16 v[156:159], v[196:199], v[36:39], v[156:159]
v_cvt_pk_bf16_f32 v162, v132, v133
s_cmp_eq_u32 s38, 163840
s_cselect_b32 s38, 0, s38
v_mfma_f32_16x16x32_bf16 v[148:151], v[200:203], v[24:27], v[148:151]
v_exp_f32 v134, v134
v_mfma_f32_16x16x32_bf16 v[156:159], v[200:203], v[40:43], v[156:159]
ds_read_b128 v[232:235], v2 offset:22528
ds_read_b128 v[236:239], v2 offset:23552
v_mfma_f32_16x16x32_bf16 v[148:151], v[204:207], v[28:31], v[148:151]
v_exp_f32 v135, v135
v_mfma_f32_16x16x32_bf16 v[156:159], v[204:207], v[44:47], v[156:159]
v_cvt_pk_bf16_f32 v163, v134, v135
s_waitcnt lgkmcnt(4)
v_mfma_f32_16x16x32_bf16 v[64:67], v[208:211], v[168:171], v[64:67]
v_exp_f32 v136, v136
v_mfma_f32_16x16x32_bf16 v[72:75], v[208:211], v[172:175], v[72:75]
ds_read_b128 v[176:179], v2 offset:8192
ds_read_b128 v[180:183], v2 offset:9216
v_mfma_f32_16x16x32_bf16 v[68:71], v[212:215], v[168:171], v[68:71]
v_exp_f32 v137, v137
v_mfma_f32_16x16x32_bf16 v[76:79], v[212:215], v[172:175], v[76:79]
v_cvt_pk_bf16_f32 v164, v136, v137
v_add_u32 v3, s38, v1
v_mfma_f32_16x16x32_bf16 v[80:83], v[216:219], v[168:171], v[80:83]
v_exp_f32 v138, v138
v_mfma_f32_16x16x32_bf16 v[88:91], v[216:219], v[172:175], v[88:91]
ds_read_b128 v[184:187], v2 offset:10240
ds_read_b128 v[188:191], v2 offset:11264
v_mfma_f32_16x16x32_bf16 v[84:87], v[220:223], v[168:171], v[84:87]
v_exp_f32 v139, v139
v_mfma_f32_16x16x32_bf16 v[92:95], v[220:223], v[172:175], v[92:95]
v_cvt_pk_bf16_f32 v165, v138, v139
s_waitcnt lgkmcnt(4)
v_mfma_f32_16x16x32_bf16 v[96:99], v[224:227], v[168:171], v[96:99]
v_exp_f32 v140, v140
v_mfma_f32_16x16x32_bf16 v[104:107], v[224:227], v[172:175], v[104:107]
ds_read_b128 v[192:195], v2 offset:12288
ds_read_b128 v[196:199], v2 offset:13312
v_mfma_f32_16x16x32_bf16 v[100:103], v[228:231], v[168:171], v[100:103]
v_exp_f32 v141, v141
v_mfma_f32_16x16x32_bf16 v[108:111], v[228:231], v[172:175], v[108:111]
v_cvt_pk_bf16_f32 v166, v140, v141
v_mfma_f32_16x16x32_bf16 v[112:115], v[232:235], v[168:171], v[112:115]
v_exp_f32 v142, v142
v_mfma_f32_16x16x32_bf16 v[120:123], v[232:235], v[172:175], v[120:123]
ds_read_b128 v[200:203], v2 offset:14336
ds_read_b128 v[204:207], v2 offset:15360
v_mfma_f32_16x16x32_bf16 v[116:119], v[236:239], v[168:171], v[116:119]
v_exp_f32 v143, v143
v_mfma_f32_16x16x32_bf16 v[124:127], v[236:239], v[172:175], v[124:127]
v_cvt_pk_bf16_f32 v167, v142, v143
v_mfma_f32_16x16x32_bf16 v[244:247], v[252:255], v[168:171], v[244:247]
v_mfma_f32_16x16x32_bf16 v[248:251], v[252:255], v[172:175], v[248:251]
s_sub_u32 s26, s26, 2
s_waitcnt lgkmcnt(4)
v_mfma_f32_16x16x32_bf16 v[128:131], v[176:179], v[16:19], v[48:51]
v_exp_f32 v144, v144
v_mfma_f32_16x16x32_bf16 v[136:139], v[176:179], v[32:35], v[52:55]
ds_read_b128 v[208:211], v2 offset:24576
ds_read_b128 v[212:215], v2 offset:25600
v_mfma_f32_16x16x32_bf16 v[128:131], v[180:183], v[20:23], v[128:131]
v_exp_f32 v145, v145
v_mfma_f32_16x16x32_bf16 v[136:139], v[180:183], v[36:39], v[136:139]
v_cvt_pk_bf16_f32 v168, v144, v145
v_mfma_f32_16x16x32_bf16 v[128:131], v[184:187], v[24:27], v[128:131]
v_exp_f32 v146, v146
v_mfma_f32_16x16x32_bf16 v[136:139], v[184:187], v[40:43], v[136:139]
ds_read_b128 v[216:219], v2 offset:26624
ds_read_b128 v[220:223], v2 offset:27648
v_mfma_f32_16x16x32_bf16 v[128:131], v[188:191], v[28:31], v[128:131]
v_exp_f32 v147, v147
v_mfma_f32_16x16x32_bf16 v[136:139], v[188:191], v[44:47], v[136:139]
v_cvt_pk_bf16_f32 v169, v146, v147
s_waitcnt lgkmcnt(4)
v_mfma_f32_16x16x32_bf16 v[132:135], v[192:195], v[16:19], v[56:59]
v_exp_f32 v148, v148
v_mfma_f32_16x16x32_bf16 v[140:143], v[192:195], v[32:35], v[60:63]
ds_read_b128 v[224:227], v2 offset:28672
ds_read_b128 v[228:231], v2 offset:29696
v_mfma_f32_16x16x32_bf16 v[132:135], v[196:199], v[20:23], v[132:135]
v_exp_f32 v149, v149
v_mfma_f32_16x16x32_bf16 v[140:143], v[196:199], v[36:39], v[140:143]
v_cvt_pk_bf16_f32 v170, v148, v149
v_mfma_f32_16x16x32_bf16 v[132:135], v[200:203], v[24:27], v[132:135]
v_exp_f32 v150, v150
v_mfma_f32_16x16x32_bf16 v[140:143], v[200:203], v[40:43], v[140:143]
ds_read_b128 v[232:235], v2 offset:30720
ds_read_b128 v[236:239], v2 offset:31744
v_mfma_f32_16x16x32_bf16 v[132:135], v[204:207], v[28:31], v[132:135]
v_exp_f32 v151, v151
v_mfma_f32_16x16x32_bf16 v[140:143], v[204:207], v[44:47], v[140:143]
v_cvt_pk_bf16_f32 v171, v150, v151
s_waitcnt vmcnt(16)
s_barrier
s_waitcnt lgkmcnt(4)
v_mfma_f32_16x16x32_bf16 v[64:67], v[208:211], v[160:163], v[64:67]
v_exp_f32 v152, v152
v_mfma_f32_16x16x32_bf16 v[72:75], v[208:211], v[164:167], v[72:75]
s_mov_b32 m0, s50
ds_read_b128 v[176:179], v3 offset:0
ds_read_b128 v[180:183], v3 offset:1024
v_mfma_f32_16x16x32_bf16 v[68:71], v[212:215], v[160:163], v[68:71]
v_exp_f32 v153, v153
v_mov_b32 v2, v3
buffer_load_dwordx4 v1, s[32:35], s36 offen offset:0 sc1 lds
v_mfma_f32_16x16x32_bf16 v[76:79], v[212:215], v[164:167], v[76:79]
v_cvt_pk_bf16_f32 v172, v152, v153
buffer_load_dwordx4 v1, s[32:35], s36 offen offset:1024 sc1 lds
v_mfma_f32_16x16x32_bf16 v[80:83], v[216:219], v[160:163], v[80:83]
v_exp_f32 v154, v154
v_mfma_f32_16x16x32_bf16 v[88:91], v[216:219], v[164:167], v[88:91]
ds_read_b128 v[184:187], v3 offset:2048
ds_read_b128 v[188:191], v3 offset:3072
v_mfma_f32_16x16x32_bf16 v[84:87], v[220:223], v[160:163], v[84:87]
v_exp_f32 v155, v155
buffer_load_dwordx4 v1, s[32:35], s36 offen offset:2048 sc1 lds
v_mfma_f32_16x16x32_bf16 v[92:95], v[220:223], v[164:167], v[92:95]
v_cvt_pk_bf16_f32 v173, v154, v155
buffer_load_dwordx4 v1, s[32:35], s36 offen offset:3072 sc1 lds
s_add_u32 m0, s50, 16384
s_waitcnt lgkmcnt(4)
v_mfma_f32_16x16x32_bf16 v[96:99], v[224:227], v[160:163], v[96:99]
v_exp_f32 v156, v156
v_mfma_f32_16x16x32_bf16 v[104:107], v[224:227], v[164:167], v[104:107]
ds_read_b128 v[192:195], v3 offset:4096
ds_read_b128 v[196:199], v3 offset:5120
v_mfma_f32_16x16x32_bf16 v[100:103], v[228:231], v[160:163], v[100:103]
v_exp_f32 v157, v157
buffer_load_dwordx4 v1, s[32:35], s37 offen offset:0 sc1 lds
v_mfma_f32_16x16x32_bf16 v[108:111], v[228:231], v[164:167], v[108:111]
v_cvt_pk_bf16_f32 v174, v156, v157
buffer_load_dwordx4 v1, s[32:35], s37 offen offset:1024 sc1 lds
v_mfma_f32_16x16x32_bf16 v[112:115], v[232:235], v[160:163], v[112:115]
v_exp_f32 v158, v158
v_mfma_f32_16x16x32_bf16 v[120:123], v[232:235], v[164:167], v[120:123]
ds_read_b128 v[200:203], v3 offset:6144
ds_read_b128 v[204:207], v3 offset:7168
v_mfma_f32_16x16x32_bf16 v[116:119], v[236:239], v[160:163], v[116:119]
v_exp_f32 v159, v159
buffer_load_dwordx4 v1, s[32:35], s37 offen offset:2048 sc1 lds
v_mfma_f32_16x16x32_bf16 v[124:127], v[236:239], v[164:167], v[124:127]
v_cvt_pk_bf16_f32 v175, v158, v159
buffer_load_dwordx4 v1, s[32:35], s37 offen offset:3072 sc1 lds
v_mfma_f32_16x16x32_bf16 v[244:247], v[252:255], v[160:163], v[244:247]
s_add_u32 s36, s36, 16384
s_add_u32 s37, s37, 16384
s_add_u32 s50, s50, 32768
s_cmp_ge_u32 s50, 163840
s_cselect_b32 s50, s39, s50
s_add_u32 s27, s27, 1
v_mfma_f32_16x16x32_bf16 v[248:251], v[252:255], v[164:167], v[248:251]
s_cmp_ge_u32 s26, s66
s_cbranch_scc1 L_kk_kernel_c1_loop
s_cmp_eq_u32 s66, 3
s_cbranch_scc1 L_kk_kernel_c1_chk
s_mov_b32 s66, 3
s_mov_b32 s18, 268435456
buffer_store_dword v5, v4, s[16:19], 0 offen sc1
s_cmp_ge_u32 s26, 3
s_cbranch_scc1 L_kk_kernel_c1_loop
L_kk_kernel_c1_chk:
s_cmp_eq_u32 s26, 0
s_cbranch_scc1 L_kk_kernel_c1_tail0
s_cmp_eq_u32 s26, 1
s_cbranch_scc0 L_kk_kernel_c1_chk1
v_cndmask_b32 v48, v48, v240, s[52:53]
v_cndmask_b32 v60, v60, v240, s[52:53]
v_mov_b32 v56, v240
v_cndmask_b32 v49, v49, v240, s[54:55]
v_cndmask_b32 v61, v61, v240, s[54:55]
v_mov_b32 v57, v240
v_cndmask_b32 v50, v50, v240, s[56:57]
v_cndmask_b32 v62, v62, v240, s[56:57]
v_mov_b32 v58, v240
v_cndmask_b32 v51, v51, v240, s[58:59]
v_cndmask_b32 v63, v63, v240, s[58:59]
v_mov_b32 v59, v240
L_kk_kernel_c1_chk1:
s_waitcnt lgkmcnt(4)
v_mfma_f32_16x16x32_bf16 v[144:147], v[176:179], v[16:19], v[48:51]
v_exp_f32 v128, v128
v_mfma_f32_16x16x32_bf16 v[152:155], v[176:179], v[32:35], v[52:55]
ds_read_b128 v[208:211], v2 offset:16384
ds_read_b128 v[212:215], v2 offset:17408
v_mfma_f32_16x16x32_bf16 v[144:147], v[180:183], v[20:23], v[144:147]
v_exp_f32 v129, v129
v_mfma_f32_16x16x32_bf16 v[152:155], v[180:183], v[36:39], v[152:155]
v_cvt_pk_bf16_f32 v160, v128, v129
s_add_u32 s38, s38, 32768
v_mfma_f32_16x16x32_bf16 v[144:147], v[184:187], v[24:27], v[144:147]
v_exp_f32 v130, v130
v_mfma_f32_16x16x32_bf16 v[152:155], v[184:187], v[40:43], v[152:155]
ds_read_b128 v[216:219], v2 offset:18432
ds_read_b128 v[220:223], v2 offset:19456
v_mfma_f32_16x16x32_bf16 v[144:147], v[188:191], v[28:31], v[144:147]
v_exp_f32 v131, v131
v_mfma_f32_16x16x32_bf16 v[152:155], v[188:191], v[44:47], v[152:155]
v_cvt_pk_bf16_f32 v161, v130, v131
s_waitcnt lgkmcnt(4)
v_mfma_f32_16x16x32_bf16 v[148:151], v[192:195], v[16:19], v[56:59]
v_exp_f32 v132, v132
v_mfma_f32_16x16x32_bf16 v[156:159], v[192:195], v[32:35], v[60:63]
ds_read_b128 v[224:227], v2 offset:20480
ds_read_b128 v[228:231], v2 offset:21504
v_mfma_f32_16x16x32_bf16 v[148:151], v[196:199], v[20:23], v[148:151]
v_exp_f32 v133, v133
v_mfma_f32_16x16x32_bf16 v[156:159], v[196:199], v[36:39], v[156:159]
v_cvt_pk_bf16_f32 v162, v132, v133
s_cmp_eq_u32 s38, 163840
s_cselect_b32 s38, 0, s38
v_mfma_f32_16x16x32_bf16 v[148:151], v[200:203], v[24:27], v[148:151]
v_exp_f32 v134, v134
v_mfma_f32_16x16x32_bf16 v[156:159], v[200:203], v[40:43], v[156:159]
ds_read_b128 v[232:235], v2 offset:22528
ds_read_b128 v[236:239], v2 offset:23552
v_mfma_f32_16x16x32_bf16 v[148:151], v[204:207], v[28:31], v[148:151]
v_exp_f32 v135, v135
v_mfma_f32_16x16x32_bf16 v[156:159], v[204:207], v[44:47], v[156:159]
v_cvt_pk_bf16_f32 v163, v134, v135
s_waitcnt lgkmcnt(4)
v_mfma_f32_16x16x32_bf16 v[64:67], v[208:211], v[168:171], v[64:67]
v_exp_f32 v136, v136
v_mfma_f32_16x16x32_bf16 v[72:75], v[208:211], v[172:175], v[72:75]
ds_read_b128 v[176:179], v2 offset:8192
ds_read_b128 v[180:183], v2 offset:9216
v_mfma_f32_16x16x32_bf16 v[68:71], v[212:215], v[168:171], v[68:71]
v_exp_f32 v137, v137
v_mfma_f32_16x16x32_bf16 v[76:79], v[212:215], v[172:175], v[76:79]
v_cvt_pk_bf16_f32 v164, v136, v137
v_add_u32 v3, s38, v1
v_mfma_f32_16x16x32_bf16 v[80:83], v[216:219], v[168:171], v[80:83]
v_exp_f32 v138, v138
v_mfma_f32_16x16x32_bf16 v[88:91], v[216:219], v[172:175], v[88:91]
ds_read_b128 v[184:187], v2 offset:10240
ds_read_b128 v[188:191], v2 offset:11264
v_mfma_f32_16x16x32_bf16 v[84:87], v[220:223], v[168:171], v[84:87]
v_exp_f32 v139, v139
v_mfma_f32_16x16x32_bf16 v[92:95], v[220:223], v[172:175], v[92:95]
v_cvt_pk_bf16_f32 v165, v138, v139
s_waitcnt lgkmcnt(4)
v_mfma_f32_16x16x32_bf16 v[96:99], v[224:227], v[168:171], v[96:99]
v_exp_f32 v140, v140
v_mfma_f32_16x16x32_bf16 v[104:107], v[224:227], v[172:175], v[104:107]
ds_read_b128 v[192:195], v2 offset:12288
ds_read_b128 v[196:199], v2 offset:13312
v_mfma_f32_16x16x32_bf16 v[100:103], v[228:231], v[168:171], v[100:103]
v_exp_f32 v141, v141
v_mfma_f32_16x16x32_bf16 v[108:111], v[228:231], v[172:175], v[108:111]
v_cvt_pk_bf16_f32 v166, v140, v141
v_mfma_f32_16x16x32_bf16 v[112:115], v[232:235], v[168:171], v[112:115]
v_exp_f32 v142, v142
v_mfma_f32_16x16x32_bf16 v[120:123], v[232:235], v[172:175], v[120:123]
ds_read_b128 v[200:203], v2 offset:14336
ds_read_b128 v[204:207], v2 offset:15360
v_mfma_f32_16x16x32_bf16 v[116:119], v[236:239], v[168:171], v[116:119]
v_exp_f32 v143, v143
v_mfma_f32_16x16x32_bf16 v[124:127], v[236:239], v[172:175], v[124:127]
v_cvt_pk_bf16_f32 v167, v142, v143
v_mfma_f32_16x16x32_bf16 v[244:247], v[252:255], v[168:171], v[244:247]
v_mfma_f32_16x16x32_bf16 v[248:251], v[252:255], v[172:175], v[248:251]
s_cmp_eq_u32 s26, 1
s_cbranch_scc1 L_kk_kernel_c1_tail1
v_cndmask_b32 v48, v48, v240, s[52:53]
v_cndmask_b32 v60, v60, v240, s[52:53]
v_mov_b32 v56, v240
v_cndmask_b32 v49, v49, v240, s[54:55]
v_cndmask_b32 v61, v61, v240, s[54:55]
v_mov_b32 v57, v240
v_cndmask_b32 v50, v50, v240, s[56:57]
v_cndmask_b32 v62, v62, v240, s[56:57]
v_mov_b32 v58, v240
v_cndmask_b32 v51, v51, v240, s[58:59]
v_cndmask_b32 v63, v63, v240, s[58:59]
v_mov_b32 v59, v240
s_waitcnt lgkmcnt(4)
v_mfma_f32_16x16x32_bf16 v[128:131], v[176:179], v[16:19], v[48:51]
v_exp_f32 v144, v144
v_mfma_f32_16x16x32_bf16 v[136:139], v[176:179], v[32:35], v[52:55]
ds_read_b128 v[208:211], v2 offset:24576
ds_read_b128 v[212:215], v2 offset:25600
v_mfma_f32_16x16x32_bf16 v[128:131], v[180:183], v[20:23], v[128:131]
v_exp_f32 v145, v145
v_mfma_f32_16x16x32_bf16 v[136:139], v[180:183], v[36:39], v[136:139]
v_cvt_pk_bf16_f32 v168, v144, v145
v_mfma_f32_16x16x32_bf16 v[128:131], v[184:187], v[24:27], v[128:131]
v_exp_f32 v146, v146
v_mfma_f32_16x16x32_bf16 v[136:139], v[184:187], v[40:43], v[136:139]
ds_read_b128 v[216:219], v2 offset:26624
ds_read_b128 v[220:223], v2 offset:27648
v_mfma_f32_16x16x32_bf16 v[128:131], v[188:191], v[28:31], v[128:131]
v_exp_f32 v147, v147
v_mfma_f32_16x16x32_bf16 v[136:139], v[188:191], v[44:47], v[136:139]
v_cvt_pk_bf16_f32 v169, v146, v147
s_waitcnt lgkmcnt(4)
v_mfma_f32_16x16x32_bf16 v[132:135], v[192:195], v[16:19], v[56:59]
v_exp_f32 v148, v148
v_mfma_f32_16x16x32_bf16 v[140:143], v[192:195], v[32:35], v[60:63]
ds_read_b128 v[224:227], v2 offset:28672
ds_read_b128 v[228:231], v2 offset:29696
v_mfma_f32_16x16x32_bf16 v[132:135], v[196:199], v[20:23], v[132:135]
v_exp_f32 v149, v149
v_mfma_f32_16x16x32_bf16 v[140:143], v[196:199], v[36:39], v[140:143]
v_cvt_pk_bf16_f32 v170, v148, v149
v_mfma_f32_16x16x32_bf16 v[132:135], v[200:203], v[24:27], v[132:135]
v_exp_f32 v150, v150
v_mfma_f32_16x16x32_bf16 v[140:143], v[200:203], v[40:43], v[140:143]
ds_read_b128 v[232:235], v2 offset:30720
ds_read_b128 v[236:239], v2 offset:31744
v_mfma_f32_16x16x32_bf16 v[132:135], v[204:207], v[28:31], v[132:135]
v_exp_f32 v151, v151
v_mfma_f32_16x16x32_bf16 v[140:143], v[204:207], v[44:47], v[140:143]
v_cvt_pk_bf16_f32 v171, v150, v151
s_cmp_ge_u32 s27, s25
s_cbranch_scc1 L_kk_kernel_c1_cb1
s_cmp_eq_u32 s27, 1
s_cbranch_scc1 L_kk_kernel_c1_cb1
s_add_u32 s15, s27, 1
s_cmp_lg_u32 s15, s25
s_cbranch_scc1 L_kk_kernel_c1_cb1n
s_waitcnt vmcnt(0)
L_kk_kernel_c1_cb1n:
s_waitcnt vmcnt(16)
s_barrier
s_cmp_eq_u32 s27, s65
s_cselect_b32 s18, 268435456, 0
s_add_u32 s15, s27, 3
s_cmp_gt_u32 s15, s25
s_cselect_b32 s34, 0, s34
buffer_store_dword v5, v4, s[16:19], 0 offen sc1
s_cbranch_scc1 L_kk_kernel_c1_cb1d
s_mov_b32 m0, s50
s_nop 0
buffer_load_dwordx4 v1, s[32:35], s36 offen offset:0 sc1 lds
buffer_load_dwordx4 v1, s[32:35], s36 offen offset:1024 sc1 lds
buffer_load_dwordx4 v1, s[32:35], s36 offen offset:2048 sc1 lds
buffer_load_dwordx4 v1, s[32:35], s36 offen offset:3072 sc1 lds
s_add_u32 m0, s50, 16384
s_nop 0
buffer_load_dwordx4 v1, s[32:35], s37 offen offset:0 sc1 lds
buffer_load_dwordx4 v1, s[32:35], s37 offen offset:1024 sc1 lds
buffer_load_dwordx4 v1, s[32:35], s37 offen offset:2048 sc1 lds
buffer_load_dwordx4 v1, s[32:35], s37 offen offset:3072 sc1 lds
s_add_u32 s36, s36, 16384
s_add_u32 s37, s37, 16384
s_add_u32 s50, s50, 32768
s_cmp_ge_u32 s50, 163840
s_cselect_b32 s50, s39, s50
s_branch L_kk_kernel_c1_cb1e
L_kk_kernel_c1_cb1d:
s_add_u32 s15, s27, 2
s_cmp_lg_u32 s15, s25
s_cbranch_scc1 L_kk_kernel_c1_cb1e
buffer_load_dword v241, v243, s[44:47], 0 offen sc1
buffer_load_dword v242, v243, s[44:47], 0 offen offset:1024 sc1
L_kk_kernel_c1_cb1e:
L_kk_kernel_c1_cb1:
v_mov_b32 v2, v3
s_add_u32 s27, s27, 1
s_waitcnt lgkmcnt(4)
v_mfma_f32_16x16x32_bf16 v[64:67], v[208:211], v[160:163], v[64:67]
v_exp_f32 v152, v152
v_mfma_f32_16x16x32_bf16 v[72:75], v[208:211], v[164:167], v[72:75]
ds_read_b128 v[176:179], v3 offset:0
ds_read_b128 v[180:183], v3 offset:1024
v_mfma_f32_16x16x32_bf16 v[68:71], v[212:215], v[160:163], v[68:71]
v_exp_f32 v153, v153
v_mfma_f32_16x16x32_bf16 v[76:79], v[212:215], v[164:167], v[76:79]
v_cvt_pk_bf16_f32 v172, v152, v153
v_mfma_f32_16x16x32_bf16 v[80:83], v[216:219], v[160:163], v[80:83]
v_exp_f32 v154, v154
v_mfma_f32_16x16x32_bf16 v[88:91], v[216:219], v[164:167], v[88:91]
ds_read_b128 v[184:187], v3 offset:2048
ds_read_b128 v[188:191], v3 offset:3072
v_mfma_f32_16x16x32_bf16 v[84:87], v[220:223], v[160:163], v[84:87]
v_exp_f32 v155, v155
v_mfma_f32_16x16x32_bf16 v[92:95], v[220:223], v[164:167], v[92:95]
v_cvt_pk_bf16_f32 v173, v154, v155
s_waitcnt lgkmcnt(4)
v_mfma_f32_16x16x32_bf16 v[96:99], v[224:227], v[160:163], v[96:99]
v_exp_f32 v156, v156
v_mfma_f32_16x16x32_bf16 v[104:107], v[224:227], v[164:167], v[104:107]
ds_read_b128 v[192:195], v3 offset:4096
ds_read_b128 v[196:199], v3 offset:5120
v_mfma_f32_16x16x32_bf16 v[100:103], v[228:231], v[160:163], v[100:103]
v_exp_f32 v157, v157
v_mfma_f32_16x16x32_bf16 v[108:111], v[228:231], v[164:167], v[108:111]
v_cvt_pk_bf16_f32 v174, v156, v157
v_mfma_f32_16x16x32_bf16 v[112:115], v[232:235], v[160:163], v[112:115]
v_exp_f32 v158, v158
v_mfma_f32_16x16x32_bf16 v[120:123], v[232:235], v[164:167], v[120:123]
ds_read_b128 v[200:203], v3 offset:6144
ds_read_b128 v[204:207], v3 offset:7168
v_mfma_f32_16x16x32_bf16 v[116:119], v[236:239], v[160:163], v[116:119]
v_exp_f32 v159, v159
v_mfma_f32_16x16x32_bf16 v[124:127], v[236:239], v[164:167], v[124:127]
v_cvt_pk_bf16_f32 v175, v158, v159
v_mfma_f32_16x16x32_bf16 v[244:247], v[252:255], v[160:163], v[244:247]
v_mfma_f32_16x16x32_bf16 v[248:251], v[252:255], v[164:167], v[248:251]
L_kk_kernel_c1_tail0:
ds_read_b128 v[176:179], v2 offset:16384
ds_read_b128 v[180:183], v2 offset:17408
ds_read_b128 v[184:187], v2 offset:18432
ds_read_b128 v[188:191], v2 offset:19456
ds_read_b128 v[192:195], v2 offset:20480
ds_read_b128 v[196:199], v2 offset:21504
ds_read_b128 v[200:203], v2 offset:22528
ds_read_b128 v[204:207], v2 offset:23552
ds_read_b128 v[208:211], v2 offset:24576
ds_read_b128 v[212:215], v2 offset:25600
ds_read_b128 v[216:219], v2 offset:26624
ds_read_b128 v[220:223], v2 offset:27648
ds_read_b128 v[224:227], v2 offset:28672
ds_read_b128 v[228:231], v2 offset:29696
ds_read_b128 v[232:235], v2 offset:30720
ds_read_b128 v[236:239], v2 offset:31744
s_waitcnt lgkmcnt(15)
v_mfma_f32_16x16x32_bf16 v[64:67], v[176:179], v[168:171], v[64:67]
v_exp_f32 v128, v128
v_mfma_f32_16x16x32_bf16 v[72:75], v[176:179], v[172:175], v[72:75]
v_exp_f32 v129, v129
s_waitcnt lgkmcnt(14)
v_mfma_f32_16x16x32_bf16 v[68:71], v[180:183], v[168:171], v[68:71]
v_exp_f32 v130, v130
v_mfma_f32_16x16x32_bf16 v[76:79], v[180:183], v[172:175], v[76:79]
v_exp_f32 v131, v131
v_cvt_pk_bf16_f32 v160, v128, v129
s_waitcnt lgkmcnt(13)
v_mfma_f32_16x16x32_bf16 v[80:83], v[184:187], v[168:171], v[80:83]
v_exp_f32 v132, v132
v_mfma_f32_16x16x32_bf16 v[88:91], v[184:187], v[172:175], v[88:91]
v_exp_f32 v133, v133
v_cvt_pk_bf16_f32 v161, v130, v131
s_waitcnt lgkmcnt(12)
v_mfma_f32_16x16x32_bf16 v[84:87], v[188:191], v[168:171], v[84:87]
v_exp_f32 v134, v134
v_mfma_f32_16x16x32_bf16 v[92:95], v[188:191], v[172:175], v[92:95]
v_exp_f32 v135, v135
v_cvt_pk_bf16_f32 v162, v132, v133
s_waitcnt lgkmcnt(11)
v_mfma_f32_16x16x32_bf16 v[96:99], v[192:195], v[168:171], v[96:99]
v_exp_f32 v136, v136
v_mfma_f32_16x16x32_bf16 v[104:107], v[192:195], v[172:175], v[104:107]
v_exp_f32 v137, v137
v_cvt_pk_bf16_f32 v163, v134, v135
s_waitcnt lgkmcnt(10)
v_mfma_f32_16x16x32_bf16 v[100:103], v[196:199], v[168:171], v[100:103]
v_exp_f32 v138, v138
v_mfma_f32_16x16x32_bf16 v[108:111], v[196:199], v[172:175], v[108:111]
v_exp_f32 v139, v139
v_cvt_pk_bf16_f32 v164, v136, v137
s_waitcnt lgkmcnt(9)
v_mfma_f32_16x16x32_bf16 v[112:115], v[200:203], v[168:171], v[112:115]
v_exp_f32 v140, v140
v_mfma_f32_16x16x32_bf16 v[120:123], v[200:203], v[172:175], v[120:123]
v_exp_f32 v141, v141
v_cvt_pk_bf16_f32 v165, v138, v139
s_waitcnt lgkmcnt(8)
v_mfma_f32_16x16x32_bf16 v[116:119], v[204:207], v[168:171], v[116:119]
v_exp_f32 v142, v142
v_mfma_f32_16x16x32_bf16 v[124:127], v[204:207], v[172:175], v[124:127]
v_exp_f32 v143, v143
v_cvt_pk_bf16_f32 v166, v140, v141
v_mfma_f32_16x16x32_bf16 v[244:247], v[252:255], v[168:171], v[244:247]
v_mfma_f32_16x16x32_bf16 v[248:251], v[252:255], v[172:175], v[248:251]
v_cvt_pk_bf16_f32 v167, v142, v143
s_cmp_ge_u32 s27, s25
s_cbranch_scc1 L_kk_kernel_c1_cb2
s_cmp_eq_u32 s27, 1
s_cbranch_scc1 L_kk_kernel_c1_cb2
s_add_u32 s15, s27, 1
s_cmp_lg_u32 s15, s25
s_cbranch_scc1 L_kk_kernel_c1_cb2n
s_waitcnt vmcnt(0)
L_kk_kernel_c1_cb2n:
s_waitcnt vmcnt(16)
s_barrier
s_cmp_eq_u32 s27, s65
s_cselect_b32 s18, 268435456, 0
s_add_u32 s15, s27, 3
s_cmp_gt_u32 s15, s25
s_cselect_b32 s34, 0, s34
buffer_store_dword v5, v4, s[16:19], 0 offen sc1
s_cbranch_scc1 L_kk_kernel_c1_cb2d
s_mov_b32 m0, s50
s_nop 0
buffer_load_dwordx4 v1, s[32:35], s36 offen offset:0 sc1 lds
buffer_load_dwordx4 v1, s[32:35], s36 offen offset:1024 sc1 lds
buffer_load_dwordx4 v1, s[32:35], s36 offen offset:2048 sc1 lds
buffer_load_dwordx4 v1, s[32:35], s36 offen offset:3072 sc1 lds
s_add_u32 m0, s50, 16384
s_nop 0
buffer_load_dwordx4 v1, s[32:35], s37 offen offset:0 sc1 lds
buffer_load_dwordx4 v1, s[32:35], s37 offen offset:1024 sc1 lds
buffer_load_dwordx4 v1, s[32:35], s37 offen offset:2048 sc1 lds
buffer_load_dwordx4 v1, s[32:35], s37 offen offset:3072 sc1 lds
s_add_u32 s36, s36, 16384
s_add_u32 s37, s37, 16384
s_add_u32 s50, s50, 32768
s_cmp_ge_u32 s50, 163840
s_cselect_b32 s50, s39, s50
s_branch L_kk_kernel_c1_cb2e
L_kk_kernel_c1_cb2d:
s_add_u32 s15, s27, 2
s_cmp_lg_u32 s15, s25
s_cbranch_scc1 L_kk_kernel_c1_cb2e
buffer_load_dword v241, v243, s[44:47], 0 offen sc1
buffer_load_dword v242, v243, s[44:47], 0 offen offset:1024 sc1
L_kk_kernel_c1_cb2e:
L_kk_kernel_c1_cb2:
v_mov_b32 v2, v3
s_add_u32 s27, s27, 1
s_waitcnt lgkmcnt(7)
v_mfma_f32_16x16x32_bf16 v[64:67], v[208:211], v[160:163], v[64:67]
v_mfma_f32_16x16x32_bf16 v[72:75], v[208:211], v[164:167], v[72:75]
s_waitcnt lgkmcnt(6)
v_mfma_f32_16x16x32_bf16 v[68:71], v[212:215], v[160:163], v[68:71]
v_mfma_f32_16x16x32_bf16 v[76:79], v[212:215], v[164:167], v[76:79]
s_waitcnt lgkmcnt(5)
v_mfma_f32_16x16x32_bf16 v[80:83], v[216:219], v[160:163], v[80:83]
v_mfma_f32_16x16x32_bf16 v[88:91], v[216:219], v[164:167], v[88:91]
s_waitcnt lgkmcnt(4)
v_mfma_f32_16x16x32_bf16 v[84:87], v[220:223], v[160:163], v[84:87]
v_mfma_f32_16x16x32_bf16 v[92:95], v[220:223], v[164:167], v[92:95]
s_waitcnt lgkmcnt(3)
v_mfma_f32_16x16x32_bf16 v[96:99], v[224:227], v[160:163], v[96:99]
v_mfma_f32_16x16x32_bf16 v[104:107], v[224:227], v[164:167], v[104:107]
s_waitcnt lgkmcnt(2)
v_mfma_f32_16x16x32_bf16 v[100:103], v[228:231], v[160:163], v[100:103]
v_mfma_f32_16x16x32_bf16 v[108:111], v[228:231], v[164:167], v[108:111]
s_waitcnt lgkmcnt(1)
v_mfma_f32_16x16x32_bf16 v[112:115], v[232:235], v[160:163], v[112:115]
v_mfma_f32_16x16x32_bf16 v[120:123], v[232:235], v[164:167], v[120:123]
s_waitcnt lgkmcnt(0)
v_mfma_f32_16x16x32_bf16 v[116:119], v[236:239], v[160:163], v[116:119]
v_mfma_f32_16x16x32_bf16 v[124:127], v[236:239], v[164:167], v[124:127]
v_mfma_f32_16x16x32_bf16 v[244:247], v[252:255], v[160:163], v[244:247]
v_mfma_f32_16x16x32_bf16 v[248:251], v[252:255], v[164:167], v[248:251]
s_branch L_kk_kernel_c1_epi
L_kk_kernel_c1_tail1:
ds_read_b128 v[176:179], v2 offset:24576
ds_read_b128 v[180:183], v2 offset:25600
ds_read_b128 v[184:187], v2 offset:26624
ds_read_b128 v[188:191], v2 offset:27648
ds_read_b128 v[192:195], v2 offset:28672
ds_read_b128 v[196:199], v2 offset:29696
ds_read_b128 v[200:203], v2 offset:30720
ds_read_b128 v[204:207], v2 offset:31744
s_waitcnt lgkmcnt(7)
v_mfma_f32_16x16x32_bf16 v[64:67], v[176:179], v[160:163], v[64:67]
v_exp_f32 v144, v144
v_mfma_f32_16x16x32_bf16 v[72:75], v[176:179], v[164:167], v[72:75]
v_exp_f32 v145, v145
s_waitcnt lgkmcnt(6)
v_mfma_f32_16x16x32_bf16 v[68:71], v[180:183], v[160:163], v[68:71]
v_exp_f32 v146, v146
v_mfma_f32_16x16x32_bf16 v[76:79], v[180:183], v[164:167], v[76:79]
v_exp_f32 v147, v147
v_cvt_pk_bf16_f32 v168, v144, v145
s_waitcnt lgkmcnt(5)
v_mfma_f32_16x16x32_bf16 v[80:83], v[184:187], v[160:163], v[80:83]
v_exp_f32 v148, v148
v_mfma_f32_16x16x32_bf16 v[88:91], v[184:187], v[164:167], v[88:91]
v_exp_f32 v149, v149
v_cvt_pk_bf16_f32 v169, v146, v147
s_waitcnt lgkmcnt(4)
v_mfma_f32_16x16x32_bf16 v[84:87], v[188:191], v[160:163], v[84:87]
v_exp_f32 v150, v150
v_mfma_f32_16x16x32_bf16 v[92:95], v[188:191], v[164:167], v[92:95]
v_exp_f32 v151, v151
v_cvt_pk_bf16_f32 v170, v148, v149
s_waitcnt lgkmcnt(3)
v_mfma_f32_16x16x32_bf16 v[96:99], v[192:195], v[160:163], v[96:99]
v_exp_f32 v152, v152
v_mfma_f32_16x16x32_bf16 v[104:107], v[192:195], v[164:167], v[104:107]
v_exp_f32 v153, v153
v_cvt_pk_bf16_f32 v171, v150, v151
s_waitcnt lgkmcnt(2)
v_mfma_f32_16x16x32_bf16 v[100:103], v[196:199], v[160:163], v[100:103]
v_exp_f32 v154, v154
v_mfma_f32_16x16x32_bf16 v[108:111], v[196:199], v[164:167], v[108:111]
v_exp_f32 v155, v155
v_cvt_pk_bf16_f32 v172, v152, v153
s_waitcnt lgkmcnt(1)
v_mfma_f32_16x16x32_bf16 v[112:115], v[200:203], v[160:163], v[112:115]
v_exp_f32 v156, v156
v_mfma_f32_16x16x32_bf16 v[120:123], v[200:203], v[164:167], v[120:123]
v_exp_f32 v157, v157
v_cvt_pk_bf16_f32 v173, v154, v155
s_waitcnt lgkmcnt(0)
v_mfma_f32_16x16x32_bf16 v[116:119], v[204:207], v[160:163], v[116:119]
v_exp_f32 v158, v158
v_mfma_f32_16x16x32_bf16 v[124:127], v[204:207], v[164:167], v[124:127]
v_exp_f32 v159, v159
v_cvt_pk_bf16_f32 v174, v156, v157
v_mfma_f32_16x16x32_bf16 v[244:247], v[252:255], v[160:163], v[244:247]
v_mfma_f32_16x16x32_bf16 v[248:251], v[252:255], v[164:167], v[248:251]
v_cvt_pk_bf16_f32 v175, v158, v159
s_cmp_ge_u32 s27, s25
s_cbranch_scc1 L_kk_kernel_c1_cb3
s_cmp_eq_u32 s27, 1
s_cbranch_scc1 L_kk_kernel_c1_cb3
s_add_u32 s15, s27, 1
s_cmp_lg_u32 s15, s25
s_cbranch_scc1 L_kk_kernel_c1_cb3n
s_waitcnt vmcnt(0)
L_kk_kernel_c1_cb3n:
s_waitcnt vmcnt(16)
s_barrier
s_cmp_eq_u32 s27, s65
s_cselect_b32 s18, 268435456, 0
s_add_u32 s15, s27, 3
s_cmp_gt_u32 s15, s25
s_cselect_b32 s34, 0, s34
buffer_store_dword v5, v4, s[16:19], 0 offen sc1
s_cbranch_scc1 L_kk_kernel_c1_cb3d
s_mov_b32 m0, s50
s_nop 0
buffer_load_dwordx4 v1, s[32:35], s36 offen offset:0 sc1 lds
buffer_load_dwordx4 v1, s[32:35], s36 offen offset:1024 sc1 lds
buffer_load_dwordx4 v1, s[32:35], s36 offen offset:2048 sc1 lds
buffer_load_dwordx4 v1, s[32:35], s36 offen offset:3072 sc1 lds
s_add_u32 m0, s50, 16384
s_nop 0
buffer_load_dwordx4 v1, s[32:35], s37 offen offset:0 sc1 lds
buffer_load_dwordx4 v1, s[32:35], s37 offen offset:1024 sc1 lds
buffer_load_dwordx4 v1, s[32:35], s37 offen offset:2048 sc1 lds
buffer_load_dwordx4 v1, s[32:35], s37 offen offset:3072 sc1 lds
s_add_u32 s36, s36, 16384
s_add_u32 s37, s37, 16384
s_add_u32 s50, s50, 32768
s_cmp_ge_u32 s50, 163840
s_cselect_b32 s50, s39, s50
s_branch L_kk_kernel_c1_cb3e
L_kk_kernel_c1_cb3d:
s_add_u32 s15, s27, 2
s_cmp_lg_u32 s15, s25
s_cbranch_scc1 L_kk_kernel_c1_cb3e
buffer_load_dword v241, v243, s[44:47], 0 offen sc1
buffer_load_dword v242, v243, s[44:47], 0 offen offset:1024 sc1
L_kk_kernel_c1_cb3e:
L_kk_kernel_c1_cb3:
ds_read_b128 v[208:211], v3 offset:16384
ds_read_b128 v[212:215], v3 offset:17408
ds_read_b128 v[216:219], v3 offset:18432
ds_read_b128 v[220:223], v3 offset:19456
ds_read_b128 v[224:227], v3 offset:20480
ds_read_b128 v[228:231], v3 offset:21504
ds_read_b128 v[232:235], v3 offset:22528
ds_read_b128 v[236:239], v3 offset:23552
v_mov_b32 v2, v3
s_add_u32 s27, s27, 1
s_waitcnt lgkmcnt(7)
v_mfma_f32_16x16x32_bf16 v[64:67], v[208:211], v[168:171], v[64:67]
v_mfma_f32_16x16x32_bf16 v[72:75], v[208:211], v[172:175], v[72:75]
s_waitcnt lgkmcnt(6)
v_mfma_f32_16x16x32_bf16 v[68:71], v[212:215], v[168:171], v[68:71]
v_mfma_f32_16x16x32_bf16 v[76:79], v[212:215], v[172:175], v[76:79]
s_waitcnt lgkmcnt(5)
v_mfma_f32_16x16x32_bf16 v[80:83], v[216:219], v[168:171], v[80:83]
v_mfma_f32_16x16x32_bf16 v[88:91], v[216:219], v[172:175], v[88:91]
s_waitcnt lgkmcnt(4)
v_mfma_f32_16x16x32_bf16 v[84:87], v[220:223], v[168:171], v[84:87]
v_mfma_f32_16x16x32_bf16 v[92:95], v[220:223], v[172:175], v[92:95]
s_waitcnt lgkmcnt(3)
v_mfma_f32_16x16x32_bf16 v[96:99], v[224:227], v[168:171], v[96:99]
v_mfma_f32_16x16x32_bf16 v[104:107], v[224:227], v[172:175], v[104:107]
s_waitcnt lgkmcnt(2)
v_mfma_f32_16x16x32_bf16 v[100:103], v[228:231], v[168:171], v[100:103]
v_mfma_f32_16x16x32_bf16 v[108:111], v[228:231], v[172:175], v[108:111]
s_waitcnt lgkmcnt(1)
v_mfma_f32_16x16x32_bf16 v[112:115], v[232:235], v[168:171], v[112:115]
v_mfma_f32_16x16x32_bf16 v[120:123], v[232:235], v[172:175], v[120:123]
s_waitcnt lgkmcnt(0)
v_mfma_f32_16x16x32_bf16 v[116:119], v[236:239], v[168:171], v[116:119]
v_mfma_f32_16x16x32_bf16 v[124:127], v[236:239], v[172:175], v[124:127]
v_mfma_f32_16x16x32_bf16 v[244:247], v[252:255], v[168:171], v[244:247]
v_mfma_f32_16x16x32_bf16 v[248:251], v[252:255], v[172:175], v[248:251]
L_kk_kernel_c1_epi:
v_mov_b32 v11, 0x4e800000
v_mov_b32 v3, 0
s_nop 5
v_add_f32 v15, v244, v248
v_cmp_nle_f32 vcc, v15, v11
s_cmp_lg_u64 vcc, 0
s_cselect_b32 s48, 1, 0
s_cbranch_scc1 L_kk_kernel_c1_post
v_rcp_f32 v12, v244
v_rcp_f32 v13, v248
s_lshr_b32 s4, s24, 1
s_mul_i32 s4, s4, 589824
s_lshl_b32 s5, s20, 14
s_add_u32 s4, s4, s5
s_and_b32 s5, s24, 1
s_lshl_b32 s5, s5, 11
s_add_u32 s4, s4, s5
s_add_u32 s4, s4, 50331648
v_mul_f32 v64, v12, v64
v_mul_f32 v65, v12, v65
v_mul_f32 v66, v12, v66
v_mul_f32 v67, v12, v67
v_mul_f32 v68, v12, v68
v_mul_f32 v69, v12, v69
v_mul_f32 v70, v12, v70
v_mul_f32 v71, v12, v71
v_cvt_pk_bf16_f32 v64, v64, v65
v_cvt_pk_bf16_f32 v65, v66, v67
v_cvt_pk_bf16_f32 v66, v68, v69
v_cvt_pk_bf16_f32 v67, v70, v71
buffer_store_dwordx4 v[64:67], v1, s[44:47], s4 offen offset:0 sc1
v_mul_f32 v72, v13, v72
v_mul_f32 v73, v13, v73
v_mul_f32 v74, v13, v74
v_mul_f32 v75, v13, v75
v_mul_f32 v76, v13, v76
v_mul_f32 v77, v13, v77
v_mul_f32 v78, v13, v78
v_mul_f32 v79, v13, v79
v_cvt_pk_bf16_f32 v72, v72, v73
v_cvt_pk_bf16_f32 v73, v74, v75
v_cvt_pk_bf16_f32 v74, v76, v77
v_cvt_pk_bf16_f32 v75, v78, v79
buffer_store_dwordx4 v[72:75], v1, s[44:47], s4 offen offset:1024 sc1
s_add_u32 s4, s4, 4096
v_mul_f32 v80, v12, v80
v_mul_f32 v81, v12, v81
v_mul_f32 v82, v12, v82
v_mul_f32 v83, v12, v83
v_mul_f32 v84, v12, v84
v_mul_f32 v85, v12, v85
v_mul_f32 v86, v12, v86
v_mul_f32 v87, v12, v87
v_cvt_pk_bf16_f32 v80, v80, v81
v_cvt_pk_bf16_f32 v81, v82, v83
v_cvt_pk_bf16_f32 v82, v84, v85
v_cvt_pk_bf16_f32 v83, v86, v87
buffer_store_dwordx4 v[80:83], v1, s[44:47], s4 offen offset:0 sc1
v_mul_f32 v88, v13, v88
v_mul_f32 v89, v13, v89
v_mul_f32 v90, v13, v90
v_mul_f32 v91, v13, v91
v_mul_f32 v92, v13, v92
v_mul_f32 v93, v13, v93
v_mul_f32 v94, v13, v94
v_mul_f32 v95, v13, v95
v_cvt_pk_bf16_f32 v88, v88, v89
v_cvt_pk_bf16_f32 v89, v90, v91
v_cvt_pk_bf16_f32 v90, v92, v93
v_cvt_pk_bf16_f32 v91, v94, v95
buffer_store_dwordx4 v[88:91], v1, s[44:47], s4 offen offset:1024 sc1
s_add_u32 s4, s4, 4096
v_mul_f32 v96, v12, v96
v_mul_f32 v97, v12, v97
v_mul_f32 v98, v12, v98
v_mul_f32 v99, v12, v99
v_mul_f32 v100, v12, v100
v_mul_f32 v101, v12, v101
v_mul_f32 v102, v12, v102
v_mul_f32 v103, v12, v103
v_cvt_pk_bf16_f32 v96, v96, v97
v_cvt_pk_bf16_f32 v97, v98, v99
v_cvt_pk_bf16_f32 v98, v100, v101
v_cvt_pk_bf16_f32 v99, v102, v103
buffer_store_dwordx4 v[96:99], v1, s[44:47], s4 offen offset:0 sc1
v_mul_f32 v104, v13, v104
v_mul_f32 v105, v13, v105
v_mul_f32 v106, v13, v106
v_mul_f32 v107, v13, v107
v_mul_f32 v108, v13, v108
v_mul_f32 v109, v13, v109
v_mul_f32 v110, v13, v110
v_mul_f32 v111, v13, v111
v_cvt_pk_bf16_f32 v104, v104, v105
v_cvt_pk_bf16_f32 v105, v106, v107
v_cvt_pk_bf16_f32 v106, v108, v109
v_cvt_pk_bf16_f32 v107, v110, v111
buffer_store_dwordx4 v[104:107], v1, s[44:47], s4 offen offset:1024 sc1
s_add_u32 s4, s4, 4096
v_mul_f32 v112, v12, v112
v_mul_f32 v113, v12, v113
v_mul_f32 v114, v12, v114
v_mul_f32 v115, v12, v115
v_mul_f32 v116, v12, v116
v_mul_f32 v117, v12, v117
v_mul_f32 v118, v12, v118
v_mul_f32 v119, v12, v119
v_cvt_pk_bf16_f32 v112, v112, v113
v_cvt_pk_bf16_f32 v113, v114, v115
v_cvt_pk_bf16_f32 v114, v116, v117
v_cvt_pk_bf16_f32 v115, v118, v119
buffer_store_dwordx4 v[112:115], v1, s[44:47], s4 offen offset:0 sc1
v_mul_f32 v120, v13, v120
v_mul_f32 v121, v13, v121
v_mul_f32 v122, v13, v122
v_mul_f32 v123, v13, v123
v_mul_f32 v124, v13, v124
v_mul_f32 v125, v13, v125
v_mul_f32 v126, v13, v126
v_mul_f32 v127, v13, v127
v_cvt_pk_bf16_f32 v120, v120, v121
v_cvt_pk_bf16_f32 v121, v122, v123
v_cvt_pk_bf16_f32 v122, v124, v125
v_cvt_pk_bf16_f32 v123, v126, v127
buffer_store_dwordx4 v[120:123], v1, s[44:47], s4 offen offset:1024 sc1
L_kk_kernel_c1_post:
v_lshlrev_b32 v8, 2, v0
s_cmp_ge_u32 s21, 4
s_cbranch_scc1 L_kk_kernel_c1_post1
L_kk_kernel_c1_pd:
s_cmp_ge_u32 s27, 8
s_cbranch_scc1 L_kk_kernel_c1_pdd
s_cmp_ge_u32 s27, s25
s_cbranch_scc1 L_kk_kernel_c1_cb4
s_cmp_eq_u32 s27, 1
s_cbranch_scc1 L_kk_kernel_c1_cb4
s_add_u32 s15, s27, 1
s_cmp_lg_u32 s15, s25
s_cbranch_scc1 L_kk_kernel_c1_cb4n
s_waitcnt vmcnt(0)
L_kk_kernel_c1_cb4n:
s_waitcnt vmcnt(16)
s_barrier
s_cmp_eq_u32 s27, s65
s_cselect_b32 s18, 268435456, 0
s_add_u32 s15, s27, 3
s_cmp_gt_u32 s15, s25
s_cselect_b32 s34, 0, s34
buffer_store_dword v5, v4, s[16:19], 0 offen sc1
s_cbranch_scc1 L_kk_kernel_c1_cb4d
s_mov_b32 m0, s50
s_nop 0
buffer_load_dwordx4 v1, s[32:35], s36 offen offset:0 sc1 lds
buffer_load_dwordx4 v1, s[32:35], s36 offen offset:1024 sc1 lds
buffer_load_dwordx4 v1, s[32:35], s36 offen offset:2048 sc1 lds
buffer_load_dwordx4 v1, s[32:35], s36 offen offset:3072 sc1 lds
s_add_u32 m0, s50, 16384
s_nop 0
buffer_load_dwordx4 v1, s[32:35], s37 offen offset:0 sc1 lds
buffer_load_dwordx4 v1, s[32:35], s37 offen offset:1024 sc1 lds
buffer_load_dwordx4 v1, s[32:35], s37 offen offset:2048 sc1 lds
buffer_load_dwordx4 v1, s[32:35], s37 offen offset:3072 sc1 lds
s_add_u32 s36, s36, 16384
s_add_u32 s37, s37, 16384
s_add_u32 s50, s50, 32768
s_cmp_ge_u32 s50, 163840
s_cselect_b32 s50, s39, s50
s_branch L_kk_kernel_c1_cb4e
L_kk_kernel_c1_cb4d:
s_add_u32 s15, s27, 2
s_cmp_lg_u32 s15, s25
s_cbranch_scc1 L_kk_kernel_c1_cb4e
buffer_load_dword v241, v243, s[44:47], 0 offen sc1
buffer_load_dword v242, v243, s[44:47], 0 offen offset:1024 sc1
L_kk_kernel_c1_cb4e:
L_kk_kernel_c1_cb4:
s_add_u32 s27, s27, 1
s_branch L_kk_kernel_c1_pd
L_kk_kernel_c1_pdd:
s_lshr_b32 s6, s24, 1
s_lshl_b32 s6, s6, 6
s_lshl_b32 s8, s20, 1
s_add_u32 s6, s6, s8
s_and_b32 s8, s24, 1
s_add_u32 s6, s6, s8
s_lshl_b32 s8, s6, 13
s_add_u32 s9, s8, 4096
s_lshl_b32 s10, s6, 10
s_mov_b32 s68, s78
s_and_b32 s69, s79, 0xffff
s_mov_b32 s70, 4194304
s_mov_b32 s71, 0x20000
s_mov_b32 s60, s76
s_and_b32 s61, s77, 0xffff
s_mov_b32 s62, 524288
s_mov_b32 s63, 0x20000
buffer_load_dwordx4 v[176:179], v1, s[68:71], s8 offen offset:0
buffer_load_dwordx4 v[180:183], v1, s[68:71], s8 offen offset:1024
buffer_load_dwordx4 v[184:187], v1, s[68:71], s8 offen offset:2048
s_cmp_ge_u32 s27, s25
s_cbranch_scc1 L_kk_kernel_c1_cb5s
s_cmp_eq_u32 s27, 1
s_cbranch_scc1 L_kk_kernel_c1_cb5s
s_add_u32 s15, s27, 1
s_cmp_lg_u32 s15, s25
s_cbranch_scc1 L_kk_kernel_c1_cb5n
s_waitcnt vmcnt(0)
L_kk_kernel_c1_cb5n:
s_waitcnt vmcnt(19)
s_barrier
s_cmp_eq_u32 s27, s65
s_cselect_b32 s18, 268435456, 0
s_add_u32 s15, s27, 3
s_cmp_gt_u32 s15, s25
s_cselect_b32 s34, 0, s34
buffer_store_dword v5, v4, s[16:19], 0 offen sc1
s_cbranch_scc1 L_kk_kernel_c1_cb5d
s_mov_b32 m0, s50
s_nop 0
buffer_load_dwordx4 v1, s[32:35], s36 offen offset:0 sc1 lds
buffer_load_dwordx4 v1, s[32:35], s36 offen offset:1024 sc1 lds
buffer_load_dwordx4 v1, s[32:35], s36 offen offset:2048 sc1 lds
buffer_load_dwordx4 v1, s[32:35], s36 offen offset:3072 sc1 lds
s_add_u32 m0, s50, 16384
s_nop 0
buffer_load_dwordx4 v1, s[32:35], s37 offen offset:0 sc1 lds
buffer_load_dwordx4 v1, s[32:35], s37 offen offset:1024 sc1 lds
buffer_load_dwordx4 v1, s[32:35], s37 offen offset:2048 sc1 lds
buffer_load_dwordx4 v1, s[32:35], s37 offen offset:3072 sc1 lds
s_add_u32 s36, s36, 16384
s_add_u32 s37, s37, 16384
s_add_u32 s50, s50, 32768
s_cmp_ge_u32 s50, 163840
s_cselect_b32 s50, s39, s50
s_branch L_kk_kernel_c1_cb5e
L_kk_kernel_c1_cb5d:
s_add_u32 s15, s27, 2
s_cmp_lg_u32 s15, s25
s_cbranch_scc1 L_kk_kernel_c1_cb5e
buffer_load_dword v241, v243, s[44:47], 0 offen sc1
buffer_load_dword v242, v243, s[44:47], 0 offen offset:1024 sc1
L_kk_kernel_c1_cb5e:
s_branch L_kk_kernel_c1_cb5
L_kk_kernel_c1_cb5s:
s_waitcnt vmcnt(0)
L_kk_kernel_c1_cb5:
s_add_u32 s27, s27, 1
buffer_load_dwordx4 v[188:191], v1, s[68:71], s8 offen offset:3072
buffer_load_dwordx4 v[192:195], v1, s[68:71], s9 offen offset:0
buffer_load_dwordx4 v[196:199], v1, s[68:71], s9 offen offset:1024
s_cmp_ge_u32 s27, s25
s_cbranch_scc1 L_kk_kernel_c1_cb6s
s_cmp_eq_u32 s27, 1
s_cbranch_scc1 L_kk_kernel_c1_cb6s
s_add_u32 s15, s27, 1
s_cmp_lg_u32 s15, s25
s_cbranch_scc1 L_kk_kernel_c1_cb6n
s_waitcnt vmcnt(0)
L_kk_kernel_c1_cb6n:
s_waitcnt vmcnt(23)
s_barrier
s_cmp_eq_u32 s27, s65
s_cselect_b32 s18, 268435456, 0
s_add_u32 s15, s27, 3
s_cmp_gt_u32 s15, s25
s_cselect_b32 s34, 0, s34
buffer_store_dword v5, v4, s[16:19], 0 offen sc1
s_cbranch_scc1 L_kk_kernel_c1_cb6d
s_mov_b32 m0, s50
s_nop 0
buffer_load_dwordx4 v1, s[32:35], s36 offen offset:0 sc1 lds
buffer_load_dwordx4 v1, s[32:35], s36 offen offset:1024 sc1 lds
buffer_load_dwordx4 v1, s[32:35], s36 offen offset:2048 sc1 lds
buffer_load_dwordx4 v1, s[32:35], s36 offen offset:3072 sc1 lds
s_add_u32 m0, s50, 16384
s_nop 0
buffer_load_dwordx4 v1, s[32:35], s37 offen offset:0 sc1 lds
buffer_load_dwordx4 v1, s[32:35], s37 offen offset:1024 sc1 lds
buffer_load_dwordx4 v1, s[32:35], s37 offen offset:2048 sc1 lds
buffer_load_dwordx4 v1, s[32:35], s37 offen offset:3072 sc1 lds
s_add_u32 s36, s36, 16384
s_add_u32 s37, s37, 16384
s_add_u32 s50, s50, 32768
s_cmp_ge_u32 s50, 163840
s_cselect_b32 s50, s39, s50
s_branch L_kk_kernel_c1_cb6e
L_kk_kernel_c1_cb6d:
s_add_u32 s15, s27, 2
s_cmp_lg_u32 s15, s25
s_cbranch_scc1 L_kk_kernel_c1_cb6e
buffer_load_dword v241, v243, s[44:47], 0 offen sc1
buffer_load_dword v242, v243, s[44:47], 0 offen offset:1024 sc1
L_kk_kernel_c1_cb6e:
s_branch L_kk_kernel_c1_cb6
L_kk_kernel_c1_cb6s:
s_waitcnt vmcnt(0)
L_kk_kernel_c1_cb6:
s_add_u32 s27, s27, 1
buffer_load_dwordx4 v[200:203], v1, s[68:71], s9 offen offset:2048
buffer_load_dwordx4 v[204:207], v1, s[68:71], s9 offen offset:3072
buffer_load_dwordx4 v[208:211], v1, s[60:63], s10 offen
v_lshlrev_b32 v8, 2, v0
buffer_load_dword v3, v8, s[44:47], s51 offen sc1
v_lshrrev_b32 v128, 3, v0
v_mul_u32_u24 v128, 589824, v128
v_and_b32 v129, 7, v0
v_lshl_add_u32 v128, v129, 4, v128
v_xor_b32 v129, 32, v128
v_xor_b32 v130, 64, v128
v_xor_b32 v131, 96, v128
s_lshl_b32 s9, s6, 4
s_and_b32 s9, s9, 96
v_xor_b32 v132, s9, v128
s_lshl_b32 s8, s6, 10
s_add_u32 s8, s8, 75497472
s_lshl_b32 s9, s6, 7
s_add_u32 s9, s9, 76021760
s_cmp_ge_u32 s27, s25
s_cbranch_scc1 L_kk_kernel_c1_cb7s
s_cmp_eq_u32 s27, 1
s_cbranch_scc1 L_kk_kernel_c1_cb7s
s_add_u32 s15, s27, 1
s_cmp_lg_u32 s15, s25
s_cbranch_scc1 L_kk_kernel_c1_cb7n
s_waitcnt vmcnt(0)
L_kk_kernel_c1_cb7n:
s_waitcnt vmcnt(28)
s_barrier
s_cmp_eq_u32 s27, s65
s_cselect_b32 s18, 268435456, 0
s_add_u32 s15, s27, 3
s_cmp_gt_u32 s15, s25
s_cselect_b32 s34, 0, s34
buffer_store_dword v5, v4, s[16:19], 0 offen sc1
s_cbranch_scc1 L_kk_kernel_c1_cb7d
s_mov_b32 m0, s50
s_nop 0
buffer_load_dwordx4 v1, s[32:35], s36 offen offset:0 sc1 lds
buffer_load_dwordx4 v1, s[32:35], s36 offen offset:1024 sc1 lds
buffer_load_dwordx4 v1, s[32:35], s36 offen offset:2048 sc1 lds
buffer_load_dwordx4 v1, s[32:35], s36 offen offset:3072 sc1 lds
s_add_u32 m0, s50, 16384
s_nop 0
buffer_load_dwordx4 v1, s[32:35], s37 offen offset:0 sc1 lds
buffer_load_dwordx4 v1, s[32:35], s37 offen offset:1024 sc1 lds
buffer_load_dwordx4 v1, s[32:35], s37 offen offset:2048 sc1 lds
buffer_load_dwordx4 v1, s[32:35], s37 offen offset:3072 sc1 lds
s_add_u32 s36, s36, 16384
s_add_u32 s37, s37, 16384
s_add_u32 s50, s50, 32768
s_cmp_ge_u32 s50, 163840
s_cselect_b32 s50, s39, s50
s_branch L_kk_kernel_c1_cb7e
L_kk_kernel_c1_cb7d:
s_add_u32 s15, s27, 2
s_cmp_lg_u32 s15, s25
s_cbranch_scc1 L_kk_kernel_c1_cb7e
buffer_load_dword v241, v243, s[44:47], 0 offen sc1
buffer_load_dword v242, v243, s[44:47], 0 offen offset:1024 sc1
L_kk_kernel_c1_cb7e:
s_branch L_kk_kernel_c1_cb7
L_kk_kernel_c1_cb7s:
s_waitcnt vmcnt(0)
L_kk_kernel_c1_cb7:
s_add_u32 s27, s27, 1
s_cmp_ge_u32 s27, s25
s_cbranch_scc1 L_kk_kernel_c1_cb8s
s_cmp_eq_u32 s27, 1
s_cbranch_scc1 L_kk_kernel_c1_cb8s
s_add_u32 s15, s27, 1
s_cmp_lg_u32 s15, s25
s_cbranch_scc1 L_kk_kernel_c1_cb8n
s_waitcnt vmcnt(0)
L_kk_kernel_c1_cb8n:
s_waitcnt vmcnt(25)
s_barrier
s_cmp_eq_u32 s27, s65
s_cselect_b32 s18, 268435456, 0
s_add_u32 s15, s27, 3
s_cmp_gt_u32 s15, s25
s_cselect_b32 s34, 0, s34
buffer_store_dword v5, v4, s[16:19], 0 offen sc1
s_cbranch_scc1 L_kk_kernel_c1_cb8d
s_mov_b32 m0, s50
s_nop 0
buffer_load_dwordx4 v1, s[32:35], s36 offen offset:0 sc1 lds
buffer_load_dwordx4 v1, s[32:35], s36 offen offset:1024 sc1 lds
buffer_load_dwordx4 v1, s[32:35], s36 offen offset:2048 sc1 lds
buffer_load_dwordx4 v1, s[32:35], s36 offen offset:3072 sc1 lds
s_add_u32 m0, s50, 16384
s_nop 0
buffer_load_dwordx4 v1, s[32:35], s37 offen offset:0 sc1 lds
buffer_load_dwordx4 v1, s[32:35], s37 offen offset:1024 sc1 lds
buffer_load_dwordx4 v1, s[32:35], s37 offen offset:2048 sc1 lds
buffer_load_dwordx4 v1, s[32:35], s37 offen offset:3072 sc1 lds
s_add_u32 s36, s36, 16384
s_add_u32 s37, s37, 16384
s_add_u32 s50, s50, 32768
s_cmp_ge_u32 s50, 163840
s_cselect_b32 s50, s39, s50
s_branch L_kk_kernel_c1_cb8e
L_kk_kernel_c1_cb8d:
s_add_u32 s15, s27, 2
s_cmp_lg_u32 s15, s25
s_cbranch_scc1 L_kk_kernel_c1_cb8e
buffer_load_dword v241, v243, s[44:47], 0 offen sc1
buffer_load_dword v242, v243, s[44:47], 0 offen offset:1024 sc1
L_kk_kernel_c1_cb8e:
s_branch L_kk_kernel_c1_cb8
L_kk_kernel_c1_cb8s:
s_waitcnt vmcnt(0)
L_kk_kernel_c1_cb8:
s_add_u32 s27, s27, 1
s_waitcnt vmcnt(13)
buffer_store_dwordx4 v[176:179], v128, s[44:47], s8 offen offset:0 sc1
s_waitcnt vmcnt(13)
buffer_store_dwordx4 v[180:183], v128, s[44:47], s8 offen offset:128 sc1
s_waitcnt vmcnt(13)
buffer_store_dwordx4 v[184:187], v129, s[44:47], s8 offen offset:256 sc1
s_cmp_ge_u32 s27, s25
s_cbranch_scc1 L_kk_kernel_c1_cb9s
s_cmp_eq_u32 s27, 1
s_cbranch_scc1 L_kk_kernel_c1_cb9s
s_add_u32 s15, s27, 1
s_cmp_lg_u32 s15, s25
s_cbranch_scc1 L_kk_kernel_c1_cb9n
s_waitcnt vmcnt(0)
L_kk_kernel_c1_cb9n:
s_waitcnt vmcnt(25)
s_barrier
s_cmp_eq_u32 s27, s65
s_cselect_b32 s18, 268435456, 0
s_add_u32 s15, s27, 3
s_cmp_gt_u32 s15, s25
s_cselect_b32 s34, 0, s34
buffer_store_dword v5, v4, s[16:19], 0 offen sc1
s_cbranch_scc1 L_kk_kernel_c1_cb9d
s_mov_b32 m0, s50
s_nop 0
buffer_load_dwordx4 v1, s[32:35], s36 offen offset:0 sc1 lds
buffer_load_dwordx4 v1, s[32:35], s36 offen offset:1024 sc1 lds
buffer_load_dwordx4 v1, s[32:35], s36 offen offset:2048 sc1 lds
buffer_load_dwordx4 v1, s[32:35], s36 offen offset:3072 sc1 lds
s_add_u32 m0, s50, 16384
s_nop 0
buffer_load_dwordx4 v1, s[32:35], s37 offen offset:0 sc1 lds
buffer_load_dwordx4 v1, s[32:35], s37 offen offset:1024 sc1 lds
buffer_load_dwordx4 v1, s[32:35], s37 offen offset:2048 sc1 lds
buffer_load_dwordx4 v1, s[32:35], s37 offen offset:3072 sc1 lds
s_add_u32 s36, s36, 16384
s_add_u32 s37, s37, 16384
s_add_u32 s50, s50, 32768
s_cmp_ge_u32 s50, 163840
s_cselect_b32 s50, s39, s50
s_branch L_kk_kernel_c1_cb9e
L_kk_kernel_c1_cb9d:
s_add_u32 s15, s27, 2
s_cmp_lg_u32 s15, s25
s_cbranch_scc1 L_kk_kernel_c1_cb9e
buffer_load_dword v241, v243, s[44:47], 0 offen sc1
buffer_load_dword v242, v243, s[44:47], 0 offen offset:1024 sc1
L_kk_kernel_c1_cb9e:
s_branch L_kk_kernel_c1_cb9
L_kk_kernel_c1_cb9s:
s_waitcnt vmcnt(0)
L_kk_kernel_c1_cb9:
s_add_u32 s27, s27, 1
s_waitcnt vmcnt(13)
buffer_store_dwordx4 v[188:191], v129, s[44:47], s8 offen offset:384 sc1
s_waitcnt vmcnt(13)
buffer_store_dwordx4 v[192:195], v130, s[44:47], s8 offen offset:512 sc1
s_waitcnt vmcnt(13)
buffer_store_dwordx4 v[196:199], v130, s[44:47], s8 offen offset:640 sc1
s_cmp_ge_u32 s27, s25
s_cbranch_scc1 L_kk_kernel_c1_cb10s
s_cmp_eq_u32 s27, 1
s_cbranch_scc1 L_kk_kernel_c1_cb10s
s_add_u32 s15, s27, 1
s_cmp_lg_u32 s15, s25
s_cbranch_scc1 L_kk_kernel_c1_cb10n
s_waitcnt vmcnt(0)
L_kk_kernel_c1_cb10n:
s_waitcnt vmcnt(24)
s_barrier
s_cmp_eq_u32 s27, s65
s_cselect_b32 s18, 268435456, 0
s_add_u32 s15, s27, 3
s_cmp_gt_u32 s15, s25
s_cselect_b32 s34, 0, s34
buffer_store_dword v5, v4, s[16:19], 0 offen sc1
s_cbranch_scc1 L_kk_kernel_c1_cb10d
s_mov_b32 m0, s50
s_nop 0
buffer_load_dwordx4 v1, s[32:35], s36 offen offset:0 sc1 lds
buffer_load_dwordx4 v1, s[32:35], s36 offen offset:1024 sc1 lds
buffer_load_dwordx4 v1, s[32:35], s36 offen offset:2048 sc1 lds
buffer_load_dwordx4 v1, s[32:35], s36 offen offset:3072 sc1 lds
s_add_u32 m0, s50, 16384
s_nop 0
buffer_load_dwordx4 v1, s[32:35], s37 offen offset:0 sc1 lds
buffer_load_dwordx4 v1, s[32:35], s37 offen offset:1024 sc1 lds
buffer_load_dwordx4 v1, s[32:35], s37 offen offset:2048 sc1 lds
buffer_load_dwordx4 v1, s[32:35], s37 offen offset:3072 sc1 lds
s_add_u32 s36, s36, 16384
s_add_u32 s37, s37, 16384
s_add_u32 s50, s50, 32768
s_cmp_ge_u32 s50, 163840
s_cselect_b32 s50, s39, s50
s_branch L_kk_kernel_c1_cb10e
L_kk_kernel_c1_cb10d:
s_add_u32 s15, s27, 2
s_cmp_lg_u32 s15, s25
s_cbranch_scc1 L_kk_kernel_c1_cb10e
buffer_load_dword v241, v243, s[44:47], 0 offen sc1
buffer_load_dword v242, v243, s[44:47], 0 offen offset:1024 sc1
L_kk_kernel_c1_cb10e:
s_branch L_kk_kernel_c1_cb10
L_kk_kernel_c1_cb10s:
s_waitcnt vmcnt(0)
L_kk_kernel_c1_cb10:
s_add_u32 s27, s27, 1
s_waitcnt vmcnt(13)
buffer_store_dwordx4 v[200:203], v131, s[44:47], s8 offen offset:768 sc1
s_waitcnt vmcnt(13)
buffer_store_dwordx4 v[204:207], v131, s[44:47], s8 offen offset:896 sc1
s_waitcnt vmcnt(13)
buffer_store_dwordx4 v[208:211], v132, s[44:47], s9 offen sc1
s_lshl_b32 s4, s21, 2
s_add_u32 s4, s4, s22
s_cmp_lg_u32 s4, 4
s_cbranch_scc1 L_kk_kernel_c1_post1
s_waitcnt vmcnt(13)
v_cmp_eq_u32 vcc, 1, v3
s_and_b32 s64, vcc_lo, 0xff00
s_cmp_eq_u32 s64, 0xff00
s_cbranch_scc1 L_kk_kernel_c1_pgo
L_kk_kernel_c1_pw:
buffer_load_dword v3, v8, s[44:47], s51 offen sc1
s_cmp_ge_u32 s27, s25
s_cbranch_scc1 L_kk_kernel_c1_cb11s
s_cmp_eq_u32 s27, 1
s_cbranch_scc1 L_kk_kernel_c1_cb11s
s_add_u32 s15, s27, 1
s_cmp_lg_u32 s15, s25
s_cbranch_scc1 L_kk_kernel_c1_cb11n
s_waitcnt vmcnt(0)
L_kk_kernel_c1_cb11n:
s_waitcnt vmcnt(16)
s_barrier
s_cmp_eq_u32 s27, s65
s_cselect_b32 s18, 268435456, 0
s_add_u32 s15, s27, 3
s_cmp_gt_u32 s15, s25
s_cselect_b32 s34, 0, s34
buffer_store_dword v5, v4, s[16:19], 0 offen sc1
s_cbranch_scc1 L_kk_kernel_c1_cb11d
s_mov_b32 m0, s50
s_nop 0
buffer_load_dwordx4 v1, s[32:35], s36 offen offset:0 sc1 lds
buffer_load_dwordx4 v1, s[32:35], s36 offen offset:1024 sc1 lds
buffer_load_dwordx4 v1, s[32:35], s36 offen offset:2048 sc1 lds
buffer_load_dwordx4 v1, s[32:35], s36 offen offset:3072 sc1 lds
s_add_u32 m0, s50, 16384
s_nop 0
buffer_load_dwordx4 v1, s[32:35], s37 offen offset:0 sc1 lds
buffer_load_dwordx4 v1, s[32:35], s37 offen offset:1024 sc1 lds
buffer_load_dwordx4 v1, s[32:35], s37 offen offset:2048 sc1 lds
buffer_load_dwordx4 v1, s[32:35], s37 offen offset:3072 sc1 lds
s_add_u32 s36, s36, 16384
s_add_u32 s37, s37, 16384
s_add_u32 s50, s50, 32768
s_cmp_ge_u32 s50, 163840
s_cselect_b32 s50, s39, s50
s_branch L_kk_kernel_c1_cb11e
L_kk_kernel_c1_cb11d:
s_add_u32 s15, s27, 2
s_cmp_lg_u32 s15, s25
s_cbranch_scc1 L_kk_kernel_c1_cb11e
buffer_load_dword v241, v243, s[44:47], 0 offen sc1
buffer_load_dword v242, v243, s[44:47], 0 offen offset:1024 sc1
L_kk_kernel_c1_cb11e:
s_branch L_kk_kernel_c1_cb11
L_kk_kernel_c1_cb11s:
s_waitcnt vmcnt(0)
L_kk_kernel_c1_cb11:
s_add_u32 s27, s27, 1
s_cmp_ge_u32 s27, s25
s_cbranch_scc1 L_kk_kernel_c1_cb12s
s_cmp_eq_u32 s27, 1
s_cbranch_scc1 L_kk_kernel_c1_cb12s
s_add_u32 s15, s27, 1
s_cmp_lg_u32 s15, s25
s_cbranch_scc1 L_kk_kernel_c1_cb12n
s_waitcnt vmcnt(0)
L_kk_kernel_c1_cb12n:
s_waitcnt vmcnt(16)
s_barrier
s_cmp_eq_u32 s27, s65
s_cselect_b32 s18, 268435456, 0
s_add_u32 s15, s27, 3
s_cmp_gt_u32 s15, s25
s_cselect_b32 s34, 0, s34
buffer_store_dword v5, v4, s[16:19], 0 offen sc1
s_cbranch_scc1 L_kk_kernel_c1_cb12d
s_mov_b32 m0, s50
s_nop 0
buffer_load_dwordx4 v1, s[32:35], s36 offen offset:0 sc1 lds
buffer_load_dwordx4 v1, s[32:35], s36 offen offset:1024 sc1 lds
buffer_load_dwordx4 v1, s[32:35], s36 offen offset:2048 sc1 lds
buffer_load_dwordx4 v1, s[32:35], s36 offen offset:3072 sc1 lds
s_add_u32 m0, s50, 16384
s_nop 0
buffer_load_dwordx4 v1, s[32:35], s37 offen offset:0 sc1 lds
buffer_load_dwordx4 v1, s[32:35], s37 offen offset:1024 sc1 lds
buffer_load_dwordx4 v1, s[32:35], s37 offen offset:2048 sc1 lds
buffer_load_dwordx4 v1, s[32:35], s37 offen offset:3072 sc1 lds
s_add_u32 s36, s36, 16384
s_add_u32 s37, s37, 16384
s_add_u32 s50, s50, 32768
s_cmp_ge_u32 s50, 163840
s_cselect_b32 s50, s39, s50
s_branch L_kk_kernel_c1_cb12e
L_kk_kernel_c1_cb12d:
s_add_u32 s15, s27, 2
s_cmp_lg_u32 s15, s25
s_cbranch_scc1 L_kk_kernel_c1_cb12e
buffer_load_dword v241, v243, s[44:47], 0 offen sc1
buffer_load_dword v242, v243, s[44:47], 0 offen offset:1024 sc1
L_kk_kernel_c1_cb12e:
s_branch L_kk_kernel_c1_cb12
L_kk_kernel_c1_cb12s:
s_waitcnt vmcnt(0)
L_kk_kernel_c1_cb12:
s_add_u32 s27, s27, 1
s_waitcnt vmcnt(2)
v_cmp_eq_u32 vcc, 1, v3
s_and_b32 s64, vcc_lo, 0xff00
s_cmp_eq_u32 s64, 0xff00
s_cbranch_scc1 L_kk_kernel_c1_pgo
s_cmp_lt_u32 s27, s25
s_cbranch_scc1 L_kk_kernel_c1_pw
s_mov_b32 s67, 0x20000
L_kk_kernel_c1_spin2:
s_sleep 8
buffer_load_dword v3, v8, s[44:47], s51 offen sc1
s_waitcnt vmcnt(0)
v_cmp_eq_u32 vcc, 1, v3
s_and_b32 s64, vcc_lo, 0xff00
s_cmp_eq_u32 s64, 0xff00
s_cbranch_scc1 L_kk_kernel_c1_pgo
s_sub_u32 s67, s67, 1
s_cmp_lg_u32 s67, 0
s_cbranch_scc1 L_kk_kernel_c1_spin2
L_kk_kernel_c1_pgo:
s_sub_u32 s4, s51, 16384
buffer_load_dwordx4 v[64:67], v1, s[44:47], s4 offen offset:0 sc1
buffer_load_dwordx4 v[68:71], v1, s[44:47], s4 offen offset:1024 sc1
buffer_load_dwordx4 v[72:75], v1, s[44:47], s4 offen offset:2048 sc1
buffer_load_dwordx4 v[76:79], v1, s[44:47], s4 offen offset:3072 sc1
s_add_u32 s4, s4, 4096
buffer_load_dwordx4 v[80:83], v1, s[44:47], s4 offen offset:0 sc1
buffer_load_dwordx4 v[84:87], v1, s[44:47], s4 offen offset:1024 sc1
buffer_load_dwordx4 v[88:91], v1, s[44:47], s4 offen offset:2048 sc1
buffer_load_dwordx4 v[92:95], v1, s[44:47], s4 offen offset:3072 sc1
s_add_u32 s4, s4, 4096
s_cmp_ge_u32 s27, s25
s_cbranch_scc1 L_kk_kernel_c1_cb13s
s_cmp_eq_u32 s27, 1
s_cbranch_scc1 L_kk_kernel_c1_cb13s
s_add_u32 s15, s27, 1
s_cmp_lg_u32 s15, s25
s_cbranch_scc1 L_kk_kernel_c1_cb13n
s_waitcnt vmcnt(0)
L_kk_kernel_c1_cb13n:
s_waitcnt vmcnt(24)
s_barrier
s_cmp_eq_u32 s27, s65
s_cselect_b32 s18, 268435456, 0
s_add_u32 s15, s27, 3
s_cmp_gt_u32 s15, s25
s_cselect_b32 s34, 0, s34
buffer_store_dword v5, v4, s[16:19], 0 offen sc1
s_cbranch_scc1 L_kk_kernel_c1_cb13d
s_mov_b32 m0, s50
s_nop 0
buffer_load_dwordx4 v1, s[32:35], s36 offen offset:0 sc1 lds
buffer_load_dwordx4 v1, s[32:35], s36 offen offset:1024 sc1 lds
buffer_load_dwordx4 v1, s[32:35], s36 offen offset:2048 sc1 lds
buffer_load_dwordx4 v1, s[32:35], s36 offen offset:3072 sc1 lds
s_add_u32 m0, s50, 16384
s_nop 0
buffer_load_dwordx4 v1, s[32:35], s37 offen offset:0 sc1 lds
buffer_load_dwordx4 v1, s[32:35], s37 offen offset:1024 sc1 lds
buffer_load_dwordx4 v1, s[32:35], s37 offen offset:2048 sc1 lds
buffer_load_dwordx4 v1, s[32:35], s37 offen offset:3072 sc1 lds
s_add_u32 s36, s36, 16384
s_add_u32 s37, s37, 16384
s_add_u32 s50, s50, 32768
s_cmp_ge_u32 s50, 163840
s_cselect_b32 s50, s39, s50
s_branch L_kk_kernel_c1_cb13e
L_kk_kernel_c1_cb13d:
s_add_u32 s15, s27, 2
s_cmp_lg_u32 s15, s25
s_cbranch_scc1 L_kk_kernel_c1_cb13e
buffer_load_dword v241, v243, s[44:47], 0 offen sc1
buffer_load_dword v242, v243, s[44:47], 0 offen offset:1024 sc1
L_kk_kernel_c1_cb13e:
s_branch L_kk_kernel_c1_cb13
L_kk_kernel_c1_cb13s:
s_waitcnt vmcnt(0)
L_kk_kernel_c1_cb13:
s_add_u32 s27, s27, 1
buffer_load_dwordx4 v[96:99], v1, s[44:47], s4 offen offset:0 sc1
buffer_load_dwordx4 v[100:103], v1, s[44:47], s4 offen offset:1024 sc1
buffer_load_dwordx4 v[104:107], v1, s[44:47], s4 offen offset:2048 sc1
buffer_load_dwordx4 v[108:111], v1, s[44:47], s4 offen offset:3072 sc1
s_add_u32 s4, s4, 4096
buffer_load_dwordx4 v[112:115], v1, s[44:47], s4 offen offset:0 sc1
buffer_load_dwordx4 v[116:119], v1, s[44:47], s4 offen offset:1024 sc1
buffer_load_dwordx4 v[120:123], v1, s[44:47], s4 offen offset:2048 sc1
buffer_load_dwordx4 v[124:127], v1, s[44:47], s4 offen offset:3072 sc1
s_cmp_ge_u32 s27, s25
s_cbranch_scc1 L_kk_kernel_c1_cb14s
s_cmp_eq_u32 s27, 1
s_cbranch_scc1 L_kk_kernel_c1_cb14s
s_add_u32 s15, s27, 1
s_cmp_lg_u32 s15, s25
s_cbranch_scc1 L_kk_kernel_c1_cb14n
s_waitcnt vmcnt(0)
L_kk_kernel_c1_cb14n:
s_waitcnt vmcnt(33)
s_barrier
s_cmp_eq_u32 s27, s65
s_cselect_b32 s18, 268435456, 0
s_add_u32 s15, s27, 3
s_cmp_gt_u32 s15, s25
s_cselect_b32 s34, 0, s34
buffer_store_dword v5, v4, s[16:19], 0 offen sc1
s_cbranch_scc1 L_kk_kernel_c1_cb14d
s_mov_b32 m0, s50
s_nop 0
buffer_load_dwordx4 v1, s[32:35], s36 offen offset:0 sc1 lds
buffer_load_dwordx4 v1, s[32:35], s36 offen offset:1024 sc1 lds
buffer_load_dwordx4 v1, s[32:35], s36 offen offset:2048 sc1 lds
buffer_load_dwordx4 v1, s[32:35], s36 offen offset:3072 sc1 lds
s_add_u32 m0, s50, 16384
s_nop 0
buffer_load_dwordx4 v1, s[32:35], s37 offen offset:0 sc1 lds
buffer_load_dwordx4 v1, s[32:35], s37 offen offset:1024 sc1 lds
buffer_load_dwordx4 v1, s[32:35], s37 offen offset:2048 sc1 lds
buffer_load_dwordx4 v1, s[32:35], s37 offen offset:3072 sc1 lds
s_add_u32 s36, s36, 16384
s_add_u32 s37, s37, 16384
s_add_u32 s50, s50, 32768
s_cmp_ge_u32 s50, 163840
s_cselect_b32 s50, s39, s50
s_branch L_kk_kernel_c1_cb14e
L_kk_kernel_c1_cb14d:
s_add_u32 s15, s27, 2
s_cmp_lg_u32 s15, s25
s_cbranch_scc1 L_kk_kernel_c1_cb14e
buffer_load_dword v241, v243, s[44:47], 0 offen sc1
buffer_load_dword v242, v243, s[44:47], 0 offen offset:1024 sc1
L_kk_kernel_c1_cb14e:
s_branch L_kk_kernel_c1_cb14
L_kk_kernel_c1_cb14s:
s_waitcnt vmcnt(0)
L_kk_kernel_c1_cb14:
s_add_u32 s27, s27, 1
s_cmp_ge_u32 s27, s25
s_cbranch_scc1 L_kk_kernel_c1_cb15s
s_cmp_eq_u32 s27, 1
s_cbranch_scc1 L_kk_kernel_c1_cb15s
s_add_u32 s15, s27, 1
s_cmp_lg_u32 s15, s25
s_cbranch_scc1 L_kk_kernel_c1_cb15n
s_waitcnt vmcnt(0)
L_kk_kernel_c1_cb15n:
s_waitcnt vmcnt(34)
s_barrier
s_cmp_eq_u32 s27, s65
s_cselect_b32 s18, 268435456, 0
s_add_u32 s15, s27, 3
s_cmp_gt_u32 s15, s25
s_cselect_b32 s34, 0, s34
buffer_store_dword v5, v4, s[16:19], 0 offen sc1
s_cbranch_scc1 L_kk_kernel_c1_cb15d
s_mov_b32 m0, s50
s_nop 0
buffer_load_dwordx4 v1, s[32:35], s36 offen offset:0 sc1 lds
buffer_load_dwordx4 v1, s[32:35], s36 offen offset:1024 sc1 lds
buffer_load_dwordx4 v1, s[32:35], s36 offen offset:2048 sc1 lds
buffer_load_dwordx4 v1, s[32:35], s36 offen offset:3072 sc1 lds
s_add_u32 m0, s50, 16384
s_nop 0
buffer_load_dwordx4 v1, s[32:35], s37 offen offset:0 sc1 lds
buffer_load_dwordx4 v1, s[32:35], s37 offen offset:1024 sc1 lds
buffer_load_dwordx4 v1, s[32:35], s37 offen offset:2048 sc1 lds
buffer_load_dwordx4 v1, s[32:35], s37 offen offset:3072 sc1 lds
s_add_u32 s36, s36, 16384
s_add_u32 s37, s37, 16384
s_add_u32 s50, s50, 32768
s_cmp_ge_u32 s50, 163840
s_cselect_b32 s50, s39, s50
s_branch L_kk_kernel_c1_cb15e
L_kk_kernel_c1_cb15d:
s_add_u32 s15, s27, 2
s_cmp_lg_u32 s15, s25
s_cbranch_scc1 L_kk_kernel_c1_cb15e
buffer_load_dword v241, v243, s[44:47], 0 offen sc1
buffer_load_dword v242, v243, s[44:47], 0 offen offset:1024 sc1
L_kk_kernel_c1_cb15e:
s_branch L_kk_kernel_c1_cb15
L_kk_kernel_c1_cb15s:
s_waitcnt vmcnt(0)
L_kk_kernel_c1_cb15:
s_add_u32 s27, s27, 1
s_waitcnt vmcnt(16)
v_pk_add_f32 v[64:65], v[64:65], v[72:73]
v_pk_add_f32 v[66:67], v[66:67], v[74:75]
s_waitcnt vmcnt(15)
v_pk_add_f32 v[68:69], v[68:69], v[76:77]
v_pk_add_f32 v[70:71], v[70:71], v[78:79]
s_waitcnt vmcnt(14)
v_pk_add_f32 v[64:65], v[64:65], v[80:81]
v_pk_add_f32 v[66:67], v[66:67], v[82:83]
s_waitcnt vmcnt(13)
v_pk_add_f32 v[68:69], v[68:69], v[84:85]
v_pk_add_f32 v[70:71], v[70:71], v[86:87]
s_waitcnt vmcnt(12)
v_pk_add_f32 v[64:65], v[64:65], v[88:89]
v_pk_add_f32 v[66:67], v[66:67], v[90:91]
s_waitcnt vmcnt(11)
v_pk_add_f32 v[68:69], v[68:69], v[92:93]
v_pk_add_f32 v[70:71], v[70:71], v[94:95]
s_waitcnt vmcnt(9)
v_pk_add_f32 v[64:65], v[64:65], v[96:97]
v_pk_add_f32 v[66:67], v[66:67], v[98:99]
s_waitcnt vmcnt(8)
v_pk_add_f32 v[68:69], v[68:69], v[100:101]
v_pk_add_f32 v[70:71], v[70:71], v[102:103]
s_waitcnt vmcnt(7)
v_pk_add_f32 v[64:65], v[64:65], v[104:105]
v_pk_add_f32 v[66:67], v[66:67], v[106:107]
s_waitcnt vmcnt(6)
v_pk_add_f32 v[68:69], v[68:69], v[108:109]
v_pk_add_f32 v[70:71], v[70:71], v[110:111]
s_waitcnt vmcnt(5)
v_pk_add_f32 v[64:65], v[64:65], v[112:113]
v_pk_add_f32 v[66:67], v[66:67], v[114:115]
s_waitcnt vmcnt(4)
v_pk_add_f32 v[68:69], v[68:69], v[116:117]
v_pk_add_f32 v[70:71], v[70:71], v[118:119]
s_waitcnt vmcnt(3)
v_pk_add_f32 v[64:65], v[64:65], v[120:121]
v_pk_add_f32 v[66:67], v[66:67], v[122:123]
s_waitcnt vmcnt(2)
v_pk_add_f32 v[68:69], v[68:69], v[124:125]
v_pk_add_f32 v[70:71], v[70:71], v[126:127]
v_cvt_pk_bf16_f32 v72, v64, v65
v_cvt_pk_bf16_f32 v73, v66, v67
v_cvt_pk_bf16_f32 v74, v68, v69
v_cvt_pk_bf16_f32 v75, v70, v71
s_lshl_b32 s4, s20, 10
s_add_u32 s4, s4, 87556096
buffer_store_dwordx4 v[72:75], v1, s[44:47], s4 offen sc1
L_kk_kernel_c1_post1:
s_lshr_b32 s4, s24, 1
s_lshl_b32 s4, s4, 8
s_lshl_b32 s5, s20, 3
s_add_u32 s4, s4, s5
s_and_b32 s5, s24, 1
s_lshl_b32 s5, s5, 2
s_add_u32 s4, s4, s5
s_add_u32 s4, s4, 90177536
v_mov_b32 v4, s4
s_add_u32 s65, s27, 2
s_cmp_eq_u32 s48, 0
s_cselect_b32 s65, s65, 0
L_kk_kernel_c1_post2:
s_cmp_ge_u32 s27, s25
s_cbranch_scc1 L_kk_kernel_c1_postdone
s_cmp_ge_u32 s27, s25
s_cbranch_scc1 L_kk_kernel_c1_cb16
s_cmp_eq_u32 s27, 1
s_cbranch_scc1 L_kk_kernel_c1_cb16
s_add_u32 s15, s27, 1
s_cmp_lg_u32 s15, s25
s_cbranch_scc1 L_kk_kernel_c1_cb16n
s_waitcnt vmcnt(0)
L_kk_kernel_c1_cb16n:
s_waitcnt vmcnt(16)
s_barrier
s_cmp_eq_u32 s27, s65
s_cselect_b32 s18, 268435456, 0
s_add_u32 s15, s27, 3
s_cmp_gt_u32 s15, s25
s_cselect_b32 s34, 0, s34
buffer_store_dword v5, v4, s[16:19], 0 offen sc1
s_cbranch_scc1 L_kk_kernel_c1_cb16d
s_mov_b32 m0, s50
s_nop 0
buffer_load_dwordx4 v1, s[32:35], s36 offen offset:0 sc1 lds
buffer_load_dwordx4 v1, s[32:35], s36 offen offset:1024 sc1 lds
buffer_load_dwordx4 v1, s[32:35], s36 offen offset:2048 sc1 lds
buffer_load_dwordx4 v1, s[32:35], s36 offen offset:3072 sc1 lds
s_add_u32 m0, s50, 16384
s_nop 0
buffer_load_dwordx4 v1, s[32:35], s37 offen offset:0 sc1 lds
buffer_load_dwordx4 v1, s[32:35], s37 offen offset:1024 sc1 lds
buffer_load_dwordx4 v1, s[32:35], s37 offen offset:2048 sc1 lds
buffer_load_dwordx4 v1, s[32:35], s37 offen offset:3072 sc1 lds
s_add_u32 s36, s36, 16384
s_add_u32 s37, s37, 16384
s_add_u32 s50, s50, 32768
s_cmp_ge_u32 s50, 163840
s_cselect_b32 s50, s39, s50
s_branch L_kk_kernel_c1_cb16e
L_kk_kernel_c1_cb16d:
s_add_u32 s15, s27, 2
s_cmp_lg_u32 s15, s25
s_cbranch_scc1 L_kk_kernel_c1_cb16e
buffer_load_dword v241, v243, s[44:47], 0 offen sc1
buffer_load_dword v242, v243, s[44:47], 0 offen offset:1024 sc1
L_kk_kernel_c1_cb16e:
L_kk_kernel_c1_cb16:
s_add_u32 s27, s27, 1
s_branch L_kk_kernel_c1_post2
L_kk_kernel_c1_postdone:
s_cmp_eq_u32 s48, 0
s_cbranch_scc1 L_kk_kernel_c1_nofb
v_mov_b32 v48, 0
v_mov_b32 v49, 0
v_mov_b32 v50, 0
v_mov_b32 v51, 0
v_mov_b32 v52, 0
v_mov_b32 v53, 0
v_mov_b32 v54, 0
v_mov_b32 v55, 0
v_mov_b32 v56, 0
v_mov_b32 v57, 0
v_mov_b32 v58, 0
v_mov_b32 v59, 0
v_mov_b32 v60, 0
v_mov_b32 v61, 0
v_mov_b32 v62, 0
v_mov_b32 v63, 0
v_mov_b32 v12, v240
v_mov_b32 v13, v240
s_add_u32 s10, s7, 16777216
s_mov_b32 s26, s24
L_kk_kernel_c1_fb1:
s_add_u32 s11, s10, 4096
buffer_load_dwordx4 v[176:179], v1, s[44:47], s10 offen offset:0 sc1
buffer_load_dwordx4 v[180:183], v1, s[44:47], s10 offen offset:1024 sc1
buffer_load_dwordx4 v[184:187], v1, s[44:47], s10 offen offset:2048 sc1
buffer_load_dwordx4 v[188:191], v1, s[44:47], s10 offen offset:3072 sc1
buffer_load_dwordx4 v[192:195], v1, s[44:47], s11 offen offset:0 sc1
buffer_load_dwordx4 v[196:199], v1, s[44:47], s11 offen offset:1024 sc1
buffer_load_dwordx4 v[200:203], v1, s[44:47], s11 offen offset:2048 sc1
buffer_load_dwordx4 v[204:207], v1, s[44:47], s11 offen offset:3072 sc1
s_cmp_eq_u32 s26, 0
s_cbranch_scc0 L_kk_kernel_c1_fb1n
v_cndmask_b32 v48, v48, v240, s[52:53]
v_cndmask_b32 v60, v60, v240, s[52:53]
v_mov_b32 v56, v240
v_cndmask_b32 v49, v49, v240, s[54:55]
v_cndmask_b32 v61, v61, v240, s[54:55]
v_mov_b32 v57, v240
v_cndmask_b32 v50, v50, v240, s[56:57]
v_cndmask_b32 v62, v62, v240, s[56:57]
v_mov_b32 v58, v240
v_cndmask_b32 v51, v51, v240, s[58:59]
v_cndmask_b32 v63, v63, v240, s[58:59]
v_mov_b32 v59, v240
L_kk_kernel_c1_fb1n:
s_waitcnt vmcnt(7)
v_mfma_f32_16x16x32_bf16 v[128:131], v[176:179], v[16:19], v[48:51]
v_mfma_f32_16x16x32_bf16 v[136:139], v[176:179], v[32:35], v[52:55]
s_waitcnt vmcnt(6)
v_mfma_f32_16x16x32_bf16 v[128:131], v[180:183], v[20:23], v[128:131]
v_mfma_f32_16x16x32_bf16 v[136:139], v[180:183], v[36:39], v[136:139]
s_waitcnt vmcnt(5)
v_mfma_f32_16x16x32_bf16 v[128:131], v[184:187], v[24:27], v[128:131]
v_mfma_f32_16x16x32_bf16 v[136:139], v[184:187], v[40:43], v[136:139]
s_waitcnt vmcnt(4)
v_mfma_f32_16x16x32_bf16 v[128:131], v[188:191], v[28:31], v[128:131]
v_mfma_f32_16x16x32_bf16 v[136:139], v[188:191], v[44:47], v[136:139]
s_waitcnt vmcnt(3)
v_mfma_f32_16x16x32_bf16 v[132:135], v[192:195], v[16:19], v[56:59]
v_mfma_f32_16x16x32_bf16 v[140:143], v[192:195], v[32:35], v[60:63]
s_waitcnt vmcnt(2)
v_mfma_f32_16x16x32_bf16 v[132:135], v[196:199], v[20:23], v[132:135]
v_mfma_f32_16x16x32_bf16 v[140:143], v[196:199], v[36:39], v[140:143]
s_waitcnt vmcnt(1)
v_mfma_f32_16x16x32_bf16 v[132:135], v[200:203], v[24:27], v[132:135]
v_mfma_f32_16x16x32_bf16 v[140:143], v[200:203], v[40:43], v[140:143]
s_waitcnt vmcnt(0)
v_mfma_f32_16x16x32_bf16 v[132:135], v[204:207], v[28:31], v[132:135]
v_mfma_f32_16x16x32_bf16 v[140:143], v[204:207], v[44:47], v[140:143]
v_max3_f32 v12, v128, v129, v12
v_max3_f32 v12, v130, v131, v12
s_nop 4
v_max3_f32 v12, v132, v133, v12
v_max3_f32 v12, v134, v135, v12
v_max3_f32 v13, v136, v137, v13
v_max3_f32 v13, v138, v139, v13
v_max3_f32 v13, v140, v141, v13
v_max3_f32 v13, v142, v143, v13
s_add_u32 s10, s10, 8192
s_cmp_eq_u32 s26, 0
s_cbranch_scc1 L_kk_kernel_c1_fb1d
s_sub_u32 s26, s26, 1
s_branch L_kk_kernel_c1_fb1
L_kk_kernel_c1_fb1d:
v_mov_b32 v14, v12
s_nop 1
v_permlane16_swap_b32 v14, v12
v_max_f32 v12, v14, v12
v_mov_b32 v14, v12
s_nop 1
v_permlane32_swap_b32 v14, v12
v_max_f32 v12, v14, v12
v_mov_b32 v14, v13
s_nop 1
v_permlane16_swap_b32 v14, v13
v_max_f32 v13, v14, v13
v_mov_b32 v14, v13
s_nop 1
v_permlane32_swap_b32 v14, v13
v_max_f32 v13, v14, v13
v_sub_f32 v48, 0, v12
v_sub_f32 v49, 0, v12
v_sub_f32 v50, 0, v12
v_sub_f32 v51, 0, v12
v_sub_f32 v56, 0, v12
v_sub_f32 v57, 0, v12
v_sub_f32 v58, 0, v12
v_sub_f32 v59, 0, v12
v_sub_f32 v52, 0, v13
v_sub_f32 v53, 0, v13
v_sub_f32 v54, 0, v13
v_sub_f32 v55, 0, v13
v_sub_f32 v60, 0, v13
v_sub_f32 v61, 0, v13
v_sub_f32 v62, 0, v13
v_sub_f32 v63, 0, v13
v_mov_b32 v64, 0
v_mov_b32 v65, 0
v_mov_b32 v66, 0
v_mov_b32 v67, 0
v_mov_b32 v68, 0
v_mov_b32 v69, 0
v_mov_b32 v70, 0
v_mov_b32 v71, 0
v_mov_b32 v72, 0
v_mov_b32 v73, 0
v_mov_b32 v74, 0
v_mov_b32 v75, 0
v_mov_b32 v76, 0
v_mov_b32 v77, 0
v_mov_b32 v78, 0
v_mov_b32 v79, 0
v_mov_b32 v80, 0
v_mov_b32 v81, 0
v_mov_b32 v82, 0
v_mov_b32 v83, 0
v_mov_b32 v84, 0
v_mov_b32 v85, 0
v_mov_b32 v86, 0
v_mov_b32 v87, 0
v_mov_b32 v88, 0
v_mov_b32 v89, 0
v_mov_b32 v90, 0
v_mov_b32 v91, 0
v_mov_b32 v92, 0
v_mov_b32 v93, 0
v_mov_b32 v94, 0
v_mov_b32 v95, 0
v_mov_b32 v96, 0
v_mov_b32 v97, 0
v_mov_b32 v98, 0
v_mov_b32 v99, 0
v_mov_b32 v100, 0
v_mov_b32 v101, 0
v_mov_b32 v102, 0
v_mov_b32 v103, 0
v_mov_b32 v104, 0
v_mov_b32 v105, 0
v_mov_b32 v106, 0
v_mov_b32 v107, 0
v_mov_b32 v108, 0
v_mov_b32 v109, 0
v_mov_b32 v110, 0
v_mov_b32 v111, 0
v_mov_b32 v112, 0
v_mov_b32 v113, 0
v_mov_b32 v114, 0
v_mov_b32 v115, 0
v_mov_b32 v116, 0
v_mov_b32 v117, 0
v_mov_b32 v118, 0
v_mov_b32 v119, 0
v_mov_b32 v120, 0
v_mov_b32 v121, 0
v_mov_b32 v122, 0
v_mov_b32 v123, 0
v_mov_b32 v124, 0
v_mov_b32 v125, 0
v_mov_b32 v126, 0
v_mov_b32 v127, 0
v_mov_b32 v244, 0
v_mov_b32 v245, 0
v_mov_b32 v246, 0
v_mov_b32 v247, 0
v_mov_b32 v248, 0
v_mov_b32 v249, 0
v_mov_b32 v250, 0
v_mov_b32 v251, 0
s_add_u32 s10, s7, 16777216
s_add_u32 s12, s7, 33554432
s_mov_b32 s26, s24
L_kk_kernel_c1_fb2:
s_add_u32 s11, s10, 4096
s_add_u32 s13, s12, 4096
buffer_load_dwordx4 v[176:179], v1, s[44:47], s10 offen offset:0 sc1
buffer_load_dwordx4 v[180:183], v1, s[44:47], s10 offen offset:1024 sc1
buffer_load_dwordx4 v[184:187], v1, s[44:47], s10 offen offset:2048 sc1
buffer_load_dwordx4 v[188:191], v1, s[44:47], s10 offen offset:3072 sc1
buffer_load_dwordx4 v[192:195], v1, s[44:47], s11 offen offset:0 sc1
buffer_load_dwordx4 v[196:199], v1, s[44:47], s11 offen offset:1024 sc1
buffer_load_dwordx4 v[200:203], v1, s[44:47], s11 offen offset:2048 sc1
buffer_load_dwordx4 v[204:207], v1, s[44:47], s11 offen offset:3072 sc1
buffer_load_dwordx4 v[208:211], v1, s[44:47], s12 offen offset:0 sc1
buffer_load_dwordx4 v[212:215], v1, s[44:47], s12 offen offset:1024 sc1
buffer_load_dwordx4 v[216:219], v1, s[44:47], s12 offen offset:2048 sc1
buffer_load_dwordx4 v[220:223], v1, s[44:47], s12 offen offset:3072 sc1
buffer_load_dwordx4 v[224:227], v1, s[44:47], s13 offen offset:0 sc1
buffer_load_dwordx4 v[228:231], v1, s[44:47], s13 offen offset:1024 sc1
buffer_load_dwordx4 v[232:235], v1, s[44:47], s13 offen offset:2048 sc1
buffer_load_dwordx4 v[236:239], v1, s[44:47], s13 offen offset:3072 sc1
s_cmp_eq_u32 s26, 0
s_cbranch_scc0 L_kk_kernel_c1_fb2n
v_cndmask_b32 v48, v48, v240, s[52:53]
v_cndmask_b32 v60, v60, v240, s[52:53]
v_mov_b32 v56, v240
v_cndmask_b32 v49, v49, v240, s[54:55]
v_cndmask_b32 v61, v61, v240, s[54:55]
v_mov_b32 v57, v240
v_cndmask_b32 v50, v50, v240, s[56:57]
v_cndmask_b32 v62, v62, v240, s[56:57]
v_mov_b32 v58, v240
v_cndmask_b32 v51, v51, v240, s[58:59]
v_cndmask_b32 v63, v63, v240, s[58:59]
v_mov_b32 v59, v240
L_kk_kernel_c1_fb2n:
s_waitcnt vmcnt(15)
v_mfma_f32_16x16x32_bf16 v[128:131], v[176:179], v[16:19], v[48:51]
v_mfma_f32_16x16x32_bf16 v[136:139], v[176:179], v[32:35], v[52:55]
s_waitcnt vmcnt(14)
v_mfma_f32_16x16x32_bf16 v[128:131], v[180:183], v[20:23], v[128:131]
v_mfma_f32_16x16x32_bf16 v[136:139], v[180:183], v[36:39], v[136:139]
s_waitcnt vmcnt(13)
v_mfma_f32_16x16x32_bf16 v[128:131], v[184:187], v[24:27], v[128:131]
v_mfma_f32_16x16x32_bf16 v[136:139], v[184:187], v[40:43], v[136:139]
s_waitcnt vmcnt(12)
v_mfma_f32_16x16x32_bf16 v[128:131], v[188:191], v[28:31], v[128:131]
v_mfma_f32_16x16x32_bf16 v[136:139], v[188:191], v[44:47], v[136:139]
s_waitcnt vmcnt(11)
v_mfma_f32_16x16x32_bf16 v[132:135], v[192:195], v[16:19], v[56:59]
v_mfma_f32_16x16x32_bf16 v[140:143], v[192:195], v[32:35], v[60:63]
s_waitcnt vmcnt(10)
v_mfma_f32_16x16x32_bf16 v[132:135], v[196:199], v[20:23], v[132:135]
v_mfma_f32_16x16x32_bf16 v[140:143], v[196:199], v[36:39], v[140:143]
s_waitcnt vmcnt(9)
v_mfma_f32_16x16x32_bf16 v[132:135], v[200:203], v[24:27], v[132:135]
v_mfma_f32_16x16x32_bf16 v[140:143], v[200:203], v[40:43], v[140:143]
s_waitcnt vmcnt(8)
v_mfma_f32_16x16x32_bf16 v[132:135], v[204:207], v[28:31], v[132:135]
v_mfma_f32_16x16x32_bf16 v[140:143], v[204:207], v[44:47], v[140:143]
v_exp_f32 v128, v128
v_exp_f32 v129, v129
v_exp_f32 v130, v130
v_exp_f32 v131, v131
s_nop 2
v_exp_f32 v132, v132
v_exp_f32 v133, v133
v_exp_f32 v134, v134
v_exp_f32 v135, v135
v_exp_f32 v136, v136
v_exp_f32 v137, v137
v_exp_f32 v138, v138
v_exp_f32 v139, v139
v_exp_f32 v140, v140
v_exp_f32 v141, v141
v_exp_f32 v142, v142
v_exp_f32 v143, v143
v_cvt_pk_bf16_f32 v160, v128, v129
v_cvt_pk_bf16_f32 v161, v130, v131
v_cvt_pk_bf16_f32 v162, v132, v133
v_cvt_pk_bf16_f32 v163, v134, v135
v_cvt_pk_bf16_f32 v164, v136, v137
v_cvt_pk_bf16_f32 v165, v138, v139
v_cvt_pk_bf16_f32 v166, v140, v141
v_cvt_pk_bf16_f32 v167, v142, v143
s_waitcnt vmcnt(7)
v_mfma_f32_16x16x32_bf16 v[64:67], v[208:211], v[160:163], v[64:67]
v_mfma_f32_16x16x32_bf16 v[72:75], v[208:211], v[164:167], v[72:75]
s_waitcnt vmcnt(6)
v_mfma_f32_16x16x32_bf16 v[68:71], v[212:215], v[160:163], v[68:71]
v_mfma_f32_16x16x32_bf16 v[76:79], v[212:215], v[164:167], v[76:79]
s_waitcnt vmcnt(5)
v_mfma_f32_16x16x32_bf16 v[80:83], v[216:219], v[160:163], v[80:83]
v_mfma_f32_16x16x32_bf16 v[88:91], v[216:219], v[164:167], v[88:91]
s_waitcnt vmcnt(4)
v_mfma_f32_16x16x32_bf16 v[84:87], v[220:223], v[160:163], v[84:87]
v_mfma_f32_16x16x32_bf16 v[92:95], v[220:223], v[164:167], v[92:95]
s_waitcnt vmcnt(3)
v_mfma_f32_16x16x32_bf16 v[96:99], v[224:227], v[160:163], v[96:99]
v_mfma_f32_16x16x32_bf16 v[104:107], v[224:227], v[164:167], v[104:107]
s_waitcnt vmcnt(2)
v_mfma_f32_16x16x32_bf16 v[100:103], v[228:231], v[160:163], v[100:103]
v_mfma_f32_16x16x32_bf16 v[108:111], v[228:231], v[164:167], v[108:111]
s_waitcnt vmcnt(1)
v_mfma_f32_16x16x32_bf16 v[112:115], v[232:235], v[160:163], v[112:115]
v_mfma_f32_16x16x32_bf16 v[120:123], v[232:235], v[164:167], v[120:123]
s_waitcnt vmcnt(0)
v_mfma_f32_16x16x32_bf16 v[116:119], v[236:239], v[160:163], v[116:119]
v_mfma_f32_16x16x32_bf16 v[124:127], v[236:239], v[164:167], v[124:127]
v_mfma_f32_16x16x32_bf16 v[244:247], v[252:255], v[160:163], v[244:247]
v_mfma_f32_16x16x32_bf16 v[248:251], v[252:255], v[164:167], v[248:251]
s_add_u32 s10, s10, 8192
s_add_u32 s12, s12, 8192
s_cmp_eq_u32 s26, 0
s_cbranch_scc1 L_kk_kernel_c1_fb2d
s_sub_u32 s26, s26, 1
s_branch L_kk_kernel_c1_fb2
L_kk_kernel_c1_fb2d:
s_nop 2
v_rcp_f32 v12, v244
v_rcp_f32 v13, v248
s_lshr_b32 s4, s24, 1
s_mul_i32 s4, s4, 589824
s_lshl_b32 s5, s20, 14
s_add_u32 s4, s4, s5
s_and_b32 s5, s24, 1
s_lshl_b32 s5, s5, 11
s_add_u32 s4, s4, s5
s_add_u32 s4, s4, 50331648
v_mul_f32 v64, v12, v64
v_mul_f32 v65, v12, v65
v_mul_f32 v66, v12, v66
v_mul_f32 v67, v12, v67
v_mul_f32 v68, v12, v68
v_mul_f32 v69, v12, v69
v_mul_f32 v70, v12, v70
v_mul_f32 v71, v12, v71
v_cvt_pk_bf16_f32 v64, v64, v65
v_cvt_pk_bf16_f32 v65, v66, v67
v_cvt_pk_bf16_f32 v66, v68, v69
v_cvt_pk_bf16_f32 v67, v70, v71
buffer_store_dwordx4 v[64:67], v1, s[44:47], s4 offen offset:0 sc1
v_mul_f32 v72, v13, v72
v_mul_f32 v73, v13, v73
v_mul_f32 v74, v13, v74
v_mul_f32 v75, v13, v75
v_mul_f32 v76, v13, v76
v_mul_f32 v77, v13, v77
v_mul_f32 v78, v13, v78
v_mul_f32 v79, v13, v79
v_cvt_pk_bf16_f32 v72, v72, v73
v_cvt_pk_bf16_f32 v73, v74, v75
v_cvt_pk_bf16_f32 v74, v76, v77
v_cvt_pk_bf16_f32 v75, v78, v79
buffer_store_dwordx4 v[72:75], v1, s[44:47], s4 offen offset:1024 sc1
s_add_u32 s4, s4, 4096
v_mul_f32 v80, v12, v80
v_mul_f32 v81, v12, v81
v_mul_f32 v82, v12, v82
v_mul_f32 v83, v12, v83
v_mul_f32 v84, v12, v84
v_mul_f32 v85, v12, v85
v_mul_f32 v86, v12, v86
v_mul_f32 v87, v12, v87
v_cvt_pk_bf16_f32 v80, v80, v81
v_cvt_pk_bf16_f32 v81, v82, v83
v_cvt_pk_bf16_f32 v82, v84, v85
v_cvt_pk_bf16_f32 v83, v86, v87
buffer_store_dwordx4 v[80:83], v1, s[44:47], s4 offen offset:0 sc1
v_mul_f32 v88, v13, v88
v_mul_f32 v89, v13, v89
v_mul_f32 v90, v13, v90
v_mul_f32 v91, v13, v91
v_mul_f32 v92, v13, v92
v_mul_f32 v93, v13, v93
v_mul_f32 v94, v13, v94
v_mul_f32 v95, v13, v95
v_cvt_pk_bf16_f32 v88, v88, v89
v_cvt_pk_bf16_f32 v89, v90, v91
v_cvt_pk_bf16_f32 v90, v92, v93
v_cvt_pk_bf16_f32 v91, v94, v95
buffer_store_dwordx4 v[88:91], v1, s[44:47], s4 offen offset:1024 sc1
s_add_u32 s4, s4, 4096
v_mul_f32 v96, v12, v96
v_mul_f32 v97, v12, v97
v_mul_f32 v98, v12, v98
v_mul_f32 v99, v12, v99
v_mul_f32 v100, v12, v100
v_mul_f32 v101, v12, v101
v_mul_f32 v102, v12, v102
v_mul_f32 v103, v12, v103
v_cvt_pk_bf16_f32 v96, v96, v97
v_cvt_pk_bf16_f32 v97, v98, v99
v_cvt_pk_bf16_f32 v98, v100, v101
v_cvt_pk_bf16_f32 v99, v102, v103
buffer_store_dwordx4 v[96:99], v1, s[44:47], s4 offen offset:0 sc1
v_mul_f32 v104, v13, v104
v_mul_f32 v105, v13, v105
v_mul_f32 v106, v13, v106
v_mul_f32 v107, v13, v107
v_mul_f32 v108, v13, v108
v_mul_f32 v109, v13, v109
v_mul_f32 v110, v13, v110
v_mul_f32 v111, v13, v111
v_cvt_pk_bf16_f32 v104, v104, v105
v_cvt_pk_bf16_f32 v105, v106, v107
v_cvt_pk_bf16_f32 v106, v108, v109
v_cvt_pk_bf16_f32 v107, v110, v111
buffer_store_dwordx4 v[104:107], v1, s[44:47], s4 offen offset:1024 sc1
s_add_u32 s4, s4, 4096
v_mul_f32 v112, v12, v112
v_mul_f32 v113, v12, v113
v_mul_f32 v114, v12, v114
v_mul_f32 v115, v12, v115
v_mul_f32 v116, v12, v116
v_mul_f32 v117, v12, v117
v_mul_f32 v118, v12, v118
v_mul_f32 v119, v12, v119
v_cvt_pk_bf16_f32 v112, v112, v113
v_cvt_pk_bf16_f32 v113, v114, v115
v_cvt_pk_bf16_f32 v114, v116, v117
v_cvt_pk_bf16_f32 v115, v118, v119
buffer_store_dwordx4 v[112:115], v1, s[44:47], s4 offen offset:0 sc1
v_mul_f32 v120, v13, v120
v_mul_f32 v121, v13, v121
v_mul_f32 v122, v13, v122
v_mul_f32 v123, v13, v123
v_mul_f32 v124, v13, v124
v_mul_f32 v125, v13, v125
v_mul_f32 v126, v13, v126
v_mul_f32 v127, v13, v127
v_cvt_pk_bf16_f32 v120, v120, v121
v_cvt_pk_bf16_f32 v121, v122, v123
v_cvt_pk_bf16_f32 v122, v124, v125
v_cvt_pk_bf16_f32 v123, v126, v127
buffer_store_dwordx4 v[120:123], v1, s[44:47], s4 offen offset:1024 sc1
L_kk_kernel_c1_nofb:
s_mov_b32 s4, s100
s_and_b32 s5, s101, 0xffff
s_mov_b32 s6, 2097152
s_mov_b32 s7, 0x20000
s_mov_b32 s8, s78
s_and_b32 s9, s79, 0xffff
s_mov_b32 s10, 4194304
s_mov_b32 s11, 0x20000
s_mov_b32 s12, s76
s_and_b32 s13, s77, 0xffff
s_mov_b32 s14, 524288
s_mov_b32 s15, 0x20000
s_and_b32 s30, s2, 6
s_lshl_b32 s30, s30, 2
s_lshr_b32 s31, s2, 3
s_and_b32 s32, s31, 7
s_add_u32 s30, s30, s32
s_lshr_b32 s31, s31, 3
s_and_b32 s33, s2, 1
s_lshl_b32 s33, s33, 2
s_add_u32 s31, s31, s33
s_lshl_b32 s28, s21, 2
s_lshr_b32 s28, 0x24130241, s28
s_and_b32 s28, s28, 7
s_lshl_b32 s28, s28, 15
s_xor_b32 s33, s3, 4
s_lshl_b32 s33, s33, 14
s_add_u32 s33, s33, s28
s_sub_u32 s29, s33, 163840
s_cmp_ge_u32 s33, 163840
s_cselect_b32 s33, s29, s33
s_waitcnt vmcnt(13)
v_lshrrev_b32 v3, 3, v0
v_lshlrev_b32 v3, 10, v3
v_lshrrev_b32 v4, 4, v0
v_lshlrev_b32 v4, 1, v4
v_and_b32 v5, 7, v0
v_xor_b32 v4, v4, v5
v_lshlrev_b32 v4, 4, v4
v_add_u32 v4, v3, v4
v_add_u32 v5, 7168, v4
v_add_u32 v6, 14336, v4
v_add_u32 v7, 21504, v4
s_mul_i32 s34, s31, 589824
s_add_u32 s34, s34, 75497472
s_lshl_b32 s39, s3, 13
s_add_u32 s35, s34, s39
s_add_u32 s35, s35, 524288
s_lshl_b32 s39, s3, 16
s_add_u32 s34, s34, s39
s_mul_i32 s37, s30, 589824
s_add_u32 s37, s37, 50331648
s_lshl_b32 s39, s3, 16
s_add_u32 s37, s37, s39
s_mul_i32 s48, s32, 0
s_and_b32 s48, s48, 15
s_mov_b32 s52, s48
s_lshr_b32 s54, s24, 1
s_lshl_b32 s54, s54, 8
s_lshl_b32 s55, s20, 3
s_add_u32 s54, s54, s55
s_and_b32 s55, s24, 1
s_lshl_b32 s55, s55, 2
s_add_u32 s54, s54, s55
s_add_u32 s54, s54, 90177536
v_mov_b32 v2, 0
v_mov_b32 v3, 1
v_lshrrev_b32 v8, 2, v0
v_lshlrev_b32 v8, 7, v8
v_lshrrev_b32 v9, 3, v0
v_and_b32 v9, 3, v9
v_lshlrev_b32 v9, 5, v9
v_and_b32 v10, 3, v0
v_lshlrev_b32 v10, 3, v10
v_add3_u32 v8, v8, v9, v10
v_add_u32 v8, s33, v8
v_xor_b32 v9, 32, v8
v_xor_b32 v10, 64, v8
v_xor_b32 v11, 96, v8
s_lshl_b32 s40, s30, 16
s_lshl_b32 s41, s3, 13
s_add_u32 s40, s40, s41
s_add_u32 s40, s40, 83886080
s_add_u32 s41, s40, 4096
s_lshl_b32 s42, s3, 12
s_add_u32 s42, s42, 87556096
s_lshl_b32 s43, s30, 10
s_add_u32 s43, s43, 87031808
s_mov_b32 s53, 0x358637bd
s_lshl_b32 s43, s30, 8
s_add_u32 s43, s43, 74448896
v_and_b32 v7, 15, v0
v_lshlrev_b32 v7, 2, v7
s_sub_u32 s55, s65, 1
s_sub_u32 s56, s25, 1
s_cmp_lt_u32 s55, s56
s_cselect_b32 s55, 268435456, 0
v_mov_b32 v2, s55
s_waitcnt vmcnt(0)
buffer_store_dword v3, v2, s[44:47], s54 offen sc1
v_and_b32 v241, v241, v242
v_cmp_eq_u32 vcc, 1, v241
s_cmp_eq_u64 vcc, -1
s_cbranch_scc1 L_kk_kernel_c1_p3wok
s_mov_b32 s55, 0x40000
L_kk_kernel_c1_p3w:
s_sleep 8
buffer_load_dword v241, v243, s[44:47], 0 offen sc1
buffer_load_dword v242, v243, s[44:47], 0 offen offset:1024 sc1
s_waitcnt vmcnt(0)
v_and_b32 v241, v241, v242
v_cmp_eq_u32 vcc, 1, v241
s_cmp_eq_u64 vcc, -1
s_cbranch_scc1 L_kk_kernel_c1_p3wok
s_sub_u32 s55, s55, 1
s_cmp_lg_u32 s55, 0
s_cbranch_scc1 L_kk_kernel_c1_p3w
L_kk_kernel_c1_p3wok:
s_add_u32 m0, s33, 0
s_lshl_b32 s49, s48, 12
s_add_u32 s49, s49, s34
s_add_u32 s48, s48, 1
s_and_b32 s48, s48, 15
buffer_load_dwordx4 v1, s[44:47], s49 offen offset:0 sc1 lds
buffer_load_dwordx4 v1, s[44:47], s49 offen offset:1024 sc1 lds
buffer_load_dwordx4 v1, s[44:47], s49 offen offset:2048 sc1 lds
buffer_load_dwordx4 v1, s[44:47], s49 offen offset:3072 sc1 lds
s_add_u32 m0, s33, 4096
s_lshl_b32 s49, s48, 12
s_add_u32 s49, s49, s34
s_add_u32 s48, s48, 1
s_and_b32 s48, s48, 15
buffer_load_dwordx4 v1, s[44:47], s49 offen offset:0 sc1 lds
buffer_load_dwordx4 v1, s[44:47], s49 offen offset:1024 sc1 lds
buffer_load_dwordx4 v1, s[44:47], s49 offen offset:2048 sc1 lds
buffer_load_dwordx4 v1, s[44:47], s49 offen offset:3072 sc1 lds
s_add_u32 m0, s33, 8192
s_lshl_b32 s49, s48, 12
s_add_u32 s49, s49, s34
s_add_u32 s48, s48, 1
s_and_b32 s48, s48, 15
buffer_load_dwordx4 v1, s[44:47], s49 offen offset:0 sc1 lds
buffer_load_dwordx4 v1, s[44:47], s49 offen offset:1024 sc1 lds
buffer_load_dwordx4 v1, s[44:47], s49 offen offset:2048 sc1 lds
buffer_load_dwordx4 v1, s[44:47], s49 offen offset:3072 sc1 lds
s_add_u32 m0, s33, 12288
s_lshl_b32 s49, s48, 12
s_add_u32 s49, s49, s34
s_add_u32 s48, s48, 1
s_and_b32 s48, s48, 15
buffer_load_dwordx4 v1, s[44:47], s49 offen offset:0 sc1 lds
buffer_load_dwordx4 v1, s[44:47], s49 offen offset:1024 sc1 lds
buffer_load_dwordx4 v1, s[44:47], s49 offen offset:2048 sc1 lds
buffer_load_dwordx4 v1, s[44:47], s49 offen offset:3072 sc1 lds
s_waitcnt vmcnt(12)
ds_read_b64_tr_b16 v[16:17], v8 offset:0
ds_read_b64_tr_b16 v[18:19], v8 offset:2048
ds_read_b64_tr_b16 v[20:21], v9 offset:0
ds_read_b64_tr_b16 v[22:23], v9 offset:2048
ds_read_b64_tr_b16 v[24:25], v10 offset:0
ds_read_b64_tr_b16 v[26:27], v10 offset:2048
ds_read_b64_tr_b16 v[28:29], v11 offset:0
ds_read_b64_tr_b16 v[30:31], v11 offset:2048
s_waitcnt lgkmcnt(0)
s_add_u32 m0, s33, 0
s_lshl_b32 s49, s48, 12
s_add_u32 s49, s49, s34
s_add_u32 s48, s48, 1
s_and_b32 s48, s48, 15
buffer_load_dwordx4 v1, s[44:47], s49 offen offset:0 sc1 lds
buffer_load_dwordx4 v1, s[44:47], s49 offen offset:1024 sc1 lds
buffer_load_dwordx4 v1, s[44:47], s49 offen offset:2048 sc1 lds
buffer_load_dwordx4 v1, s[44:47], s49 offen offset:3072 sc1 lds
s_waitcnt vmcnt(12)
ds_read_b64_tr_b16 v[32:33], v8 offset:4096
ds_read_b64_tr_b16 v[34:35], v8 offset:6144
ds_read_b64_tr_b16 v[36:37], v9 offset:4096
ds_read_b64_tr_b16 v[38:39], v9 offset:6144
ds_read_b64_tr_b16 v[40:41], v10 offset:4096
ds_read_b64_tr_b16 v[42:43], v10 offset:6144
ds_read_b64_tr_b16 v[44:45], v11 offset:4096
ds_read_b64_tr_b16 v[46:47], v11 offset:6144
s_waitcnt lgkmcnt(0)
s_add_u32 m0, s33, 4096
s_lshl_b32 s49, s48, 12
s_add_u32 s49, s49, s34
s_add_u32 s48, s48, 1
s_and_b32 s48, s48, 15
buffer_load_dwordx4 v1, s[44:47], s49 offen offset:0 sc1 lds
buffer_load_dwordx4 v1, s[44:47], s49 offen offset:1024 sc1 lds
buffer_load_dwordx4 v1, s[44:47], s49 offen offset:2048 sc1 lds
buffer_load_dwordx4 v1, s[44:47], s49 offen offset:3072 sc1 lds
s_waitcnt vmcnt(12)
ds_read_b64_tr_b16 v[48:49], v8 offset:8192
ds_read_b64_tr_b16 v[50:51], v8 offset:10240
ds_read_b64_tr_b16 v[52:53], v9 offset:8192
ds_read_b64_tr_b16 v[54:55], v9 offset:10240
ds_read_b64_tr_b16 v[56:57], v10 offset:8192
ds_read_b64_tr_b16 v[58:59], v10 offset:10240
ds_read_b64_tr_b16 v[60:61], v11 offset:8192
ds_read_b64_tr_b16 v[62:63], v11 offset:10240
s_waitcnt lgkmcnt(0)
s_add_u32 m0, s33, 8192
s_lshl_b32 s49, s48, 12
s_add_u32 s49, s49, s34
s_add_u32 s48, s48, 1
s_and_b32 s48, s48, 15
buffer_load_dwordx4 v1, s[44:47], s49 offen offset:0 sc1 lds
buffer_load_dwordx4 v1, s[44:47], s49 offen offset:1024 sc1 lds
buffer_load_dwordx4 v1, s[44:47], s49 offen offset:2048 sc1 lds
buffer_load_dwordx4 v1, s[44:47], s49 offen offset:3072 sc1 lds
s_waitcnt vmcnt(12)
ds_read_b64_tr_b16 v[192:193], v8 offset:12288
ds_read_b64_tr_b16 v[194:195], v8 offset:14336
ds_read_b64_tr_b16 v[196:197], v9 offset:12288
ds_read_b64_tr_b16 v[198:199], v9 offset:14336
ds_read_b64_tr_b16 v[200:201], v10 offset:12288
ds_read_b64_tr_b16 v[202:203], v10 offset:14336
ds_read_b64_tr_b16 v[204:205], v11 offset:12288
ds_read_b64_tr_b16 v[206:207], v11 offset:14336
s_waitcnt lgkmcnt(0)
s_add_u32 m0, s33, 12288
s_lshl_b32 s49, s48, 12
s_add_u32 s49, s49, s34
s_add_u32 s48, s48, 1
s_and_b32 s48, s48, 15
buffer_load_dwordx4 v1, s[44:47], s49 offen offset:0 sc1 lds
buffer_load_dwordx4 v1, s[44:47], s49 offen offset:1024 sc1 lds
buffer_load_dwordx4 v1, s[44:47], s49 offen offset:2048 sc1 lds
buffer_load_dwordx4 v1, s[44:47], s49 offen offset:3072 sc1 lds
s_waitcnt vmcnt(12)
ds_read_b64_tr_b16 v[208:209], v8 offset:0
ds_read_b64_tr_b16 v[210:211], v8 offset:2048
ds_read_b64_tr_b16 v[212:213], v9 offset:0
ds_read_b64_tr_b16 v[214:215], v9 offset:2048
ds_read_b64_tr_b16 v[216:217], v10 offset:0
ds_read_b64_tr_b16 v[218:219], v10 offset:2048
ds_read_b64_tr_b16 v[220:221], v11 offset:0
ds_read_b64_tr_b16 v[222:223], v11 offset:2048
s_waitcnt lgkmcnt(0)
s_add_u32 m0, s33, 0
s_lshl_b32 s49, s48, 12
s_add_u32 s49, s49, s34
s_add_u32 s48, s48, 1
s_and_b32 s48, s48, 15
buffer_load_dwordx4 v1, s[44:47], s49 offen offset:0 sc1 lds
buffer_load_dwordx4 v1, s[44:47], s49 offen offset:1024 sc1 lds
buffer_load_dwordx4 v1, s[44:47], s49 offen offset:2048 sc1 lds
buffer_load_dwordx4 v1, s[44:47], s49 offen offset:3072 sc1 lds
s_waitcnt vmcnt(12)
ds_read_b64_tr_b16 v[224:225], v8 offset:4096
ds_read_b64_tr_b16 v[226:227], v8 offset:6144
ds_read_b64_tr_b16 v[228:229], v9 offset:4096
ds_read_b64_tr_b16 v[230:231], v9 offset:6144
ds_read_b64_tr_b16 v[232:233], v10 offset:4096
ds_read_b64_tr_b16 v[234:235], v10 offset:6144
ds_read_b64_tr_b16 v[236:237], v11 offset:4096
ds_read_b64_tr_b16 v[238:239], v11 offset:6144
s_waitcnt lgkmcnt(0)
s_add_u32 m0, s33, 4096
s_lshl_b32 s49, s48, 12
s_add_u32 s49, s49, s34
s_add_u32 s48, s48, 1
s_and_b32 s48, s48, 15
buffer_load_dwordx4 v1, s[44:47], s49 offen offset:0 sc1 lds
buffer_load_dwordx4 v1, s[44:47], s49 offen offset:1024 sc1 lds
buffer_load_dwordx4 v1, s[44:47], s49 offen offset:2048 sc1 lds
buffer_load_dwordx4 v1, s[44:47], s49 offen offset:3072 sc1 lds
s_waitcnt vmcnt(12)
ds_read_b64_tr_b16 v[240:241], v8 offset:8192
ds_read_b64_tr_b16 v[242:243], v8 offset:10240
ds_read_b64_tr_b16 v[244:245], v9 offset:8192
ds_read_b64_tr_b16 v[246:247], v9 offset:10240
ds_read_b64_tr_b16 v[248:249], v10 offset:8192
ds_read_b64_tr_b16 v[250:251], v10 offset:10240
ds_read_b64_tr_b16 v[252:253], v11 offset:8192
ds_read_b64_tr_b16 v[254:255], v11 offset:10240
s_waitcnt lgkmcnt(0)
s_add_u32 m0, s33, 8192
s_lshl_b32 s49, s48, 12
s_add_u32 s49, s49, s34
s_add_u32 s48, s48, 1
s_and_b32 s48, s48, 15
buffer_load_dwordx4 v1, s[44:47], s49 offen offset:0 sc1 lds
buffer_load_dwordx4 v1, s[44:47], s49 offen offset:1024 sc1 lds
buffer_load_dwordx4 v1, s[44:47], s49 offen offset:2048 sc1 lds
buffer_load_dwordx4 v1, s[44:47], s49 offen offset:3072 sc1 lds
s_barrier
s_cmp_lg_u32 s22, 0
s_cbranch_scc1 L_kk_kernel_c1_p3go
s_mov_b32 s55, 0x40000
v_lshlrev_b32 v2, 2, v0
s_lshl_b32 s54, s30, 8
s_add_u32 s54, s54, 90177536
s_mov_b32 s56, 90178304
L_kk_kernel_c1_p3spin:
buffer_load_dword v3, v2, s[44:47], s54 offen sc1
buffer_load_dword v12, v2, s[44:47], s56 offen sc1
s_waitcnt vmcnt(0)
v_cmp_eq_u32 vcc, 1, v12
s_and_b32 s57, vcc_lo, vcc_hi
s_or_b32 s57, s57, 0x55555555
v_cmp_eq_u32 vcc, 1, v3
s_and_b32 s57, s57, vcc_lo
s_and_b32 s57, s57, vcc_hi
s_cmp_eq_u32 s57, -1
s_cbranch_scc1 L_kk_kernel_c1_p3go
s_sleep 8
s_sub_u32 s55, s55, 1
s_cmp_lg_u32 s55, 0
s_cbranch_scc1 L_kk_kernel_c1_p3spin
L_kk_kernel_c1_p3go:
s_barrier
s_lshl_b32 s50, s52, 12
s_add_u32 s50, s50, s37
s_add_u32 s52, s52, 1
s_and_b32 s52, s52, 15
buffer_load_dwordx4 v[128:131], v1, s[44:47], s50 offen offset:0 sc1
buffer_load_dwordx4 v[132:135], v1, s[44:47], s50 offen offset:1024 sc1
buffer_load_dwordx4 v[136:139], v1, s[44:47], s50 offen offset:2048 sc1
buffer_load_dwordx4 v[140:143], v1, s[44:47], s50 offen offset:3072 sc1
s_lshl_b32 s50, s52, 12
s_add_u32 s50, s50, s37
s_add_u32 s52, s52, 1
s_and_b32 s52, s52, 15
buffer_load_dwordx4 v[144:147], v1, s[44:47], s50 offen offset:0 sc1
buffer_load_dwordx4 v[148:151], v1, s[44:47], s50 offen offset:1024 sc1
buffer_load_dwordx4 v[152:155], v1, s[44:47], s50 offen offset:2048 sc1
buffer_load_dwordx4 v[156:159], v1, s[44:47], s50 offen offset:3072 sc1
s_lshl_b32 s50, s52, 12
s_add_u32 s50, s50, s37
s_add_u32 s52, s52, 1
s_and_b32 s52, s52, 15
buffer_load_dwordx4 v[160:163], v1, s[44:47], s50 offen offset:0 sc1
buffer_load_dwordx4 v[164:167], v1, s[44:47], s50 offen offset:1024 sc1
buffer_load_dwordx4 v[168:171], v1, s[44:47], s50 offen offset:2048 sc1
buffer_load_dwordx4 v[172:175], v1, s[44:47], s50 offen offset:3072 sc1
s_lshl_b32 s50, s52, 12
s_add_u32 s50, s50, s37
s_add_u32 s52, s52, 1
s_and_b32 s52, s52, 15
buffer_load_dwordx4 v[176:179], v1, s[44:47], s50 offen offset:0 sc1
buffer_load_dwordx4 v[180:183], v1, s[44:47], s50 offen offset:1024 sc1
buffer_load_dwordx4 v[184:187], v1, s[44:47], s50 offen offset:2048 sc1
buffer_load_dwordx4 v[188:191], v1, s[44:47], s50 offen offset:3072 sc1
s_waitcnt vmcnt(15)
v_mfma_f32_16x16x32_bf16 v[64:67], v[16:19], v[128:131], 0
s_waitcnt vmcnt(14)
v_mfma_f32_16x16x32_bf16 v[68:71], v[16:19], v[132:135], 0
s_waitcnt vmcnt(13)
v_mfma_f32_16x16x32_bf16 v[72:75], v[16:19], v[136:139], 0
s_waitcnt vmcnt(12)
v_mfma_f32_16x16x32_bf16 v[76:79], v[16:19], v[140:143], 0
v_mfma_f32_16x16x32_bf16 v[80:83], v[20:23], v[128:131], 0
v_mfma_f32_16x16x32_bf16 v[84:87], v[20:23], v[132:135], 0
v_mfma_f32_16x16x32_bf16 v[88:91], v[20:23], v[136:139], 0
v_mfma_f32_16x16x32_bf16 v[92:95], v[20:23], v[140:143], 0
v_mfma_f32_16x16x32_bf16 v[96:99], v[24:27], v[128:131], 0
v_mfma_f32_16x16x32_bf16 v[100:103], v[24:27], v[132:135], 0
v_mfma_f32_16x16x32_bf16 v[104:107], v[24:27], v[136:139], 0
v_mfma_f32_16x16x32_bf16 v[108:111], v[24:27], v[140:143], 0
v_mfma_f32_16x16x32_bf16 v[112:115], v[28:31], v[128:131], 0
v_mfma_f32_16x16x32_bf16 v[116:119], v[28:31], v[132:135], 0
v_mfma_f32_16x16x32_bf16 v[120:123], v[28:31], v[136:139], 0
v_mfma_f32_16x16x32_bf16 v[124:127], v[28:31], v[140:143], 0
s_lshl_b32 s50, s52, 12
s_add_u32 s50, s50, s37
s_add_u32 s52, s52, 1
s_and_b32 s52, s52, 15
buffer_load_dwordx4 v[128:131], v1, s[44:47], s50 offen offset:0 sc1
buffer_load_dwordx4 v[132:135], v1, s[44:47], s50 offen offset:1024 sc1
buffer_load_dwordx4 v[136:139], v1, s[44:47], s50 offen offset:2048 sc1
buffer_load_dwordx4 v[140:143], v1, s[44:47], s50 offen offset:3072 sc1
s_waitcnt vmcnt(15)
v_mfma_f32_16x16x32_bf16 v[64:67], v[32:35], v[144:147], v[64:67]
s_waitcnt vmcnt(14)
v_mfma_f32_16x16x32_bf16 v[68:71], v[32:35], v[148:151], v[68:71]
s_waitcnt vmcnt(13)
v_mfma_f32_16x16x32_bf16 v[72:75], v[32:35], v[152:155], v[72:75]
s_waitcnt vmcnt(12)
v_mfma_f32_16x16x32_bf16 v[76:79], v[32:35], v[156:159], v[76:79]
v_mfma_f32_16x16x32_bf16 v[80:83], v[36:39], v[144:147], v[80:83]
v_mfma_f32_16x16x32_bf16 v[84:87], v[36:39], v[148:151], v[84:87]
v_mfma_f32_16x16x32_bf16 v[88:91], v[36:39], v[152:155], v[88:91]
v_mfma_f32_16x16x32_bf16 v[92:95], v[36:39], v[156:159], v[92:95]
v_mfma_f32_16x16x32_bf16 v[96:99], v[40:43], v[144:147], v[96:99]
v_mfma_f32_16x16x32_bf16 v[100:103], v[40:43], v[148:151], v[100:103]
v_mfma_f32_16x16x32_bf16 v[104:107], v[40:43], v[152:155], v[104:107]
v_mfma_f32_16x16x32_bf16 v[108:111], v[40:43], v[156:159], v[108:111]
v_mfma_f32_16x16x32_bf16 v[112:115], v[44:47], v[144:147], v[112:115]
v_mfma_f32_16x16x32_bf16 v[116:119], v[44:47], v[148:151], v[116:119]
v_mfma_f32_16x16x32_bf16 v[120:123], v[44:47], v[152:155], v[120:123]
v_mfma_f32_16x16x32_bf16 v[124:127], v[44:47], v[156:159], v[124:127]
s_lshl_b32 s50, s52, 12
s_add_u32 s50, s50, s37
s_add_u32 s52, s52, 1
s_and_b32 s52, s52, 15
buffer_load_dwordx4 v[144:147], v1, s[44:47], s50 offen offset:0 sc1
buffer_load_dwordx4 v[148:151], v1, s[44:47], s50 offen offset:1024 sc1
buffer_load_dwordx4 v[152:155], v1, s[44:47], s50 offen offset:2048 sc1
buffer_load_dwordx4 v[156:159], v1, s[44:47], s50 offen offset:3072 sc1
s_waitcnt vmcnt(15)
v_mfma_f32_16x16x32_bf16 v[64:67], v[48:51], v[160:163], v[64:67]
s_waitcnt vmcnt(14)
v_mfma_f32_16x16x32_bf16 v[68:71], v[48:51], v[164:167], v[68:71]
s_waitcnt vmcnt(13)
v_mfma_f32_16x16x32_bf16 v[72:75], v[48:51], v[168:171], v[72:75]
s_waitcnt vmcnt(12)
v_mfma_f32_16x16x32_bf16 v[76:79], v[48:51], v[172:175], v[76:79]
v_mfma_f32_16x16x32_bf16 v[80:83], v[52:55], v[160:163], v[80:83]
v_mfma_f32_16x16x32_bf16 v[84:87], v[52:55], v[164:167], v[84:87]
v_mfma_f32_16x16x32_bf16 v[88:91], v[52:55], v[168:171], v[88:91]
v_mfma_f32_16x16x32_bf16 v[92:95], v[52:55], v[172:175], v[92:95]
v_mfma_f32_16x16x32_bf16 v[96:99], v[56:59], v[160:163], v[96:99]
v_mfma_f32_16x16x32_bf16 v[100:103], v[56:59], v[164:167], v[100:103]
v_mfma_f32_16x16x32_bf16 v[104:107], v[56:59], v[168:171], v[104:107]
v_mfma_f32_16x16x32_bf16 v[108:111], v[56:59], v[172:175], v[108:111]
v_mfma_f32_16x16x32_bf16 v[112:115], v[60:63], v[160:163], v[112:115]
v_mfma_f32_16x16x32_bf16 v[116:119], v[60:63], v[164:167], v[116:119]
v_mfma_f32_16x16x32_bf16 v[120:123], v[60:63], v[168:171], v[120:123]
v_mfma_f32_16x16x32_bf16 v[124:127], v[60:63], v[172:175], v[124:127]
s_lshl_b32 s50, s52, 12
s_add_u32 s50, s50, s37
s_add_u32 s52, s52, 1
s_and_b32 s52, s52, 15
buffer_load_dwordx4 v[160:163], v1, s[44:47], s50 offen offset:0 sc1
buffer_load_dwordx4 v[164:167], v1, s[44:47], s50 offen offset:1024 sc1
buffer_load_dwordx4 v[168:171], v1, s[44:47], s50 offen offset:2048 sc1
buffer_load_dwordx4 v[172:175], v1, s[44:47], s50 offen offset:3072 sc1
buffer_load_dwordx4 v[16:19], v1, s[44:47], s40 offen offset:0 sc1
buffer_load_dwordx4 v[20:23], v1, s[44:47], s40 offen offset:1024 sc1
buffer_load_dwordx4 v[24:27], v1, s[44:47], s40 offen offset:2048 sc1
buffer_load_dwordx4 v[28:31], v1, s[44:47], s40 offen offset:3072 sc1
buffer_load_dwordx4 v[32:35], v1, s[44:47], s41 offen offset:0 sc1
buffer_load_dwordx4 v[36:39], v1, s[44:47], s41 offen offset:1024 sc1
buffer_load_dwordx4 v[40:43], v1, s[44:47], s41 offen offset:2048 sc1
buffer_load_dwordx4 v[44:47], v1, s[44:47], s41 offen offset:3072 sc1
buffer_load_dwordx4 v[48:51], v1, s[44:47], s42 offen offset:0 sc1
buffer_load_dwordx4 v[52:55], v1, s[44:47], s42 offen offset:1024 sc1
buffer_load_dwordx4 v[56:59], v1, s[44:47], s42 offen offset:2048 sc1
buffer_load_dwordx4 v[60:63], v1, s[44:47], s42 offen offset:3072 sc1
buffer_load_dword v12, v7, s[44:47], s43 offen offset:0 sc1
buffer_load_dword v13, v7, s[44:47], s43 offen offset:64 sc1
buffer_load_dword v14, v7, s[44:47], s43 offen offset:128 sc1
buffer_load_dword v15, v7, s[44:47], s43 offen offset:192 sc1
s_waitcnt vmcnt(31)
v_mfma_f32_16x16x32_bf16 v[64:67], v[192:195], v[176:179], v[64:67]
s_waitcnt vmcnt(30)
v_mfma_f32_16x16x32_bf16 v[68:71], v[192:195], v[180:183], v[68:71]
s_waitcnt vmcnt(29)
v_mfma_f32_16x16x32_bf16 v[72:75], v[192:195], v[184:187], v[72:75]
s_waitcnt vmcnt(28)
v_mfma_f32_16x16x32_bf16 v[76:79], v[192:195], v[188:191], v[76:79]
v_mfma_f32_16x16x32_bf16 v[80:83], v[196:199], v[176:179], v[80:83]
v_mfma_f32_16x16x32_bf16 v[84:87], v[196:199], v[180:183], v[84:87]
v_mfma_f32_16x16x32_bf16 v[88:91], v[196:199], v[184:187], v[88:91]
v_mfma_f32_16x16x32_bf16 v[92:95], v[196:199], v[188:191], v[92:95]
v_mfma_f32_16x16x32_bf16 v[96:99], v[200:203], v[176:179], v[96:99]
v_mfma_f32_16x16x32_bf16 v[100:103], v[200:203], v[180:183], v[100:103]
v_mfma_f32_16x16x32_bf16 v[104:107], v[200:203], v[184:187], v[104:107]
v_mfma_f32_16x16x32_bf16 v[108:111], v[200:203], v[188:191], v[108:111]
v_mfma_f32_16x16x32_bf16 v[112:115], v[204:207], v[176:179], v[112:115]
v_mfma_f32_16x16x32_bf16 v[116:119], v[204:207], v[180:183], v[116:119]
v_mfma_f32_16x16x32_bf16 v[120:123], v[204:207], v[184:187], v[120:123]
v_mfma_f32_16x16x32_bf16 v[124:127], v[204:207], v[188:191], v[124:127]
s_lshl_b32 s50, s52, 12
s_add_u32 s50, s50, s37
s_add_u32 s52, s52, 1
s_and_b32 s52, s52, 15
buffer_load_dwordx4 v[176:179], v1, s[44:47], s50 offen offset:0 sc1
buffer_load_dwordx4 v[180:183], v1, s[44:47], s50 offen offset:1024 sc1
buffer_load_dwordx4 v[184:187], v1, s[44:47], s50 offen offset:2048 sc1
buffer_load_dwordx4 v[188:191], v1, s[44:47], s50 offen offset:3072 sc1
s_waitcnt vmcnt(31)
v_mfma_f32_16x16x32_bf16 v[64:67], v[208:211], v[128:131], v[64:67]
s_waitcnt vmcnt(30)
v_mfma_f32_16x16x32_bf16 v[68:71], v[208:211], v[132:135], v[68:71]
s_waitcnt vmcnt(29)
v_mfma_f32_16x16x32_bf16 v[72:75], v[208:211], v[136:139], v[72:75]
s_waitcnt vmcnt(28)
v_mfma_f32_16x16x32_bf16 v[76:79], v[208:211], v[140:143], v[76:79]
v_mfma_f32_16x16x32_bf16 v[80:83], v[212:215], v[128:131], v[80:83]
v_mfma_f32_16x16x32_bf16 v[84:87], v[212:215], v[132:135], v[84:87]
v_mfma_f32_16x16x32_bf16 v[88:91], v[212:215], v[136:139], v[88:91]
v_mfma_f32_16x16x32_bf16 v[92:95], v[212:215], v[140:143], v[92:95]
v_mfma_f32_16x16x32_bf16 v[96:99], v[216:219], v[128:131], v[96:99]
v_mfma_f32_16x16x32_bf16 v[100:103], v[216:219], v[132:135], v[100:103]
v_mfma_f32_16x16x32_bf16 v[104:107], v[216:219], v[136:139], v[104:107]
v_mfma_f32_16x16x32_bf16 v[108:111], v[216:219], v[140:143], v[108:111]
v_mfma_f32_16x16x32_bf16 v[112:115], v[220:223], v[128:131], v[112:115]
v_mfma_f32_16x16x32_bf16 v[116:119], v[220:223], v[132:135], v[116:119]
v_mfma_f32_16x16x32_bf16 v[120:123], v[220:223], v[136:139], v[120:123]
v_mfma_f32_16x16x32_bf16 v[124:127], v[220:223], v[140:143], v[124:127]
s_lshl_b32 s50, s52, 12
s_add_u32 s50, s50, s37
s_add_u32 s52, s52, 1
s_and_b32 s52, s52, 15
buffer_load_dwordx4 v[128:131], v1, s[44:47], s50 offen offset:0 sc1
buffer_load_dwordx4 v[132:135], v1, s[44:47], s50 offen offset:1024 sc1
buffer_load_dwordx4 v[136:139], v1, s[44:47], s50 offen offset:2048 sc1
buffer_load_dwordx4 v[140:143], v1, s[44:47], s50 offen offset:3072 sc1
s_waitcnt vmcnt(31)
v_mfma_f32_16x16x32_bf16 v[64:67], v[224:227], v[144:147], v[64:67]
s_waitcnt vmcnt(30)
v_mfma_f32_16x16x32_bf16 v[68:71], v[224:227], v[148:151], v[68:71]
s_waitcnt vmcnt(29)
v_mfma_f32_16x16x32_bf16 v[72:75], v[224:227], v[152:155], v[72:75]
s_waitcnt vmcnt(28)
v_mfma_f32_16x16x32_bf16 v[76:79], v[224:227], v[156:159], v[76:79]
v_mfma_f32_16x16x32_bf16 v[80:83], v[228:231], v[144:147], v[80:83]
v_mfma_f32_16x16x32_bf16 v[84:87], v[228:231], v[148:151], v[84:87]
v_mfma_f32_16x16x32_bf16 v[88:91], v[228:231], v[152:155], v[88:91]
v_mfma_f32_16x16x32_bf16 v[92:95], v[228:231], v[156:159], v[92:95]
v_mfma_f32_16x16x32_bf16 v[96:99], v[232:235], v[144:147], v[96:99]
v_mfma_f32_16x16x32_bf16 v[100:103], v[232:235], v[148:151], v[100:103]
v_mfma_f32_16x16x32_bf16 v[104:107], v[232:235], v[152:155], v[104:107]
v_mfma_f32_16x16x32_bf16 v[108:111], v[232:235], v[156:159], v[108:111]
v_mfma_f32_16x16x32_bf16 v[112:115], v[236:239], v[144:147], v[112:115]
v_mfma_f32_16x16x32_bf16 v[116:119], v[236:239], v[148:151], v[116:119]
v_mfma_f32_16x16x32_bf16 v[120:123], v[236:239], v[152:155], v[120:123]
v_mfma_f32_16x16x32_bf16 v[124:127], v[236:239], v[156:159], v[124:127]
s_lshl_b32 s50, s52, 12
s_add_u32 s50, s50, s37
s_add_u32 s52, s52, 1
s_and_b32 s52, s52, 15
buffer_load_dwordx4 v[144:147], v1, s[44:47], s50 offen offset:0 sc1
buffer_load_dwordx4 v[148:151], v1, s[44:47], s50 offen offset:1024 sc1
buffer_load_dwordx4 v[152:155], v1, s[44:47], s50 offen offset:2048 sc1
buffer_load_dwordx4 v[156:159], v1, s[44:47], s50 offen offset:3072 sc1
s_waitcnt vmcnt(31)
v_mfma_f32_16x16x32_bf16 v[64:67], v[240:243], v[160:163], v[64:67]
s_waitcnt vmcnt(30)
v_mfma_f32_16x16x32_bf16 v[68:71], v[240:243], v[164:167], v[68:71]
s_waitcnt vmcnt(29)
v_mfma_f32_16x16x32_bf16 v[72:75], v[240:243], v[168:171], v[72:75]
s_waitcnt vmcnt(28)
v_mfma_f32_16x16x32_bf16 v[76:79], v[240:243], v[172:175], v[76:79]
v_mfma_f32_16x16x32_bf16 v[80:83], v[244:247], v[160:163], v[80:83]
v_mfma_f32_16x16x32_bf16 v[84:87], v[244:247], v[164:167], v[84:87]
v_mfma_f32_16x16x32_bf16 v[88:91], v[244:247], v[168:171], v[88:91]
v_mfma_f32_16x16x32_bf16 v[92:95], v[244:247], v[172:175], v[92:95]
v_mfma_f32_16x16x32_bf16 v[96:99], v[248:251], v[160:163], v[96:99]
v_mfma_f32_16x16x32_bf16 v[100:103], v[248:251], v[164:167], v[100:103]
v_mfma_f32_16x16x32_bf16 v[104:107], v[248:251], v[168:171], v[104:107]
v_mfma_f32_16x16x32_bf16 v[108:111], v[248:251], v[172:175], v[108:111]
v_mfma_f32_16x16x32_bf16 v[112:115], v[252:255], v[160:163], v[112:115]
v_mfma_f32_16x16x32_bf16 v[116:119], v[252:255], v[164:167], v[116:119]
v_mfma_f32_16x16x32_bf16 v[120:123], v[252:255], v[168:171], v[120:123]
v_mfma_f32_16x16x32_bf16 v[124:127], v[252:255], v[172:175], v[124:127]
s_waitcnt vmcnt(63)
ds_read_b64_tr_b16 v[208:209], v8 offset:12288
ds_read_b64_tr_b16 v[210:211], v8 offset:14336
ds_read_b64_tr_b16 v[212:213], v9 offset:12288
ds_read_b64_tr_b16 v[214:215], v9 offset:14336
ds_read_b64_tr_b16 v[216:217], v10 offset:12288
ds_read_b64_tr_b16 v[218:219], v10 offset:14336
ds_read_b64_tr_b16 v[220:221], v11 offset:12288
ds_read_b64_tr_b16 v[222:223], v11 offset:14336
s_lshl_b32 s50, s52, 12
s_add_u32 s50, s50, s37
s_add_u32 s52, s52, 1
s_and_b32 s52, s52, 15
buffer_load_dwordx4 v[160:163], v1, s[44:47], s50 offen offset:0 sc1
buffer_load_dwordx4 v[164:167], v1, s[44:47], s50 offen offset:1024 sc1
buffer_load_dwordx4 v[168:171], v1, s[44:47], s50 offen offset:2048 sc1
buffer_load_dwordx4 v[172:175], v1, s[44:47], s50 offen offset:3072 sc1
s_waitcnt vmcnt(15) lgkmcnt(6)
v_mfma_f32_16x16x32_bf16 v[64:67], v[208:211], v[176:179], v[64:67]
s_waitcnt vmcnt(14)
v_mfma_f32_16x16x32_bf16 v[68:71], v[208:211], v[180:183], v[68:71]
s_waitcnt vmcnt(13)
v_mfma_f32_16x16x32_bf16 v[72:75], v[208:211], v[184:187], v[72:75]
s_waitcnt vmcnt(12)
v_mfma_f32_16x16x32_bf16 v[76:79], v[208:211], v[188:191], v[76:79]
s_waitcnt lgkmcnt(4)
v_mfma_f32_16x16x32_bf16 v[80:83], v[212:215], v[176:179], v[80:83]
v_mfma_f32_16x16x32_bf16 v[84:87], v[212:215], v[180:183], v[84:87]
v_mfma_f32_16x16x32_bf16 v[88:91], v[212:215], v[184:187], v[88:91]
v_mfma_f32_16x16x32_bf16 v[92:95], v[212:215], v[188:191], v[92:95]
s_waitcnt lgkmcnt(2)
v_mfma_f32_16x16x32_bf16 v[96:99], v[216:219], v[176:179], v[96:99]
v_mfma_f32_16x16x32_bf16 v[100:103], v[216:219], v[180:183], v[100:103]
v_mfma_f32_16x16x32_bf16 v[104:107], v[216:219], v[184:187], v[104:107]
v_mfma_f32_16x16x32_bf16 v[108:111], v[216:219], v[188:191], v[108:111]
s_waitcnt lgkmcnt(0)
v_mfma_f32_16x16x32_bf16 v[112:115], v[220:223], v[176:179], v[112:115]
v_mfma_f32_16x16x32_bf16 v[116:119], v[220:223], v[180:183], v[116:119]
v_mfma_f32_16x16x32_bf16 v[120:123], v[220:223], v[184:187], v[120:123]
v_mfma_f32_16x16x32_bf16 v[124:127], v[220:223], v[188:191], v[124:127]
s_waitcnt vmcnt(63)
ds_read_b64_tr_b16 v[224:225], v8 offset:0
ds_read_b64_tr_b16 v[226:227], v8 offset:2048
ds_read_b64_tr_b16 v[228:229], v9 offset:0
ds_read_b64_tr_b16 v[230:231], v9 offset:2048
ds_read_b64_tr_b16 v[232:233], v10 offset:0
ds_read_b64_tr_b16 v[234:235], v10 offset:2048
ds_read_b64_tr_b16 v[236:237], v11 offset:0
ds_read_b64_tr_b16 v[238:239], v11 offset:2048
s_add_u32 m0, s33, 12288
s_lshl_b32 s49, s48, 12
s_add_u32 s49, s49, s34
s_add_u32 s48, s48, 1
s_and_b32 s48, s48, 15
buffer_load_dwordx4 v1, s[44:47], s49 offen offset:0 sc1 lds
buffer_load_dwordx4 v1, s[44:47], s49 offen offset:1024 sc1 lds
buffer_load_dwordx4 v1, s[44:47], s49 offen offset:2048 sc1 lds
buffer_load_dwordx4 v1, s[44:47], s49 offen offset:3072 sc1 lds
s_lshl_b32 s50, s52, 12
s_add_u32 s50, s50, s37
s_add_u32 s52, s52, 1
s_and_b32 s52, s52, 15
buffer_load_dwordx4 v[176:179], v1, s[44:47], s50 offen offset:0 sc1
buffer_load_dwordx4 v[180:183], v1, s[44:47], s50 offen offset:1024 sc1
buffer_load_dwordx4 v[184:187], v1, s[44:47], s50 offen offset:2048 sc1
buffer_load_dwordx4 v[188:191], v1, s[44:47], s50 offen offset:3072 sc1
s_waitcnt vmcnt(19) lgkmcnt(6)
v_mfma_f32_16x16x32_bf16 v[64:67], v[224:227], v[128:131], v[64:67]
s_waitcnt vmcnt(18)
v_mfma_f32_16x16x32_bf16 v[68:71], v[224:227], v[132:135], v[68:71]
s_waitcnt vmcnt(17)
v_mfma_f32_16x16x32_bf16 v[72:75], v[224:227], v[136:139], v[72:75]
s_waitcnt vmcnt(16)
v_mfma_f32_16x16x32_bf16 v[76:79], v[224:227], v[140:143], v[76:79]
s_waitcnt lgkmcnt(4)
v_mfma_f32_16x16x32_bf16 v[80:83], v[228:231], v[128:131], v[80:83]
v_mfma_f32_16x16x32_bf16 v[84:87], v[228:231], v[132:135], v[84:87]
v_mfma_f32_16x16x32_bf16 v[88:91], v[228:231], v[136:139], v[88:91]
v_mfma_f32_16x16x32_bf16 v[92:95], v[228:231], v[140:143], v[92:95]
s_waitcnt lgkmcnt(2)
v_mfma_f32_16x16x32_bf16 v[96:99], v[232:235], v[128:131], v[96:99]
v_mfma_f32_16x16x32_bf16 v[100:103], v[232:235], v[132:135], v[100:103]
v_mfma_f32_16x16x32_bf16 v[104:107], v[232:235], v[136:139], v[104:107]
v_mfma_f32_16x16x32_bf16 v[108:111], v[232:235], v[140:143], v[108:111]
s_waitcnt lgkmcnt(0)
v_mfma_f32_16x16x32_bf16 v[112:115], v[236:239], v[128:131], v[112:115]
v_mfma_f32_16x16x32_bf16 v[116:119], v[236:239], v[132:135], v[116:119]
v_mfma_f32_16x16x32_bf16 v[120:123], v[236:239], v[136:139], v[120:123]
v_mfma_f32_16x16x32_bf16 v[124:127], v[236:239], v[140:143], v[124:127]
v_mfma_f32_16x16x16_bf16 v[192:195], v[48:49], v[16:17], 0
v_mfma_f32_16x16x16_bf16 v[240:243], v[50:51], v[16:17], 0
v_mfma_f32_16x16x16_bf16 v[196:199], v[48:49], v[18:19], 0
v_mfma_f32_16x16x16_bf16 v[244:247], v[50:51], v[18:19], 0
v_mfma_f32_16x16x16_bf16 v[200:203], v[48:49], v[20:21], 0
v_mfma_f32_16x16x16_bf16 v[248:251], v[50:51], v[20:21], 0
v_mfma_f32_16x16x16_bf16 v[204:207], v[48:49], v[22:23], 0
v_mfma_f32_16x16x16_bf16 v[252:255], v[50:51], v[22:23], 0
s_nop 1
v_add_f32 v240, s53, v240
s_nop 0
v_add_f32 v244, s53, v244
s_nop 0
v_add_f32 v248, s53, v248
s_nop 0
v_add_f32 v252, s53, v252
v_rcp_f32 v240, v240
v_rcp_f32 v244, v244
v_rcp_f32 v248, v248
v_rcp_f32 v252, v252
v_mul_f32 v240, v12, v240
v_mul_f32 v244, v13, v244
v_mul_f32 v248, v14, v248
v_mul_f32 v252, v15, v252
v_mul_f32 v192, v240, v192
v_mul_f32 v193, v240, v193
v_mul_f32 v194, v240, v194
v_mul_f32 v195, v240, v195
v_mul_f32 v196, v244, v196
v_mul_f32 v197, v244, v197
v_mul_f32 v198, v244, v198
v_mul_f32 v199, v244, v199
v_mul_f32 v200, v248, v200
v_mul_f32 v201, v248, v201
v_mul_f32 v202, v248, v202
v_mul_f32 v203, v248, v203
v_mul_f32 v204, v252, v204
v_mul_f32 v205, v252, v205
v_mul_f32 v206, v252, v206
v_mul_f32 v207, v252, v207
v_cvt_pk_bf16_f32 v16, v192, v193
v_cvt_pk_bf16_f32 v17, v194, v195
v_cvt_pk_bf16_f32 v18, v196, v197
v_cvt_pk_bf16_f32 v19, v198, v199
v_cvt_pk_bf16_f32 v20, v200, v201
v_cvt_pk_bf16_f32 v21, v202, v203
v_cvt_pk_bf16_f32 v22, v204, v205
v_cvt_pk_bf16_f32 v23, v206, v207
s_waitcnt vmcnt(63)
ds_read_b64_tr_b16 v[208:209], v8 offset:4096
ds_read_b64_tr_b16 v[210:211], v8 offset:6144
ds_read_b64_tr_b16 v[212:213], v9 offset:4096
ds_read_b64_tr_b16 v[214:215], v9 offset:6144
ds_read_b64_tr_b16 v[216:217], v10 offset:4096
ds_read_b64_tr_b16 v[218:219], v10 offset:6144
ds_read_b64_tr_b16 v[220:221], v11 offset:4096
ds_read_b64_tr_b16 v[222:223], v11 offset:6144
s_add_u32 m0, s33, 0
s_lshl_b32 s49, s48, 12
s_add_u32 s49, s49, s34
s_add_u32 s48, s48, 1
s_and_b32 s48, s48, 15
buffer_load_dwordx4 v1, s[44:47], s49 offen offset:0 sc1 lds
buffer_load_dwordx4 v1, s[44:47], s49 offen offset:1024 sc1 lds
buffer_load_dwordx4 v1, s[44:47], s49 offen offset:2048 sc1 lds
buffer_load_dwordx4 v1, s[44:47], s49 offen offset:3072 sc1 lds
s_lshl_b32 s50, s52, 12
s_add_u32 s50, s50, s37
s_add_u32 s52, s52, 1
s_and_b32 s52, s52, 15
buffer_load_dwordx4 v[128:131], v1, s[44:47], s50 offen offset:0 sc1
buffer_load_dwordx4 v[132:135], v1, s[44:47], s50 offen offset:1024 sc1
buffer_load_dwordx4 v[136:139], v1, s[44:47], s50 offen offset:2048 sc1
buffer_load_dwordx4 v[140:143], v1, s[44:47], s50 offen offset:3072 sc1
s_waitcnt vmcnt(23) lgkmcnt(6)
v_mfma_f32_16x16x32_bf16 v[64:67], v[208:211], v[144:147], v[64:67]
s_waitcnt vmcnt(22)
v_mfma_f32_16x16x32_bf16 v[68:71], v[208:211], v[148:151], v[68:71]
s_waitcnt vmcnt(21)
v_mfma_f32_16x16x32_bf16 v[72:75], v[208:211], v[152:155], v[72:75]
s_waitcnt vmcnt(20)
v_mfma_f32_16x16x32_bf16 v[76:79], v[208:211], v[156:159], v[76:79]
s_waitcnt lgkmcnt(4)
v_mfma_f32_16x16x32_bf16 v[80:83], v[212:215], v[144:147], v[80:83]
v_mfma_f32_16x16x32_bf16 v[84:87], v[212:215], v[148:151], v[84:87]
v_mfma_f32_16x16x32_bf16 v[88:91], v[212:215], v[152:155], v[88:91]
v_mfma_f32_16x16x32_bf16 v[92:95], v[212:215], v[156:159], v[92:95]
s_waitcnt lgkmcnt(2)
v_mfma_f32_16x16x32_bf16 v[96:99], v[216:219], v[144:147], v[96:99]
v_mfma_f32_16x16x32_bf16 v[100:103], v[216:219], v[148:151], v[100:103]
v_mfma_f32_16x16x32_bf16 v[104:107], v[216:219], v[152:155], v[104:107]
v_mfma_f32_16x16x32_bf16 v[108:111], v[216:219], v[156:159], v[108:111]
s_waitcnt lgkmcnt(0)
v_mfma_f32_16x16x32_bf16 v[112:115], v[220:223], v[144:147], v[112:115]
v_mfma_f32_16x16x32_bf16 v[116:119], v[220:223], v[148:151], v[116:119]
v_mfma_f32_16x16x32_bf16 v[120:123], v[220:223], v[152:155], v[120:123]
v_mfma_f32_16x16x32_bf16 v[124:127], v[220:223], v[156:159], v[124:127]
s_waitcnt vmcnt(63)
ds_read_b64_tr_b16 v[224:225], v8 offset:8192
ds_read_b64_tr_b16 v[226:227], v8 offset:10240
ds_read_b64_tr_b16 v[228:229], v9 offset:8192
ds_read_b64_tr_b16 v[230:231], v9 offset:10240
ds_read_b64_tr_b16 v[232:233], v10 offset:8192
ds_read_b64_tr_b16 v[234:235], v10 offset:10240
ds_read_b64_tr_b16 v[236:237], v11 offset:8192
ds_read_b64_tr_b16 v[238:239], v11 offset:10240
s_add_u32 m0, s33, 4096
s_lshl_b32 s49, s48, 12
s_add_u32 s49, s49, s34
s_add_u32 s48, s48, 1
s_and_b32 s48, s48, 15
buffer_load_dwordx4 v1, s[44:47], s49 offen offset:0 sc1 lds
buffer_load_dwordx4 v1, s[44:47], s49 offen offset:1024 sc1 lds
buffer_load_dwordx4 v1, s[44:47], s49 offen offset:2048 sc1 lds
buffer_load_dwordx4 v1, s[44:47], s49 offen offset:3072 sc1 lds
s_lshl_b32 s50, s52, 12
s_add_u32 s50, s50, s37
s_add_u32 s52, s52, 1
s_and_b32 s52, s52, 15
buffer_load_dwordx4 v[144:147], v1, s[44:47], s50 offen offset:0 sc1
buffer_load_dwordx4 v[148:151], v1, s[44:47], s50 offen offset:1024 sc1
buffer_load_dwordx4 v[152:155], v1, s[44:47], s50 offen offset:2048 sc1
buffer_load_dwordx4 v[156:159], v1, s[44:47], s50 offen offset:3072 sc1
s_waitcnt vmcnt(27) lgkmcnt(6)
v_mfma_f32_16x16x32_bf16 v[64:67], v[224:227], v[160:163], v[64:67]
s_waitcnt vmcnt(26)
v_mfma_f32_16x16x32_bf16 v[68:71], v[224:227], v[164:167], v[68:71]
s_waitcnt vmcnt(25)
v_mfma_f32_16x16x32_bf16 v[72:75], v[224:227], v[168:171], v[72:75]
s_waitcnt vmcnt(24)
v_mfma_f32_16x16x32_bf16 v[76:79], v[224:227], v[172:175], v[76:79]
s_waitcnt lgkmcnt(4)
v_mfma_f32_16x16x32_bf16 v[80:83], v[228:231], v[160:163], v[80:83]
v_mfma_f32_16x16x32_bf16 v[84:87], v[228:231], v[164:167], v[84:87]
v_mfma_f32_16x16x32_bf16 v[88:91], v[228:231], v[168:171], v[88:91]
v_mfma_f32_16x16x32_bf16 v[92:95], v[228:231], v[172:175], v[92:95]
s_waitcnt lgkmcnt(2)
v_mfma_f32_16x16x32_bf16 v[96:99], v[232:235], v[160:163], v[96:99]
v_mfma_f32_16x16x32_bf16 v[100:103], v[232:235], v[164:167], v[100:103]
v_mfma_f32_16x16x32_bf16 v[104:107], v[232:235], v[168:171], v[104:107]
v_mfma_f32_16x16x32_bf16 v[108:111], v[232:235], v[172:175], v[108:111]
s_waitcnt lgkmcnt(0)
v_mfma_f32_16x16x32_bf16 v[112:115], v[236:239], v[160:163], v[112:115]
v_mfma_f32_16x16x32_bf16 v[116:119], v[236:239], v[164:167], v[116:119]
v_mfma_f32_16x16x32_bf16 v[120:123], v[236:239], v[168:171], v[120:123]
v_mfma_f32_16x16x32_bf16 v[124:127], v[236:239], v[172:175], v[124:127]
v_mfma_f32_16x16x16_bf16 v[192:195], v[52:53], v[24:25], 0
v_mfma_f32_16x16x16_bf16 v[240:243], v[54:55], v[24:25], 0
v_mfma_f32_16x16x16_bf16 v[196:199], v[52:53], v[26:27], 0
v_mfma_f32_16x16x16_bf16 v[244:247], v[54:55], v[26:27], 0
v_mfma_f32_16x16x16_bf16 v[200:203], v[52:53], v[28:29], 0
v_mfma_f32_16x16x16_bf16 v[248:251], v[54:55], v[28:29], 0
v_mfma_f32_16x16x16_bf16 v[204:207], v[52:53], v[30:31], 0
v_mfma_f32_16x16x16_bf16 v[252:255], v[54:55], v[30:31], 0
s_nop 1
v_add_f32 v240, s53, v240
s_nop 0
v_add_f32 v244, s53, v244
s_nop 0
v_add_f32 v248, s53, v248
s_nop 0
v_add_f32 v252, s53, v252
v_rcp_f32 v240, v240
v_rcp_f32 v244, v244
v_rcp_f32 v248, v248
v_rcp_f32 v252, v252
v_mul_f32 v240, v12, v240
v_mul_f32 v244, v13, v244
v_mul_f32 v248, v14, v248
v_mul_f32 v252, v15, v252
v_mul_f32 v192, v240, v192
v_mul_f32 v193, v240, v193
v_mul_f32 v194, v240, v194
v_mul_f32 v195, v240, v195
v_mul_f32 v196, v244, v196
v_mul_f32 v197, v244, v197
v_mul_f32 v198, v244, v198
v_mul_f32 v199, v244, v199
v_mul_f32 v200, v248, v200
v_mul_f32 v201, v248, v201
v_mul_f32 v202, v248, v202
v_mul_f32 v203, v248, v203
v_mul_f32 v204, v252, v204
v_mul_f32 v205, v252, v205
v_mul_f32 v206, v252, v206
v_mul_f32 v207, v252, v207
v_mov_b32 v28, v22
v_mov_b32 v29, v23
v_mov_b32 v24, v20
v_mov_b32 v25, v21
v_mov_b32 v20, v18
v_mov_b32 v21, v19
v_cvt_pk_bf16_f32 v18, v192, v193
v_cvt_pk_bf16_f32 v19, v194, v195
v_cvt_pk_bf16_f32 v22, v196, v197
v_cvt_pk_bf16_f32 v23, v198, v199
v_cvt_pk_bf16_f32 v26, v200, v201
v_cvt_pk_bf16_f32 v27, v202, v203
v_cvt_pk_bf16_f32 v30, v204, v205
v_cvt_pk_bf16_f32 v31, v206, v207
s_waitcnt vmcnt(20)
ds_read_b64_tr_b16 v[208:209], v8 offset:12288
ds_read_b64_tr_b16 v[210:211], v8 offset:14336
ds_read_b64_tr_b16 v[212:213], v9 offset:12288
ds_read_b64_tr_b16 v[214:215], v9 offset:14336
ds_read_b64_tr_b16 v[216:217], v10 offset:12288
ds_read_b64_tr_b16 v[218:219], v10 offset:14336
ds_read_b64_tr_b16 v[220:221], v11 offset:12288
ds_read_b64_tr_b16 v[222:223], v11 offset:14336
s_add_u32 m0, s33, 8192
s_lshl_b32 s49, s48, 12
s_add_u32 s49, s49, s34
s_add_u32 s48, s48, 1
s_and_b32 s48, s48, 15
buffer_load_dwordx4 v1, s[44:47], s49 offen offset:0 sc1 lds
buffer_load_dwordx4 v1, s[44:47], s49 offen offset:1024 sc1 lds
buffer_load_dwordx4 v1, s[44:47], s49 offen offset:2048 sc1 lds
buffer_load_dwordx4 v1, s[44:47], s49 offen offset:3072 sc1 lds
s_lshl_b32 s50, s52, 12
s_add_u32 s50, s50, s37
s_add_u32 s52, s52, 1
s_and_b32 s52, s52, 15
buffer_load_dwordx4 v[160:163], v1, s[44:47], s50 offen offset:0 sc1
buffer_load_dwordx4 v[164:167], v1, s[44:47], s50 offen offset:1024 sc1
buffer_load_dwordx4 v[168:171], v1, s[44:47], s50 offen offset:2048 sc1
buffer_load_dwordx4 v[172:175], v1, s[44:47], s50 offen offset:3072 sc1
s_waitcnt vmcnt(27) lgkmcnt(6)
v_mfma_f32_16x16x32_bf16 v[64:67], v[208:211], v[176:179], v[64:67]
s_waitcnt vmcnt(26)
v_mfma_f32_16x16x32_bf16 v[68:71], v[208:211], v[180:183], v[68:71]
s_waitcnt vmcnt(25)
v_mfma_f32_16x16x32_bf16 v[72:75], v[208:211], v[184:187], v[72:75]
s_waitcnt vmcnt(24)
v_mfma_f32_16x16x32_bf16 v[76:79], v[208:211], v[188:191], v[76:79]
s_waitcnt lgkmcnt(4)
v_mfma_f32_16x16x32_bf16 v[80:83], v[212:215], v[176:179], v[80:83]
v_mfma_f32_16x16x32_bf16 v[84:87], v[212:215], v[180:183], v[84:87]
v_mfma_f32_16x16x32_bf16 v[88:91], v[212:215], v[184:187], v[88:91]
v_mfma_f32_16x16x32_bf16 v[92:95], v[212:215], v[188:191], v[92:95]
s_waitcnt lgkmcnt(2)
v_mfma_f32_16x16x32_bf16 v[96:99], v[216:219], v[176:179], v[96:99]
v_mfma_f32_16x16x32_bf16 v[100:103], v[216:219], v[180:183], v[100:103]
v_mfma_f32_16x16x32_bf16 v[104:107], v[216:219], v[184:187], v[104:107]
v_mfma_f32_16x16x32_bf16 v[108:111], v[216:219], v[188:191], v[108:111]
s_waitcnt lgkmcnt(0)
v_mfma_f32_16x16x32_bf16 v[112:115], v[220:223], v[176:179], v[112:115]
v_mfma_f32_16x16x32_bf16 v[116:119], v[220:223], v[180:183], v[116:119]
v_mfma_f32_16x16x32_bf16 v[120:123], v[220:223], v[184:187], v[120:123]
v_mfma_f32_16x16x32_bf16 v[124:127], v[220:223], v[188:191], v[124:127]
s_waitcnt vmcnt(20)
ds_read_b64_tr_b16 v[224:225], v8 offset:0
ds_read_b64_tr_b16 v[226:227], v8 offset:2048
ds_read_b64_tr_b16 v[228:229], v9 offset:0
ds_read_b64_tr_b16 v[230:231], v9 offset:2048
ds_read_b64_tr_b16 v[232:233], v10 offset:0
ds_read_b64_tr_b16 v[234:235], v10 offset:2048
ds_read_b64_tr_b16 v[236:237], v11 offset:0
ds_read_b64_tr_b16 v[238:239], v11 offset:2048
s_add_u32 m0, s33, 12288
s_lshl_b32 s49, s48, 12
s_add_u32 s49, s49, s34
s_add_u32 s48, s48, 1
s_and_b32 s48, s48, 15
buffer_load_dwordx4 v1, s[44:47], s49 offen offset:0 sc1 lds
buffer_load_dwordx4 v1, s[44:47], s49 offen offset:1024 sc1 lds
buffer_load_dwordx4 v1, s[44:47], s49 offen offset:2048 sc1 lds
buffer_load_dwordx4 v1, s[44:47], s49 offen offset:3072 sc1 lds
s_lshl_b32 s50, s52, 12
s_add_u32 s50, s50, s37
s_add_u32 s52, s52, 1
s_and_b32 s52, s52, 15
buffer_load_dwordx4 v[176:179], v1, s[44:47], s50 offen offset:0 sc1
buffer_load_dwordx4 v[180:183], v1, s[44:47], s50 offen offset:1024 sc1
buffer_load_dwordx4 v[184:187], v1, s[44:47], s50 offen offset:2048 sc1
buffer_load_dwordx4 v[188:191], v1, s[44:47], s50 offen offset:3072 sc1
s_waitcnt vmcnt(27) lgkmcnt(6)
v_mfma_f32_16x16x32_bf16 v[64:67], v[224:227], v[128:131], v[64:67]
s_waitcnt vmcnt(26)
v_mfma_f32_16x16x32_bf16 v[68:71], v[224:227], v[132:135], v[68:71]
s_waitcnt vmcnt(25)
v_mfma_f32_16x16x32_bf16 v[72:75], v[224:227], v[136:139], v[72:75]
s_waitcnt vmcnt(24)
v_mfma_f32_16x16x32_bf16 v[76:79], v[224:227], v[140:143], v[76:79]
s_waitcnt lgkmcnt(4)
v_mfma_f32_16x16x32_bf16 v[80:83], v[228:231], v[128:131], v[80:83]
v_mfma_f32_16x16x32_bf16 v[84:87], v[228:231], v[132:135], v[84:87]
v_mfma_f32_16x16x32_bf16 v[88:91], v[228:231], v[136:139], v[88:91]
v_mfma_f32_16x16x32_bf16 v[92:95], v[228:231], v[140:143], v[92:95]
s_waitcnt lgkmcnt(2)
v_mfma_f32_16x16x32_bf16 v[96:99], v[232:235], v[128:131], v[96:99]
v_mfma_f32_16x16x32_bf16 v[100:103], v[232:235], v[132:135], v[100:103]
v_mfma_f32_16x16x32_bf16 v[104:107], v[232:235], v[136:139], v[104:107]
v_mfma_f32_16x16x32_bf16 v[108:111], v[232:235], v[140:143], v[108:111]
s_waitcnt lgkmcnt(0)
v_mfma_f32_16x16x32_bf16 v[112:115], v[236:239], v[128:131], v[112:115]
v_mfma_f32_16x16x32_bf16 v[116:119], v[236:239], v[132:135], v[116:119]
v_mfma_f32_16x16x32_bf16 v[120:123], v[236:239], v[136:139], v[120:123]
v_mfma_f32_16x16x32_bf16 v[124:127], v[236:239], v[140:143], v[124:127]
v_mfma_f32_16x16x16_bf16 v[192:195], v[56:57], v[32:33], 0
v_mfma_f32_16x16x16_bf16 v[240:243], v[58:59], v[32:33], 0
v_mfma_f32_16x16x16_bf16 v[196:199], v[56:57], v[34:35], 0
v_mfma_f32_16x16x16_bf16 v[244:247], v[58:59], v[34:35], 0
v_mfma_f32_16x16x16_bf16 v[200:203], v[56:57], v[36:37], 0
v_mfma_f32_16x16x16_bf16 v[248:251], v[58:59], v[36:37], 0
v_mfma_f32_16x16x16_bf16 v[204:207], v[56:57], v[38:39], 0
v_mfma_f32_16x16x16_bf16 v[252:255], v[58:59], v[38:39], 0
s_nop 1
v_add_f32 v240, s53, v240
s_nop 0
v_add_f32 v244, s53, v244
s_nop 0
v_add_f32 v248, s53, v248
s_nop 0
v_add_f32 v252, s53, v252
v_rcp_f32 v240, v240
v_rcp_f32 v244, v244
v_rcp_f32 v248, v248
v_rcp_f32 v252, v252
v_mul_f32 v240, v12, v240
v_mul_f32 v244, v13, v244
v_mul_f32 v248, v14, v248
v_mul_f32 v252, v15, v252
v_mul_f32 v192, v240, v192
v_mul_f32 v193, v240, v193
v_mul_f32 v194, v240, v194
v_mul_f32 v195, v240, v195
v_mul_f32 v196, v244, v196
v_mul_f32 v197, v244, v197
v_mul_f32 v198, v244, v198
v_mul_f32 v199, v244, v199
v_mul_f32 v200, v248, v200
v_mul_f32 v201, v248, v201
v_mul_f32 v202, v248, v202
v_mul_f32 v203, v248, v203
v_mul_f32 v204, v252, v204
v_mul_f32 v205, v252, v205
v_mul_f32 v206, v252, v206
v_mul_f32 v207, v252, v207
v_cvt_pk_bf16_f32 v32, v192, v193
v_cvt_pk_bf16_f32 v33, v194, v195
v_cvt_pk_bf16_f32 v34, v196, v197
v_cvt_pk_bf16_f32 v35, v198, v199
v_cvt_pk_bf16_f32 v36, v200, v201
v_cvt_pk_bf16_f32 v37, v202, v203
v_cvt_pk_bf16_f32 v38, v204, v205
v_cvt_pk_bf16_f32 v39, v206, v207
s_waitcnt vmcnt(20)
ds_read_b64_tr_b16 v[208:209], v8 offset:4096
ds_read_b64_tr_b16 v[210:211], v8 offset:6144
ds_read_b64_tr_b16 v[212:213], v9 offset:4096
ds_read_b64_tr_b16 v[214:215], v9 offset:6144
ds_read_b64_tr_b16 v[216:217], v10 offset:4096
ds_read_b64_tr_b16 v[218:219], v10 offset:6144
ds_read_b64_tr_b16 v[220:221], v11 offset:4096
ds_read_b64_tr_b16 v[222:223], v11 offset:6144
s_add_u32 m0, s33, 0
s_nop 0
buffer_load_dwordx4 v1, s[44:47], s35 offen offset:0 sc1 lds
buffer_load_dwordx4 v1, s[44:47], s35 offen offset:1024 sc1 lds
buffer_load_dwordx4 v1, s[44:47], s35 offen offset:2048 sc1 lds
buffer_load_dwordx4 v1, s[44:47], s35 offen offset:3072 sc1 lds
s_add_u32 s35, s35, 4096
s_waitcnt vmcnt(23) lgkmcnt(6)
v_mfma_f32_16x16x32_bf16 v[64:67], v[208:211], v[144:147], v[64:67]
s_waitcnt vmcnt(22)
v_mfma_f32_16x16x32_bf16 v[68:71], v[208:211], v[148:151], v[68:71]
s_waitcnt vmcnt(21)
v_mfma_f32_16x16x32_bf16 v[72:75], v[208:211], v[152:155], v[72:75]
s_waitcnt vmcnt(20)
v_mfma_f32_16x16x32_bf16 v[76:79], v[208:211], v[156:159], v[76:79]
s_waitcnt lgkmcnt(4)
v_mfma_f32_16x16x32_bf16 v[80:83], v[212:215], v[144:147], v[80:83]
v_mfma_f32_16x16x32_bf16 v[84:87], v[212:215], v[148:151], v[84:87]
v_mfma_f32_16x16x32_bf16 v[88:91], v[212:215], v[152:155], v[88:91]
v_mfma_f32_16x16x32_bf16 v[92:95], v[212:215], v[156:159], v[92:95]
s_waitcnt lgkmcnt(2)
v_mfma_f32_16x16x32_bf16 v[96:99], v[216:219], v[144:147], v[96:99]
v_mfma_f32_16x16x32_bf16 v[100:103], v[216:219], v[148:151], v[100:103]
v_mfma_f32_16x16x32_bf16 v[104:107], v[216:219], v[152:155], v[104:107]
v_mfma_f32_16x16x32_bf16 v[108:111], v[216:219], v[156:159], v[108:111]
s_waitcnt lgkmcnt(0)
v_mfma_f32_16x16x32_bf16 v[112:115], v[220:223], v[144:147], v[112:115]
v_mfma_f32_16x16x32_bf16 v[116:119], v[220:223], v[148:151], v[116:119]
v_mfma_f32_16x16x32_bf16 v[120:123], v[220:223], v[152:155], v[120:123]
v_mfma_f32_16x16x32_bf16 v[124:127], v[220:223], v[156:159], v[124:127]
s_waitcnt vmcnt(16)
ds_read_b64_tr_b16 v[224:225], v8 offset:8192
ds_read_b64_tr_b16 v[226:227], v8 offset:10240
ds_read_b64_tr_b16 v[228:229], v9 offset:8192
ds_read_b64_tr_b16 v[230:231], v9 offset:10240
ds_read_b64_tr_b16 v[232:233], v10 offset:8192
ds_read_b64_tr_b16 v[234:235], v10 offset:10240
ds_read_b64_tr_b16 v[236:237], v11 offset:8192
ds_read_b64_tr_b16 v[238:239], v11 offset:10240
s_add_u32 m0, s33, 4096
s_nop 0
buffer_load_dwordx4 v1, s[44:47], s35 offen offset:0 sc1 lds
buffer_load_dwordx4 v1, s[44:47], s35 offen offset:1024 sc1 lds
buffer_load_dwordx4 v1, s[44:47], s35 offen offset:2048 sc1 lds
buffer_load_dwordx4 v1, s[44:47], s35 offen offset:3072 sc1 lds
s_add_u32 s35, s35, 4096
s_waitcnt vmcnt(19) lgkmcnt(6)
v_mfma_f32_16x16x32_bf16 v[64:67], v[224:227], v[160:163], v[64:67]
s_waitcnt vmcnt(18)
v_mfma_f32_16x16x32_bf16 v[68:71], v[224:227], v[164:167], v[68:71]
s_waitcnt vmcnt(17)
v_mfma_f32_16x16x32_bf16 v[72:75], v[224:227], v[168:171], v[72:75]
s_waitcnt vmcnt(16)
v_mfma_f32_16x16x32_bf16 v[76:79], v[224:227], v[172:175], v[76:79]
s_waitcnt lgkmcnt(4)
v_mfma_f32_16x16x32_bf16 v[80:83], v[228:231], v[160:163], v[80:83]
v_mfma_f32_16x16x32_bf16 v[84:87], v[228:231], v[164:167], v[84:87]
v_mfma_f32_16x16x32_bf16 v[88:91], v[228:231], v[168:171], v[88:91]
v_mfma_f32_16x16x32_bf16 v[92:95], v[228:231], v[172:175], v[92:95]
s_waitcnt lgkmcnt(2)
v_mfma_f32_16x16x32_bf16 v[96:99], v[232:235], v[160:163], v[96:99]
v_mfma_f32_16x16x32_bf16 v[100:103], v[232:235], v[164:167], v[100:103]
v_mfma_f32_16x16x32_bf16 v[104:107], v[232:235], v[168:171], v[104:107]
v_mfma_f32_16x16x32_bf16 v[108:111], v[232:235], v[172:175], v[108:111]
s_waitcnt lgkmcnt(0)
v_mfma_f32_16x16x32_bf16 v[112:115], v[236:239], v[160:163], v[112:115]
v_mfma_f32_16x16x32_bf16 v[116:119], v[236:239], v[164:167], v[116:119]
v_mfma_f32_16x16x32_bf16 v[120:123], v[236:239], v[168:171], v[120:123]
v_mfma_f32_16x16x32_bf16 v[124:127], v[236:239], v[172:175], v[124:127]
v_mfma_f32_16x16x16_bf16 v[192:195], v[60:61], v[40:41], 0
v_mfma_f32_16x16x16_bf16 v[240:243], v[62:63], v[40:41], 0
v_mfma_f32_16x16x16_bf16 v[196:199], v[60:61], v[42:43], 0
v_mfma_f32_16x16x16_bf16 v[244:247], v[62:63], v[42:43], 0
v_mfma_f32_16x16x16_bf16 v[200:203], v[60:61], v[44:45], 0
v_mfma_f32_16x16x16_bf16 v[248:251], v[62:63], v[44:45], 0
v_mfma_f32_16x16x16_bf16 v[204:207], v[60:61], v[46:47], 0
v_mfma_f32_16x16x16_bf16 v[252:255], v[62:63], v[46:47], 0
s_nop 1
v_add_f32 v240, s53, v240
s_nop 0
v_add_f32 v244, s53, v244
s_nop 0
v_add_f32 v248, s53, v248
s_nop 0
v_add_f32 v252, s53, v252
v_rcp_f32 v240, v240
v_rcp_f32 v244, v244
v_rcp_f32 v248, v248
v_rcp_f32 v252, v252
v_mul_f32 v240, v12, v240
v_mul_f32 v244, v13, v244
v_mul_f32 v248, v14, v248
v_mul_f32 v252, v15, v252
v_mul_f32 v192, v240, v192
v_mul_f32 v193, v240, v193
v_mul_f32 v194, v240, v194
v_mul_f32 v195, v240, v195
v_mul_f32 v196, v244, v196
v_mul_f32 v197, v244, v197
v_mul_f32 v198, v244, v198
v_mul_f32 v199, v244, v199
v_mul_f32 v200, v248, v200
v_mul_f32 v201, v248, v201
v_mul_f32 v202, v248, v202
v_mul_f32 v203, v248, v203
v_mul_f32 v204, v252, v204
v_mul_f32 v205, v252, v205
v_mul_f32 v206, v252, v206
v_mul_f32 v207, v252, v207
v_mov_b32 v44, v38
v_mov_b32 v45, v39
v_mov_b32 v40, v36
v_mov_b32 v41, v37
v_mov_b32 v36, v34
v_mov_b32 v37, v35
v_cvt_pk_bf16_f32 v34, v192, v193
v_cvt_pk_bf16_f32 v35, v194, v195
v_cvt_pk_bf16_f32 v38, v196, v197
v_cvt_pk_bf16_f32 v39, v198, v199
v_cvt_pk_bf16_f32 v42, v200, v201
v_cvt_pk_bf16_f32 v43, v202, v203
v_cvt_pk_bf16_f32 v46, v204, v205
v_cvt_pk_bf16_f32 v47, v206, v207
s_waitcnt vmcnt(12)
ds_read_b64_tr_b16 v[208:209], v8 offset:12288
ds_read_b64_tr_b16 v[210:211], v8 offset:14336
ds_read_b64_tr_b16 v[212:213], v9 offset:12288
ds_read_b64_tr_b16 v[214:215], v9 offset:14336
ds_read_b64_tr_b16 v[216:217], v10 offset:12288
ds_read_b64_tr_b16 v[218:219], v10 offset:14336
ds_read_b64_tr_b16 v[220:221], v11 offset:12288
ds_read_b64_tr_b16 v[222:223], v11 offset:14336
s_waitcnt vmcnt(11) lgkmcnt(6)
v_mfma_f32_16x16x32_bf16 v[64:67], v[208:211], v[176:179], v[64:67]
s_waitcnt vmcnt(10)
v_mfma_f32_16x16x32_bf16 v[68:71], v[208:211], v[180:183], v[68:71]
s_waitcnt vmcnt(9)
v_mfma_f32_16x16x32_bf16 v[72:75], v[208:211], v[184:187], v[72:75]
s_waitcnt vmcnt(8)
v_mfma_f32_16x16x32_bf16 v[76:79], v[208:211], v[188:191], v[76:79]
s_waitcnt lgkmcnt(4)
v_mfma_f32_16x16x32_bf16 v[80:83], v[212:215], v[176:179], v[80:83]
v_mfma_f32_16x16x32_bf16 v[84:87], v[212:215], v[180:183], v[84:87]
v_mfma_f32_16x16x32_bf16 v[88:91], v[212:215], v[184:187], v[88:91]
v_mfma_f32_16x16x32_bf16 v[92:95], v[212:215], v[188:191], v[92:95]
s_waitcnt lgkmcnt(2)
v_mfma_f32_16x16x32_bf16 v[96:99], v[216:219], v[176:179], v[96:99]
v_mfma_f32_16x16x32_bf16 v[100:103], v[216:219], v[180:183], v[100:103]
v_mfma_f32_16x16x32_bf16 v[104:107], v[216:219], v[184:187], v[104:107]
v_mfma_f32_16x16x32_bf16 v[108:111], v[216:219], v[188:191], v[108:111]
s_waitcnt lgkmcnt(0)
v_mfma_f32_16x16x32_bf16 v[112:115], v[220:223], v[176:179], v[112:115]
v_mfma_f32_16x16x32_bf16 v[116:119], v[220:223], v[180:183], v[116:119]
v_mfma_f32_16x16x32_bf16 v[120:123], v[220:223], v[184:187], v[120:123]
v_mfma_f32_16x16x32_bf16 v[124:127], v[220:223], v[188:191], v[124:127]
s_waitcnt vmcnt(4)
ds_read_b64_tr_b16 v[224:225], v8 offset:0
ds_read_b64_tr_b16 v[226:227], v8 offset:2048
ds_read_b64_tr_b16 v[228:229], v9 offset:0
ds_read_b64_tr_b16 v[230:231], v9 offset:2048
ds_read_b64_tr_b16 v[232:233], v10 offset:0
ds_read_b64_tr_b16 v[234:235], v10 offset:2048
ds_read_b64_tr_b16 v[236:237], v11 offset:0
ds_read_b64_tr_b16 v[238:239], v11 offset:2048
v_sub_f32 v192, 1.0, v12
v_sub_f32 v194, 1.0, v13
v_sub_f32 v196, 1.0, v14
v_sub_f32 v198, 1.0, v15
v_pk_mul_f32 v[64:65], v[64:65], v[192:193] op_sel_hi:[1,0]
v_pk_mul_f32 v[66:67], v[66:67], v[192:193] op_sel_hi:[1,0]
v_pk_mul_f32 v[68:69], v[68:69], v[194:195] op_sel_hi:[1,0]
v_pk_mul_f32 v[70:71], v[70:71], v[194:195] op_sel_hi:[1,0]
v_pk_mul_f32 v[72:73], v[72:73], v[196:197] op_sel_hi:[1,0]
v_pk_mul_f32 v[74:75], v[74:75], v[196:197] op_sel_hi:[1,0]
v_pk_mul_f32 v[76:77], v[76:77], v[198:199] op_sel_hi:[1,0]
v_pk_mul_f32 v[78:79], v[78:79], v[198:199] op_sel_hi:[1,0]
v_pk_mul_f32 v[80:81], v[80:81], v[192:193] op_sel_hi:[1,0]
v_pk_mul_f32 v[82:83], v[82:83], v[192:193] op_sel_hi:[1,0]
v_pk_mul_f32 v[84:85], v[84:85], v[194:195] op_sel_hi:[1,0]
v_pk_mul_f32 v[86:87], v[86:87], v[194:195] op_sel_hi:[1,0]
v_pk_mul_f32 v[88:89], v[88:89], v[196:197] op_sel_hi:[1,0]
v_pk_mul_f32 v[90:91], v[90:91], v[196:197] op_sel_hi:[1,0]
v_pk_mul_f32 v[92:93], v[92:93], v[198:199] op_sel_hi:[1,0]
v_pk_mul_f32 v[94:95], v[94:95], v[198:199] op_sel_hi:[1,0]
v_pk_mul_f32 v[96:97], v[96:97], v[192:193] op_sel_hi:[1,0]
v_pk_mul_f32 v[98:99], v[98:99], v[192:193] op_sel_hi:[1,0]
v_pk_mul_f32 v[100:101], v[100:101], v[194:195] op_sel_hi:[1,0]
v_pk_mul_f32 v[102:103], v[102:103], v[194:195] op_sel_hi:[1,0]
v_pk_mul_f32 v[104:105], v[104:105], v[196:197] op_sel_hi:[1,0]
v_pk_mul_f32 v[106:107], v[106:107], v[196:197] op_sel_hi:[1,0]
v_pk_mul_f32 v[108:109], v[108:109], v[198:199] op_sel_hi:[1,0]
v_pk_mul_f32 v[110:111], v[110:111], v[198:199] op_sel_hi:[1,0]
v_pk_mul_f32 v[112:113], v[112:113], v[192:193] op_sel_hi:[1,0]
v_pk_mul_f32 v[114:115], v[114:115], v[192:193] op_sel_hi:[1,0]
v_pk_mul_f32 v[116:117], v[116:117], v[194:195] op_sel_hi:[1,0]
v_pk_mul_f32 v[118:119], v[118:119], v[194:195] op_sel_hi:[1,0]
v_pk_mul_f32 v[120:121], v[120:121], v[196:197] op_sel_hi:[1,0]
v_pk_mul_f32 v[122:123], v[122:123], v[196:197] op_sel_hi:[1,0]
v_pk_mul_f32 v[124:125], v[124:125], v[198:199] op_sel_hi:[1,0]
v_pk_mul_f32 v[126:127], v[126:127], v[198:199] op_sel_hi:[1,0]
s_waitcnt lgkmcnt(6)
v_mfma_f32_16x16x32_bf16 v[64:67], v[224:227], v[16:19], v[64:67]
v_mfma_f32_16x16x32_bf16 v[68:71], v[224:227], v[20:23], v[68:71]
v_mfma_f32_16x16x32_bf16 v[72:75], v[224:227], v[24:27], v[72:75]
v_mfma_f32_16x16x32_bf16 v[76:79], v[224:227], v[28:31], v[76:79]
s_waitcnt lgkmcnt(4)
v_mfma_f32_16x16x32_bf16 v[80:83], v[228:231], v[16:19], v[80:83]
v_mfma_f32_16x16x32_bf16 v[84:87], v[228:231], v[20:23], v[84:87]
v_mfma_f32_16x16x32_bf16 v[88:91], v[228:231], v[24:27], v[88:91]
v_mfma_f32_16x16x32_bf16 v[92:95], v[228:231], v[28:31], v[92:95]
s_waitcnt lgkmcnt(2)
v_mfma_f32_16x16x32_bf16 v[96:99], v[232:235], v[16:19], v[96:99]
v_mfma_f32_16x16x32_bf16 v[100:103], v[232:235], v[20:23], v[100:103]
v_mfma_f32_16x16x32_bf16 v[104:107], v[232:235], v[24:27], v[104:107]
v_mfma_f32_16x16x32_bf16 v[108:111], v[232:235], v[28:31], v[108:111]
s_waitcnt lgkmcnt(0)
v_mfma_f32_16x16x32_bf16 v[112:115], v[236:239], v[16:19], v[112:115]
v_mfma_f32_16x16x32_bf16 v[116:119], v[236:239], v[20:23], v[116:119]
v_mfma_f32_16x16x32_bf16 v[120:123], v[236:239], v[24:27], v[120:123]
v_mfma_f32_16x16x32_bf16 v[124:127], v[236:239], v[28:31], v[124:127]
s_waitcnt vmcnt(0)
ds_read_b64_tr_b16 v[208:209], v8 offset:4096
ds_read_b64_tr_b16 v[210:211], v8 offset:6144
ds_read_b64_tr_b16 v[212:213], v9 offset:4096
ds_read_b64_tr_b16 v[214:215], v9 offset:6144
ds_read_b64_tr_b16 v[216:217], v10 offset:4096
ds_read_b64_tr_b16 v[218:219], v10 offset:6144
ds_read_b64_tr_b16 v[220:221], v11 offset:4096
ds_read_b64_tr_b16 v[222:223], v11 offset:6144
s_waitcnt lgkmcnt(6)
v_mfma_f32_16x16x32_bf16 v[64:67], v[208:211], v[32:35], v[64:67]
v_mfma_f32_16x16x32_bf16 v[68:71], v[208:211], v[36:39], v[68:71]
v_mfma_f32_16x16x32_bf16 v[72:75], v[208:211], v[40:43], v[72:75]
v_mfma_f32_16x16x32_bf16 v[76:79], v[208:211], v[44:47], v[76:79]
s_waitcnt lgkmcnt(4)
v_mfma_f32_16x16x32_bf16 v[80:83], v[212:215], v[32:35], v[80:83]
v_mfma_f32_16x16x32_bf16 v[84:87], v[212:215], v[36:39], v[84:87]
v_mfma_f32_16x16x32_bf16 v[88:91], v[212:215], v[40:43], v[88:91]
v_mfma_f32_16x16x32_bf16 v[92:95], v[212:215], v[44:47], v[92:95]
s_waitcnt lgkmcnt(2)
v_mfma_f32_16x16x32_bf16 v[96:99], v[216:219], v[32:35], v[96:99]
v_mfma_f32_16x16x32_bf16 v[100:103], v[216:219], v[36:39], v[100:103]
v_mfma_f32_16x16x32_bf16 v[104:107], v[216:219], v[40:43], v[104:107]
v_mfma_f32_16x16x32_bf16 v[108:111], v[216:219], v[44:47], v[108:111]
s_waitcnt lgkmcnt(0)
v_mfma_f32_16x16x32_bf16 v[112:115], v[220:223], v[32:35], v[112:115]
v_mfma_f32_16x16x32_bf16 v[116:119], v[220:223], v[36:39], v[116:119]
v_mfma_f32_16x16x32_bf16 v[120:123], v[220:223], v[40:43], v[120:123]
v_mfma_f32_16x16x32_bf16 v[124:127], v[220:223], v[44:47], v[124:127]
v_add_u32 v12, s33, v1
ds_write_b128 v12, v[64:67] offset:0
ds_write_b128 v12, v[68:71] offset:1024
ds_write_b128 v12, v[72:75] offset:2048
ds_write_b128 v12, v[76:79] offset:3072
ds_write_b128 v12, v[80:83] offset:4096
ds_write_b128 v12, v[84:87] offset:5120
ds_write_b128 v12, v[88:91] offset:6144
ds_write_b128 v12, v[92:95] offset:7168
ds_write_b128 v12, v[96:99] offset:8192
ds_write_b128 v12, v[100:103] offset:9216
ds_write_b128 v12, v[104:107] offset:10240
ds_write_b128 v12, v[108:111] offset:11264
ds_write_b128 v12, v[112:115] offset:12288
ds_write_b128 v12, v[116:119] offset:13312
ds_write_b128 v12, v[120:123] offset:14336
ds_write_b128 v12, v[124:127] offset:15360
s_lshr_b32 s41, s3, 1
s_and_b32 s42, s3, 1
v_lshrrev_b32 v13, 5, v0
v_lshlrev_b32 v13, 12, v13
v_and_b32 v14, 15, v0
v_lshlrev_b32 v14, 4, v14
v_and_b32 v15, 16, v0
v_lshlrev_b32 v15, 5, v15
v_add3_u32 v13, v13, v14, v15
s_lshl_b32 s43, s42, 13
s_lshl_b32 s40, s41, 10
s_add_u32 s43, s43, s40
v_add_u32 v13, s43, v13
v_add_u32 v24, s28, v13
s_add_u32 s28, s28, 32768
s_cmp_eq_u32 s28, 163840
s_cselect_b32 s28, 0, s28
v_add_u32 v25, s28, v13
s_add_u32 s28, s28, 32768
s_cmp_eq_u32 s28, 163840
s_cselect_b32 s28, 0, s28
v_add_u32 v26, s28, v13
s_add_u32 s28, s28, 32768
s_cmp_eq_u32 s28, 163840
s_cselect_b32 s28, 0, s28
v_add_u32 v27, s28, v13
v_and_b32 v20, 15, v0
v_lshlrev_b32 v20, 10, v20
v_lshrrev_b32 v21, 4, v0
v_lshlrev_b32 v21, 4, v21
v_add_u32 v20, v20, v21
s_lshl_b32 s43, s30, 16
s_lshl_b32 s40, s41, 14
s_add_u32 s43, s43, s40
s_lshl_b32 s40, s31, 7
s_add_u32 s43, s43, s40
s_lshl_b32 s40, s42, 6
s_add_u32 s43, s43, s40
s_waitcnt lgkmcnt(0)
s_barrier
ds_read_b128 v[128:131], v24 offset:0
ds_read_b128 v[132:135], v24 offset:256
ds_read_b128 v[136:139], v24 offset:16384
ds_read_b128 v[140:143], v24 offset:16640
ds_read_b128 v[144:147], v25 offset:0
ds_read_b128 v[148:151], v25 offset:256
ds_read_b128 v[152:155], v25 offset:16384
ds_read_b128 v[156:159], v25 offset:16640
ds_read_b128 v[160:163], v26 offset:0
ds_read_b128 v[164:167], v26 offset:256
ds_read_b128 v[168:171], v26 offset:16384
ds_read_b128 v[172:175], v26 offset:16640
ds_read_b128 v[176:179], v27 offset:0
ds_read_b128 v[180:183], v27 offset:256
ds_read_b128 v[184:187], v27 offset:16384
ds_read_b128 v[188:191], v27 offset:16640
s_waitcnt lgkmcnt(13)
v_add_f32 v128, v128, v136
v_add_f32 v129, v129, v137
v_add_f32 v130, v130, v138
v_add_f32 v131, v131, v139
s_waitcnt lgkmcnt(12)
v_add_f32 v132, v132, v140
v_add_f32 v133, v133, v141
v_add_f32 v134, v134, v142
v_add_f32 v135, v135, v143
s_waitcnt lgkmcnt(11)
v_add_f32 v128, v128, v144
v_add_f32 v129, v129, v145
v_add_f32 v130, v130, v146
v_add_f32 v131, v131, v147
s_waitcnt lgkmcnt(10)
v_add_f32 v132, v132, v148
v_add_f32 v133, v133, v149
v_add_f32 v134, v134, v150
v_add_f32 v135, v135, v151
s_waitcnt lgkmcnt(9)
v_add_f32 v128, v128, v152
v_add_f32 v129, v129, v153
v_add_f32 v130, v130, v154
v_add_f32 v131, v131, v155
s_waitcnt lgkmcnt(8)
v_add_f32 v132, v132, v156
v_add_f32 v133, v133, v157
v_add_f32 v134, v134, v158
v_add_f32 v135, v135, v159
s_waitcnt lgkmcnt(7)
v_add_f32 v128, v128, v160
v_add_f32 v129, v129, v161
v_add_f32 v130, v130, v162
v_add_f32 v131, v131, v163
s_waitcnt lgkmcnt(6)
v_add_f32 v132, v132, v164
v_add_f32 v133, v133, v165
v_add_f32 v134, v134, v166
v_add_f32 v135, v135, v167
s_waitcnt lgkmcnt(5)
v_add_f32 v128, v128, v168
v_add_f32 v129, v129, v169
v_add_f32 v130, v130, v170
v_add_f32 v131, v131, v171
s_waitcnt lgkmcnt(4)
v_add_f32 v132, v132, v172
v_add_f32 v133, v133, v173
v_add_f32 v134, v134, v174
v_add_f32 v135, v135, v175
s_waitcnt lgkmcnt(3)
v_add_f32 v128, v128, v176
v_add_f32 v129, v129, v177
v_add_f32 v130, v130, v178
v_add_f32 v131, v131, v179
s_waitcnt lgkmcnt(2)
v_add_f32 v132, v132, v180
v_add_f32 v133, v133, v181
v_add_f32 v134, v134, v182
v_add_f32 v135, v135, v183
s_waitcnt lgkmcnt(1)
v_add_f32 v128, v128, v184
v_add_f32 v129, v129, v185
v_add_f32 v130, v130, v186
v_add_f32 v131, v131, v187
s_waitcnt lgkmcnt(0)
v_add_f32 v132, v132, v188
v_add_f32 v133, v133, v189
v_add_f32 v134, v134, v190
v_add_f32 v135, v135, v191
v_cvt_pk_bf16_f32 v16, v128, v129
v_cvt_pk_bf16_f32 v17, v130, v131
v_cvt_pk_bf16_f32 v18, v132, v133
v_cvt_pk_bf16_f32 v19, v134, v135
buffer_store_dwordx4 v[16:19], v20, s[4:7], s43 offen
s_endpgm
L_kk_kernel_end:
s_endpgm
.section .rodata,"a"
.p2align 6
.amdhsa_kernel gated_mix__linear_attn_block__compressed_kv_cla__prompt_kernel
  .amdhsa_next_free_vgpr 256
  .amdhsa_next_free_sgpr 102
  .amdhsa_accum_offset 256
  .amdhsa_group_segment_fixed_size 0
  .amdhsa_kernarg_size 104
  .amdhsa_user_sgpr_count 2
  .amdhsa_user_sgpr_kernarg_segment_ptr 1
  .amdhsa_system_sgpr_workgroup_id_x 1
.end_amdhsa_kernel
.text
L_code_end:
```
